```python
import torch

def _softmax(x, axis=-1):
    return torch.softmax(x, dim=axis)

def _gelu(x):
    return torch.nn.functional.gelu(x, approximate='tanh')

def _silu(x):
    return torch.nn.functional.silu(x)

def _sigmoid(x):
    return torch.sigmoid(x)

def _layernorm(x, axis=-1, eps=1e-05):
    m = x.mean(dim=axis, keepdim=True)
    v = x.var(dim=axis, keepdim=True, unbiased=False)
    return (x - m) / torch.sqrt(v + eps)

def _scatter_add(tgt, idx, src, axis=0):
    return tgt.clone().index_add_(axis, idx, src)

def _segment_sum(src, seg, n):
    out = torch.zeros((n,) + src.shape[1:], dtype=src.dtype)
    return out.index_add_(0, seg, src)

def _pad(x, pw):
    flat = tuple((v for pair in reversed(pw) for v in pair))
    return torch.nn.functional.pad(x, flat)
kernel_name = 'interleave_layers__memory_aug_recurrent_mem_tr__dense_activation_gelu__prompt'

def setup_inputs():

    _w = lambda a: (lambda t: t.to(torch.bfloat16) if t.is_floating_point() else t)(torch.as_tensor(a))

    def _A_setup():
        B, S, Dm = (1, 2048, 512)
        H, Dh = (32, 128)
        M, seg = (8, 32)
        seg = min(seg, S)
        S = S // seg * seg
        return {'x': _w((lambda *s: torch.randn(*s, dtype=torch.bfloat16) * 0.05)(B, S, Dm)), 'mem0': _w((lambda *s: torch.randn(*s, dtype=torch.bfloat16) * 0.2)(B, M, Dm)), 'Wq': _w((lambda *s: torch.randn(*s, dtype=torch.bfloat16) * 1.6)(Dm, H, Dh) * Dm ** (-0.5)), 'Wk': _w((lambda *s: torch.randn(*s, dtype=torch.bfloat16) * 1.6)(Dm, H, Dh) * Dm ** (-0.5)), 'Wv': _w((lambda *s: torch.randn(*s, dtype=torch.bfloat16) * 0.2)(Dm, H, Dh) * Dm ** (-0.5)), 'Wo': _w((lambda *s: torch.randn(*s, dtype=torch.bfloat16) * 0.2)(H, Dh, Dm) * (H * Dh) ** (-0.5)), 'seg_len': seg}
    _A_in = _A_setup()

    def _B_setup():
        B, S, D, F = (1, 2048, 512, 1376)
        return {'x': _w((lambda *s: torch.randn(*s, dtype=torch.bfloat16) * 0.05)(B, S, D)), 'w1': _w((lambda *s: torch.randn(*s, dtype=torch.bfloat16) * 0.4)(D, F) * D ** (-0.5)), 'b1': _w((lambda *s: torch.randn(*s, dtype=torch.bfloat16) * 12.8)(F) * 0.01), 'w2': _w((lambda *s: torch.randn(*s, dtype=torch.bfloat16) * 0.1)(F, D) * F ** (-0.5)), 'b2': _w((lambda *s: torch.randn(*s, dtype=torch.bfloat16) * 0.8)(D) * 0.01)}
    _B_in = _B_setup()
    return {'A_x': _A_in['x'], 'A_mem0': _A_in['mem0'], 'A_Wq': _A_in['Wq'], 'A_Wk': _A_in['Wk'], 'A_Wv': _A_in['Wv'], 'A_Wo': _A_in['Wo'], 'A_seg_len': _A_in['seg_len'], 'B_x': _B_in['x'], 'B_w1': _B_in['w1'], 'B_b1': _B_in['b1'], 'B_w2': _B_in['w2'], 'B_b2': _B_in['b2']}

def reference(A_x, A_mem0, A_Wq, A_Wk, A_Wv, A_Wo, A_seg_len, B_x, B_w1, B_b1, B_w2, B_b2):

    def _A_ref(x, mem0, Wq, Wk, Wv, Wo, seg_len):
        B, S, Dm = x.shape
        H, Dh = (Wq.shape[1], Wq.shape[2])
        M = mem0.shape[1]
        scale = Dh ** (-0.5)
        n_seg = S // seg_len
        L = M + seg_len
        idx = torch.arange(L)
        mask = (idx[:, None] < M) | (idx[:, None] >= idx[None, :])
        mem = mem0
        outs = []
        for s in range(n_seg):
            xs = x[:, s * seg_len:(s + 1) * seg_len, :].clone()
            h = torch.concatenate([mem, xs], axis=1)
            q = torch.einsum('btd,dhe->bhte', h, Wq)
            k = torch.einsum('btd,dhe->bhte', h, Wk)
            v = torch.einsum('btd,dhe->bhte', h, Wv)
            scores = torch.einsum('bhqe,bhke->bhqk', q, k) * scale
            scores = torch.where(mask[None, None], scores, -1000000000.0)
            p = _softmax(scores, axis=-1)
            o = torch.einsum('bhqk,bhke->bhqe', p, v)
            o = torch.einsum('bhte,hed->btd', o, Wo)
            mem = o[:, :M, :].clone()
            outs.append(o[:, M:, :])
        return torch.concatenate(outs, axis=1)

    def _B_ref(x, w1, b1, w2, b2):
        h = torch.einsum('bsd,df->bsf', x, w1) + b1
        h = _gelu(h)
        return torch.einsum('bsf,fd->bsd', h, w2) + b2
    x = A_x
    x = x + _A_ref(_layernorm(x, axis=-1), A_mem0, A_Wq, A_Wk, A_Wv, A_Wo, A_seg_len)
    x = x + _B_ref(_layernorm(x, axis=-1), B_w1, B_b1, B_w2, B_b2)
    x = x + _A_ref(_layernorm(x, axis=-1), A_mem0, A_Wq, A_Wk, A_Wv, A_Wo, A_seg_len)
    x = x + _B_ref(_layernorm(x, axis=-1), B_w1, B_b1, B_w2, B_b2)
    return x
```

```asm
; @launch kernel=interleave_layers__memory_aug_recurrent_mem_tr__dense_activation_gelu__prompt_kernel grid=(256,1,1) block=(256,1,1) lds=163840
.amdgcn_target "amdgcn-amd-amdhsa--gfx950"
.text
.globl interleave_layers__memory_aug_recurrent_mem_tr__dense_activation_gelu__prompt_kernel
.p2align 8
.type interleave_layers__memory_aug_recurrent_mem_tr__dense_activation_gelu__prompt_kernel,@function
interleave_layers__memory_aug_recurrent_mem_tr__dense_activation_gelu__prompt_kernel:
s_load_dwordx16 s[16:31], s[0:1], 0
s_load_dwordx8 s[32:39], s[0:1], 64
s_load_dwordx4 s[40:43], s[0:1], 96
s_load_dwordx2 s[62:63], s[0:1], 112
s_memtime s[60:61]
s_getreg_b32 s64, hwreg(HW_REG_XCC_ID)
v_lshrrev_b32 v1, 6, v0
v_and_b32 v0, 63, v0
s_waitcnt lgkmcnt(0)
s_mov_b32 s46, s60
v_readfirstlane_b32 s47, v1
s_and_b32 s64, s64, 7
s_mov_b32 s4, s62
s_mov_b32 s5, s63
s_mov_b32 s6, 268435456
s_mov_b32 s7, 0x00020000
s_mov_b32 s8, s42
s_mov_b32 s9, s43
s_mov_b32 s10, 256
s_mov_b32 s11, 0x00020000
s_mov_b32 s44, 0x05040100
s_mov_b32 s45, 0x07060302
s_cmp_lg_u32 s47, 0
s_cbranch_scc1 L_gotslot
s_mov_b64 exec, 1
s_lshl_b32 s66, s64, 2
v_mov_b32 v1, 1
v_mov_b32 v2, s66
buffer_atomic_add v1, v2, s[8:11], 0 offen sc0 sc1
s_waitcnt vmcnt(0)
v_readfirstlane_b32 s65, v1
s_lshl_b32 s66, s64, 5
s_add_u32 s56, s66, s65
s_cmp_lt_u32 s65, 32
s_cbranch_scc1 L_pubslot
s_mov_b32 s66, 0
L_ovf:
s_lshl_b32 s65, s66, 2
v_mov_b32 v2, s65
buffer_load_dword v1, v2, s[8:11], 0 offen sc1
s_waitcnt vmcnt(0)
v_readfirstlane_b32 s65, v1
s_cmp_ge_u32 s65, 32
s_cbranch_scc1 L_ovf_next
v_mov_b32 v1, 1
buffer_atomic_add v1, v2, s[8:11], 0 offen sc0 sc1
s_waitcnt vmcnt(0)
v_readfirstlane_b32 s65, v1
s_lshl_b32 s56, s66, 5
s_add_u32 s56, s56, s65
s_cmp_lt_u32 s65, 32
s_cbranch_scc1 L_pubslot
s_nop 0
L_ovf_next:
s_add_u32 s66, s66, 1
s_cmp_lt_u32 s66, 8
s_cbranch_scc1 L_ovf
s_mov_b32 s56, -1
L_pubslot:
v_mov_b32 v1, s56
v_mov_b32 v2, 163824
ds_write_b32 v2, v1
s_waitcnt lgkmcnt(0)
s_mov_b64 exec, -1
L_gotslot:
s_barrier
v_mov_b32 v2, 163824
ds_read_b32 v1, v2
s_waitcnt lgkmcnt(0)
v_readfirstlane_b32 s56, v1
s_cmp_lt_i32 s56, 0
s_cbranch_scc1 L_exit
s_lshl_b32 s60, s56, 10
s_lshl_b32 s61, s47, 8
s_add_u32 s60, s60, s61
v_lshlrev_b32 v2, 2, v0
v_mov_b32 v1, 0
buffer_store_dword v1, v2, s[4:7], s60 offen sc1
s_mov_b32 s48, s16
s_mov_b32 s49, s17
s_mov_b32 s50, 2097152
s_mov_b32 s51, 0x00020000
s_mov_b32 s67, s56
s_cmp_lt_u32 s67, 32
s_cbranch_scc1 L_noprep
L_prep:
v_and_b32 v3, 15, v0
v_lshrrev_b32 v4, 4, v0
v_lshlrev_b32 v3, 10, v3
v_lshl_add_u32 v3, v4, 6, v3
v_add_u32 v4, 0x4000, v3
s_lshr_b32 s60, s67, 2
s_lshl_b32 s60, s60, 15
s_and_b32 s61, s67, 3
s_lshl_b32 s65, s61, 8
s_lshl_b32 s66, s47, 4
s_add_u32 s65, s65, s66
s_add_u32 s65, s65, s60
buffer_load_dwordx4 v[8:11], v3, s[48:51], s65 offen
buffer_load_dwordx4 v[12:15], v4, s[48:51], s65 offen
s_lshl_b32 s61, s61, 13
s_lshl_b32 s66, s47, 11
s_add_u32 s60, s60, s61
s_add_u32 s60, s60, s66
s_add_u32 s60, s60, 10485760
v_lshlrev_b32 v2, 4, v0
s_waitcnt vmcnt(0)
buffer_store_dwordx4 v[8:11], v2, s[4:7], s60 offen sc1
buffer_store_dwordx4 v[12:15], v2, s[4:7], s60 offen offset:1024 sc1
v_lshlrev_b32 v16, 16, v8
v_and_b32 v17, 0xffff0000, v8
v_lshlrev_b32 v18, 16, v9
v_and_b32 v19, 0xffff0000, v9
v_lshlrev_b32 v20, 16, v10
v_and_b32 v21, 0xffff0000, v10
v_lshlrev_b32 v22, 16, v11
v_and_b32 v23, 0xffff0000, v11
v_lshlrev_b32 v24, 16, v12
v_and_b32 v25, 0xffff0000, v12
v_lshlrev_b32 v26, 16, v13
v_and_b32 v27, 0xffff0000, v13
v_lshlrev_b32 v28, 16, v14
v_and_b32 v29, 0xffff0000, v14
v_lshlrev_b32 v30, 16, v15
v_and_b32 v31, 0xffff0000, v15
v_pk_add_f32 v[32:33], v[16:17], v[18:19]
v_pk_mul_f32 v[36:37], v[16:17], v[16:17]
v_pk_add_f32 v[32:33], v[32:33], v[20:21]
v_pk_fma_f32 v[36:37], v[18:19], v[18:19], v[36:37]
v_pk_add_f32 v[32:33], v[32:33], v[22:23]
v_pk_fma_f32 v[36:37], v[20:21], v[20:21], v[36:37]
v_pk_fma_f32 v[36:37], v[22:23], v[22:23], v[36:37]
v_pk_add_f32 v[34:35], v[24:25], v[26:27]
v_pk_mul_f32 v[38:39], v[24:25], v[24:25]
v_pk_add_f32 v[34:35], v[34:35], v[28:29]
v_pk_fma_f32 v[38:39], v[26:27], v[26:27], v[38:39]
v_pk_add_f32 v[34:35], v[34:35], v[30:31]
v_pk_fma_f32 v[38:39], v[28:29], v[28:29], v[38:39]
v_pk_fma_f32 v[38:39], v[30:31], v[30:31], v[38:39]
v_add_f32 v32, v32, v33
v_add_f32 v34, v34, v35
v_add_f32 v36, v36, v37
v_add_f32 v38, v38, v39
v_permlane16_swap_b32 v32, v34
v_add_f32 v32, v32, v34
v_permlane16_swap_b32 v36, v38
v_add_f32 v36, v36, v38
s_nop 1
v_permlane32_swap_b32 v32, v36
v_add_f32 v32, v32, v36
s_lshl_b32 s60, s67, 10
s_lshl_b32 s61, s47, 2
s_add_u32 s60, s60, s61
s_add_u32 s60, s60, 12582912
buffer_store_dword v32, v2, s[4:7], s60 offen sc1
s_sub_u32 s67, s67, 32
s_cmp_lt_u32 s67, 32
s_cbranch_scc1 L_prep
L_noprep:
s_lshr_b32 s60, s56, 5
s_and_b32 s61, s56, 31
s_cmp_lt_u32 s60, 2
s_cbranch_scc1 L_dispC
s_cmp_lt_u32 s60, 6
s_cbranch_scc1 L_dispH
s_sub_u32 s57, s60, 6
s_mov_b32 s58, s61
s_and_b32 s59, s61, 1
s_cmp_lt_u32 s61, 16
s_cbranch_scc1 L_dispO
s_cmp_lt_u32 s61, 24
s_cbranch_scc1 L_dispF
s_cmp_eq_u32 s57, 0
s_cbranch_scc1 L_G0
s_branch L_G1
L_dispF:
s_cmp_eq_u32 s57, 0
s_cbranch_scc1 L_F0
s_branch L_F1
L_dispO:
s_cmp_eq_u32 s57, 0
s_cbranch_scc1 L_O0
s_branch L_O1
L_dispC:
s_mov_b32 s57, s60
s_mov_b32 s58, s61
s_cmp_eq_u32 s60, 0
s_cbranch_scc1 L_C0
s_branch L_C1
L_dispH:
s_sub_u32 s60, s60, 2
s_lshl_b32 s60, s60, 3
s_bfe_u32 s58, s61, 0x30001
s_add_u32 s58, s58, s60
s_and_b32 s59, s61, 1
s_lshr_b32 s57, s61, 4
s_cmp_eq_u32 s57, 0
s_cbranch_scc1 L_H0
s_branch L_H1
L_abort:
s_mov_b64 exec, 1
s_lshl_b32 s60, s56, 8
s_or_b32 s60, s60, s61
s_lshl_b32 s61, s47, 16
s_or_b32 s60, s60, s61
s_or_b32 s60, s60, 0x40000000
v_mov_b32 v1, s60
v_mov_b32 v2, 160
buffer_store_dword v1, v2, s[8:11], 0 offen sc1
s_waitcnt vmcnt(0)
L_exit:
s_endpgm
L_C0:
L_C1:
v_lshlrev_b32 v1, 4, v0
v_and_b32 v24, 15, v0
v_lshrrev_b32 v25, 4, v0
v_mov_b32 v32, -1
v_mov_b32 v33, -1
v_mov_b32 v34, -1
v_mov_b32 v35, -1
s_lshl_b32 s60, s58, 13
s_lshl_b32 s61, s47, 11
s_add_u32 s60, s60, s61
s_add_u32 s60, s60, 2097152
s_lshl_b32 s61, s57, 20
s_add_u32 s60, s60, s61
s_add_u32 s61, s60, 0x80000
buffer_store_dwordx4 v[32:35], v1, s[4:7], s60 offen offset:0 sc1
buffer_store_dwordx4 v[32:35], v1, s[4:7], s61 offen offset:0 sc1
buffer_store_dwordx4 v[32:35], v1, s[4:7], s60 offen offset:1024 sc1
buffer_store_dwordx4 v[32:35], v1, s[4:7], s61 offen offset:1024 sc1
s_lshr_b32 s60, s58, 3
s_lshl_b32 s60, s60, 1
s_lshr_b32 s61, s47, 1
s_add_u32 s60, s60, s61
s_lshl_b32 s69, s60, 10
s_and_b32 s60, s58, 1
s_lshl_b32 s60, s60, 6
s_add_u32 s69, s69, s60
s_bfe_u32 s60, s58, 0x10002
s_lshl_b32 s60, s60, 5
s_add_u32 s69, s69, s60
s_bfe_u32 s60, s58, 0x10001
s_lshl_b32 s60, s60, 7
s_add_u32 s69, s69, s60
s_and_b32 s60, s47, 1
s_lshl_b32 s60, s60, 9
s_add_u32 s69, s69, s60
s_add_u32 s69, s69, 234881024
s_lshl_b32 s60, s57, 22
s_add_u32 s69, s69, s60
v_and_b32 v26, 3, v0
v_lshrrev_b32 v27, 5, v0
v_and_b32 v28, 1, v0
v_lshlrev_b32 v18, 3, v28
v_bfe_u32 v28, v0, 1, 1
v_lshl_add_u32 v18, v28, 8, v18
v_bfe_u32 v28, v0, 4, 1
v_lshl_add_u32 v18, v28, 4, v18
s_lshl_b32 s77, s58, 8
s_lshl_b32 s60, s47, 6
s_add_u32 s77, s77, s60
s_lshl_b32 s60, s57, 22
s_add_u32 s77, s77, s60
s_add_u32 s77, s77, 234889216
s_mov_b64 exec, 0xf
buffer_store_dwordx4 v[32:35], v1, s[4:7], s77 offen sc1
s_mov_b64 exec, -1
s_add_u32 s77, s77, 8192
s_cmp_eq_u32 s57, 0
s_cbranch_scc1 Lc1_1
s_waitcnt vmcnt(0)
s_barrier
s_cmp_lg_u32 s47, 0
s_cbranch_scc1 Larr_2
s_getreg_b32 s60, hwreg(HW_REG_XCC_ID)
s_and_b32 s60, s60, 7
s_lshr_b32 s61, s56, 5
s_cmp_eq_u32 s60, s61
s_cselect_b32 s60, 1, 0x10001
s_mov_b64 exec, 1
v_mov_b32 v30, s60
v_mov_b32 v31, 136
buffer_atomic_add v30, v31, s[8:11], 0 offen sc1
s_mov_b64 exec, -1
Larr_2:
Lc1_1:
v_lshlrev_b32 v1, 4, v0
s_mov_b32 s92, 0x00ff00ff
s_mov_b32 s93, 0x00ff00ff
s_mov_b32 s94, 0x000f000f
s_mov_b32 s95, 0
v_mov_b32 v28, 0x8888
v_mov_b32 v29, 0xdddd
v_cmp_gt_u32 vcc, 8, v24
s_nop 1
v_cndmask_b32 v2, v29, v28, vcc
v_lshlrev_b32 v28, 2, v25
v_sub_u32 v28, v24, v28
v_mov_b32 v29, 0x3f80
v_mov_b32 v30, 0x3f800000
v_cmp_eq_u32 vcc, 0, v28
s_nop 1
v_cndmask_b32 v4, 0, v29, vcc
v_cmp_eq_u32 vcc, 1, v28
s_nop 1
v_cndmask_b32 v4, v4, v30, vcc
v_cmp_eq_u32 vcc, 2, v28
s_nop 1
v_cndmask_b32 v5, 0, v29, vcc
v_cmp_eq_u32 vcc, 3, v28
s_nop 1
v_cndmask_b32 v5, v5, v30, vcc
v_mov_b32 v29, 0xf149f2ca
v_mov_b32 v30, 0x3f803f80
v_cmp_gt_u32 vcc, 2, v25
s_nop 1
v_cndmask_b32 v6, 0, v29, vcc
v_mov_b32 v14, 0
v_mov_b32 v7, v6
v_mov_b32 v8, v6
v_mov_b32 v9, v6
v_mov_b32 v15, v14
v_mov_b32 v10, v30
v_mov_b32 v11, v30
v_mov_b32 v12, v30
v_mov_b32 v13, v30
v_lshrrev_b32 v28, 3, v0
v_bfe_u32 v29, v0, 2, 1
v_and_b32 v30, 3, v0
v_lshl_add_u32 v28, v29, 3, v28
v_lshl_add_u32 v28, v30, 4, v28
s_lshl_b32 s60, s47, 11
s_add_u32 s60, s60, 131072
v_lshl_add_u32 v3, v0, 4, s60
v_lshlrev_b32 v28, 4, v24
v_lshl_add_u32 v16, v25, 13, v28
v_lshrrev_b32 v28, 2, v0
v_lshlrev_b32 v28, 8, v28
v_lshl_add_u32 v17, v26, 4, v28
s_and_b32 s60, s47, 1
s_lshl_b32 s60, s60, 9
s_lshr_b32 s61, s47, 1
s_lshl_b32 s61, s61, 10
s_add_u32 s60, s60, s61
s_add_u32 s60, s60, 152576
v_lshlrev_b32 v28, 4, v24
v_lshl_add_u32 v28, v27, 8, v28
v_and_b32 v29, 1, v25
v_lshl_add_u32 v28, v29, 3, v28
v_add_u32 v19, s60, v28
v_add_u32 v20, 131072, v1
s_lshl_b32 s60, s47, 15
v_add_u32 v21, s60, v1
v_lshlrev_b32 v22, 3, v0
s_mov_b32 s70, 0x3e0293ee
s_mov_b32 s12, s26
s_mov_b32 s13, s27
s_mov_b32 s14, 4194304
s_mov_b32 s15, 0x00020000
s_lshl_b32 s60, s58, 17
s_lshl_b32 s61, s47, 8
s_add_u32 s60, s60, s61
v_lshlrev_b32 v26, 13, v25
v_lshl_add_u32 v26, v24, 4, v26
v_add_u32 v26, s60, v26
s_mov_b32 s60, 0
buffer_load_dwordx4 v[128:131], v26, s[12:15], s60 offen offset:0
buffer_load_dwordx4 v[132:135], v26, s[12:15], s60 offen offset:1024
buffer_load_dwordx4 v[136:139], v26, s[12:15], s60 offen offset:2048
buffer_load_dwordx4 v[140:143], v26, s[12:15], s60 offen offset:3072
s_mov_b32 s60, 4096
buffer_load_dwordx4 v[144:147], v26, s[12:15], s60 offen offset:0
buffer_load_dwordx4 v[148:151], v26, s[12:15], s60 offen offset:1024
buffer_load_dwordx4 v[152:155], v26, s[12:15], s60 offen offset:2048
buffer_load_dwordx4 v[156:159], v26, s[12:15], s60 offen offset:3072
s_mov_b32 s60, 32768
buffer_load_dwordx4 v[160:163], v26, s[12:15], s60 offen offset:0
buffer_load_dwordx4 v[164:167], v26, s[12:15], s60 offen offset:1024
buffer_load_dwordx4 v[168:171], v26, s[12:15], s60 offen offset:2048
buffer_load_dwordx4 v[172:175], v26, s[12:15], s60 offen offset:3072
s_mov_b32 s60, 36864
buffer_load_dwordx4 v[176:179], v26, s[12:15], s60 offen offset:0
buffer_load_dwordx4 v[180:183], v26, s[12:15], s60 offen offset:1024
buffer_load_dwordx4 v[184:187], v26, s[12:15], s60 offen offset:2048
buffer_load_dwordx4 v[188:191], v26, s[12:15], s60 offen offset:3072
s_mov_b32 s60, 65536
buffer_load_dwordx4 v[192:195], v26, s[12:15], s60 offen offset:0
buffer_load_dwordx4 v[196:199], v26, s[12:15], s60 offen offset:1024
buffer_load_dwordx4 v[200:203], v26, s[12:15], s60 offen offset:2048
buffer_load_dwordx4 v[204:207], v26, s[12:15], s60 offen offset:3072
s_mov_b32 s60, 69632
buffer_load_dwordx4 v[208:211], v26, s[12:15], s60 offen offset:0
buffer_load_dwordx4 v[212:215], v26, s[12:15], s60 offen offset:1024
buffer_load_dwordx4 v[216:219], v26, s[12:15], s60 offen offset:2048
buffer_load_dwordx4 v[220:223], v26, s[12:15], s60 offen offset:3072
s_mov_b32 s60, 98304
buffer_load_dwordx4 v[224:227], v26, s[12:15], s60 offen offset:0
buffer_load_dwordx4 v[228:231], v26, s[12:15], s60 offen offset:1024
buffer_load_dwordx4 v[232:235], v26, s[12:15], s60 offen offset:2048
buffer_load_dwordx4 v[236:239], v26, s[12:15], s60 offen offset:3072
s_mov_b32 s60, 102400
buffer_load_dwordx4 v[240:243], v26, s[12:15], s60 offen offset:0
buffer_load_dwordx4 v[244:247], v26, s[12:15], s60 offen offset:1024
buffer_load_dwordx4 v[248:251], v26, s[12:15], s60 offen offset:2048
buffer_load_dwordx4 v[252:255], v26, s[12:15], s60 offen offset:3072
s_lshl_b32 s60, s58, 8
s_lshl_b32 s61, s47, 6
s_add_u32 s60, s60, s61
v_lshlrev_b32 v26, 16, v25
v_lshl_add_u32 v26, v24, 2, v26
v_add_u32 v26, s60, v26
s_lshl_b32 s74, s47, 20
s_mov_b32 s12, s20
s_mov_b32 s13, s21
s_mov_b32 s14, 4194304
s_mov_b32 s15, 0x00020000
s_xor_b32 s60, s74, 0
buffer_load_dword v32, v26, s[12:15], s60 offen
s_xor_b32 s60, s74, 8192
buffer_load_dword v33, v26, s[12:15], s60 offen
s_xor_b32 s60, s74, 16384
buffer_load_dword v34, v26, s[12:15], s60 offen
s_xor_b32 s60, s74, 24576
buffer_load_dword v35, v26, s[12:15], s60 offen
s_xor_b32 s60, s74, 32768
buffer_load_dword v36, v26, s[12:15], s60 offen
s_xor_b32 s60, s74, 40960
buffer_load_dword v37, v26, s[12:15], s60 offen
s_xor_b32 s60, s74, 49152
buffer_load_dword v38, v26, s[12:15], s60 offen
s_xor_b32 s60, s74, 57344
buffer_load_dword v39, v26, s[12:15], s60 offen
s_xor_b32 s60, s74, 262144
buffer_load_dword v40, v26, s[12:15], s60 offen
s_xor_b32 s60, s74, 270336
buffer_load_dword v41, v26, s[12:15], s60 offen
s_xor_b32 s60, s74, 278528
buffer_load_dword v42, v26, s[12:15], s60 offen
s_xor_b32 s60, s74, 286720
buffer_load_dword v43, v26, s[12:15], s60 offen
s_xor_b32 s60, s74, 294912
buffer_load_dword v44, v26, s[12:15], s60 offen
s_xor_b32 s60, s74, 303104
buffer_load_dword v45, v26, s[12:15], s60 offen
s_xor_b32 s60, s74, 311296
buffer_load_dword v46, v26, s[12:15], s60 offen
s_xor_b32 s60, s74, 319488
buffer_load_dword v47, v26, s[12:15], s60 offen
s_xor_b32 s60, s74, 524288
buffer_load_dword v48, v26, s[12:15], s60 offen
s_xor_b32 s60, s74, 532480
buffer_load_dword v49, v26, s[12:15], s60 offen
s_xor_b32 s60, s74, 540672
buffer_load_dword v50, v26, s[12:15], s60 offen
s_xor_b32 s60, s74, 548864
buffer_load_dword v51, v26, s[12:15], s60 offen
s_xor_b32 s60, s74, 557056
buffer_load_dword v52, v26, s[12:15], s60 offen
s_xor_b32 s60, s74, 565248
buffer_load_dword v53, v26, s[12:15], s60 offen
s_xor_b32 s60, s74, 573440
buffer_load_dword v54, v26, s[12:15], s60 offen
s_xor_b32 s60, s74, 581632
buffer_load_dword v55, v26, s[12:15], s60 offen
s_xor_b32 s60, s74, 786432
buffer_load_dword v56, v26, s[12:15], s60 offen
s_xor_b32 s60, s74, 794624
buffer_load_dword v57, v26, s[12:15], s60 offen
s_xor_b32 s60, s74, 802816
buffer_load_dword v58, v26, s[12:15], s60 offen
s_xor_b32 s60, s74, 811008
buffer_load_dword v59, v26, s[12:15], s60 offen
s_xor_b32 s60, s74, 819200
buffer_load_dword v60, v26, s[12:15], s60 offen
s_xor_b32 s60, s74, 827392
buffer_load_dword v61, v26, s[12:15], s60 offen
s_xor_b32 s60, s74, 835584
buffer_load_dword v62, v26, s[12:15], s60 offen
s_xor_b32 s60, s74, 843776
buffer_load_dword v63, v26, s[12:15], s60 offen
s_xor_b32 s60, s74, 1048576
buffer_load_dword v64, v26, s[12:15], s60 offen
s_xor_b32 s60, s74, 1056768
buffer_load_dword v65, v26, s[12:15], s60 offen
s_xor_b32 s60, s74, 1064960
buffer_load_dword v66, v26, s[12:15], s60 offen
s_xor_b32 s60, s74, 1073152
buffer_load_dword v67, v26, s[12:15], s60 offen
s_xor_b32 s60, s74, 1081344
buffer_load_dword v68, v26, s[12:15], s60 offen
s_xor_b32 s60, s74, 1089536
buffer_load_dword v69, v26, s[12:15], s60 offen
s_xor_b32 s60, s74, 1097728
buffer_load_dword v70, v26, s[12:15], s60 offen
s_xor_b32 s60, s74, 1105920
buffer_load_dword v71, v26, s[12:15], s60 offen
s_xor_b32 s60, s74, 1310720
buffer_load_dword v72, v26, s[12:15], s60 offen
s_xor_b32 s60, s74, 1318912
buffer_load_dword v73, v26, s[12:15], s60 offen
s_xor_b32 s60, s74, 1327104
buffer_load_dword v74, v26, s[12:15], s60 offen
s_xor_b32 s60, s74, 1335296
buffer_load_dword v75, v26, s[12:15], s60 offen
s_xor_b32 s60, s74, 1343488
buffer_load_dword v76, v26, s[12:15], s60 offen
s_xor_b32 s60, s74, 1351680
buffer_load_dword v77, v26, s[12:15], s60 offen
s_xor_b32 s60, s74, 1359872
buffer_load_dword v78, v26, s[12:15], s60 offen
s_xor_b32 s60, s74, 1368064
buffer_load_dword v79, v26, s[12:15], s60 offen
s_xor_b32 s60, s74, 1572864
buffer_load_dword v80, v26, s[12:15], s60 offen
s_xor_b32 s60, s74, 1581056
buffer_load_dword v81, v26, s[12:15], s60 offen
s_xor_b32 s60, s74, 1589248
buffer_load_dword v82, v26, s[12:15], s60 offen
s_xor_b32 s60, s74, 1597440
buffer_load_dword v83, v26, s[12:15], s60 offen
s_xor_b32 s60, s74, 1605632
buffer_load_dword v84, v26, s[12:15], s60 offen
s_xor_b32 s60, s74, 1613824
buffer_load_dword v85, v26, s[12:15], s60 offen
s_xor_b32 s60, s74, 1622016
buffer_load_dword v86, v26, s[12:15], s60 offen
s_xor_b32 s60, s74, 1630208
buffer_load_dword v87, v26, s[12:15], s60 offen
s_xor_b32 s60, s74, 1835008
buffer_load_dword v88, v26, s[12:15], s60 offen
s_xor_b32 s60, s74, 1843200
buffer_load_dword v89, v26, s[12:15], s60 offen
s_xor_b32 s60, s74, 1851392
buffer_load_dword v90, v26, s[12:15], s60 offen
s_xor_b32 s60, s74, 1859584
buffer_load_dword v91, v26, s[12:15], s60 offen
s_xor_b32 s60, s74, 1867776
buffer_load_dword v92, v26, s[12:15], s60 offen
s_xor_b32 s60, s74, 1875968
buffer_load_dword v93, v26, s[12:15], s60 offen
s_xor_b32 s60, s74, 1884160
buffer_load_dword v94, v26, s[12:15], s60 offen
s_xor_b32 s60, s74, 1892352
buffer_load_dword v95, v26, s[12:15], s60 offen
s_waitcnt vmcnt(56)
v_perm_b32 v96, v33, v32, s44
v_accvgpr_write_b32 a0, v96
v_perm_b32 v97, v35, v34, s44
v_accvgpr_write_b32 a1, v97
v_perm_b32 v98, v37, v36, s44
v_accvgpr_write_b32 a2, v98
v_perm_b32 v99, v39, v38, s44
v_accvgpr_write_b32 a3, v99
v_perm_b32 v100, v33, v32, s45
v_accvgpr_write_b32 a64, v100
v_perm_b32 v101, v35, v34, s45
v_accvgpr_write_b32 a65, v101
v_perm_b32 v102, v37, v36, s45
v_accvgpr_write_b32 a66, v102
v_perm_b32 v103, v39, v38, s45
v_accvgpr_write_b32 a67, v103
s_xor_b32 s60, s74, 2097152
buffer_load_dword v32, v26, s[12:15], s60 offen
s_xor_b32 s60, s74, 2105344
buffer_load_dword v33, v26, s[12:15], s60 offen
s_xor_b32 s60, s74, 2113536
buffer_load_dword v34, v26, s[12:15], s60 offen
s_xor_b32 s60, s74, 2121728
buffer_load_dword v35, v26, s[12:15], s60 offen
s_xor_b32 s60, s74, 2129920
buffer_load_dword v36, v26, s[12:15], s60 offen
s_xor_b32 s60, s74, 2138112
buffer_load_dword v37, v26, s[12:15], s60 offen
s_xor_b32 s60, s74, 2146304
buffer_load_dword v38, v26, s[12:15], s60 offen
s_xor_b32 s60, s74, 2154496
buffer_load_dword v39, v26, s[12:15], s60 offen
s_waitcnt vmcnt(56)
v_perm_b32 v96, v41, v40, s44
v_accvgpr_write_b32 a4, v96
v_perm_b32 v97, v43, v42, s44
v_accvgpr_write_b32 a5, v97
v_perm_b32 v98, v45, v44, s44
v_accvgpr_write_b32 a6, v98
v_perm_b32 v99, v47, v46, s44
v_accvgpr_write_b32 a7, v99
v_perm_b32 v100, v41, v40, s45
v_accvgpr_write_b32 a68, v100
v_perm_b32 v101, v43, v42, s45
v_accvgpr_write_b32 a69, v101
v_perm_b32 v102, v45, v44, s45
v_accvgpr_write_b32 a70, v102
v_perm_b32 v103, v47, v46, s45
v_accvgpr_write_b32 a71, v103
s_xor_b32 s60, s74, 2359296
buffer_load_dword v40, v26, s[12:15], s60 offen
s_xor_b32 s60, s74, 2367488
buffer_load_dword v41, v26, s[12:15], s60 offen
s_xor_b32 s60, s74, 2375680
buffer_load_dword v42, v26, s[12:15], s60 offen
s_xor_b32 s60, s74, 2383872
buffer_load_dword v43, v26, s[12:15], s60 offen
s_xor_b32 s60, s74, 2392064
buffer_load_dword v44, v26, s[12:15], s60 offen
s_xor_b32 s60, s74, 2400256
buffer_load_dword v45, v26, s[12:15], s60 offen
s_xor_b32 s60, s74, 2408448
buffer_load_dword v46, v26, s[12:15], s60 offen
s_xor_b32 s60, s74, 2416640
buffer_load_dword v47, v26, s[12:15], s60 offen
s_waitcnt vmcnt(56)
v_perm_b32 v96, v49, v48, s44
v_accvgpr_write_b32 a8, v96
v_perm_b32 v97, v51, v50, s44
v_accvgpr_write_b32 a9, v97
v_perm_b32 v98, v53, v52, s44
v_accvgpr_write_b32 a10, v98
v_perm_b32 v99, v55, v54, s44
v_accvgpr_write_b32 a11, v99
v_perm_b32 v100, v49, v48, s45
v_accvgpr_write_b32 a72, v100
v_perm_b32 v101, v51, v50, s45
v_accvgpr_write_b32 a73, v101
v_perm_b32 v102, v53, v52, s45
v_accvgpr_write_b32 a74, v102
v_perm_b32 v103, v55, v54, s45
v_accvgpr_write_b32 a75, v103
s_xor_b32 s60, s74, 2621440
buffer_load_dword v48, v26, s[12:15], s60 offen
s_xor_b32 s60, s74, 2629632
buffer_load_dword v49, v26, s[12:15], s60 offen
s_xor_b32 s60, s74, 2637824
buffer_load_dword v50, v26, s[12:15], s60 offen
s_xor_b32 s60, s74, 2646016
buffer_load_dword v51, v26, s[12:15], s60 offen
s_xor_b32 s60, s74, 2654208
buffer_load_dword v52, v26, s[12:15], s60 offen
s_xor_b32 s60, s74, 2662400
buffer_load_dword v53, v26, s[12:15], s60 offen
s_xor_b32 s60, s74, 2670592
buffer_load_dword v54, v26, s[12:15], s60 offen
s_xor_b32 s60, s74, 2678784
buffer_load_dword v55, v26, s[12:15], s60 offen
s_waitcnt vmcnt(56)
v_perm_b32 v96, v57, v56, s44
v_accvgpr_write_b32 a12, v96
v_perm_b32 v97, v59, v58, s44
v_accvgpr_write_b32 a13, v97
v_perm_b32 v98, v61, v60, s44
v_accvgpr_write_b32 a14, v98
v_perm_b32 v99, v63, v62, s44
v_accvgpr_write_b32 a15, v99
v_perm_b32 v100, v57, v56, s45
v_accvgpr_write_b32 a76, v100
v_perm_b32 v101, v59, v58, s45
v_accvgpr_write_b32 a77, v101
v_perm_b32 v102, v61, v60, s45
v_accvgpr_write_b32 a78, v102
v_perm_b32 v103, v63, v62, s45
v_accvgpr_write_b32 a79, v103
s_xor_b32 s60, s74, 2883584
buffer_load_dword v56, v26, s[12:15], s60 offen
s_xor_b32 s60, s74, 2891776
buffer_load_dword v57, v26, s[12:15], s60 offen
s_xor_b32 s60, s74, 2899968
buffer_load_dword v58, v26, s[12:15], s60 offen
s_xor_b32 s60, s74, 2908160
buffer_load_dword v59, v26, s[12:15], s60 offen
s_xor_b32 s60, s74, 2916352
buffer_load_dword v60, v26, s[12:15], s60 offen
s_xor_b32 s60, s74, 2924544
buffer_load_dword v61, v26, s[12:15], s60 offen
s_xor_b32 s60, s74, 2932736
buffer_load_dword v62, v26, s[12:15], s60 offen
s_xor_b32 s60, s74, 2940928
buffer_load_dword v63, v26, s[12:15], s60 offen
s_waitcnt vmcnt(56)
v_perm_b32 v96, v65, v64, s44
v_accvgpr_write_b32 a16, v96
v_perm_b32 v97, v67, v66, s44
v_accvgpr_write_b32 a17, v97
v_perm_b32 v98, v69, v68, s44
v_accvgpr_write_b32 a18, v98
v_perm_b32 v99, v71, v70, s44
v_accvgpr_write_b32 a19, v99
v_perm_b32 v100, v65, v64, s45
v_accvgpr_write_b32 a80, v100
v_perm_b32 v101, v67, v66, s45
v_accvgpr_write_b32 a81, v101
v_perm_b32 v102, v69, v68, s45
v_accvgpr_write_b32 a82, v102
v_perm_b32 v103, v71, v70, s45
v_accvgpr_write_b32 a83, v103
s_xor_b32 s60, s74, 3145728
buffer_load_dword v64, v26, s[12:15], s60 offen
s_xor_b32 s60, s74, 3153920
buffer_load_dword v65, v26, s[12:15], s60 offen
s_xor_b32 s60, s74, 3162112
buffer_load_dword v66, v26, s[12:15], s60 offen
s_xor_b32 s60, s74, 3170304
buffer_load_dword v67, v26, s[12:15], s60 offen
s_xor_b32 s60, s74, 3178496
buffer_load_dword v68, v26, s[12:15], s60 offen
s_xor_b32 s60, s74, 3186688
buffer_load_dword v69, v26, s[12:15], s60 offen
s_xor_b32 s60, s74, 3194880
buffer_load_dword v70, v26, s[12:15], s60 offen
s_xor_b32 s60, s74, 3203072
buffer_load_dword v71, v26, s[12:15], s60 offen
s_waitcnt vmcnt(56)
v_perm_b32 v96, v73, v72, s44
v_accvgpr_write_b32 a20, v96
v_perm_b32 v97, v75, v74, s44
v_accvgpr_write_b32 a21, v97
v_perm_b32 v98, v77, v76, s44
v_accvgpr_write_b32 a22, v98
v_perm_b32 v99, v79, v78, s44
v_accvgpr_write_b32 a23, v99
v_perm_b32 v100, v73, v72, s45
v_accvgpr_write_b32 a84, v100
v_perm_b32 v101, v75, v74, s45
v_accvgpr_write_b32 a85, v101
v_perm_b32 v102, v77, v76, s45
v_accvgpr_write_b32 a86, v102
v_perm_b32 v103, v79, v78, s45
v_accvgpr_write_b32 a87, v103
s_xor_b32 s60, s74, 3407872
buffer_load_dword v72, v26, s[12:15], s60 offen
s_xor_b32 s60, s74, 3416064
buffer_load_dword v73, v26, s[12:15], s60 offen
s_xor_b32 s60, s74, 3424256
buffer_load_dword v74, v26, s[12:15], s60 offen
s_xor_b32 s60, s74, 3432448
buffer_load_dword v75, v26, s[12:15], s60 offen
s_xor_b32 s60, s74, 3440640
buffer_load_dword v76, v26, s[12:15], s60 offen
s_xor_b32 s60, s74, 3448832
buffer_load_dword v77, v26, s[12:15], s60 offen
s_xor_b32 s60, s74, 3457024
buffer_load_dword v78, v26, s[12:15], s60 offen
s_xor_b32 s60, s74, 3465216
buffer_load_dword v79, v26, s[12:15], s60 offen
s_waitcnt vmcnt(56)
v_perm_b32 v96, v81, v80, s44
v_accvgpr_write_b32 a24, v96
v_perm_b32 v97, v83, v82, s44
v_accvgpr_write_b32 a25, v97
v_perm_b32 v98, v85, v84, s44
v_accvgpr_write_b32 a26, v98
v_perm_b32 v99, v87, v86, s44
v_accvgpr_write_b32 a27, v99
v_perm_b32 v100, v81, v80, s45
v_accvgpr_write_b32 a88, v100
v_perm_b32 v101, v83, v82, s45
v_accvgpr_write_b32 a89, v101
v_perm_b32 v102, v85, v84, s45
v_accvgpr_write_b32 a90, v102
v_perm_b32 v103, v87, v86, s45
v_accvgpr_write_b32 a91, v103
s_xor_b32 s60, s74, 3670016
buffer_load_dword v80, v26, s[12:15], s60 offen
s_xor_b32 s60, s74, 3678208
buffer_load_dword v81, v26, s[12:15], s60 offen
s_xor_b32 s60, s74, 3686400
buffer_load_dword v82, v26, s[12:15], s60 offen
s_xor_b32 s60, s74, 3694592
buffer_load_dword v83, v26, s[12:15], s60 offen
s_xor_b32 s60, s74, 3702784
buffer_load_dword v84, v26, s[12:15], s60 offen
s_xor_b32 s60, s74, 3710976
buffer_load_dword v85, v26, s[12:15], s60 offen
s_xor_b32 s60, s74, 3719168
buffer_load_dword v86, v26, s[12:15], s60 offen
s_xor_b32 s60, s74, 3727360
buffer_load_dword v87, v26, s[12:15], s60 offen
s_waitcnt vmcnt(56)
v_perm_b32 v96, v89, v88, s44
v_accvgpr_write_b32 a28, v96
v_perm_b32 v97, v91, v90, s44
v_accvgpr_write_b32 a29, v97
v_perm_b32 v98, v93, v92, s44
v_accvgpr_write_b32 a30, v98
v_perm_b32 v99, v95, v94, s44
v_accvgpr_write_b32 a31, v99
v_perm_b32 v100, v89, v88, s45
v_accvgpr_write_b32 a92, v100
v_perm_b32 v101, v91, v90, s45
v_accvgpr_write_b32 a93, v101
v_perm_b32 v102, v93, v92, s45
v_accvgpr_write_b32 a94, v102
v_perm_b32 v103, v95, v94, s45
v_accvgpr_write_b32 a95, v103
s_xor_b32 s60, s74, 3932160
buffer_load_dword v88, v26, s[12:15], s60 offen
s_xor_b32 s60, s74, 3940352
buffer_load_dword v89, v26, s[12:15], s60 offen
s_xor_b32 s60, s74, 3948544
buffer_load_dword v90, v26, s[12:15], s60 offen
s_xor_b32 s60, s74, 3956736
buffer_load_dword v91, v26, s[12:15], s60 offen
s_xor_b32 s60, s74, 3964928
buffer_load_dword v92, v26, s[12:15], s60 offen
s_xor_b32 s60, s74, 3973120
buffer_load_dword v93, v26, s[12:15], s60 offen
s_xor_b32 s60, s74, 3981312
buffer_load_dword v94, v26, s[12:15], s60 offen
s_xor_b32 s60, s74, 3989504
buffer_load_dword v95, v26, s[12:15], s60 offen
s_waitcnt vmcnt(56)
v_perm_b32 v96, v33, v32, s44
v_accvgpr_write_b32 a32, v96
v_perm_b32 v97, v35, v34, s44
v_accvgpr_write_b32 a33, v97
v_perm_b32 v98, v37, v36, s44
v_accvgpr_write_b32 a34, v98
v_perm_b32 v99, v39, v38, s44
v_accvgpr_write_b32 a35, v99
v_perm_b32 v100, v33, v32, s45
v_accvgpr_write_b32 a96, v100
v_perm_b32 v101, v35, v34, s45
v_accvgpr_write_b32 a97, v101
v_perm_b32 v102, v37, v36, s45
v_accvgpr_write_b32 a98, v102
v_perm_b32 v103, v39, v38, s45
v_accvgpr_write_b32 a99, v103
s_mov_b32 s12, s22
s_mov_b32 s13, s23
s_mov_b32 s14, 4194304
s_mov_b32 s15, 0x00020000
s_xor_b32 s60, s74, 0
buffer_load_dword v32, v26, s[12:15], s60 offen
s_xor_b32 s60, s74, 8192
buffer_load_dword v33, v26, s[12:15], s60 offen
s_xor_b32 s60, s74, 16384
buffer_load_dword v34, v26, s[12:15], s60 offen
s_xor_b32 s60, s74, 24576
buffer_load_dword v35, v26, s[12:15], s60 offen
s_xor_b32 s60, s74, 32768
buffer_load_dword v36, v26, s[12:15], s60 offen
s_xor_b32 s60, s74, 40960
buffer_load_dword v37, v26, s[12:15], s60 offen
s_xor_b32 s60, s74, 49152
buffer_load_dword v38, v26, s[12:15], s60 offen
s_xor_b32 s60, s74, 57344
buffer_load_dword v39, v26, s[12:15], s60 offen
s_waitcnt vmcnt(56)
v_perm_b32 v96, v41, v40, s44
v_accvgpr_write_b32 a36, v96
v_perm_b32 v97, v43, v42, s44
v_accvgpr_write_b32 a37, v97
v_perm_b32 v98, v45, v44, s44
v_accvgpr_write_b32 a38, v98
v_perm_b32 v99, v47, v46, s44
v_accvgpr_write_b32 a39, v99
v_perm_b32 v100, v41, v40, s45
v_accvgpr_write_b32 a100, v100
v_perm_b32 v101, v43, v42, s45
v_accvgpr_write_b32 a101, v101
v_perm_b32 v102, v45, v44, s45
v_accvgpr_write_b32 a102, v102
v_perm_b32 v103, v47, v46, s45
v_accvgpr_write_b32 a103, v103
s_xor_b32 s60, s74, 262144
buffer_load_dword v40, v26, s[12:15], s60 offen
s_xor_b32 s60, s74, 270336
buffer_load_dword v41, v26, s[12:15], s60 offen
s_xor_b32 s60, s74, 278528
buffer_load_dword v42, v26, s[12:15], s60 offen
s_xor_b32 s60, s74, 286720
buffer_load_dword v43, v26, s[12:15], s60 offen
s_xor_b32 s60, s74, 294912
buffer_load_dword v44, v26, s[12:15], s60 offen
s_xor_b32 s60, s74, 303104
buffer_load_dword v45, v26, s[12:15], s60 offen
s_xor_b32 s60, s74, 311296
buffer_load_dword v46, v26, s[12:15], s60 offen
s_xor_b32 s60, s74, 319488
buffer_load_dword v47, v26, s[12:15], s60 offen
s_waitcnt vmcnt(56)
v_perm_b32 v96, v49, v48, s44
v_accvgpr_write_b32 a40, v96
v_perm_b32 v97, v51, v50, s44
v_accvgpr_write_b32 a41, v97
v_perm_b32 v98, v53, v52, s44
v_accvgpr_write_b32 a42, v98
v_perm_b32 v99, v55, v54, s44
v_accvgpr_write_b32 a43, v99
v_perm_b32 v100, v49, v48, s45
v_accvgpr_write_b32 a104, v100
v_perm_b32 v101, v51, v50, s45
v_accvgpr_write_b32 a105, v101
v_perm_b32 v102, v53, v52, s45
v_accvgpr_write_b32 a106, v102
v_perm_b32 v103, v55, v54, s45
v_accvgpr_write_b32 a107, v103
s_xor_b32 s60, s74, 524288
buffer_load_dword v48, v26, s[12:15], s60 offen
s_xor_b32 s60, s74, 532480
buffer_load_dword v49, v26, s[12:15], s60 offen
s_xor_b32 s60, s74, 540672
buffer_load_dword v50, v26, s[12:15], s60 offen
s_xor_b32 s60, s74, 548864
buffer_load_dword v51, v26, s[12:15], s60 offen
s_xor_b32 s60, s74, 557056
buffer_load_dword v52, v26, s[12:15], s60 offen
s_xor_b32 s60, s74, 565248
buffer_load_dword v53, v26, s[12:15], s60 offen
s_xor_b32 s60, s74, 573440
buffer_load_dword v54, v26, s[12:15], s60 offen
s_xor_b32 s60, s74, 581632
buffer_load_dword v55, v26, s[12:15], s60 offen
s_waitcnt vmcnt(56)
v_perm_b32 v96, v57, v56, s44
v_accvgpr_write_b32 a44, v96
v_perm_b32 v97, v59, v58, s44
v_accvgpr_write_b32 a45, v97
v_perm_b32 v98, v61, v60, s44
v_accvgpr_write_b32 a46, v98
v_perm_b32 v99, v63, v62, s44
v_accvgpr_write_b32 a47, v99
v_perm_b32 v100, v57, v56, s45
v_accvgpr_write_b32 a108, v100
v_perm_b32 v101, v59, v58, s45
v_accvgpr_write_b32 a109, v101
v_perm_b32 v102, v61, v60, s45
v_accvgpr_write_b32 a110, v102
v_perm_b32 v103, v63, v62, s45
v_accvgpr_write_b32 a111, v103
s_xor_b32 s60, s74, 786432
buffer_load_dword v56, v26, s[12:15], s60 offen
s_xor_b32 s60, s74, 794624
buffer_load_dword v57, v26, s[12:15], s60 offen
s_xor_b32 s60, s74, 802816
buffer_load_dword v58, v26, s[12:15], s60 offen
s_xor_b32 s60, s74, 811008
buffer_load_dword v59, v26, s[12:15], s60 offen
s_xor_b32 s60, s74, 819200
buffer_load_dword v60, v26, s[12:15], s60 offen
s_xor_b32 s60, s74, 827392
buffer_load_dword v61, v26, s[12:15], s60 offen
s_xor_b32 s60, s74, 835584
buffer_load_dword v62, v26, s[12:15], s60 offen
s_xor_b32 s60, s74, 843776
buffer_load_dword v63, v26, s[12:15], s60 offen
s_waitcnt vmcnt(56)
v_perm_b32 v96, v65, v64, s44
v_accvgpr_write_b32 a48, v96
v_perm_b32 v97, v67, v66, s44
v_accvgpr_write_b32 a49, v97
v_perm_b32 v98, v69, v68, s44
v_accvgpr_write_b32 a50, v98
v_perm_b32 v99, v71, v70, s44
v_accvgpr_write_b32 a51, v99
v_perm_b32 v100, v65, v64, s45
v_accvgpr_write_b32 a112, v100
v_perm_b32 v101, v67, v66, s45
v_accvgpr_write_b32 a113, v101
v_perm_b32 v102, v69, v68, s45
v_accvgpr_write_b32 a114, v102
v_perm_b32 v103, v71, v70, s45
v_accvgpr_write_b32 a115, v103
s_xor_b32 s60, s74, 1048576
buffer_load_dword v64, v26, s[12:15], s60 offen
s_xor_b32 s60, s74, 1056768
buffer_load_dword v65, v26, s[12:15], s60 offen
s_xor_b32 s60, s74, 1064960
buffer_load_dword v66, v26, s[12:15], s60 offen
s_xor_b32 s60, s74, 1073152
buffer_load_dword v67, v26, s[12:15], s60 offen
s_xor_b32 s60, s74, 1081344
buffer_load_dword v68, v26, s[12:15], s60 offen
s_xor_b32 s60, s74, 1089536
buffer_load_dword v69, v26, s[12:15], s60 offen
s_xor_b32 s60, s74, 1097728
buffer_load_dword v70, v26, s[12:15], s60 offen
s_xor_b32 s60, s74, 1105920
buffer_load_dword v71, v26, s[12:15], s60 offen
s_waitcnt vmcnt(56)
v_perm_b32 v96, v73, v72, s44
v_accvgpr_write_b32 a52, v96
v_perm_b32 v97, v75, v74, s44
v_accvgpr_write_b32 a53, v97
v_perm_b32 v98, v77, v76, s44
v_accvgpr_write_b32 a54, v98
v_perm_b32 v99, v79, v78, s44
v_accvgpr_write_b32 a55, v99
v_perm_b32 v100, v73, v72, s45
v_accvgpr_write_b32 a116, v100
v_perm_b32 v101, v75, v74, s45
v_accvgpr_write_b32 a117, v101
v_perm_b32 v102, v77, v76, s45
v_accvgpr_write_b32 a118, v102
v_perm_b32 v103, v79, v78, s45
v_accvgpr_write_b32 a119, v103
s_xor_b32 s60, s74, 1310720
buffer_load_dword v72, v26, s[12:15], s60 offen
s_xor_b32 s60, s74, 1318912
buffer_load_dword v73, v26, s[12:15], s60 offen
s_xor_b32 s60, s74, 1327104
buffer_load_dword v74, v26, s[12:15], s60 offen
s_xor_b32 s60, s74, 1335296
buffer_load_dword v75, v26, s[12:15], s60 offen
s_xor_b32 s60, s74, 1343488
buffer_load_dword v76, v26, s[12:15], s60 offen
s_xor_b32 s60, s74, 1351680
buffer_load_dword v77, v26, s[12:15], s60 offen
s_xor_b32 s60, s74, 1359872
buffer_load_dword v78, v26, s[12:15], s60 offen
s_xor_b32 s60, s74, 1368064
buffer_load_dword v79, v26, s[12:15], s60 offen
s_waitcnt vmcnt(56)
v_perm_b32 v96, v81, v80, s44
v_accvgpr_write_b32 a56, v96
v_perm_b32 v97, v83, v82, s44
v_accvgpr_write_b32 a57, v97
v_perm_b32 v98, v85, v84, s44
v_accvgpr_write_b32 a58, v98
v_perm_b32 v99, v87, v86, s44
v_accvgpr_write_b32 a59, v99
v_perm_b32 v100, v81, v80, s45
v_accvgpr_write_b32 a120, v100
v_perm_b32 v101, v83, v82, s45
v_accvgpr_write_b32 a121, v101
v_perm_b32 v102, v85, v84, s45
v_accvgpr_write_b32 a122, v102
v_perm_b32 v103, v87, v86, s45
v_accvgpr_write_b32 a123, v103
s_xor_b32 s60, s74, 1572864
buffer_load_dword v80, v26, s[12:15], s60 offen
s_xor_b32 s60, s74, 1581056
buffer_load_dword v81, v26, s[12:15], s60 offen
s_xor_b32 s60, s74, 1589248
buffer_load_dword v82, v26, s[12:15], s60 offen
s_xor_b32 s60, s74, 1597440
buffer_load_dword v83, v26, s[12:15], s60 offen
s_xor_b32 s60, s74, 1605632
buffer_load_dword v84, v26, s[12:15], s60 offen
s_xor_b32 s60, s74, 1613824
buffer_load_dword v85, v26, s[12:15], s60 offen
s_xor_b32 s60, s74, 1622016
buffer_load_dword v86, v26, s[12:15], s60 offen
s_xor_b32 s60, s74, 1630208
buffer_load_dword v87, v26, s[12:15], s60 offen
s_waitcnt vmcnt(56)
v_perm_b32 v96, v89, v88, s44
v_accvgpr_write_b32 a60, v96
v_perm_b32 v97, v91, v90, s44
v_accvgpr_write_b32 a61, v97
v_perm_b32 v98, v93, v92, s44
v_accvgpr_write_b32 a62, v98
v_perm_b32 v99, v95, v94, s44
v_accvgpr_write_b32 a63, v99
v_perm_b32 v100, v89, v88, s45
v_accvgpr_write_b32 a124, v100
v_perm_b32 v101, v91, v90, s45
v_accvgpr_write_b32 a125, v101
v_perm_b32 v102, v93, v92, s45
v_accvgpr_write_b32 a126, v102
v_perm_b32 v103, v95, v94, s45
v_accvgpr_write_b32 a127, v103
s_cmp_lg_u32 s57, 0
s_cbranch_scc1 Lc1_4
s_barrier
s_cmp_lg_u32 s47, 0
s_cbranch_scc1 Larr_5
s_getreg_b32 s60, hwreg(HW_REG_XCC_ID)
s_and_b32 s60, s60, 7
s_lshr_b32 s61, s56, 5
s_cmp_eq_u32 s60, s61
s_cselect_b32 s60, 1, 0x10001
s_mov_b64 exec, 1
v_mov_b32 v30, s60
v_mov_b32 v31, 136
buffer_atomic_add v30, v31, s[8:11], 0 offen sc1
s_mov_b64 exec, -1
Larr_5:
Lc1_4:
s_xor_b32 s60, s74, 1835008
buffer_load_dword v88, v26, s[12:15], s60 offen
s_xor_b32 s60, s74, 1843200
buffer_load_dword v89, v26, s[12:15], s60 offen
s_xor_b32 s60, s74, 1851392
buffer_load_dword v90, v26, s[12:15], s60 offen
s_xor_b32 s60, s74, 1859584
buffer_load_dword v91, v26, s[12:15], s60 offen
s_xor_b32 s60, s74, 1867776
buffer_load_dword v92, v26, s[12:15], s60 offen
s_xor_b32 s60, s74, 1875968
buffer_load_dword v93, v26, s[12:15], s60 offen
s_xor_b32 s60, s74, 1884160
buffer_load_dword v94, v26, s[12:15], s60 offen
s_xor_b32 s60, s74, 1892352
buffer_load_dword v95, v26, s[12:15], s60 offen
s_waitcnt vmcnt(56)
v_perm_b32 v96, v33, v32, s44
v_accvgpr_write_b32 a128, v96
v_perm_b32 v97, v35, v34, s44
v_accvgpr_write_b32 a129, v97
v_perm_b32 v98, v37, v36, s44
v_accvgpr_write_b32 a130, v98
v_perm_b32 v99, v39, v38, s44
v_accvgpr_write_b32 a131, v99
v_perm_b32 v100, v33, v32, s45
v_accvgpr_write_b32 a192, v100
v_perm_b32 v101, v35, v34, s45
v_accvgpr_write_b32 a193, v101
v_perm_b32 v102, v37, v36, s45
v_accvgpr_write_b32 a194, v102
v_perm_b32 v103, v39, v38, s45
v_accvgpr_write_b32 a195, v103
s_xor_b32 s60, s74, 2097152
buffer_load_dword v32, v26, s[12:15], s60 offen
s_xor_b32 s60, s74, 2105344
buffer_load_dword v33, v26, s[12:15], s60 offen
s_xor_b32 s60, s74, 2113536
buffer_load_dword v34, v26, s[12:15], s60 offen
s_xor_b32 s60, s74, 2121728
buffer_load_dword v35, v26, s[12:15], s60 offen
s_xor_b32 s60, s74, 2129920
buffer_load_dword v36, v26, s[12:15], s60 offen
s_xor_b32 s60, s74, 2138112
buffer_load_dword v37, v26, s[12:15], s60 offen
s_xor_b32 s60, s74, 2146304
buffer_load_dword v38, v26, s[12:15], s60 offen
s_xor_b32 s60, s74, 2154496
buffer_load_dword v39, v26, s[12:15], s60 offen
s_waitcnt vmcnt(56)
v_perm_b32 v96, v41, v40, s44
v_accvgpr_write_b32 a132, v96
v_perm_b32 v97, v43, v42, s44
v_accvgpr_write_b32 a133, v97
v_perm_b32 v98, v45, v44, s44
v_accvgpr_write_b32 a134, v98
v_perm_b32 v99, v47, v46, s44
v_accvgpr_write_b32 a135, v99
v_perm_b32 v100, v41, v40, s45
v_accvgpr_write_b32 a196, v100
v_perm_b32 v101, v43, v42, s45
v_accvgpr_write_b32 a197, v101
v_perm_b32 v102, v45, v44, s45
v_accvgpr_write_b32 a198, v102
v_perm_b32 v103, v47, v46, s45
v_accvgpr_write_b32 a199, v103
s_xor_b32 s60, s74, 2359296
buffer_load_dword v40, v26, s[12:15], s60 offen
s_xor_b32 s60, s74, 2367488
buffer_load_dword v41, v26, s[12:15], s60 offen
s_xor_b32 s60, s74, 2375680
buffer_load_dword v42, v26, s[12:15], s60 offen
s_xor_b32 s60, s74, 2383872
buffer_load_dword v43, v26, s[12:15], s60 offen
s_xor_b32 s60, s74, 2392064
buffer_load_dword v44, v26, s[12:15], s60 offen
s_xor_b32 s60, s74, 2400256
buffer_load_dword v45, v26, s[12:15], s60 offen
s_xor_b32 s60, s74, 2408448
buffer_load_dword v46, v26, s[12:15], s60 offen
s_xor_b32 s60, s74, 2416640
buffer_load_dword v47, v26, s[12:15], s60 offen
s_waitcnt vmcnt(56)
v_perm_b32 v96, v49, v48, s44
v_accvgpr_write_b32 a136, v96
v_perm_b32 v97, v51, v50, s44
v_accvgpr_write_b32 a137, v97
v_perm_b32 v98, v53, v52, s44
v_accvgpr_write_b32 a138, v98
v_perm_b32 v99, v55, v54, s44
v_accvgpr_write_b32 a139, v99
v_perm_b32 v100, v49, v48, s45
v_accvgpr_write_b32 a200, v100
v_perm_b32 v101, v51, v50, s45
v_accvgpr_write_b32 a201, v101
v_perm_b32 v102, v53, v52, s45
v_accvgpr_write_b32 a202, v102
v_perm_b32 v103, v55, v54, s45
v_accvgpr_write_b32 a203, v103
s_xor_b32 s60, s74, 2621440
buffer_load_dword v48, v26, s[12:15], s60 offen
s_xor_b32 s60, s74, 2629632
buffer_load_dword v49, v26, s[12:15], s60 offen
s_xor_b32 s60, s74, 2637824
buffer_load_dword v50, v26, s[12:15], s60 offen
s_xor_b32 s60, s74, 2646016
buffer_load_dword v51, v26, s[12:15], s60 offen
s_xor_b32 s60, s74, 2654208
buffer_load_dword v52, v26, s[12:15], s60 offen
s_xor_b32 s60, s74, 2662400
buffer_load_dword v53, v26, s[12:15], s60 offen
s_xor_b32 s60, s74, 2670592
buffer_load_dword v54, v26, s[12:15], s60 offen
s_xor_b32 s60, s74, 2678784
buffer_load_dword v55, v26, s[12:15], s60 offen
s_waitcnt vmcnt(56)
v_perm_b32 v96, v57, v56, s44
v_accvgpr_write_b32 a140, v96
v_perm_b32 v97, v59, v58, s44
v_accvgpr_write_b32 a141, v97
v_perm_b32 v98, v61, v60, s44
v_accvgpr_write_b32 a142, v98
v_perm_b32 v99, v63, v62, s44
v_accvgpr_write_b32 a143, v99
v_perm_b32 v100, v57, v56, s45
v_accvgpr_write_b32 a204, v100
v_perm_b32 v101, v59, v58, s45
v_accvgpr_write_b32 a205, v101
v_perm_b32 v102, v61, v60, s45
v_accvgpr_write_b32 a206, v102
v_perm_b32 v103, v63, v62, s45
v_accvgpr_write_b32 a207, v103
s_xor_b32 s60, s74, 2883584
buffer_load_dword v56, v26, s[12:15], s60 offen
s_xor_b32 s60, s74, 2891776
buffer_load_dword v57, v26, s[12:15], s60 offen
s_xor_b32 s60, s74, 2899968
buffer_load_dword v58, v26, s[12:15], s60 offen
s_xor_b32 s60, s74, 2908160
buffer_load_dword v59, v26, s[12:15], s60 offen
s_xor_b32 s60, s74, 2916352
buffer_load_dword v60, v26, s[12:15], s60 offen
s_xor_b32 s60, s74, 2924544
buffer_load_dword v61, v26, s[12:15], s60 offen
s_xor_b32 s60, s74, 2932736
buffer_load_dword v62, v26, s[12:15], s60 offen
s_xor_b32 s60, s74, 2940928
buffer_load_dword v63, v26, s[12:15], s60 offen
s_waitcnt vmcnt(56)
v_perm_b32 v96, v65, v64, s44
v_accvgpr_write_b32 a144, v96
v_perm_b32 v97, v67, v66, s44
v_accvgpr_write_b32 a145, v97
v_perm_b32 v98, v69, v68, s44
v_accvgpr_write_b32 a146, v98
v_perm_b32 v99, v71, v70, s44
v_accvgpr_write_b32 a147, v99
v_perm_b32 v100, v65, v64, s45
v_accvgpr_write_b32 a208, v100
v_perm_b32 v101, v67, v66, s45
v_accvgpr_write_b32 a209, v101
v_perm_b32 v102, v69, v68, s45
v_accvgpr_write_b32 a210, v102
v_perm_b32 v103, v71, v70, s45
v_accvgpr_write_b32 a211, v103
s_xor_b32 s60, s74, 3145728
buffer_load_dword v64, v26, s[12:15], s60 offen
s_xor_b32 s60, s74, 3153920
buffer_load_dword v65, v26, s[12:15], s60 offen
s_xor_b32 s60, s74, 3162112
buffer_load_dword v66, v26, s[12:15], s60 offen
s_xor_b32 s60, s74, 3170304
buffer_load_dword v67, v26, s[12:15], s60 offen
s_xor_b32 s60, s74, 3178496
buffer_load_dword v68, v26, s[12:15], s60 offen
s_xor_b32 s60, s74, 3186688
buffer_load_dword v69, v26, s[12:15], s60 offen
s_xor_b32 s60, s74, 3194880
buffer_load_dword v70, v26, s[12:15], s60 offen
s_xor_b32 s60, s74, 3203072
buffer_load_dword v71, v26, s[12:15], s60 offen
s_waitcnt vmcnt(56)
v_perm_b32 v96, v73, v72, s44
v_accvgpr_write_b32 a148, v96
v_perm_b32 v97, v75, v74, s44
v_accvgpr_write_b32 a149, v97
v_perm_b32 v98, v77, v76, s44
v_accvgpr_write_b32 a150, v98
v_perm_b32 v99, v79, v78, s44
v_accvgpr_write_b32 a151, v99
v_perm_b32 v100, v73, v72, s45
v_accvgpr_write_b32 a212, v100
v_perm_b32 v101, v75, v74, s45
v_accvgpr_write_b32 a213, v101
v_perm_b32 v102, v77, v76, s45
v_accvgpr_write_b32 a214, v102
v_perm_b32 v103, v79, v78, s45
v_accvgpr_write_b32 a215, v103
s_xor_b32 s60, s74, 3407872
buffer_load_dword v72, v26, s[12:15], s60 offen
s_xor_b32 s60, s74, 3416064
buffer_load_dword v73, v26, s[12:15], s60 offen
s_xor_b32 s60, s74, 3424256
buffer_load_dword v74, v26, s[12:15], s60 offen
s_xor_b32 s60, s74, 3432448
buffer_load_dword v75, v26, s[12:15], s60 offen
s_xor_b32 s60, s74, 3440640
buffer_load_dword v76, v26, s[12:15], s60 offen
s_xor_b32 s60, s74, 3448832
buffer_load_dword v77, v26, s[12:15], s60 offen
s_xor_b32 s60, s74, 3457024
buffer_load_dword v78, v26, s[12:15], s60 offen
s_xor_b32 s60, s74, 3465216
buffer_load_dword v79, v26, s[12:15], s60 offen
s_waitcnt vmcnt(56)
v_perm_b32 v96, v81, v80, s44
v_accvgpr_write_b32 a152, v96
v_perm_b32 v97, v83, v82, s44
v_accvgpr_write_b32 a153, v97
v_perm_b32 v98, v85, v84, s44
v_accvgpr_write_b32 a154, v98
v_perm_b32 v99, v87, v86, s44
v_accvgpr_write_b32 a155, v99
v_perm_b32 v100, v81, v80, s45
v_accvgpr_write_b32 a216, v100
v_perm_b32 v101, v83, v82, s45
v_accvgpr_write_b32 a217, v101
v_perm_b32 v102, v85, v84, s45
v_accvgpr_write_b32 a218, v102
v_perm_b32 v103, v87, v86, s45
v_accvgpr_write_b32 a219, v103
s_xor_b32 s60, s74, 3670016
buffer_load_dword v80, v26, s[12:15], s60 offen
s_xor_b32 s60, s74, 3678208
buffer_load_dword v81, v26, s[12:15], s60 offen
s_xor_b32 s60, s74, 3686400
buffer_load_dword v82, v26, s[12:15], s60 offen
s_xor_b32 s60, s74, 3694592
buffer_load_dword v83, v26, s[12:15], s60 offen
s_xor_b32 s60, s74, 3702784
buffer_load_dword v84, v26, s[12:15], s60 offen
s_xor_b32 s60, s74, 3710976
buffer_load_dword v85, v26, s[12:15], s60 offen
s_xor_b32 s60, s74, 3719168
buffer_load_dword v86, v26, s[12:15], s60 offen
s_xor_b32 s60, s74, 3727360
buffer_load_dword v87, v26, s[12:15], s60 offen
s_waitcnt vmcnt(56)
v_perm_b32 v96, v89, v88, s44
v_accvgpr_write_b32 a156, v96
v_perm_b32 v97, v91, v90, s44
v_accvgpr_write_b32 a157, v97
v_perm_b32 v98, v93, v92, s44
v_accvgpr_write_b32 a158, v98
v_perm_b32 v99, v95, v94, s44
v_accvgpr_write_b32 a159, v99
v_perm_b32 v100, v89, v88, s45
v_accvgpr_write_b32 a220, v100
v_perm_b32 v101, v91, v90, s45
v_accvgpr_write_b32 a221, v101
v_perm_b32 v102, v93, v92, s45
v_accvgpr_write_b32 a222, v102
v_perm_b32 v103, v95, v94, s45
v_accvgpr_write_b32 a223, v103
s_xor_b32 s60, s74, 3932160
buffer_load_dword v88, v26, s[12:15], s60 offen
s_xor_b32 s60, s74, 3940352
buffer_load_dword v89, v26, s[12:15], s60 offen
s_xor_b32 s60, s74, 3948544
buffer_load_dword v90, v26, s[12:15], s60 offen
s_xor_b32 s60, s74, 3956736
buffer_load_dword v91, v26, s[12:15], s60 offen
s_xor_b32 s60, s74, 3964928
buffer_load_dword v92, v26, s[12:15], s60 offen
s_xor_b32 s60, s74, 3973120
buffer_load_dword v93, v26, s[12:15], s60 offen
s_xor_b32 s60, s74, 3981312
buffer_load_dword v94, v26, s[12:15], s60 offen
s_xor_b32 s60, s74, 3989504
buffer_load_dword v95, v26, s[12:15], s60 offen
s_waitcnt vmcnt(56)
v_perm_b32 v96, v33, v32, s44
v_accvgpr_write_b32 a160, v96
v_perm_b32 v97, v35, v34, s44
v_accvgpr_write_b32 a161, v97
v_perm_b32 v98, v37, v36, s44
v_accvgpr_write_b32 a162, v98
v_perm_b32 v99, v39, v38, s44
v_accvgpr_write_b32 a163, v99
v_perm_b32 v100, v33, v32, s45
v_accvgpr_write_b32 a224, v100
v_perm_b32 v101, v35, v34, s45
v_accvgpr_write_b32 a225, v101
v_perm_b32 v102, v37, v36, s45
v_accvgpr_write_b32 a226, v102
v_perm_b32 v103, v39, v38, s45
v_accvgpr_write_b32 a227, v103
s_mov_b32 s12, s24
s_mov_b32 s13, s25
s_mov_b32 s14, 4194304
s_mov_b32 s15, 0x00020000
s_xor_b32 s60, s74, 0
buffer_load_dword v32, v26, s[12:15], s60 offen
s_xor_b32 s60, s74, 8192
buffer_load_dword v33, v26, s[12:15], s60 offen
s_xor_b32 s60, s74, 16384
buffer_load_dword v34, v26, s[12:15], s60 offen
s_xor_b32 s60, s74, 24576
buffer_load_dword v35, v26, s[12:15], s60 offen
s_xor_b32 s60, s74, 32768
buffer_load_dword v36, v26, s[12:15], s60 offen
s_xor_b32 s60, s74, 40960
buffer_load_dword v37, v26, s[12:15], s60 offen
s_xor_b32 s60, s74, 49152
buffer_load_dword v38, v26, s[12:15], s60 offen
s_xor_b32 s60, s74, 57344
buffer_load_dword v39, v26, s[12:15], s60 offen
s_waitcnt vmcnt(56)
v_perm_b32 v96, v41, v40, s44
v_accvgpr_write_b32 a164, v96
v_perm_b32 v97, v43, v42, s44
v_accvgpr_write_b32 a165, v97
v_perm_b32 v98, v45, v44, s44
v_accvgpr_write_b32 a166, v98
v_perm_b32 v99, v47, v46, s44
v_accvgpr_write_b32 a167, v99
v_perm_b32 v100, v41, v40, s45
v_accvgpr_write_b32 a228, v100
v_perm_b32 v101, v43, v42, s45
v_accvgpr_write_b32 a229, v101
v_perm_b32 v102, v45, v44, s45
v_accvgpr_write_b32 a230, v102
v_perm_b32 v103, v47, v46, s45
v_accvgpr_write_b32 a231, v103
s_xor_b32 s60, s74, 262144
buffer_load_dword v40, v26, s[12:15], s60 offen
s_xor_b32 s60, s74, 270336
buffer_load_dword v41, v26, s[12:15], s60 offen
s_xor_b32 s60, s74, 278528
buffer_load_dword v42, v26, s[12:15], s60 offen
s_xor_b32 s60, s74, 286720
buffer_load_dword v43, v26, s[12:15], s60 offen
s_xor_b32 s60, s74, 294912
buffer_load_dword v44, v26, s[12:15], s60 offen
s_xor_b32 s60, s74, 303104
buffer_load_dword v45, v26, s[12:15], s60 offen
s_xor_b32 s60, s74, 311296
buffer_load_dword v46, v26, s[12:15], s60 offen
s_xor_b32 s60, s74, 319488
buffer_load_dword v47, v26, s[12:15], s60 offen
s_waitcnt vmcnt(56)
v_perm_b32 v96, v49, v48, s44
v_accvgpr_write_b32 a168, v96
v_perm_b32 v97, v51, v50, s44
v_accvgpr_write_b32 a169, v97
v_perm_b32 v98, v53, v52, s44
v_accvgpr_write_b32 a170, v98
v_perm_b32 v99, v55, v54, s44
v_accvgpr_write_b32 a171, v99
v_perm_b32 v100, v49, v48, s45
v_accvgpr_write_b32 a232, v100
v_perm_b32 v101, v51, v50, s45
v_accvgpr_write_b32 a233, v101
v_perm_b32 v102, v53, v52, s45
v_accvgpr_write_b32 a234, v102
v_perm_b32 v103, v55, v54, s45
v_accvgpr_write_b32 a235, v103
s_xor_b32 s60, s74, 524288
buffer_load_dword v48, v26, s[12:15], s60 offen
s_xor_b32 s60, s74, 532480
buffer_load_dword v49, v26, s[12:15], s60 offen
s_xor_b32 s60, s74, 540672
buffer_load_dword v50, v26, s[12:15], s60 offen
s_xor_b32 s60, s74, 548864
buffer_load_dword v51, v26, s[12:15], s60 offen
s_xor_b32 s60, s74, 557056
buffer_load_dword v52, v26, s[12:15], s60 offen
s_xor_b32 s60, s74, 565248
buffer_load_dword v53, v26, s[12:15], s60 offen
s_xor_b32 s60, s74, 573440
buffer_load_dword v54, v26, s[12:15], s60 offen
s_xor_b32 s60, s74, 581632
buffer_load_dword v55, v26, s[12:15], s60 offen
s_waitcnt vmcnt(56)
v_perm_b32 v96, v57, v56, s44
v_accvgpr_write_b32 a172, v96
v_perm_b32 v97, v59, v58, s44
v_accvgpr_write_b32 a173, v97
v_perm_b32 v98, v61, v60, s44
v_accvgpr_write_b32 a174, v98
v_perm_b32 v99, v63, v62, s44
v_accvgpr_write_b32 a175, v99
v_perm_b32 v100, v57, v56, s45
v_accvgpr_write_b32 a236, v100
v_perm_b32 v101, v59, v58, s45
v_accvgpr_write_b32 a237, v101
v_perm_b32 v102, v61, v60, s45
v_accvgpr_write_b32 a238, v102
v_perm_b32 v103, v63, v62, s45
v_accvgpr_write_b32 a239, v103
s_xor_b32 s60, s74, 786432
buffer_load_dword v56, v26, s[12:15], s60 offen
s_xor_b32 s60, s74, 794624
buffer_load_dword v57, v26, s[12:15], s60 offen
s_xor_b32 s60, s74, 802816
buffer_load_dword v58, v26, s[12:15], s60 offen
s_xor_b32 s60, s74, 811008
buffer_load_dword v59, v26, s[12:15], s60 offen
s_xor_b32 s60, s74, 819200
buffer_load_dword v60, v26, s[12:15], s60 offen
s_xor_b32 s60, s74, 827392
buffer_load_dword v61, v26, s[12:15], s60 offen
s_xor_b32 s60, s74, 835584
buffer_load_dword v62, v26, s[12:15], s60 offen
s_xor_b32 s60, s74, 843776
buffer_load_dword v63, v26, s[12:15], s60 offen
s_waitcnt vmcnt(56)
v_perm_b32 v96, v65, v64, s44
v_accvgpr_write_b32 a176, v96
v_perm_b32 v97, v67, v66, s44
v_accvgpr_write_b32 a177, v97
v_perm_b32 v98, v69, v68, s44
v_accvgpr_write_b32 a178, v98
v_perm_b32 v99, v71, v70, s44
v_accvgpr_write_b32 a179, v99
v_perm_b32 v100, v65, v64, s45
v_accvgpr_write_b32 a240, v100
v_perm_b32 v101, v67, v66, s45
v_accvgpr_write_b32 a241, v101
v_perm_b32 v102, v69, v68, s45
v_accvgpr_write_b32 a242, v102
v_perm_b32 v103, v71, v70, s45
v_accvgpr_write_b32 a243, v103
s_xor_b32 s60, s74, 1048576
buffer_load_dword v64, v26, s[12:15], s60 offen
s_xor_b32 s60, s74, 1056768
buffer_load_dword v65, v26, s[12:15], s60 offen
s_xor_b32 s60, s74, 1064960
buffer_load_dword v66, v26, s[12:15], s60 offen
s_xor_b32 s60, s74, 1073152
buffer_load_dword v67, v26, s[12:15], s60 offen
s_xor_b32 s60, s74, 1081344
buffer_load_dword v68, v26, s[12:15], s60 offen
s_xor_b32 s60, s74, 1089536
buffer_load_dword v69, v26, s[12:15], s60 offen
s_xor_b32 s60, s74, 1097728
buffer_load_dword v70, v26, s[12:15], s60 offen
s_xor_b32 s60, s74, 1105920
buffer_load_dword v71, v26, s[12:15], s60 offen
s_waitcnt vmcnt(56)
v_perm_b32 v96, v73, v72, s44
v_accvgpr_write_b32 a180, v96
v_perm_b32 v97, v75, v74, s44
v_accvgpr_write_b32 a181, v97
v_perm_b32 v98, v77, v76, s44
v_accvgpr_write_b32 a182, v98
v_perm_b32 v99, v79, v78, s44
v_accvgpr_write_b32 a183, v99
v_perm_b32 v100, v73, v72, s45
v_accvgpr_write_b32 a244, v100
v_perm_b32 v101, v75, v74, s45
v_accvgpr_write_b32 a245, v101
v_perm_b32 v102, v77, v76, s45
v_accvgpr_write_b32 a246, v102
v_perm_b32 v103, v79, v78, s45
v_accvgpr_write_b32 a247, v103
s_xor_b32 s60, s74, 1310720
buffer_load_dword v72, v26, s[12:15], s60 offen
s_xor_b32 s60, s74, 1318912
buffer_load_dword v73, v26, s[12:15], s60 offen
s_xor_b32 s60, s74, 1327104
buffer_load_dword v74, v26, s[12:15], s60 offen
s_xor_b32 s60, s74, 1335296
buffer_load_dword v75, v26, s[12:15], s60 offen
s_xor_b32 s60, s74, 1343488
buffer_load_dword v76, v26, s[12:15], s60 offen
s_xor_b32 s60, s74, 1351680
buffer_load_dword v77, v26, s[12:15], s60 offen
s_xor_b32 s60, s74, 1359872
buffer_load_dword v78, v26, s[12:15], s60 offen
s_xor_b32 s60, s74, 1368064
buffer_load_dword v79, v26, s[12:15], s60 offen
s_waitcnt vmcnt(56)
v_perm_b32 v96, v81, v80, s44
v_accvgpr_write_b32 a184, v96
v_perm_b32 v97, v83, v82, s44
v_accvgpr_write_b32 a185, v97
v_perm_b32 v98, v85, v84, s44
v_accvgpr_write_b32 a186, v98
v_perm_b32 v99, v87, v86, s44
v_accvgpr_write_b32 a187, v99
v_perm_b32 v100, v81, v80, s45
v_accvgpr_write_b32 a248, v100
v_perm_b32 v101, v83, v82, s45
v_accvgpr_write_b32 a249, v101
v_perm_b32 v102, v85, v84, s45
v_accvgpr_write_b32 a250, v102
v_perm_b32 v103, v87, v86, s45
v_accvgpr_write_b32 a251, v103
s_xor_b32 s60, s74, 1572864
buffer_load_dword v80, v26, s[12:15], s60 offen
s_xor_b32 s60, s74, 1581056
buffer_load_dword v81, v26, s[12:15], s60 offen
s_xor_b32 s60, s74, 1589248
buffer_load_dword v82, v26, s[12:15], s60 offen
s_xor_b32 s60, s74, 1597440
buffer_load_dword v83, v26, s[12:15], s60 offen
s_xor_b32 s60, s74, 1605632
buffer_load_dword v84, v26, s[12:15], s60 offen
s_xor_b32 s60, s74, 1613824
buffer_load_dword v85, v26, s[12:15], s60 offen
s_xor_b32 s60, s74, 1622016
buffer_load_dword v86, v26, s[12:15], s60 offen
s_xor_b32 s60, s74, 1630208
buffer_load_dword v87, v26, s[12:15], s60 offen
s_waitcnt vmcnt(56)
v_perm_b32 v96, v89, v88, s44
v_accvgpr_write_b32 a188, v96
v_perm_b32 v97, v91, v90, s44
v_accvgpr_write_b32 a189, v97
v_perm_b32 v98, v93, v92, s44
v_accvgpr_write_b32 a190, v98
v_perm_b32 v99, v95, v94, s44
v_accvgpr_write_b32 a191, v99
v_perm_b32 v100, v89, v88, s45
v_accvgpr_write_b32 a252, v100
v_perm_b32 v101, v91, v90, s45
v_accvgpr_write_b32 a253, v101
v_perm_b32 v102, v93, v92, s45
v_accvgpr_write_b32 a254, v102
v_perm_b32 v103, v95, v94, s45
v_accvgpr_write_b32 a255, v103
s_xor_b32 s60, s74, 1835008
buffer_load_dword v88, v26, s[12:15], s60 offen
s_xor_b32 s60, s74, 1843200
buffer_load_dword v89, v26, s[12:15], s60 offen
s_xor_b32 s60, s74, 1851392
buffer_load_dword v90, v26, s[12:15], s60 offen
s_xor_b32 s60, s74, 1859584
buffer_load_dword v91, v26, s[12:15], s60 offen
s_xor_b32 s60, s74, 1867776
buffer_load_dword v92, v26, s[12:15], s60 offen
s_xor_b32 s60, s74, 1875968
buffer_load_dword v93, v26, s[12:15], s60 offen
s_xor_b32 s60, s74, 1884160
buffer_load_dword v94, v26, s[12:15], s60 offen
s_xor_b32 s60, s74, 1892352
buffer_load_dword v95, v26, s[12:15], s60 offen
s_waitcnt vmcnt(56)
v_perm_b32 v96, v33, v32, s44
v_perm_b32 v97, v35, v34, s44
v_perm_b32 v98, v37, v36, s44
v_perm_b32 v99, v39, v38, s44
v_perm_b32 v100, v33, v32, s45
v_perm_b32 v101, v35, v34, s45
v_perm_b32 v102, v37, v36, s45
v_perm_b32 v103, v39, v38, s45
ds_write_b128 v21, v[96:99] offset:0
ds_write_b128 v21, v[100:103] offset:16384
s_xor_b32 s60, s74, 2097152
buffer_load_dword v32, v26, s[12:15], s60 offen
s_xor_b32 s60, s74, 2105344
buffer_load_dword v33, v26, s[12:15], s60 offen
s_xor_b32 s60, s74, 2113536
buffer_load_dword v34, v26, s[12:15], s60 offen
s_xor_b32 s60, s74, 2121728
buffer_load_dword v35, v26, s[12:15], s60 offen
s_xor_b32 s60, s74, 2129920
buffer_load_dword v36, v26, s[12:15], s60 offen
s_xor_b32 s60, s74, 2138112
buffer_load_dword v37, v26, s[12:15], s60 offen
s_xor_b32 s60, s74, 2146304
buffer_load_dword v38, v26, s[12:15], s60 offen
s_xor_b32 s60, s74, 2154496
buffer_load_dword v39, v26, s[12:15], s60 offen
s_waitcnt vmcnt(56)
v_perm_b32 v96, v41, v40, s44
v_perm_b32 v97, v43, v42, s44
v_perm_b32 v98, v45, v44, s44
v_perm_b32 v99, v47, v46, s44
v_perm_b32 v100, v41, v40, s45
v_perm_b32 v101, v43, v42, s45
v_perm_b32 v102, v45, v44, s45
v_perm_b32 v103, v47, v46, s45
ds_write_b128 v21, v[96:99] offset:1024
ds_write_b128 v21, v[100:103] offset:17408
s_xor_b32 s60, s74, 2359296
buffer_load_dword v40, v26, s[12:15], s60 offen
s_xor_b32 s60, s74, 2367488
buffer_load_dword v41, v26, s[12:15], s60 offen
s_xor_b32 s60, s74, 2375680
buffer_load_dword v42, v26, s[12:15], s60 offen
s_xor_b32 s60, s74, 2383872
buffer_load_dword v43, v26, s[12:15], s60 offen
s_xor_b32 s60, s74, 2392064
buffer_load_dword v44, v26, s[12:15], s60 offen
s_xor_b32 s60, s74, 2400256
buffer_load_dword v45, v26, s[12:15], s60 offen
s_xor_b32 s60, s74, 2408448
buffer_load_dword v46, v26, s[12:15], s60 offen
s_xor_b32 s60, s74, 2416640
buffer_load_dword v47, v26, s[12:15], s60 offen
s_waitcnt vmcnt(56)
v_perm_b32 v96, v49, v48, s44
v_perm_b32 v97, v51, v50, s44
v_perm_b32 v98, v53, v52, s44
v_perm_b32 v99, v55, v54, s44
v_perm_b32 v100, v49, v48, s45
v_perm_b32 v101, v51, v50, s45
v_perm_b32 v102, v53, v52, s45
v_perm_b32 v103, v55, v54, s45
ds_write_b128 v21, v[96:99] offset:2048
ds_write_b128 v21, v[100:103] offset:18432
s_xor_b32 s60, s74, 2621440
buffer_load_dword v48, v26, s[12:15], s60 offen
s_xor_b32 s60, s74, 2629632
buffer_load_dword v49, v26, s[12:15], s60 offen
s_xor_b32 s60, s74, 2637824
buffer_load_dword v50, v26, s[12:15], s60 offen
s_xor_b32 s60, s74, 2646016
buffer_load_dword v51, v26, s[12:15], s60 offen
s_xor_b32 s60, s74, 2654208
buffer_load_dword v52, v26, s[12:15], s60 offen
s_xor_b32 s60, s74, 2662400
buffer_load_dword v53, v26, s[12:15], s60 offen
s_xor_b32 s60, s74, 2670592
buffer_load_dword v54, v26, s[12:15], s60 offen
s_xor_b32 s60, s74, 2678784
buffer_load_dword v55, v26, s[12:15], s60 offen
s_waitcnt vmcnt(56)
v_perm_b32 v96, v57, v56, s44
v_perm_b32 v97, v59, v58, s44
v_perm_b32 v98, v61, v60, s44
v_perm_b32 v99, v63, v62, s44
v_perm_b32 v100, v57, v56, s45
v_perm_b32 v101, v59, v58, s45
v_perm_b32 v102, v61, v60, s45
v_perm_b32 v103, v63, v62, s45
ds_write_b128 v21, v[96:99] offset:3072
ds_write_b128 v21, v[100:103] offset:19456
s_xor_b32 s60, s74, 2883584
buffer_load_dword v56, v26, s[12:15], s60 offen
s_xor_b32 s60, s74, 2891776
buffer_load_dword v57, v26, s[12:15], s60 offen
s_xor_b32 s60, s74, 2899968
buffer_load_dword v58, v26, s[12:15], s60 offen
s_xor_b32 s60, s74, 2908160
buffer_load_dword v59, v26, s[12:15], s60 offen
s_xor_b32 s60, s74, 2916352
buffer_load_dword v60, v26, s[12:15], s60 offen
s_xor_b32 s60, s74, 2924544
buffer_load_dword v61, v26, s[12:15], s60 offen
s_xor_b32 s60, s74, 2932736
buffer_load_dword v62, v26, s[12:15], s60 offen
s_xor_b32 s60, s74, 2940928
buffer_load_dword v63, v26, s[12:15], s60 offen
s_waitcnt vmcnt(56)
v_perm_b32 v96, v65, v64, s44
v_perm_b32 v97, v67, v66, s44
v_perm_b32 v98, v69, v68, s44
v_perm_b32 v99, v71, v70, s44
v_perm_b32 v100, v65, v64, s45
v_perm_b32 v101, v67, v66, s45
v_perm_b32 v102, v69, v68, s45
v_perm_b32 v103, v71, v70, s45
ds_write_b128 v21, v[96:99] offset:4096
ds_write_b128 v21, v[100:103] offset:20480
s_xor_b32 s60, s74, 3145728
buffer_load_dword v64, v26, s[12:15], s60 offen
s_xor_b32 s60, s74, 3153920
buffer_load_dword v65, v26, s[12:15], s60 offen
s_xor_b32 s60, s74, 3162112
buffer_load_dword v66, v26, s[12:15], s60 offen
s_xor_b32 s60, s74, 3170304
buffer_load_dword v67, v26, s[12:15], s60 offen
s_xor_b32 s60, s74, 3178496
buffer_load_dword v68, v26, s[12:15], s60 offen
s_xor_b32 s60, s74, 3186688
buffer_load_dword v69, v26, s[12:15], s60 offen
s_xor_b32 s60, s74, 3194880
buffer_load_dword v70, v26, s[12:15], s60 offen
s_xor_b32 s60, s74, 3203072
buffer_load_dword v71, v26, s[12:15], s60 offen
s_waitcnt vmcnt(56)
v_perm_b32 v96, v73, v72, s44
v_perm_b32 v97, v75, v74, s44
v_perm_b32 v98, v77, v76, s44
v_perm_b32 v99, v79, v78, s44
v_perm_b32 v100, v73, v72, s45
v_perm_b32 v101, v75, v74, s45
v_perm_b32 v102, v77, v76, s45
v_perm_b32 v103, v79, v78, s45
ds_write_b128 v21, v[96:99] offset:5120
ds_write_b128 v21, v[100:103] offset:21504
s_xor_b32 s60, s74, 3407872
buffer_load_dword v72, v26, s[12:15], s60 offen
s_xor_b32 s60, s74, 3416064
buffer_load_dword v73, v26, s[12:15], s60 offen
s_xor_b32 s60, s74, 3424256
buffer_load_dword v74, v26, s[12:15], s60 offen
s_xor_b32 s60, s74, 3432448
buffer_load_dword v75, v26, s[12:15], s60 offen
s_xor_b32 s60, s74, 3440640
buffer_load_dword v76, v26, s[12:15], s60 offen
s_xor_b32 s60, s74, 3448832
buffer_load_dword v77, v26, s[12:15], s60 offen
s_xor_b32 s60, s74, 3457024
buffer_load_dword v78, v26, s[12:15], s60 offen
s_xor_b32 s60, s74, 3465216
buffer_load_dword v79, v26, s[12:15], s60 offen
s_waitcnt vmcnt(56)
v_perm_b32 v96, v81, v80, s44
v_perm_b32 v97, v83, v82, s44
v_perm_b32 v98, v85, v84, s44
v_perm_b32 v99, v87, v86, s44
v_perm_b32 v100, v81, v80, s45
v_perm_b32 v101, v83, v82, s45
v_perm_b32 v102, v85, v84, s45
v_perm_b32 v103, v87, v86, s45
ds_write_b128 v21, v[96:99] offset:6144
ds_write_b128 v21, v[100:103] offset:22528
s_xor_b32 s60, s74, 3670016
buffer_load_dword v80, v26, s[12:15], s60 offen
s_xor_b32 s60, s74, 3678208
buffer_load_dword v81, v26, s[12:15], s60 offen
s_xor_b32 s60, s74, 3686400
buffer_load_dword v82, v26, s[12:15], s60 offen
s_xor_b32 s60, s74, 3694592
buffer_load_dword v83, v26, s[12:15], s60 offen
s_xor_b32 s60, s74, 3702784
buffer_load_dword v84, v26, s[12:15], s60 offen
s_xor_b32 s60, s74, 3710976
buffer_load_dword v85, v26, s[12:15], s60 offen
s_xor_b32 s60, s74, 3719168
buffer_load_dword v86, v26, s[12:15], s60 offen
s_xor_b32 s60, s74, 3727360
buffer_load_dword v87, v26, s[12:15], s60 offen
s_waitcnt vmcnt(56)
v_perm_b32 v96, v89, v88, s44
v_perm_b32 v97, v91, v90, s44
v_perm_b32 v98, v93, v92, s44
v_perm_b32 v99, v95, v94, s44
v_perm_b32 v100, v89, v88, s45
v_perm_b32 v101, v91, v90, s45
v_perm_b32 v102, v93, v92, s45
v_perm_b32 v103, v95, v94, s45
ds_write_b128 v21, v[96:99] offset:7168
ds_write_b128 v21, v[100:103] offset:23552
s_xor_b32 s60, s74, 3932160
buffer_load_dword v88, v26, s[12:15], s60 offen
s_xor_b32 s60, s74, 3940352
buffer_load_dword v89, v26, s[12:15], s60 offen
s_xor_b32 s60, s74, 3948544
buffer_load_dword v90, v26, s[12:15], s60 offen
s_xor_b32 s60, s74, 3956736
buffer_load_dword v91, v26, s[12:15], s60 offen
s_xor_b32 s60, s74, 3964928
buffer_load_dword v92, v26, s[12:15], s60 offen
s_xor_b32 s60, s74, 3973120
buffer_load_dword v93, v26, s[12:15], s60 offen
s_xor_b32 s60, s74, 3981312
buffer_load_dword v94, v26, s[12:15], s60 offen
s_xor_b32 s60, s74, 3989504
buffer_load_dword v95, v26, s[12:15], s60 offen
s_waitcnt vmcnt(56)
v_perm_b32 v96, v33, v32, s44
v_perm_b32 v97, v35, v34, s44
v_perm_b32 v98, v37, v36, s44
v_perm_b32 v99, v39, v38, s44
v_perm_b32 v100, v33, v32, s45
v_perm_b32 v101, v35, v34, s45
v_perm_b32 v102, v37, v36, s45
v_perm_b32 v103, v39, v38, s45
ds_write_b128 v21, v[96:99] offset:8192
ds_write_b128 v21, v[100:103] offset:24576
s_waitcnt vmcnt(48)
v_perm_b32 v96, v41, v40, s44
v_perm_b32 v97, v43, v42, s44
v_perm_b32 v98, v45, v44, s44
v_perm_b32 v99, v47, v46, s44
v_perm_b32 v100, v41, v40, s45
v_perm_b32 v101, v43, v42, s45
v_perm_b32 v102, v45, v44, s45
v_perm_b32 v103, v47, v46, s45
ds_write_b128 v21, v[96:99] offset:9216
ds_write_b128 v21, v[100:103] offset:25600
s_waitcnt vmcnt(40)
v_perm_b32 v96, v49, v48, s44
v_perm_b32 v97, v51, v50, s44
v_perm_b32 v98, v53, v52, s44
v_perm_b32 v99, v55, v54, s44
v_perm_b32 v100, v49, v48, s45
v_perm_b32 v101, v51, v50, s45
v_perm_b32 v102, v53, v52, s45
v_perm_b32 v103, v55, v54, s45
ds_write_b128 v21, v[96:99] offset:10240
ds_write_b128 v21, v[100:103] offset:26624
s_waitcnt vmcnt(32)
v_perm_b32 v96, v57, v56, s44
v_perm_b32 v97, v59, v58, s44
v_perm_b32 v98, v61, v60, s44
v_perm_b32 v99, v63, v62, s44
v_perm_b32 v100, v57, v56, s45
v_perm_b32 v101, v59, v58, s45
v_perm_b32 v102, v61, v60, s45
v_perm_b32 v103, v63, v62, s45
ds_write_b128 v21, v[96:99] offset:11264
ds_write_b128 v21, v[100:103] offset:27648
s_waitcnt vmcnt(24)
v_perm_b32 v96, v65, v64, s44
v_perm_b32 v97, v67, v66, s44
v_perm_b32 v98, v69, v68, s44
v_perm_b32 v99, v71, v70, s44
v_perm_b32 v100, v65, v64, s45
v_perm_b32 v101, v67, v66, s45
v_perm_b32 v102, v69, v68, s45
v_perm_b32 v103, v71, v70, s45
ds_write_b128 v21, v[96:99] offset:12288
ds_write_b128 v21, v[100:103] offset:28672
s_waitcnt vmcnt(16)
v_perm_b32 v96, v73, v72, s44
v_perm_b32 v97, v75, v74, s44
v_perm_b32 v98, v77, v76, s44
v_perm_b32 v99, v79, v78, s44
v_perm_b32 v100, v73, v72, s45
v_perm_b32 v101, v75, v74, s45
v_perm_b32 v102, v77, v76, s45
v_perm_b32 v103, v79, v78, s45
ds_write_b128 v21, v[96:99] offset:13312
ds_write_b128 v21, v[100:103] offset:29696
s_waitcnt vmcnt(8)
v_perm_b32 v96, v81, v80, s44
v_perm_b32 v97, v83, v82, s44
v_perm_b32 v98, v85, v84, s44
v_perm_b32 v99, v87, v86, s44
v_perm_b32 v100, v81, v80, s45
v_perm_b32 v101, v83, v82, s45
v_perm_b32 v102, v85, v84, s45
v_perm_b32 v103, v87, v86, s45
ds_write_b128 v21, v[96:99] offset:14336
ds_write_b128 v21, v[100:103] offset:30720
s_waitcnt vmcnt(0)
v_perm_b32 v96, v89, v88, s44
v_perm_b32 v97, v91, v90, s44
v_perm_b32 v98, v93, v92, s44
v_perm_b32 v99, v95, v94, s44
v_perm_b32 v100, v89, v88, s45
v_perm_b32 v101, v91, v90, s45
v_perm_b32 v102, v93, v92, s45
v_perm_b32 v103, v95, v94, s45
ds_write_b128 v21, v[96:99] offset:15360
ds_write_b128 v21, v[100:103] offset:31744
v_pk_mov_b32 v[32:33], v[128:129], v[128:129] op_sel:[0,1]
v_pk_mov_b32 v[34:35], v[130:131], v[130:131] op_sel:[0,1]
v_pk_mov_b32 v[36:37], v[132:133], v[132:133] op_sel:[0,1]
v_pk_mov_b32 v[38:39], v[134:135], v[134:135] op_sel:[0,1]
v_pk_mov_b32 v[40:41], v[136:137], v[136:137] op_sel:[0,1]
v_pk_mov_b32 v[42:43], v[138:139], v[138:139] op_sel:[0,1]
v_pk_mov_b32 v[44:45], v[140:141], v[140:141] op_sel:[0,1]
v_pk_mov_b32 v[46:47], v[142:143], v[142:143] op_sel:[0,1]
v_pk_mov_b32 v[48:49], v[144:145], v[144:145] op_sel:[0,1]
v_pk_mov_b32 v[50:51], v[146:147], v[146:147] op_sel:[0,1]
v_pk_mov_b32 v[52:53], v[148:149], v[148:149] op_sel:[0,1]
v_pk_mov_b32 v[54:55], v[150:151], v[150:151] op_sel:[0,1]
v_pk_mov_b32 v[56:57], v[152:153], v[152:153] op_sel:[0,1]
v_pk_mov_b32 v[58:59], v[154:155], v[154:155] op_sel:[0,1]
v_pk_mov_b32 v[60:61], v[156:157], v[156:157] op_sel:[0,1]
v_pk_mov_b32 v[62:63], v[158:159], v[158:159] op_sel:[0,1]
v_pk_mov_b32 v[64:65], v[160:161], v[160:161] op_sel:[0,1]
v_pk_mov_b32 v[66:67], v[162:163], v[162:163] op_sel:[0,1]
v_pk_mov_b32 v[68:69], v[164:165], v[164:165] op_sel:[0,1]
v_pk_mov_b32 v[70:71], v[166:167], v[166:167] op_sel:[0,1]
v_pk_mov_b32 v[72:73], v[168:169], v[168:169] op_sel:[0,1]
v_pk_mov_b32 v[74:75], v[170:171], v[170:171] op_sel:[0,1]
v_pk_mov_b32 v[76:77], v[172:173], v[172:173] op_sel:[0,1]
v_pk_mov_b32 v[78:79], v[174:175], v[174:175] op_sel:[0,1]
v_pk_mov_b32 v[80:81], v[176:177], v[176:177] op_sel:[0,1]
v_pk_mov_b32 v[82:83], v[178:179], v[178:179] op_sel:[0,1]
v_pk_mov_b32 v[84:85], v[180:181], v[180:181] op_sel:[0,1]
v_pk_mov_b32 v[86:87], v[182:183], v[182:183] op_sel:[0,1]
v_pk_mov_b32 v[88:89], v[184:185], v[184:185] op_sel:[0,1]
v_pk_mov_b32 v[90:91], v[186:187], v[186:187] op_sel:[0,1]
v_pk_mov_b32 v[92:93], v[188:189], v[188:189] op_sel:[0,1]
v_pk_mov_b32 v[94:95], v[190:191], v[190:191] op_sel:[0,1]
v_perm_b32 v128, v36, v32, s44
v_perm_b32 v129, v44, v40, s44
v_perm_b32 v130, v52, v48, s44
v_perm_b32 v131, v60, v56, s44
v_perm_b32 v136, v36, v32, s45
v_perm_b32 v137, v44, v40, s45
v_perm_b32 v138, v52, v48, s45
v_perm_b32 v139, v60, v56, s45
v_perm_b32 v144, v37, v33, s44
v_perm_b32 v145, v45, v41, s44
v_perm_b32 v146, v53, v49, s44
v_perm_b32 v147, v61, v57, s44
v_perm_b32 v152, v37, v33, s45
v_perm_b32 v153, v45, v41, s45
v_perm_b32 v154, v53, v49, s45
v_perm_b32 v155, v61, v57, s45
v_perm_b32 v160, v38, v34, s44
v_perm_b32 v161, v46, v42, s44
v_perm_b32 v162, v54, v50, s44
v_perm_b32 v163, v62, v58, s44
v_perm_b32 v168, v38, v34, s45
v_perm_b32 v169, v46, v42, s45
v_perm_b32 v170, v54, v50, s45
v_perm_b32 v171, v62, v58, s45
v_perm_b32 v176, v39, v35, s44
v_perm_b32 v177, v47, v43, s44
v_perm_b32 v178, v55, v51, s44
v_perm_b32 v179, v63, v59, s44
v_perm_b32 v184, v39, v35, s45
v_perm_b32 v185, v47, v43, s45
v_perm_b32 v186, v55, v51, s45
v_perm_b32 v187, v63, v59, s45
v_perm_b32 v132, v68, v64, s44
v_perm_b32 v133, v76, v72, s44
v_perm_b32 v134, v84, v80, s44
v_perm_b32 v135, v92, v88, s44
v_perm_b32 v140, v68, v64, s45
v_perm_b32 v141, v76, v72, s45
v_perm_b32 v142, v84, v80, s45
v_perm_b32 v143, v92, v88, s45
v_perm_b32 v148, v69, v65, s44
v_perm_b32 v149, v77, v73, s44
v_perm_b32 v150, v85, v81, s44
v_perm_b32 v151, v93, v89, s44
v_perm_b32 v156, v69, v65, s45
v_perm_b32 v157, v77, v73, s45
v_perm_b32 v158, v85, v81, s45
v_perm_b32 v159, v93, v89, s45
v_perm_b32 v164, v70, v66, s44
v_perm_b32 v165, v78, v74, s44
v_perm_b32 v166, v86, v82, s44
v_perm_b32 v167, v94, v90, s44
v_perm_b32 v172, v70, v66, s45
v_perm_b32 v173, v78, v74, s45
v_perm_b32 v174, v86, v82, s45
v_perm_b32 v175, v94, v90, s45
v_perm_b32 v180, v71, v67, s44
v_perm_b32 v181, v79, v75, s44
v_perm_b32 v182, v87, v83, s44
v_perm_b32 v183, v95, v91, s44
v_perm_b32 v188, v71, v67, s45
v_perm_b32 v189, v79, v75, s45
v_perm_b32 v190, v87, v83, s45
v_perm_b32 v191, v95, v91, s45
v_pk_mov_b32 v[32:33], v[192:193], v[192:193] op_sel:[0,1]
v_pk_mov_b32 v[34:35], v[194:195], v[194:195] op_sel:[0,1]
v_pk_mov_b32 v[36:37], v[196:197], v[196:197] op_sel:[0,1]
v_pk_mov_b32 v[38:39], v[198:199], v[198:199] op_sel:[0,1]
v_pk_mov_b32 v[40:41], v[200:201], v[200:201] op_sel:[0,1]
v_pk_mov_b32 v[42:43], v[202:203], v[202:203] op_sel:[0,1]
v_pk_mov_b32 v[44:45], v[204:205], v[204:205] op_sel:[0,1]
v_pk_mov_b32 v[46:47], v[206:207], v[206:207] op_sel:[0,1]
v_pk_mov_b32 v[48:49], v[208:209], v[208:209] op_sel:[0,1]
v_pk_mov_b32 v[50:51], v[210:211], v[210:211] op_sel:[0,1]
v_pk_mov_b32 v[52:53], v[212:213], v[212:213] op_sel:[0,1]
v_pk_mov_b32 v[54:55], v[214:215], v[214:215] op_sel:[0,1]
v_pk_mov_b32 v[56:57], v[216:217], v[216:217] op_sel:[0,1]
v_pk_mov_b32 v[58:59], v[218:219], v[218:219] op_sel:[0,1]
v_pk_mov_b32 v[60:61], v[220:221], v[220:221] op_sel:[0,1]
v_pk_mov_b32 v[62:63], v[222:223], v[222:223] op_sel:[0,1]
v_pk_mov_b32 v[64:65], v[224:225], v[224:225] op_sel:[0,1]
v_pk_mov_b32 v[66:67], v[226:227], v[226:227] op_sel:[0,1]
v_pk_mov_b32 v[68:69], v[228:229], v[228:229] op_sel:[0,1]
v_pk_mov_b32 v[70:71], v[230:231], v[230:231] op_sel:[0,1]
v_pk_mov_b32 v[72:73], v[232:233], v[232:233] op_sel:[0,1]
v_pk_mov_b32 v[74:75], v[234:235], v[234:235] op_sel:[0,1]
v_pk_mov_b32 v[76:77], v[236:237], v[236:237] op_sel:[0,1]
v_pk_mov_b32 v[78:79], v[238:239], v[238:239] op_sel:[0,1]
v_pk_mov_b32 v[80:81], v[240:241], v[240:241] op_sel:[0,1]
v_pk_mov_b32 v[82:83], v[242:243], v[242:243] op_sel:[0,1]
v_pk_mov_b32 v[84:85], v[244:245], v[244:245] op_sel:[0,1]
v_pk_mov_b32 v[86:87], v[246:247], v[246:247] op_sel:[0,1]
v_pk_mov_b32 v[88:89], v[248:249], v[248:249] op_sel:[0,1]
v_pk_mov_b32 v[90:91], v[250:251], v[250:251] op_sel:[0,1]
v_pk_mov_b32 v[92:93], v[252:253], v[252:253] op_sel:[0,1]
v_pk_mov_b32 v[94:95], v[254:255], v[254:255] op_sel:[0,1]
v_perm_b32 v192, v36, v32, s44
v_perm_b32 v193, v44, v40, s44
v_perm_b32 v194, v52, v48, s44
v_perm_b32 v195, v60, v56, s44
v_perm_b32 v200, v36, v32, s45
v_perm_b32 v201, v44, v40, s45
v_perm_b32 v202, v52, v48, s45
v_perm_b32 v203, v60, v56, s45
v_perm_b32 v208, v37, v33, s44
v_perm_b32 v209, v45, v41, s44
v_perm_b32 v210, v53, v49, s44
v_perm_b32 v211, v61, v57, s44
v_perm_b32 v216, v37, v33, s45
v_perm_b32 v217, v45, v41, s45
v_perm_b32 v218, v53, v49, s45
v_perm_b32 v219, v61, v57, s45
v_perm_b32 v224, v38, v34, s44
v_perm_b32 v225, v46, v42, s44
v_perm_b32 v226, v54, v50, s44
v_perm_b32 v227, v62, v58, s44
v_perm_b32 v232, v38, v34, s45
v_perm_b32 v233, v46, v42, s45
v_perm_b32 v234, v54, v50, s45
v_perm_b32 v235, v62, v58, s45
v_perm_b32 v240, v39, v35, s44
v_perm_b32 v241, v47, v43, s44
v_perm_b32 v242, v55, v51, s44
v_perm_b32 v243, v63, v59, s44
v_perm_b32 v248, v39, v35, s45
v_perm_b32 v249, v47, v43, s45
v_perm_b32 v250, v55, v51, s45
v_perm_b32 v251, v63, v59, s45
v_perm_b32 v196, v68, v64, s44
v_perm_b32 v197, v76, v72, s44
v_perm_b32 v198, v84, v80, s44
v_perm_b32 v199, v92, v88, s44
v_perm_b32 v204, v68, v64, s45
v_perm_b32 v205, v76, v72, s45
v_perm_b32 v206, v84, v80, s45
v_perm_b32 v207, v92, v88, s45
v_perm_b32 v212, v69, v65, s44
v_perm_b32 v213, v77, v73, s44
v_perm_b32 v214, v85, v81, s44
v_perm_b32 v215, v93, v89, s44
v_perm_b32 v220, v69, v65, s45
v_perm_b32 v221, v77, v73, s45
v_perm_b32 v222, v85, v81, s45
v_perm_b32 v223, v93, v89, s45
v_perm_b32 v228, v70, v66, s44
v_perm_b32 v229, v78, v74, s44
v_perm_b32 v230, v86, v82, s44
v_perm_b32 v231, v94, v90, s44
v_perm_b32 v236, v70, v66, s45
v_perm_b32 v237, v78, v74, s45
v_perm_b32 v238, v86, v82, s45
v_perm_b32 v239, v94, v90, s45
v_perm_b32 v244, v71, v67, s44
v_perm_b32 v245, v79, v75, s44
v_perm_b32 v246, v87, v83, s44
v_perm_b32 v247, v95, v91, s44
v_perm_b32 v252, v71, v67, s45
v_perm_b32 v253, v79, v75, s45
v_perm_b32 v254, v87, v83, s45
v_perm_b32 v255, v95, v91, s45
s_mov_b32 s12, s18
s_mov_b32 s13, s19
s_mov_b32 s14, 8192
s_mov_b32 s15, 0x00020000
v_and_b32 v26, 7, v0
v_lshlrev_b32 v26, 10, v26
v_lshl_add_u32 v26, v25, 5, v26
s_lshl_b32 s60, s47, 8
buffer_load_dwordx4 v[32:35], v26, s[12:15], s60 offen
buffer_load_dwordx4 v[36:39], v26, s[12:15], s60 offen offset:16
buffer_load_dwordx4 v[40:43], v26, s[12:15], s60 offen offset:128
buffer_load_dwordx4 v[44:47], v26, s[12:15], s60 offen offset:144
v_mov_b32 v28, s44
v_mov_b32 v29, s45
v_cmp_gt_u32 vcc, 8, v24
s_nop 1
v_cndmask_b32 v28, v29, v28, vcc
s_lshl_b32 s60, s47, 11
v_add_u32 v29, s60, v20
s_waitcnt vmcnt(0)
v_perm_b32 v64, v33, v32, v28
v_perm_b32 v65, v35, v34, v28
v_perm_b32 v66, v37, v36, v28
v_perm_b32 v67, v39, v38, v28
ds_write_b128 v29, v[64:67] offset:0
v_perm_b32 v68, v41, v40, v28
v_perm_b32 v69, v43, v42, v28
v_perm_b32 v70, v45, v44, v28
v_perm_b32 v71, v47, v46, v28
ds_write_b128 v29, v[68:71] offset:1024
v_and_b32 v28, 1, v0
v_lshlrev_b32 v28, 4, v28
v_mov_b32 v29, 0x3c00
v_lshlrev_b32 v28, v28, v29
v_bfe_u32 v29, v0, 1, 2
v_cmp_eq_u32 vcc, 0, v29
s_nop 1
v_cndmask_b32 v32, 0, v28, vcc
v_cmp_eq_u32 vcc, 1, v29
s_nop 1
v_cndmask_b32 v33, 0, v28, vcc
v_cmp_eq_u32 vcc, 2, v29
s_nop 1
v_cndmask_b32 v34, 0, v28, vcc
v_cmp_eq_u32 vcc, 3, v29
s_nop 1
v_cndmask_b32 v35, 0, v28, vcc
ds_write_b128 v20, v[32:35] offset:23552
s_nop 0
s_cmp_eq_u32 s57, 1
s_cbranch_scc1 L_C1_main
L_C0_main:
s_mov_b64 exec, 1
v_mov_b32 v33, 136
s_nop 1
Lgb_22:
buffer_load_dword v32, v33, s[8:11], 0 offen sc1
s_memtime s[60:61]
s_waitcnt lgkmcnt(0)
s_sub_u32 s60, s60, s46
s_mov_b32 s61, 2
s_cmp_gt_u32 s60, 67108864
s_cbranch_scc1 L_abortC
s_waitcnt vmcnt(0)
v_readfirstlane_b32 s60, v32
s_and_b32 s61, s60, 0xffff
s_cmp_lt_u32 s61, 256
s_cbranch_scc1 Lgb_22
s_mov_b64 exec, -1
s_cmp_lt_u32 s60, 0x10000
s_cselect_b32 s63, 1, 0
s_lshl_b32 s60, s58, 2
s_add_u32 s60, s60, s47
s_add_u32 s60, s60, 0
s_lshl_b32 s64, s60, 12
s_add_u32 s64, s64, 33554432
s_lshl_b32 s72, s60, 11
s_add_u32 s72, s72, 100663296
s_mov_b32 s71, s72
s_lshl_b32 s73, s60, 2
s_add_u32 s73, s73, 65536
s_lshl_b32 s66, s47, 11
s_add_u32 s66, s66, 234881024
s_lshl_b32 s67, s47, 16
s_lshl_b32 s60, s58, 8
s_add_u32 s67, s67, s60
s_add_u32 s67, s67, 2097152
s_lshl_b32 s68, s58, 13
s_lshl_b32 s60, s47, 6
s_add_u32 s68, s68, s60
s_add_u32 s68, s68, 2097152
s_mov_b32 s62, 0
v_mov_b32 v31, 0
s_mov_b64 exec, 1
s_branch Lpoll_24
Lpoll_23:
s_sleep 1
Lpoll_24:
buffer_load_dword v32, v31, s[4:7], s73 offen offset:0 sc1
s_memtime s[60:61]
s_waitcnt lgkmcnt(0)
s_sub_u32 s60, s60, s46
s_mov_b32 s61, 20
s_cmp_gt_u32 s60, 67108864
s_cbranch_scc1 L_abortC
s_waitcnt vmcnt(0)
v_cmp_eq_u32 vcc, 0, v32
s_cbranch_vccnz Lpoll_23
s_mov_b64 exec, -1
v_cmp_eq_u32 vcc, 0, v0
s_nop 1
v_cndmask_b32 v23, 0, 1, vcc
v_bfe_u32 v24, v0, 3, 1
v_mul_u32_u24 v24, 3200, v24
v_and_b32 v25, 0x37, v0
v_lshl_add_u32 v24, v25, 4, v24
v_add_u32 v22, 139264, v24
s_mul_i32 s96, s47, 3200
s_add_u32 s96, s96, 8192
s_add_u32 s78, s68, 0x80000
s_add_u32 s76, s78, 4096
v_pk_mov_b32 v[40:41], 0, 0
v_pk_mov_b32 v[42:43], 0, 0
v_pk_mov_b32 v[44:45], 0, 0
v_pk_mov_b32 v[46:47], 0, 0
v_pk_mov_b32 v[48:49], 0, 0
v_pk_mov_b32 v[50:51], 0, 0
v_pk_mov_b32 v[52:53], 0, 0
v_pk_mov_b32 v[54:55], 0, 0
v_pk_mov_b32 v[56:57], 0, 0
v_pk_mov_b32 v[58:59], 0, 0
v_pk_mov_b32 v[60:61], 0, 0
v_pk_mov_b32 v[62:63], 0, 0
ds_read_b128 v[80:83], v21 offset:0
ds_read_b128 v[84:87], v21 offset:1024
ds_read_b128 v[88:91], v21 offset:16384
ds_read_b128 v[92:95], v21 offset:17408
ds_read_b128 v[96:99], v21 offset:2048
ds_read_b128 v[100:103], v21 offset:3072
ds_read_b128 v[104:107], v21 offset:18432
ds_read_b128 v[108:111], v21 offset:19456
ds_read_b128 v[112:115], v21 offset:4096
ds_read_b128 v[116:119], v21 offset:5120
ds_read_b128 v[120:123], v21 offset:20480
ds_read_b128 v[124:127], v21 offset:21504
s_waitcnt lgkmcnt(0)
s_branch L_C0_B1
L_C0_loop:
s_nop 15
s_nop 15
L_C0_pub:
buffer_load_dwordx4 v[64:67], v1, s[4:7], s66 offen sc1
buffer_load_dwordx4 v[68:71], v1, s[4:7], s66 offen offset:1024 sc1
s_memtime s[60:61]
s_waitcnt lgkmcnt(0)
s_sub_u32 s60, s60, s46
s_mov_b32 s61, 21
s_cmp_gt_u32 s60, 67108864
s_cbranch_scc1 L_abortC
s_waitcnt vmcnt(0)
v_max3_u32 v24, v64, v65, v66
v_max3_u32 v25, v67, v68, v69
v_max3_u32 v24, v24, v70, v71
v_max_u32 v24, v24, v25
v_cmpx_eq_u32 vcc, -1, v24
s_cbranch_vccnz L_C0_pub
s_mov_b64 exec, -1
ds_write_b128 v3, v[64:67]
ds_write_b128 v3, v[68:71] offset:1024
L_C0_B1:
buffer_load_dwordx4 v[72:75], v1, s[4:7], s64 offen offset:0 sc1
buffer_load_dwordx4 v[76:79], v1, s[4:7], s64 offen offset:1024 sc1
v_xor_b32 v14, 0x800, v3
v_xor_b32 v15, 0x1000, v3
s_waitcnt lgkmcnt(0)
s_barrier
ds_read_b128 v[24:27], v14 offset:0
ds_read_b128 v[28:31], v14 offset:1024
ds_read_b128 v[32:35], v15 offset:0
ds_read_b128 v[36:39], v15 offset:1024
v_xor_b32 v14, 0x1000, v14
v_smfmac_f32_16x16x64_bf16 v[40:43], v[64:67], a[0:7], v2
v_smfmac_f32_16x16x64_bf16 v[56:59], v[64:67], v[80:87], v2
ds_read_b128 v[80:83], v21 offset:6144
ds_read_b128 v[84:87], v21 offset:7168
v_smfmac_f32_16x16x64_bf16 v[44:47], v[64:67], a[64:71], v2
v_smfmac_f32_16x16x64_bf16 v[48:51], v[64:67], a[128:135], v2
v_smfmac_f32_16x16x64_bf16 v[60:63], v[64:67], v[88:95], v2
ds_read_b128 v[88:91], v21 offset:22528
ds_read_b128 v[92:95], v21 offset:23552
v_smfmac_f32_16x16x64_bf16 v[52:55], v[64:67], a[192:199], v2
v_smfmac_f32_16x16x64_bf16 v[40:43], v[68:71], a[8:15], v2
v_smfmac_f32_16x16x64_bf16 v[56:59], v[68:71], v[96:103], v2
ds_read_b128 v[96:99], v21 offset:8192
ds_read_b128 v[100:103], v21 offset:9216
v_smfmac_f32_16x16x64_bf16 v[44:47], v[68:71], a[72:79], v2
v_smfmac_f32_16x16x64_bf16 v[48:51], v[68:71], a[136:143], v2
v_smfmac_f32_16x16x64_bf16 v[60:63], v[68:71], v[104:111], v2
ds_read_b128 v[104:107], v21 offset:24576
ds_read_b128 v[108:111], v21 offset:25600
v_smfmac_f32_16x16x64_bf16 v[52:55], v[68:71], a[200:207], v2
v_readlane_b32 s60, v23, 0
v_readlane_b32 s65, v23, 8
s_cmp_ge_u32 s62, 63
s_cbranch_scc1 Lnokv_25
s_cmp_lg_u32 s60, 0
s_cbranch_scc1 Lok_26
s_nop 1
Lkvp_28:
buffer_load_dword v23, off, s[4:7], s73 sc1
s_memtime s[60:61]
s_waitcnt lgkmcnt(0)
s_sub_u32 s60, s60, s46
s_mov_b32 s61, 22
s_cmp_gt_u32 s60, 67108864
s_cbranch_scc1 L_abortC
s_waitcnt vmcnt(0)
v_cmp_eq_u32 vcc, 0, v23
s_cbranch_vccnz Lkvp_28
buffer_load_dwordx4 v[72:75], v1, s[4:7], s64 offen offset:0 sc1
buffer_load_dwordx4 v[76:79], v1, s[4:7], s64 offen offset:1024 sc1
s_nop 1
Lok_26:
buffer_load_dwordx4 v[64:67], v1, s[4:7], s64 offen offset:2048 sc1
buffer_load_dwordx4 v[68:71], v1, s[4:7], s64 offen offset:3072 sc1
s_cmp_eq_u32 s65, 0
s_cselect_b32 s60, 0, 524288
s_add_u32 s60, s60, s64
s_and_b32 s60, s60, 0xfe3fffff
v_lshlrev_b32 v23, 2, v1
buffer_load_dword v23, v23, s[4:7], s60 offen sc1
s_nop 0
Lnokv_25:
s_waitcnt lgkmcnt(11)
v_smfmac_f32_16x16x64_bf16 v[40:43], v[24:27], a[16:23], v2
v_smfmac_f32_16x16x64_bf16 v[56:59], v[24:27], v[112:119], v2
ds_read_b128 v[112:115], v21 offset:10240
ds_read_b128 v[116:119], v21 offset:11264
v_smfmac_f32_16x16x64_bf16 v[44:47], v[24:27], a[80:87], v2
v_smfmac_f32_16x16x64_bf16 v[48:51], v[24:27], a[144:151], v2
v_smfmac_f32_16x16x64_bf16 v[60:63], v[24:27], v[120:127], v2
ds_read_b128 v[120:123], v21 offset:26624
ds_read_b128 v[124:127], v21 offset:27648
v_smfmac_f32_16x16x64_bf16 v[52:55], v[24:27], a[208:215], v2
ds_read_b128 v[24:27], v14 offset:0
s_waitcnt lgkmcnt(15)
v_smfmac_f32_16x16x64_bf16 v[40:43], v[28:31], a[24:31], v2
s_waitcnt lgkmcnt(11)
v_smfmac_f32_16x16x64_bf16 v[56:59], v[28:31], v[80:87], v2
ds_read_b128 v[80:83], v21 offset:12288
ds_read_b128 v[84:87], v21 offset:13312
v_smfmac_f32_16x16x64_bf16 v[44:47], v[28:31], a[88:95], v2
v_smfmac_f32_16x16x64_bf16 v[48:51], v[28:31], a[152:159], v2
s_waitcnt lgkmcnt(11)
v_smfmac_f32_16x16x64_bf16 v[60:63], v[28:31], v[88:95], v2
ds_read_b128 v[88:91], v21 offset:28672
ds_read_b128 v[92:95], v21 offset:29696
v_smfmac_f32_16x16x64_bf16 v[52:55], v[28:31], a[216:223], v2
ds_read_b128 v[28:31], v14 offset:1024
v_smfmac_f32_16x16x64_bf16 v[40:43], v[32:35], a[32:39], v2
v_smfmac_f32_16x16x64_bf16 v[44:47], v[32:35], a[96:103], v2
v_smfmac_f32_16x16x64_bf16 v[48:51], v[32:35], a[160:167], v2
v_smfmac_f32_16x16x64_bf16 v[52:55], v[32:35], a[224:231], v2
v_smfmac_f32_16x16x64_bf16 v[40:43], v[36:39], a[40:47], v2
v_smfmac_f32_16x16x64_bf16 v[44:47], v[36:39], a[104:111], v2
v_smfmac_f32_16x16x64_bf16 v[48:51], v[36:39], a[168:175], v2
v_smfmac_f32_16x16x64_bf16 v[52:55], v[36:39], a[232:239], v2
s_waitcnt lgkmcnt(5)
v_smfmac_f32_16x16x64_bf16 v[40:43], v[24:27], a[48:55], v2
v_smfmac_f32_16x16x64_bf16 v[44:47], v[24:27], a[112:119], v2
v_smfmac_f32_16x16x64_bf16 v[48:51], v[24:27], a[176:183], v2
v_smfmac_f32_16x16x64_bf16 v[52:55], v[24:27], a[240:247], v2
s_waitcnt lgkmcnt(0)
v_smfmac_f32_16x16x64_bf16 v[40:43], v[28:31], a[56:63], v2
v_smfmac_f32_16x16x64_bf16 v[44:47], v[28:31], a[120:127], v2
v_smfmac_f32_16x16x64_bf16 v[48:51], v[28:31], a[184:191], v2
v_smfmac_f32_16x16x64_bf16 v[52:55], v[28:31], a[248:255], v2
v_mov_b32 v14, 0
v_mov_b32 v15, 0
v_smfmac_f32_16x16x64_bf16 v[56:59], v[32:35], v[96:103], v2
ds_read_b128 v[96:99], v21 offset:14336
ds_read_b128 v[100:103], v21 offset:15360
v_smfmac_f32_16x16x64_bf16 v[60:63], v[32:35], v[104:111], v2
ds_read_b128 v[104:107], v21 offset:30720
ds_read_b128 v[108:111], v21 offset:31744
v_permlane32_swap_b32 v40, v48
v_add_f32 v40, v40, v48
v_permlane32_swap_b32 v41, v49
v_add_f32 v41, v41, v49
v_permlane32_swap_b32 v42, v50
v_add_f32 v42, v42, v50
v_permlane32_swap_b32 v43, v51
v_add_f32 v43, v43, v51
v_cvt_pk_bf16_f32 v48, v40, v41
v_cvt_pk_bf16_f32 v49, v42, v43
s_nop 1
v_mfma_f32_16x16x16_bf16 v[40:43], v[48:49], v[4:5], 0
v_smfmac_f32_16x16x64_bf16 v[56:59], v[36:39], v[112:119], v2
v_permlane32_swap_b32 v44, v52
v_add_f32 v44, v44, v52
v_permlane32_swap_b32 v45, v53
v_add_f32 v45, v45, v53
v_permlane32_swap_b32 v46, v54
v_add_f32 v46, v46, v54
v_permlane32_swap_b32 v47, v55
v_add_f32 v47, v47, v55
v_cvt_pk_bf16_f32 v52, v44, v45
v_cvt_pk_bf16_f32 v53, v46, v47
s_nop 1
v_mfma_f32_16x16x16_bf16 v[44:47], v[52:53], v[4:5], 0
v_smfmac_f32_16x16x64_bf16 v[60:63], v[36:39], v[120:127], v2
v_smfmac_f32_16x16x64_bf16 v[56:59], v[24:27], v[80:87], v2
s_nop 5
v_cvt_pk_bf16_f32 v52, v40, v44
v_cvt_pk_bf16_f32 v53, v41, v45
v_cvt_pk_bf16_f32 v54, v42, v46
v_cvt_pk_bf16_f32 v55, v43, v47
s_cmp_ge_u32 s62, 63
s_cbranch_scc1 L_C0_last
s_waitcnt vmcnt(3)
v_mfma_f32_16x16x32_bf16 v[40:43], v[52:55], v[52:55], v[6:9]
v_mfma_f32_16x16x32_bf16 v[44:47], v[72:75], v[52:55], 0
v_mfma_f32_16x16x32_bf16 v[48:51], v[76:79], v[52:55], 0
v_smfmac_f32_16x16x64_bf16 v[60:63], v[24:27], v[88:95], v2
s_waitcnt lgkmcnt(2)
v_smfmac_f32_16x16x64_bf16 v[56:59], v[28:31], v[96:103], v2
s_waitcnt lgkmcnt(0)
v_smfmac_f32_16x16x64_bf16 v[60:63], v[28:31], v[104:111], v2
v_add_u32 v76, s96, v20
s_mov_b64 exec, s[92:93]
ds_write_b128 v76, v[40:43] offset:0
ds_write_b128 v76, v[44:47] offset:1024
ds_write_b128 v76, v[48:51] offset:2048
s_mov_b64 exec, -1
s_waitcnt lgkmcnt(0)
s_barrier
ds_read_b128 v[40:43], v22 offset:0
ds_read_b128 v[24:27], v22 offset:6400
ds_read_b128 v[44:47], v22 offset:1024
ds_read_b128 v[28:31], v22 offset:7424
ds_read_b128 v[48:51], v22 offset:2048
ds_read_b128 v[32:35], v22 offset:8448
buffer_store_dwordx4 v[52:55], v1, s[4:7], s72 offen sc1
v_mfma_f32_32x32x8bf16_1k v[96:111], v[14:15], v[14:15], 0
v_cvt_pk_bf16_f32 v80, v56, v57
v_cvt_pk_bf16_f32 v81, v58, v59
v_cvt_pk_bf16_f32 v82, v60, v61
v_cvt_pk_bf16_f32 v83, v62, v63
v_permlane32_swap_b32 v56, v60
v_add_f32 v56, v56, v60
v_permlane32_swap_b32 v57, v61
v_add_f32 v57, v57, v61
v_permlane32_swap_b32 v58, v62
v_add_f32 v58, v58, v62
v_permlane32_swap_b32 v59, v63
v_add_f32 v59, v59, v63
v_cvt_pk_bf16_f32 v84, v56, v57
v_cvt_pk_bf16_f32 v85, v58, v59
v_lshlrev_b32 v86, 3, v0
buffer_store_dwordx2 v[84:85], v86, s[4:7], s72 offen offset:1024 sc1
v_mfma_f32_32x32x8bf16_1k v[112:127], v[14:15], v[14:15], 0
s_waitcnt lgkmcnt(4)
v_pk_add_f32 v[40:41], v[40:41], v[24:25]
v_pk_add_f32 v[42:43], v[42:43], v[26:27]
s_waitcnt lgkmcnt(2)
v_pk_add_f32 v[44:45], v[44:45], v[28:29]
v_pk_add_f32 v[46:47], v[46:47], v[30:31]
s_waitcnt lgkmcnt(0)
v_pk_add_f32 v[48:49], v[48:49], v[32:33]
v_pk_add_f32 v[50:51], v[50:51], v[34:35]
v_add_f32_dpp v40, v40, v40 row_ror:8 row_mask:0xf bank_mask:0xf
v_add_f32_dpp v41, v41, v41 row_ror:8 row_mask:0xf bank_mask:0xf
v_add_f32_dpp v42, v42, v42 row_ror:8 row_mask:0xf bank_mask:0xf
v_add_f32_dpp v43, v43, v43 row_ror:8 row_mask:0xf bank_mask:0xf
v_add_f32_dpp v44, v44, v44 row_ror:8 row_mask:0xf bank_mask:0xf
v_add_f32_dpp v45, v45, v45 row_ror:8 row_mask:0xf bank_mask:0xf
v_add_f32_dpp v46, v46, v46 row_ror:8 row_mask:0xf bank_mask:0xf
v_add_f32_dpp v47, v47, v47 row_ror:8 row_mask:0xf bank_mask:0xf
v_add_f32_dpp v48, v48, v48 row_ror:8 row_mask:0xf bank_mask:0xf
v_add_f32_dpp v49, v49, v49 row_ror:8 row_mask:0xf bank_mask:0xf
v_add_f32_dpp v50, v50, v50 row_ror:8 row_mask:0xf bank_mask:0xf
v_add_f32_dpp v51, v51, v51 row_ror:8 row_mask:0xf bank_mask:0xf
v_max3_f32 v52, v40, v41, v42
v_max3_f32 v53, v43, v44, v45
v_max3_f32 v52, v52, v46, v47
v_max3_f32 v53, v53, v48, v49
v_max3_f32 v52, v52, v50, v51
v_max_f32 v52, v52, v53
v_mov_b32 v53, v52
s_nop 1
v_permlane16_swap_b32 v52, v53
v_max_f32 v52, v52, v53
v_mov_b32 v53, v52
s_nop 1
v_permlane32_swap_b32 v52, v53
v_max_f32 v52, v52, v53
v_mul_f32 v52, s70, v52
v_fma_f32 v40, v40, s70, -v52
v_fma_f32 v41, v41, s70, -v52
v_fma_f32 v42, v42, s70, -v52
v_fma_f32 v43, v43, s70, -v52
v_fma_f32 v44, v44, s70, -v52
v_fma_f32 v45, v45, s70, -v52
v_fma_f32 v46, v46, s70, -v52
v_fma_f32 v47, v47, s70, -v52
v_fma_f32 v48, v48, s70, -v52
v_fma_f32 v49, v49, s70, -v52
v_fma_f32 v50, v50, s70, -v52
v_fma_f32 v51, v51, s70, -v52
v_exp_f32 v40, v40
v_exp_f32 v41, v41
v_exp_f32 v42, v42
v_exp_f32 v43, v43
v_exp_f32 v44, v44
v_exp_f32 v45, v45
v_exp_f32 v46, v46
v_exp_f32 v47, v47
v_exp_f32 v48, v48
v_exp_f32 v49, v49
v_exp_f32 v50, v50
v_exp_f32 v51, v51
v_cvt_pk_bf16_f32 v76, v40, v41
v_cvt_pk_bf16_f32 v77, v42, v43
v_cvt_pk_bf16_f32 v72, v44, v45
v_cvt_pk_bf16_f32 v73, v46, v47
v_cvt_pk_bf16_f32 v74, v48, v49
v_cvt_pk_bf16_f32 v75, v50, v51
v_mov_b32 v78, v76
v_mov_b32 v79, v77
v_mfma_f32_16x16x16_bf16 v[40:43], v[10:11], v[76:77], 0
v_mov_b32 v52, v76
v_mov_b32 v53, v77
s_nop 0
v_permlane32_swap_b32 v52, v78
v_permlane32_swap_b32 v53, v79
s_waitcnt vmcnt(3)
v_mfma_f32_16x16x32_bf16 v[44:47], v[64:67], v[72:75], 0
v_mfma_f32_16x16x32_bf16 v[48:51], v[68:71], v[72:75], 0
v_mfma_f32_16x16x32_bf16 v[40:43], v[10:13], v[72:75], v[40:43]
s_nop 3
v_mfma_f32_16x16x16_bf16 v[44:47], v[80:81], v[78:79], v[44:47]
v_mfma_f32_16x16x16_bf16 v[48:51], v[82:83], v[78:79], v[48:51]
s_nop 1
v_rcp_f32 v40, v40
s_nop 3
v_pk_mul_f32 v[44:45], v[44:45], v[40:41] op_sel_hi:[1,0]
v_pk_mul_f32 v[46:47], v[46:47], v[40:41] op_sel_hi:[1,0]
v_pk_mul_f32 v[48:49], v[48:49], v[40:41] op_sel_hi:[1,0]
v_pk_mul_f32 v[50:51], v[50:51], v[40:41] op_sel_hi:[1,0]
v_cvt_pk_bf16_f32 v88, v44, v45
v_cvt_pk_bf16_f32 v89, v46, v47
v_cvt_pk_bf16_f32 v90, v48, v49
v_cvt_pk_bf16_f32 v91, v50, v51
s_mov_b64 exec, s[92:93]
ds_write_b64 v19, v[88:89] offset:0
ds_write_b64 v19, v[90:91] offset:128
s_mov_b64 exec, -1
s_waitcnt lgkmcnt(0)
s_barrier
ds_read_b128 v[24:27], v20 offset:21504
ds_read_b128 v[28:31], v20 offset:22528
s_and_b32 s60, s62, 1
s_lshl_b32 s60, s60, 19
s_add_u32 s74, s67, s60
s_add_u32 s75, s74, 0x8000
s_add_u32 s78, s68, s60
s_add_u32 s76, s78, 4096
s_waitcnt lgkmcnt(1)
v_smfmac_f32_16x16x64_bf16 v[96:99], v[24:27], v[128:135], v2
s_waitcnt lgkmcnt(0)
v_smfmac_f32_16x16x64_bf16 v[96:99], v[28:31], v[192:199], v2
v_smfmac_f32_16x16x64_bf16 v[100:103], v[24:27], v[136:143], v2
s_mov_b64 exec, 0x101
buffer_load_dword v23, v17, s[4:7], s73 offen offset:512 sc1
s_mov_b64 exec, -1
v_smfmac_f32_16x16x64_bf16 v[100:103], v[28:31], v[200:207], v2
v_smfmac_f32_16x16x64_bf16 v[104:107], v[24:27], v[144:151], v2
v_smfmac_f32_16x16x64_bf16 v[104:107], v[28:31], v[208:215], v2
v_smfmac_f32_16x16x64_bf16 v[108:111], v[24:27], v[152:159], v2
s_nop 4
v_permlane32_swap_b32 v96, v100
v_add_f32 v40, v96, v100
v_smfmac_f32_16x16x64_bf16 v[108:111], v[28:31], v[216:223], v2
v_permlane32_swap_b32 v97, v101
v_add_f32 v44, v97, v101
v_permlane32_swap_b32 v98, v102
v_smfmac_f32_16x16x64_bf16 v[112:115], v[24:27], v[160:167], v2
v_add_f32 v48, v98, v102
v_permlane32_swap_b32 v99, v103
v_smfmac_f32_16x16x64_bf16 v[112:115], v[28:31], v[224:231], v2
v_add_f32 v52, v99, v103
v_smfmac_f32_16x16x64_bf16 v[116:119], v[24:27], v[168:175], v2
v_permlane32_swap_b32 v104, v108
v_add_f32 v41, v104, v108
v_smfmac_f32_16x16x64_bf16 v[116:119], v[28:31], v[232:239], v2
v_permlane32_swap_b32 v105, v109
v_add_f32 v45, v105, v109
v_permlane32_swap_b32 v106, v110
v_smfmac_f32_16x16x64_bf16 v[120:123], v[24:27], v[176:183], v2
v_add_f32 v49, v106, v110
v_permlane32_swap_b32 v107, v111
v_smfmac_f32_16x16x64_bf16 v[120:123], v[28:31], v[240:247], v2
v_add_f32 v53, v107, v111
v_cvt_pk_f16_f32 v64, v40, v41
v_cvt_pk_f16_f32 v66, v44, v45
v_smfmac_f32_16x16x64_bf16 v[124:127], v[24:27], v[184:191], v2
v_cvt_pk_f16_f32 v68, v48, v49
v_cvt_pk_f16_f32 v70, v52, v53
v_smfmac_f32_16x16x64_bf16 v[124:127], v[28:31], v[248:255], v2
v_permlane32_swap_b32 v112, v116
v_add_f32 v42, v112, v116
v_permlane32_swap_b32 v113, v117
v_add_f32 v46, v113, v117
v_permlane32_swap_b32 v114, v118
v_add_f32 v50, v114, v118
v_permlane32_swap_b32 v115, v119
v_add_f32 v54, v115, v119
v_permlane32_swap_b32 v120, v124
v_permlane32_swap_b32 v121, v125
v_permlane32_swap_b32 v122, v126
v_permlane32_swap_b32 v123, v127
v_add_f32 v43, v120, v124
v_add_f32 v47, v121, v125
v_add_f32 v51, v122, v126
v_add_f32 v55, v123, v127
v_cvt_pk_f16_f32 v65, v42, v43
v_cvt_pk_f16_f32 v67, v46, v47
v_cvt_pk_f16_f32 v69, v50, v51
v_cvt_pk_f16_f32 v71, v54, v55
s_cmp_eq_u32 s63, 0
s_cbranch_scc1 Lslow_29
buffer_store_dwordx4 v[64:67], v16, s[4:7], s74 offen
buffer_store_dwordx4 v[68:71], v16, s[4:7], s75 offen
s_branch Ljoin_30
Lslow_29:
buffer_store_dwordx4 v[64:67], v16, s[4:7], s74 offen sc1
buffer_store_dwordx4 v[68:71], v16, s[4:7], s75 offen sc1
Ljoin_30:
ds_read_b128 v[72:75], v20 offset:23552
ds_read_b128 v[80:83], v21 offset:0
ds_read_b128 v[84:87], v21 offset:1024
ds_read_b128 v[88:91], v21 offset:16384
ds_read_b128 v[92:95], v21 offset:17408
ds_read_b128 v[96:99], v21 offset:2048
ds_read_b128 v[100:103], v21 offset:3072
ds_read_b128 v[104:107], v21 offset:18432
ds_read_b128 v[108:111], v21 offset:19456
ds_read_b128 v[112:115], v21 offset:4096
ds_read_b128 v[116:119], v21 offset:5120
ds_read_b128 v[120:123], v21 offset:20480
ds_read_b128 v[124:127], v21 offset:21504
v_pk_mov_b32 v[40:41], 0, 0
v_pk_mov_b32 v[42:43], 0, 0
v_pk_mov_b32 v[44:45], 0, 0
v_pk_mov_b32 v[46:47], 0, 0
v_pk_mov_b32 v[48:49], 0, 0
v_pk_mov_b32 v[50:51], 0, 0
v_pk_mov_b32 v[52:53], 0, 0
v_pk_mov_b32 v[54:55], 0, 0
v_pk_mov_b32 v[56:57], 0, 0
v_pk_mov_b32 v[58:59], 0, 0
v_pk_mov_b32 v[60:61], 0, 0
v_pk_mov_b32 v[62:63], 0, 0
v_mov_b32 v32, -1
v_mov_b32 v33, -1
v_mov_b32 v34, -1
v_mov_b32 v35, -1
s_add_u32 s69, s69, 8192
s_and_b32 s69, s69, 0xffff7fff
s_nop 15
s_nop 15
L_C0_red:
buffer_load_dwordx4 v[24:27], v17, s[4:7], s78 offen sc1
buffer_load_dwordx4 v[28:31], v17, s[4:7], s76 offen sc1
s_memtime s[60:61]
s_waitcnt lgkmcnt(0)
s_sub_u32 s60, s60, s46
s_mov_b32 s61, 23
s_cmp_gt_u32 s60, 67108864
s_cbranch_scc1 L_abortC
s_waitcnt vmcnt(0)
v_max3_u32 v76, v24, v25, v26
v_max3_u32 v77, v27, v28, v29
v_max3_u32 v76, v76, v30, v31
v_max_u32 v76, v76, v77
v_cmpx_eq_u32 vcc, -1, v76
s_cbranch_vccnz L_C0_red
s_mov_b64 exec, -1
v_mfma_f32_16x16x32_f16 v[76:79], v[72:75], v[24:27], 0
v_mfma_f32_16x16x32_f16 v[76:79], v[72:75], v[28:31], v[76:79]
s_nop 7
v_add_f32_dpp v76, v76, v76 row_ror:8 row_mask:0xf bank_mask:0xf
v_add_f32_dpp v77, v77, v77 row_ror:8 row_mask:0xf bank_mask:0xf
v_add_f32_dpp v78, v78, v78 row_ror:8 row_mask:0xf bank_mask:0xf
v_add_f32_dpp v79, v79, v79 row_ror:8 row_mask:0xf bank_mask:0xf
v_add_f32_dpp v76, v76, v76 row_ror:4 row_mask:0xf bank_mask:0xf
v_add_f32_dpp v77, v77, v77 row_ror:4 row_mask:0xf bank_mask:0xf
v_add_f32_dpp v78, v78, v78 row_ror:4 row_mask:0xf bank_mask:0xf
v_add_f32_dpp v79, v79, v79 row_ror:4 row_mask:0xf bank_mask:0xf
v_cvt_pk_bf16_f32 v76, v76, v77
v_cvt_pk_bf16_f32 v77, v78, v79
s_mov_b64 exec, s[94:95]
s_cmp_eq_u32 s63, 0
s_cbranch_scc1 Lslow_31
buffer_store_dwordx2 v[76:77], v18, s[4:7], s69 offen
s_mov_b64 exec, 0xf
buffer_store_dwordx4 v[32:35], v1, s[4:7], s77 offen
s_mov_b64 exec, -1
buffer_store_dwordx4 v[32:35], v17, s[4:7], s78 offen
buffer_store_dwordx4 v[32:35], v17, s[4:7], s76 offen
s_branch Ljoin_32
Lslow_31:
buffer_store_dwordx2 v[76:77], v18, s[4:7], s69 offen sc1
s_mov_b64 exec, 0xf
buffer_store_dwordx4 v[32:35], v1, s[4:7], s77 offen sc1
s_mov_b64 exec, -1
buffer_store_dwordx4 v[32:35], v17, s[4:7], s78 offen sc1
buffer_store_dwordx4 v[32:35], v17, s[4:7], s76 offen sc1
Ljoin_32:
s_add_u32 s62, s62, 1
s_add_u32 s66, s66, 8192
s_add_u32 s77, s77, 8192
s_and_b32 s66, s66, 0xffff7fff
s_and_b32 s77, s77, 0xffff7fff
s_add_u32 s64, s64, 524288
s_and_b32 s64, s64, 0xfe3fffff
s_and_b32 s60, s62, 7
s_lshl_b32 s60, s60, 18
s_add_u32 s72, s71, s60
s_add_u32 s73, s73, 512
s_branch L_C0_loop
L_C0_last:
buffer_store_dwordx4 v[52:55], v1, s[4:7], s72 offen sc1
v_smfmac_f32_16x16x64_bf16 v[60:63], v[24:27], v[88:95], v2
s_waitcnt lgkmcnt(2)
v_smfmac_f32_16x16x64_bf16 v[56:59], v[28:31], v[96:103], v2
s_waitcnt lgkmcnt(0)
v_smfmac_f32_16x16x64_bf16 v[60:63], v[28:31], v[104:111], v2
s_nop 7
v_permlane32_swap_b32 v56, v60
v_add_f32 v56, v56, v60
v_permlane32_swap_b32 v57, v61
v_add_f32 v57, v57, v61
v_permlane32_swap_b32 v58, v62
v_add_f32 v58, v58, v62
v_permlane32_swap_b32 v59, v63
v_add_f32 v59, v59, v63
v_cvt_pk_bf16_f32 v84, v56, v57
v_cvt_pk_bf16_f32 v85, v58, v59
v_lshlrev_b32 v86, 3, v0
buffer_store_dwordx2 v[84:85], v86, s[4:7], s72 offen offset:1024 sc1
s_waitcnt vmcnt(0)
s_endpgm
L_C1_main:
s_mov_b64 exec, 1
v_mov_b32 v33, 136
s_nop 1
Lgb_38:
buffer_load_dword v32, v33, s[8:11], 0 offen sc1
s_memtime s[60:61]
s_waitcnt lgkmcnt(0)
s_sub_u32 s60, s60, s46
s_mov_b32 s61, 2
s_cmp_gt_u32 s60, 67108864
s_cbranch_scc1 L_abortC
s_waitcnt vmcnt(0)
v_readfirstlane_b32 s60, v32
s_and_b32 s61, s60, 0xffff
s_cmp_lt_u32 s61, 256
s_cbranch_scc1 Lgb_38
s_mov_b64 exec, -1
s_cmp_lt_u32 s60, 0x10000
s_cselect_b32 s63, 1, 0
s_and_b32 s61, s56, 31
s_lshl_b32 s61, s61, 2
s_add_u32 s61, s61, s47
s_mul_i32 s60, s61, 8192
v_mul_u32_u24 v32, 128, v0
v_add_u32 v32, s60, v32
s_sleep 64
s_sleep 64
s_sleep 64
s_sleep 64
s_sleep 64
s_sleep 64
s_mov_b32 s60, 0x4000000
buffer_load_dword v33, v32, s[4:7], s60 offen sc1
s_waitcnt vmcnt(12)
s_mov_b32 s60, 0x4100000
buffer_load_dword v33, v32, s[4:7], s60 offen sc1
s_waitcnt vmcnt(12)
s_mov_b32 s60, 0x4200000
buffer_load_dword v33, v32, s[4:7], s60 offen sc1
s_waitcnt vmcnt(12)
s_mov_b32 s60, 0x4300000
buffer_load_dword v33, v32, s[4:7], s60 offen sc1
s_waitcnt vmcnt(12)
s_mov_b32 s60, 0x1200000
buffer_load_dword v33, v32, s[4:7], s60 offen sc1
s_waitcnt vmcnt(12)
s_mov_b32 s60, 0x1300000
buffer_load_dword v33, v32, s[4:7], s60 offen sc1
s_waitcnt vmcnt(12)
s_mov_b32 s60, 0x500000
buffer_load_dword v33, v32, s[4:7], s60 offen sc1
s_waitcnt vmcnt(12)
s_mov_b32 s60, 0x900000
buffer_load_dword v33, v32, s[4:7], s60 offen sc1
s_waitcnt vmcnt(12)
s_mov_b32 s60, 0x1400000
buffer_load_dword v33, v32, s[4:7], s60 offen sc1
s_waitcnt vmcnt(12)
s_waitcnt vmcnt(0)
s_lshl_b32 s60, s58, 2
s_add_u32 s60, s60, s47
s_add_u32 s60, s60, 8192
s_lshl_b32 s64, s60, 12
s_add_u32 s64, s64, 33554432
s_lshl_b32 s72, s60, 11
s_add_u32 s72, s72, 85983232
s_mov_b32 s71, s72
s_lshl_b32 s73, s60, 2
s_add_u32 s73, s73, 65536
s_lshl_b32 s66, s47, 11
s_add_u32 s66, s66, 239075328
s_lshl_b32 s67, s47, 16
s_lshl_b32 s60, s58, 8
s_add_u32 s67, s67, s60
s_add_u32 s67, s67, 3145728
s_lshl_b32 s68, s58, 13
s_lshl_b32 s60, s47, 6
s_add_u32 s68, s68, s60
s_add_u32 s68, s68, 3145728
s_mov_b32 s62, 0
v_mov_b32 v31, 0
s_mov_b64 exec, 1
s_branch Lpoll_40
Lpoll_39:
s_sleep 1
Lpoll_40:
buffer_load_dword v32, v31, s[4:7], s73 offen offset:0 sc1
s_memtime s[60:61]
s_waitcnt lgkmcnt(0)
s_sub_u32 s60, s60, s46
s_mov_b32 s61, 20
s_cmp_gt_u32 s60, 67108864
s_cbranch_scc1 L_abortC
s_waitcnt vmcnt(0)
v_cmp_eq_u32 vcc, 0, v32
s_cbranch_vccnz Lpoll_39
s_mov_b64 exec, -1
v_cmp_eq_u32 vcc, 0, v0
s_nop 1
v_cndmask_b32 v23, 0, 1, vcc
v_bfe_u32 v24, v0, 3, 1
v_mul_u32_u24 v24, 3200, v24
v_and_b32 v25, 0x37, v0
v_lshl_add_u32 v24, v25, 4, v24
v_add_u32 v22, 139264, v24
s_mul_i32 s96, s47, 3200
s_add_u32 s96, s96, 8192
s_add_u32 s78, s68, 0x80000
s_add_u32 s76, s78, 4096
v_pk_mov_b32 v[40:41], 0, 0
v_pk_mov_b32 v[42:43], 0, 0
v_pk_mov_b32 v[44:45], 0, 0
v_pk_mov_b32 v[46:47], 0, 0
v_pk_mov_b32 v[48:49], 0, 0
v_pk_mov_b32 v[50:51], 0, 0
v_pk_mov_b32 v[52:53], 0, 0
v_pk_mov_b32 v[54:55], 0, 0
v_pk_mov_b32 v[56:57], 0, 0
v_pk_mov_b32 v[58:59], 0, 0
v_pk_mov_b32 v[60:61], 0, 0
v_pk_mov_b32 v[62:63], 0, 0
ds_read_b128 v[80:83], v21 offset:0
ds_read_b128 v[84:87], v21 offset:1024
ds_read_b128 v[88:91], v21 offset:16384
ds_read_b128 v[92:95], v21 offset:17408
ds_read_b128 v[96:99], v21 offset:2048
ds_read_b128 v[100:103], v21 offset:3072
ds_read_b128 v[104:107], v21 offset:18432
ds_read_b128 v[108:111], v21 offset:19456
ds_read_b128 v[112:115], v21 offset:4096
ds_read_b128 v[116:119], v21 offset:5120
ds_read_b128 v[120:123], v21 offset:20480
ds_read_b128 v[124:127], v21 offset:21504
s_waitcnt lgkmcnt(0)
s_branch L_C1_B1
L_C1_loop:
s_nop 15
s_nop 15
L_C1_pub:
buffer_load_dwordx4 v[64:67], v1, s[4:7], s66 offen sc1
buffer_load_dwordx4 v[68:71], v1, s[4:7], s66 offen offset:1024 sc1
s_memtime s[60:61]
s_waitcnt lgkmcnt(0)
s_sub_u32 s60, s60, s46
s_mov_b32 s61, 21
s_cmp_gt_u32 s60, 67108864
s_cbranch_scc1 L_abortC
s_waitcnt vmcnt(0)
v_max3_u32 v24, v64, v65, v66
v_max3_u32 v25, v67, v68, v69
v_max3_u32 v24, v24, v70, v71
v_max_u32 v24, v24, v25
v_cmpx_eq_u32 vcc, -1, v24
s_cbranch_vccnz L_C1_pub
s_mov_b64 exec, -1
ds_write_b128 v3, v[64:67]
ds_write_b128 v3, v[68:71] offset:1024
L_C1_B1:
buffer_load_dwordx4 v[72:75], v1, s[4:7], s64 offen offset:0 sc1
buffer_load_dwordx4 v[76:79], v1, s[4:7], s64 offen offset:1024 sc1
v_xor_b32 v14, 0x800, v3
v_xor_b32 v15, 0x1000, v3
s_waitcnt lgkmcnt(0)
s_barrier
ds_read_b128 v[24:27], v14 offset:0
ds_read_b128 v[28:31], v14 offset:1024
ds_read_b128 v[32:35], v15 offset:0
ds_read_b128 v[36:39], v15 offset:1024
v_xor_b32 v14, 0x1000, v14
v_smfmac_f32_16x16x64_bf16 v[40:43], v[64:67], a[0:7], v2
v_smfmac_f32_16x16x64_bf16 v[56:59], v[64:67], v[80:87], v2
ds_read_b128 v[80:83], v21 offset:6144
ds_read_b128 v[84:87], v21 offset:7168
v_smfmac_f32_16x16x64_bf16 v[44:47], v[64:67], a[64:71], v2
v_smfmac_f32_16x16x64_bf16 v[48:51], v[64:67], a[128:135], v2
v_smfmac_f32_16x16x64_bf16 v[60:63], v[64:67], v[88:95], v2
ds_read_b128 v[88:91], v21 offset:22528
ds_read_b128 v[92:95], v21 offset:23552
v_smfmac_f32_16x16x64_bf16 v[52:55], v[64:67], a[192:199], v2
v_smfmac_f32_16x16x64_bf16 v[40:43], v[68:71], a[8:15], v2
v_smfmac_f32_16x16x64_bf16 v[56:59], v[68:71], v[96:103], v2
ds_read_b128 v[96:99], v21 offset:8192
ds_read_b128 v[100:103], v21 offset:9216
v_smfmac_f32_16x16x64_bf16 v[44:47], v[68:71], a[72:79], v2
v_smfmac_f32_16x16x64_bf16 v[48:51], v[68:71], a[136:143], v2
v_smfmac_f32_16x16x64_bf16 v[60:63], v[68:71], v[104:111], v2
ds_read_b128 v[104:107], v21 offset:24576
ds_read_b128 v[108:111], v21 offset:25600
v_smfmac_f32_16x16x64_bf16 v[52:55], v[68:71], a[200:207], v2
v_readlane_b32 s60, v23, 0
v_readlane_b32 s65, v23, 8
s_cmp_ge_u32 s62, 63
s_cbranch_scc1 Lnokv_41
s_cmp_lg_u32 s60, 0
s_cbranch_scc1 Lok_42
s_nop 1
Lkvp_44:
buffer_load_dword v23, off, s[4:7], s73 sc1
s_memtime s[60:61]
s_waitcnt lgkmcnt(0)
s_sub_u32 s60, s60, s46
s_mov_b32 s61, 22
s_cmp_gt_u32 s60, 67108864
s_cbranch_scc1 L_abortC
s_waitcnt vmcnt(0)
v_cmp_eq_u32 vcc, 0, v23
s_cbranch_vccnz Lkvp_44
buffer_load_dwordx4 v[72:75], v1, s[4:7], s64 offen offset:0 sc1
buffer_load_dwordx4 v[76:79], v1, s[4:7], s64 offen offset:1024 sc1
s_nop 1
Lok_42:
buffer_load_dwordx4 v[64:67], v1, s[4:7], s64 offen offset:2048 sc1
buffer_load_dwordx4 v[68:71], v1, s[4:7], s64 offen offset:3072 sc1
s_cmp_eq_u32 s65, 0
s_cselect_b32 s60, 0, 524288
s_add_u32 s60, s60, s64
s_and_b32 s60, s60, 0xfe3fffff
v_lshlrev_b32 v23, 2, v1
buffer_load_dword v23, v23, s[4:7], s60 offen sc1
s_nop 0
Lnokv_41:
s_waitcnt lgkmcnt(11)
v_smfmac_f32_16x16x64_bf16 v[40:43], v[24:27], a[16:23], v2
v_smfmac_f32_16x16x64_bf16 v[56:59], v[24:27], v[112:119], v2
ds_read_b128 v[112:115], v21 offset:10240
ds_read_b128 v[116:119], v21 offset:11264
v_smfmac_f32_16x16x64_bf16 v[44:47], v[24:27], a[80:87], v2
v_smfmac_f32_16x16x64_bf16 v[48:51], v[24:27], a[144:151], v2
v_smfmac_f32_16x16x64_bf16 v[60:63], v[24:27], v[120:127], v2
ds_read_b128 v[120:123], v21 offset:26624
ds_read_b128 v[124:127], v21 offset:27648
v_smfmac_f32_16x16x64_bf16 v[52:55], v[24:27], a[208:215], v2
ds_read_b128 v[24:27], v14 offset:0
s_waitcnt lgkmcnt(15)
v_smfmac_f32_16x16x64_bf16 v[40:43], v[28:31], a[24:31], v2
s_waitcnt lgkmcnt(11)
v_smfmac_f32_16x16x64_bf16 v[56:59], v[28:31], v[80:87], v2
ds_read_b128 v[80:83], v21 offset:12288
ds_read_b128 v[84:87], v21 offset:13312
v_smfmac_f32_16x16x64_bf16 v[44:47], v[28:31], a[88:95], v2
v_smfmac_f32_16x16x64_bf16 v[48:51], v[28:31], a[152:159], v2
s_waitcnt lgkmcnt(11)
v_smfmac_f32_16x16x64_bf16 v[60:63], v[28:31], v[88:95], v2
ds_read_b128 v[88:91], v21 offset:28672
ds_read_b128 v[92:95], v21 offset:29696
v_smfmac_f32_16x16x64_bf16 v[52:55], v[28:31], a[216:223], v2
ds_read_b128 v[28:31], v14 offset:1024
v_smfmac_f32_16x16x64_bf16 v[40:43], v[32:35], a[32:39], v2
v_smfmac_f32_16x16x64_bf16 v[44:47], v[32:35], a[96:103], v2
v_smfmac_f32_16x16x64_bf16 v[48:51], v[32:35], a[160:167], v2
v_smfmac_f32_16x16x64_bf16 v[52:55], v[32:35], a[224:231], v2
v_smfmac_f32_16x16x64_bf16 v[40:43], v[36:39], a[40:47], v2
v_smfmac_f32_16x16x64_bf16 v[44:47], v[36:39], a[104:111], v2
v_smfmac_f32_16x16x64_bf16 v[48:51], v[36:39], a[168:175], v2
v_smfmac_f32_16x16x64_bf16 v[52:55], v[36:39], a[232:239], v2
s_waitcnt lgkmcnt(5)
v_smfmac_f32_16x16x64_bf16 v[40:43], v[24:27], a[48:55], v2
v_smfmac_f32_16x16x64_bf16 v[44:47], v[24:27], a[112:119], v2
v_smfmac_f32_16x16x64_bf16 v[48:51], v[24:27], a[176:183], v2
v_smfmac_f32_16x16x64_bf16 v[52:55], v[24:27], a[240:247], v2
s_waitcnt lgkmcnt(0)
v_smfmac_f32_16x16x64_bf16 v[40:43], v[28:31], a[56:63], v2
v_smfmac_f32_16x16x64_bf16 v[44:47], v[28:31], a[120:127], v2
v_smfmac_f32_16x16x64_bf16 v[48:51], v[28:31], a[184:191], v2
v_smfmac_f32_16x16x64_bf16 v[52:55], v[28:31], a[248:255], v2
v_mov_b32 v14, 0
v_mov_b32 v15, 0
v_smfmac_f32_16x16x64_bf16 v[56:59], v[32:35], v[96:103], v2
ds_read_b128 v[96:99], v21 offset:14336
ds_read_b128 v[100:103], v21 offset:15360
v_smfmac_f32_16x16x64_bf16 v[60:63], v[32:35], v[104:111], v2
ds_read_b128 v[104:107], v21 offset:30720
ds_read_b128 v[108:111], v21 offset:31744
v_permlane32_swap_b32 v40, v48
v_add_f32 v40, v40, v48
v_permlane32_swap_b32 v41, v49
v_add_f32 v41, v41, v49
v_permlane32_swap_b32 v42, v50
v_add_f32 v42, v42, v50
v_permlane32_swap_b32 v43, v51
v_add_f32 v43, v43, v51
v_cvt_pk_bf16_f32 v48, v40, v41
v_cvt_pk_bf16_f32 v49, v42, v43
s_nop 1
v_mfma_f32_16x16x16_bf16 v[40:43], v[48:49], v[4:5], 0
v_smfmac_f32_16x16x64_bf16 v[56:59], v[36:39], v[112:119], v2
v_permlane32_swap_b32 v44, v52
v_add_f32 v44, v44, v52
v_permlane32_swap_b32 v45, v53
v_add_f32 v45, v45, v53
v_permlane32_swap_b32 v46, v54
v_add_f32 v46, v46, v54
v_permlane32_swap_b32 v47, v55
v_add_f32 v47, v47, v55
v_cvt_pk_bf16_f32 v52, v44, v45
v_cvt_pk_bf16_f32 v53, v46, v47
s_nop 1
v_mfma_f32_16x16x16_bf16 v[44:47], v[52:53], v[4:5], 0
v_smfmac_f32_16x16x64_bf16 v[60:63], v[36:39], v[120:127], v2
v_smfmac_f32_16x16x64_bf16 v[56:59], v[24:27], v[80:87], v2
s_nop 5
v_cvt_pk_bf16_f32 v52, v40, v44
v_cvt_pk_bf16_f32 v53, v41, v45
v_cvt_pk_bf16_f32 v54, v42, v46
v_cvt_pk_bf16_f32 v55, v43, v47
s_cmp_ge_u32 s62, 63
s_cbranch_scc1 L_C1_last
s_waitcnt vmcnt(3)
v_mfma_f32_16x16x32_bf16 v[40:43], v[52:55], v[52:55], v[6:9]
v_mfma_f32_16x16x32_bf16 v[44:47], v[72:75], v[52:55], 0
v_mfma_f32_16x16x32_bf16 v[48:51], v[76:79], v[52:55], 0
v_smfmac_f32_16x16x64_bf16 v[60:63], v[24:27], v[88:95], v2
s_waitcnt lgkmcnt(2)
v_smfmac_f32_16x16x64_bf16 v[56:59], v[28:31], v[96:103], v2
s_waitcnt lgkmcnt(0)
v_smfmac_f32_16x16x64_bf16 v[60:63], v[28:31], v[104:111], v2
v_add_u32 v76, s96, v20
s_mov_b64 exec, s[92:93]
ds_write_b128 v76, v[40:43] offset:0
ds_write_b128 v76, v[44:47] offset:1024
ds_write_b128 v76, v[48:51] offset:2048
s_mov_b64 exec, -1
s_waitcnt lgkmcnt(0)
s_barrier
ds_read_b128 v[40:43], v22 offset:0
ds_read_b128 v[24:27], v22 offset:6400
ds_read_b128 v[44:47], v22 offset:1024
ds_read_b128 v[28:31], v22 offset:7424
ds_read_b128 v[48:51], v22 offset:2048
ds_read_b128 v[32:35], v22 offset:8448
buffer_store_dwordx4 v[52:55], v1, s[4:7], s72 offen sc1
v_mfma_f32_32x32x8bf16_1k v[96:111], v[14:15], v[14:15], 0
v_cvt_pk_bf16_f32 v80, v56, v57
v_cvt_pk_bf16_f32 v81, v58, v59
v_cvt_pk_bf16_f32 v82, v60, v61
v_cvt_pk_bf16_f32 v83, v62, v63
v_permlane32_swap_b32 v56, v60
v_add_f32 v56, v56, v60
v_permlane32_swap_b32 v57, v61
v_add_f32 v57, v57, v61
v_permlane32_swap_b32 v58, v62
v_add_f32 v58, v58, v62
v_permlane32_swap_b32 v59, v63
v_add_f32 v59, v59, v63
v_cvt_pk_bf16_f32 v84, v56, v57
v_cvt_pk_bf16_f32 v85, v58, v59
v_lshlrev_b32 v86, 3, v0
buffer_store_dwordx2 v[84:85], v86, s[4:7], s72 offen offset:1024 sc1
v_mfma_f32_32x32x8bf16_1k v[112:127], v[14:15], v[14:15], 0
s_waitcnt lgkmcnt(4)
v_pk_add_f32 v[40:41], v[40:41], v[24:25]
v_pk_add_f32 v[42:43], v[42:43], v[26:27]
s_waitcnt lgkmcnt(2)
v_pk_add_f32 v[44:45], v[44:45], v[28:29]
v_pk_add_f32 v[46:47], v[46:47], v[30:31]
s_waitcnt lgkmcnt(0)
v_pk_add_f32 v[48:49], v[48:49], v[32:33]
v_pk_add_f32 v[50:51], v[50:51], v[34:35]
v_add_f32_dpp v40, v40, v40 row_ror:8 row_mask:0xf bank_mask:0xf
v_add_f32_dpp v41, v41, v41 row_ror:8 row_mask:0xf bank_mask:0xf
v_add_f32_dpp v42, v42, v42 row_ror:8 row_mask:0xf bank_mask:0xf
v_add_f32_dpp v43, v43, v43 row_ror:8 row_mask:0xf bank_mask:0xf
v_add_f32_dpp v44, v44, v44 row_ror:8 row_mask:0xf bank_mask:0xf
v_add_f32_dpp v45, v45, v45 row_ror:8 row_mask:0xf bank_mask:0xf
v_add_f32_dpp v46, v46, v46 row_ror:8 row_mask:0xf bank_mask:0xf
v_add_f32_dpp v47, v47, v47 row_ror:8 row_mask:0xf bank_mask:0xf
v_add_f32_dpp v48, v48, v48 row_ror:8 row_mask:0xf bank_mask:0xf
v_add_f32_dpp v49, v49, v49 row_ror:8 row_mask:0xf bank_mask:0xf
v_add_f32_dpp v50, v50, v50 row_ror:8 row_mask:0xf bank_mask:0xf
v_add_f32_dpp v51, v51, v51 row_ror:8 row_mask:0xf bank_mask:0xf
v_max3_f32 v52, v40, v41, v42
v_max3_f32 v53, v43, v44, v45
v_max3_f32 v52, v52, v46, v47
v_max3_f32 v53, v53, v48, v49
v_max3_f32 v52, v52, v50, v51
v_max_f32 v52, v52, v53
v_mov_b32 v53, v52
s_nop 1
v_permlane16_swap_b32 v52, v53
v_max_f32 v52, v52, v53
v_mov_b32 v53, v52
s_nop 1
v_permlane32_swap_b32 v52, v53
v_max_f32 v52, v52, v53
v_mul_f32 v52, s70, v52
v_fma_f32 v40, v40, s70, -v52
v_fma_f32 v41, v41, s70, -v52
v_fma_f32 v42, v42, s70, -v52
v_fma_f32 v43, v43, s70, -v52
v_fma_f32 v44, v44, s70, -v52
v_fma_f32 v45, v45, s70, -v52
v_fma_f32 v46, v46, s70, -v52
v_fma_f32 v47, v47, s70, -v52
v_fma_f32 v48, v48, s70, -v52
v_fma_f32 v49, v49, s70, -v52
v_fma_f32 v50, v50, s70, -v52
v_fma_f32 v51, v51, s70, -v52
v_exp_f32 v40, v40
v_exp_f32 v41, v41
v_exp_f32 v42, v42
v_exp_f32 v43, v43
v_exp_f32 v44, v44
v_exp_f32 v45, v45
v_exp_f32 v46, v46
v_exp_f32 v47, v47
v_exp_f32 v48, v48
v_exp_f32 v49, v49
v_exp_f32 v50, v50
v_exp_f32 v51, v51
v_cvt_pk_bf16_f32 v76, v40, v41
v_cvt_pk_bf16_f32 v77, v42, v43
v_cvt_pk_bf16_f32 v72, v44, v45
v_cvt_pk_bf16_f32 v73, v46, v47
v_cvt_pk_bf16_f32 v74, v48, v49
v_cvt_pk_bf16_f32 v75, v50, v51
v_mov_b32 v78, v76
v_mov_b32 v79, v77
v_mfma_f32_16x16x16_bf16 v[40:43], v[10:11], v[76:77], 0
v_mov_b32 v52, v76
v_mov_b32 v53, v77
s_nop 0
v_permlane32_swap_b32 v52, v78
v_permlane32_swap_b32 v53, v79
s_waitcnt vmcnt(3)
v_mfma_f32_16x16x32_bf16 v[44:47], v[64:67], v[72:75], 0
v_mfma_f32_16x16x32_bf16 v[48:51], v[68:71], v[72:75], 0
v_mfma_f32_16x16x32_bf16 v[40:43], v[10:13], v[72:75], v[40:43]
s_nop 3
v_mfma_f32_16x16x16_bf16 v[44:47], v[80:81], v[78:79], v[44:47]
v_mfma_f32_16x16x16_bf16 v[48:51], v[82:83], v[78:79], v[48:51]
s_nop 1
v_rcp_f32 v40, v40
s_nop 3
v_pk_mul_f32 v[44:45], v[44:45], v[40:41] op_sel_hi:[1,0]
v_pk_mul_f32 v[46:47], v[46:47], v[40:41] op_sel_hi:[1,0]
v_pk_mul_f32 v[48:49], v[48:49], v[40:41] op_sel_hi:[1,0]
v_pk_mul_f32 v[50:51], v[50:51], v[40:41] op_sel_hi:[1,0]
v_cvt_pk_bf16_f32 v88, v44, v45
v_cvt_pk_bf16_f32 v89, v46, v47
v_cvt_pk_bf16_f32 v90, v48, v49
v_cvt_pk_bf16_f32 v91, v50, v51
s_mov_b64 exec, s[92:93]
ds_write_b64 v19, v[88:89] offset:0
ds_write_b64 v19, v[90:91] offset:128
s_mov_b64 exec, -1
s_waitcnt lgkmcnt(0)
s_barrier
ds_read_b128 v[24:27], v20 offset:21504
ds_read_b128 v[28:31], v20 offset:22528
s_and_b32 s60, s62, 1
s_lshl_b32 s60, s60, 19
s_add_u32 s74, s67, s60
s_add_u32 s75, s74, 0x8000
s_add_u32 s78, s68, s60
s_add_u32 s76, s78, 4096
s_waitcnt lgkmcnt(1)
v_smfmac_f32_16x16x64_bf16 v[96:99], v[24:27], v[128:135], v2
s_waitcnt lgkmcnt(0)
v_smfmac_f32_16x16x64_bf16 v[96:99], v[28:31], v[192:199], v2
v_smfmac_f32_16x16x64_bf16 v[100:103], v[24:27], v[136:143], v2
s_mov_b64 exec, 0x101
buffer_load_dword v23, v17, s[4:7], s73 offen offset:512 sc1
s_mov_b64 exec, -1
v_smfmac_f32_16x16x64_bf16 v[100:103], v[28:31], v[200:207], v2
v_smfmac_f32_16x16x64_bf16 v[104:107], v[24:27], v[144:151], v2
v_smfmac_f32_16x16x64_bf16 v[104:107], v[28:31], v[208:215], v2
v_smfmac_f32_16x16x64_bf16 v[108:111], v[24:27], v[152:159], v2
s_nop 4
v_permlane32_swap_b32 v96, v100
v_add_f32 v40, v96, v100
v_smfmac_f32_16x16x64_bf16 v[108:111], v[28:31], v[216:223], v2
v_permlane32_swap_b32 v97, v101
v_add_f32 v44, v97, v101
v_permlane32_swap_b32 v98, v102
v_smfmac_f32_16x16x64_bf16 v[112:115], v[24:27], v[160:167], v2
v_add_f32 v48, v98, v102
v_permlane32_swap_b32 v99, v103
v_smfmac_f32_16x16x64_bf16 v[112:115], v[28:31], v[224:231], v2
v_add_f32 v52, v99, v103
v_smfmac_f32_16x16x64_bf16 v[116:119], v[24:27], v[168:175], v2
v_permlane32_swap_b32 v104, v108
v_add_f32 v41, v104, v108
v_smfmac_f32_16x16x64_bf16 v[116:119], v[28:31], v[232:239], v2
v_permlane32_swap_b32 v105, v109
v_add_f32 v45, v105, v109
v_permlane32_swap_b32 v106, v110
v_smfmac_f32_16x16x64_bf16 v[120:123], v[24:27], v[176:183], v2
v_add_f32 v49, v106, v110
v_permlane32_swap_b32 v107, v111
v_smfmac_f32_16x16x64_bf16 v[120:123], v[28:31], v[240:247], v2
v_add_f32 v53, v107, v111
v_cvt_pk_f16_f32 v64, v40, v41
v_cvt_pk_f16_f32 v66, v44, v45
v_smfmac_f32_16x16x64_bf16 v[124:127], v[24:27], v[184:191], v2
v_cvt_pk_f16_f32 v68, v48, v49
v_cvt_pk_f16_f32 v70, v52, v53
v_smfmac_f32_16x16x64_bf16 v[124:127], v[28:31], v[248:255], v2
v_permlane32_swap_b32 v112, v116
v_add_f32 v42, v112, v116
v_permlane32_swap_b32 v113, v117
v_add_f32 v46, v113, v117
v_permlane32_swap_b32 v114, v118
v_add_f32 v50, v114, v118
v_permlane32_swap_b32 v115, v119
v_add_f32 v54, v115, v119
v_permlane32_swap_b32 v120, v124
v_permlane32_swap_b32 v121, v125
v_permlane32_swap_b32 v122, v126
v_permlane32_swap_b32 v123, v127
v_add_f32 v43, v120, v124
v_add_f32 v47, v121, v125
v_add_f32 v51, v122, v126
v_add_f32 v55, v123, v127
v_cvt_pk_f16_f32 v65, v42, v43
v_cvt_pk_f16_f32 v67, v46, v47
v_cvt_pk_f16_f32 v69, v50, v51
v_cvt_pk_f16_f32 v71, v54, v55
s_cmp_eq_u32 s63, 0
s_cbranch_scc1 Lslow_45
buffer_store_dwordx4 v[64:67], v16, s[4:7], s74 offen
buffer_store_dwordx4 v[68:71], v16, s[4:7], s75 offen
s_branch Ljoin_46
Lslow_45:
buffer_store_dwordx4 v[64:67], v16, s[4:7], s74 offen sc1
buffer_store_dwordx4 v[68:71], v16, s[4:7], s75 offen sc1
Ljoin_46:
ds_read_b128 v[72:75], v20 offset:23552
ds_read_b128 v[80:83], v21 offset:0
ds_read_b128 v[84:87], v21 offset:1024
ds_read_b128 v[88:91], v21 offset:16384
ds_read_b128 v[92:95], v21 offset:17408
ds_read_b128 v[96:99], v21 offset:2048
ds_read_b128 v[100:103], v21 offset:3072
ds_read_b128 v[104:107], v21 offset:18432
ds_read_b128 v[108:111], v21 offset:19456
ds_read_b128 v[112:115], v21 offset:4096
ds_read_b128 v[116:119], v21 offset:5120
ds_read_b128 v[120:123], v21 offset:20480
ds_read_b128 v[124:127], v21 offset:21504
v_pk_mov_b32 v[40:41], 0, 0
v_pk_mov_b32 v[42:43], 0, 0
v_pk_mov_b32 v[44:45], 0, 0
v_pk_mov_b32 v[46:47], 0, 0
v_pk_mov_b32 v[48:49], 0, 0
v_pk_mov_b32 v[50:51], 0, 0
v_pk_mov_b32 v[52:53], 0, 0
v_pk_mov_b32 v[54:55], 0, 0
v_pk_mov_b32 v[56:57], 0, 0
v_pk_mov_b32 v[58:59], 0, 0
v_pk_mov_b32 v[60:61], 0, 0
v_pk_mov_b32 v[62:63], 0, 0
v_mov_b32 v32, -1
v_mov_b32 v33, -1
v_mov_b32 v34, -1
v_mov_b32 v35, -1
s_add_u32 s69, s69, 8192
s_and_b32 s69, s69, 0xffff7fff
s_nop 15
s_nop 15
L_C1_red:
buffer_load_dwordx4 v[24:27], v17, s[4:7], s78 offen sc1
buffer_load_dwordx4 v[28:31], v17, s[4:7], s76 offen sc1
s_memtime s[60:61]
s_waitcnt lgkmcnt(0)
s_sub_u32 s60, s60, s46
s_mov_b32 s61, 23
s_cmp_gt_u32 s60, 67108864
s_cbranch_scc1 L_abortC
s_waitcnt vmcnt(0)
v_max3_u32 v76, v24, v25, v26
v_max3_u32 v77, v27, v28, v29
v_max3_u32 v76, v76, v30, v31
v_max_u32 v76, v76, v77
v_cmpx_eq_u32 vcc, -1, v76
s_cbranch_vccnz L_C1_red
s_mov_b64 exec, -1
v_mfma_f32_16x16x32_f16 v[76:79], v[72:75], v[24:27], 0
v_mfma_f32_16x16x32_f16 v[76:79], v[72:75], v[28:31], v[76:79]
s_nop 7
v_add_f32_dpp v76, v76, v76 row_ror:8 row_mask:0xf bank_mask:0xf
v_add_f32_dpp v77, v77, v77 row_ror:8 row_mask:0xf bank_mask:0xf
v_add_f32_dpp v78, v78, v78 row_ror:8 row_mask:0xf bank_mask:0xf
v_add_f32_dpp v79, v79, v79 row_ror:8 row_mask:0xf bank_mask:0xf
v_add_f32_dpp v76, v76, v76 row_ror:4 row_mask:0xf bank_mask:0xf
v_add_f32_dpp v77, v77, v77 row_ror:4 row_mask:0xf bank_mask:0xf
v_add_f32_dpp v78, v78, v78 row_ror:4 row_mask:0xf bank_mask:0xf
v_add_f32_dpp v79, v79, v79 row_ror:4 row_mask:0xf bank_mask:0xf
v_cvt_pk_bf16_f32 v76, v76, v77
v_cvt_pk_bf16_f32 v77, v78, v79
s_mov_b64 exec, s[94:95]
s_cmp_eq_u32 s63, 0
s_cbranch_scc1 Lslow_47
buffer_store_dwordx2 v[76:77], v18, s[4:7], s69 offen
s_mov_b64 exec, 0xf
buffer_store_dwordx4 v[32:35], v1, s[4:7], s77 offen
s_mov_b64 exec, -1
buffer_store_dwordx4 v[32:35], v17, s[4:7], s78 offen
buffer_store_dwordx4 v[32:35], v17, s[4:7], s76 offen
s_branch Ljoin_48
Lslow_47:
buffer_store_dwordx2 v[76:77], v18, s[4:7], s69 offen sc1
s_mov_b64 exec, 0xf
buffer_store_dwordx4 v[32:35], v1, s[4:7], s77 offen sc1
s_mov_b64 exec, -1
buffer_store_dwordx4 v[32:35], v17, s[4:7], s78 offen sc1
buffer_store_dwordx4 v[32:35], v17, s[4:7], s76 offen sc1
Ljoin_48:
s_add_u32 s62, s62, 1
s_add_u32 s66, s66, 8192
s_add_u32 s77, s77, 8192
s_and_b32 s66, s66, 0xffff7fff
s_and_b32 s77, s77, 0xffff7fff
s_add_u32 s64, s64, 524288
s_and_b32 s64, s64, 0xfe3fffff
s_and_b32 s60, s62, 7
s_lshl_b32 s60, s60, 18
s_add_u32 s72, s71, s60
s_add_u32 s73, s73, 512
s_branch L_C1_loop
L_C1_last:
buffer_store_dwordx4 v[52:55], v1, s[4:7], s72 offen sc1
v_smfmac_f32_16x16x64_bf16 v[60:63], v[24:27], v[88:95], v2
s_waitcnt lgkmcnt(2)
v_smfmac_f32_16x16x64_bf16 v[56:59], v[28:31], v[96:103], v2
s_waitcnt lgkmcnt(0)
v_smfmac_f32_16x16x64_bf16 v[60:63], v[28:31], v[104:111], v2
s_nop 7
v_permlane32_swap_b32 v56, v60
v_add_f32 v56, v56, v60
v_permlane32_swap_b32 v57, v61
v_add_f32 v57, v57, v61
v_permlane32_swap_b32 v58, v62
v_add_f32 v58, v58, v62
v_permlane32_swap_b32 v59, v63
v_add_f32 v59, v59, v63
v_cvt_pk_bf16_f32 v84, v56, v57
v_cvt_pk_bf16_f32 v85, v58, v59
v_lshlrev_b32 v86, 3, v0
buffer_store_dwordx2 v[84:85], v86, s[4:7], s72 offen offset:1024 sc1
s_waitcnt vmcnt(0)
s_endpgm
L_abortC:
s_mov_b64 exec, 1
s_lshl_b32 s60, s56, 8
s_or_b32 s60, s60, s61
s_lshl_b32 s61, s47, 16
s_or_b32 s60, s60, s61
s_or_b32 s60, s60, 0x40000000
v_mov_b32 v1, s60
v_mov_b32 v2, 160
buffer_store_dword v1, v2, s[8:11], 0 offen sc1
s_waitcnt vmcnt(0)
s_endpgm
L_H0:
L_H1:
s_lshl_b32 s60, s57, 3
s_add_u32 s60, s60, s59
s_lshl_b32 s60, s60, 5
s_add_u32 s60, s60, s58
s_lshl_b32 s93, s60, 13
s_add_u32 s93, s93, 100663296
s_lshl_b32 s92, s47, 11
s_add_u32 s60, s93, s92
v_lshlrev_b32 v1, 4, v0
v_mov_b32 v8, -1
v_mov_b32 v9, -1
v_mov_b32 v10, -1
v_mov_b32 v11, -1
buffer_store_dwordx4 v[8:11], v1, s[4:7], s60 offen sc1
buffer_store_dwordx4 v[8:11], v1, s[4:7], s60 offen offset:1024 sc1
s_add_u32 s60, s60, 524288
buffer_store_dwordx4 v[8:11], v1, s[4:7], s60 offen sc1
buffer_store_dwordx4 v[8:11], v1, s[4:7], s60 offen offset:1024 sc1
s_add_u32 s60, s60, 524288
buffer_store_dwordx4 v[8:11], v1, s[4:7], s60 offen sc1
buffer_store_dwordx4 v[8:11], v1, s[4:7], s60 offen offset:1024 sc1
s_add_u32 s60, s60, 524288
buffer_store_dwordx4 v[8:11], v1, s[4:7], s60 offen sc1
buffer_store_dwordx4 v[8:11], v1, s[4:7], s60 offen offset:1024 sc1
s_add_u32 s60, s60, 524288
s_waitcnt vmcnt(0)
s_barrier
s_cmp_lg_u32 s47, 0
s_cbranch_scc1 Larr_49
s_getreg_b32 s60, hwreg(HW_REG_XCC_ID)
s_and_b32 s60, s60, 7
s_lshr_b32 s61, s56, 5
s_cmp_eq_u32 s60, s61
s_cselect_b32 s60, 1, 0x10001
s_mov_b64 exec, 1
v_mov_b32 v1, s60
v_mov_b32 v2, 136
buffer_atomic_add v1, v2, s[8:11], 0 offen sc1
s_mov_b64 exec, -1
Larr_49:
v_lshlrev_b32 v1, 4, v0
v_and_b32 v14, 15, v0
v_lshrrev_b32 v15, 4, v0
v_mov_b32 v2, 0x3f803f80
v_mov_b32 v3, v2
v_mov_b32 v4, v2
v_mov_b32 v5, v2
v_lshlrev_b32 v6, 2, v0
v_and_b32 v7, 31, v0
v_lshlrev_b32 v10, 2, v7
v_lshlrev_b32 v7, 3, v7
s_lshl_b32 s60, s47, 8
s_add_u32 s60, s60, 77824
v_add_u32 v10, s60, v10
v_lshl_add_u32 v8, v14, 2, s60
v_lshl_add_u32 v9, v15, 4, s60
s_mov_b32 s70, 0x3e0293ee
s_mov_b32 s71, 0x3f803f80
s_lshl_b32 s60, s58, 8
s_lshl_b32 s61, s47, 6
s_add_u32 s60, s60, s61
v_lshlrev_b32 v16, 18, v15
v_lshl_add_u32 v16, v14, 2, v16
v_add_u32 v16, s60, v16
s_mov_b32 s12, s20
s_mov_b32 s13, s21
s_mov_b32 s14, 4194304
s_mov_b32 s15, 0x00020000
buffer_load_dword v32, v16, s[12:15], 0 offen offset:0
s_mov_b32 s60, 8192
buffer_load_dword v33, v16, s[12:15], s60 offen
s_mov_b32 s60, 16384
buffer_load_dword v34, v16, s[12:15], s60 offen
s_mov_b32 s60, 24576
buffer_load_dword v35, v16, s[12:15], s60 offen
s_mov_b32 s60, 32768
buffer_load_dword v36, v16, s[12:15], s60 offen
s_mov_b32 s60, 40960
buffer_load_dword v37, v16, s[12:15], s60 offen
s_mov_b32 s60, 49152
buffer_load_dword v38, v16, s[12:15], s60 offen
s_mov_b32 s60, 57344
buffer_load_dword v39, v16, s[12:15], s60 offen
s_mov_b32 s60, 65536
buffer_load_dword v40, v16, s[12:15], s60 offen
s_mov_b32 s60, 73728
buffer_load_dword v41, v16, s[12:15], s60 offen
s_mov_b32 s60, 81920
buffer_load_dword v42, v16, s[12:15], s60 offen
s_mov_b32 s60, 90112
buffer_load_dword v43, v16, s[12:15], s60 offen
s_mov_b32 s60, 98304
buffer_load_dword v44, v16, s[12:15], s60 offen
s_mov_b32 s60, 106496
buffer_load_dword v45, v16, s[12:15], s60 offen
s_mov_b32 s60, 114688
buffer_load_dword v46, v16, s[12:15], s60 offen
s_mov_b32 s60, 122880
buffer_load_dword v47, v16, s[12:15], s60 offen
s_mov_b32 s60, 131072
buffer_load_dword v48, v16, s[12:15], s60 offen
s_mov_b32 s60, 139264
buffer_load_dword v49, v16, s[12:15], s60 offen
s_mov_b32 s60, 147456
buffer_load_dword v50, v16, s[12:15], s60 offen
s_mov_b32 s60, 155648
buffer_load_dword v51, v16, s[12:15], s60 offen
s_mov_b32 s60, 163840
buffer_load_dword v52, v16, s[12:15], s60 offen
s_mov_b32 s60, 172032
buffer_load_dword v53, v16, s[12:15], s60 offen
s_mov_b32 s60, 180224
buffer_load_dword v54, v16, s[12:15], s60 offen
s_mov_b32 s60, 188416
buffer_load_dword v55, v16, s[12:15], s60 offen
s_mov_b32 s60, 196608
buffer_load_dword v56, v16, s[12:15], s60 offen
s_mov_b32 s60, 204800
buffer_load_dword v57, v16, s[12:15], s60 offen
s_mov_b32 s60, 212992
buffer_load_dword v58, v16, s[12:15], s60 offen
s_mov_b32 s60, 221184
buffer_load_dword v59, v16, s[12:15], s60 offen
s_mov_b32 s60, 229376
buffer_load_dword v60, v16, s[12:15], s60 offen
s_mov_b32 s60, 237568
buffer_load_dword v61, v16, s[12:15], s60 offen
s_mov_b32 s60, 245760
buffer_load_dword v62, v16, s[12:15], s60 offen
s_mov_b32 s60, 253952
buffer_load_dword v63, v16, s[12:15], s60 offen
s_mov_b32 s60, 1048576
buffer_load_dword v64, v16, s[12:15], s60 offen
s_mov_b32 s60, 1056768
buffer_load_dword v65, v16, s[12:15], s60 offen
s_mov_b32 s60, 1064960
buffer_load_dword v66, v16, s[12:15], s60 offen
s_mov_b32 s60, 1073152
buffer_load_dword v67, v16, s[12:15], s60 offen
s_mov_b32 s60, 1081344
buffer_load_dword v68, v16, s[12:15], s60 offen
s_mov_b32 s60, 1089536
buffer_load_dword v69, v16, s[12:15], s60 offen
s_mov_b32 s60, 1097728
buffer_load_dword v70, v16, s[12:15], s60 offen
s_mov_b32 s60, 1105920
buffer_load_dword v71, v16, s[12:15], s60 offen
s_mov_b32 s60, 1114112
buffer_load_dword v72, v16, s[12:15], s60 offen
s_mov_b32 s60, 1122304
buffer_load_dword v73, v16, s[12:15], s60 offen
s_mov_b32 s60, 1130496
buffer_load_dword v74, v16, s[12:15], s60 offen
s_mov_b32 s60, 1138688
buffer_load_dword v75, v16, s[12:15], s60 offen
s_mov_b32 s60, 1146880
buffer_load_dword v76, v16, s[12:15], s60 offen
s_mov_b32 s60, 1155072
buffer_load_dword v77, v16, s[12:15], s60 offen
s_mov_b32 s60, 1163264
buffer_load_dword v78, v16, s[12:15], s60 offen
s_mov_b32 s60, 1171456
buffer_load_dword v79, v16, s[12:15], s60 offen
s_mov_b32 s60, 1179648
buffer_load_dword v80, v16, s[12:15], s60 offen
s_mov_b32 s60, 1187840
buffer_load_dword v81, v16, s[12:15], s60 offen
s_mov_b32 s60, 1196032
buffer_load_dword v82, v16, s[12:15], s60 offen
s_mov_b32 s60, 1204224
buffer_load_dword v83, v16, s[12:15], s60 offen
s_mov_b32 s60, 1212416
buffer_load_dword v84, v16, s[12:15], s60 offen
s_mov_b32 s60, 1220608
buffer_load_dword v85, v16, s[12:15], s60 offen
s_mov_b32 s60, 1228800
buffer_load_dword v86, v16, s[12:15], s60 offen
s_mov_b32 s60, 1236992
buffer_load_dword v87, v16, s[12:15], s60 offen
s_mov_b32 s60, 1245184
buffer_load_dword v88, v16, s[12:15], s60 offen
s_mov_b32 s60, 1253376
buffer_load_dword v89, v16, s[12:15], s60 offen
s_mov_b32 s60, 1261568
buffer_load_dword v90, v16, s[12:15], s60 offen
s_mov_b32 s60, 1269760
buffer_load_dword v91, v16, s[12:15], s60 offen
s_mov_b32 s60, 1277952
buffer_load_dword v92, v16, s[12:15], s60 offen
s_mov_b32 s60, 1286144
buffer_load_dword v93, v16, s[12:15], s60 offen
s_mov_b32 s60, 1294336
buffer_load_dword v94, v16, s[12:15], s60 offen
s_mov_b32 s60, 1302528
buffer_load_dword v95, v16, s[12:15], s60 offen
s_waitcnt vmcnt(56)
v_perm_b32 v96, v33, v32, s44
v_accvgpr_write_b32 a0, v96
v_perm_b32 v97, v35, v34, s44
v_accvgpr_write_b32 a1, v97
v_perm_b32 v98, v37, v36, s44
v_accvgpr_write_b32 a2, v98
v_perm_b32 v99, v39, v38, s44
v_accvgpr_write_b32 a3, v99
v_perm_b32 v100, v33, v32, s45
v_accvgpr_write_b32 a64, v100
v_perm_b32 v101, v35, v34, s45
v_accvgpr_write_b32 a65, v101
v_perm_b32 v102, v37, v36, s45
v_accvgpr_write_b32 a66, v102
v_perm_b32 v103, v39, v38, s45
v_accvgpr_write_b32 a67, v103
s_mov_b32 s60, 2097152
buffer_load_dword v32, v16, s[12:15], s60 offen
s_mov_b32 s60, 2105344
buffer_load_dword v33, v16, s[12:15], s60 offen
s_mov_b32 s60, 2113536
buffer_load_dword v34, v16, s[12:15], s60 offen
s_mov_b32 s60, 2121728
buffer_load_dword v35, v16, s[12:15], s60 offen
s_mov_b32 s60, 2129920
buffer_load_dword v36, v16, s[12:15], s60 offen
s_mov_b32 s60, 2138112
buffer_load_dword v37, v16, s[12:15], s60 offen
s_mov_b32 s60, 2146304
buffer_load_dword v38, v16, s[12:15], s60 offen
s_mov_b32 s60, 2154496
buffer_load_dword v39, v16, s[12:15], s60 offen
s_waitcnt vmcnt(56)
v_perm_b32 v96, v41, v40, s44
v_accvgpr_write_b32 a4, v96
v_perm_b32 v97, v43, v42, s44
v_accvgpr_write_b32 a5, v97
v_perm_b32 v98, v45, v44, s44
v_accvgpr_write_b32 a6, v98
v_perm_b32 v99, v47, v46, s44
v_accvgpr_write_b32 a7, v99
v_perm_b32 v100, v41, v40, s45
v_accvgpr_write_b32 a68, v100
v_perm_b32 v101, v43, v42, s45
v_accvgpr_write_b32 a69, v101
v_perm_b32 v102, v45, v44, s45
v_accvgpr_write_b32 a70, v102
v_perm_b32 v103, v47, v46, s45
v_accvgpr_write_b32 a71, v103
s_mov_b32 s60, 2162688
buffer_load_dword v40, v16, s[12:15], s60 offen
s_mov_b32 s60, 2170880
buffer_load_dword v41, v16, s[12:15], s60 offen
s_mov_b32 s60, 2179072
buffer_load_dword v42, v16, s[12:15], s60 offen
s_mov_b32 s60, 2187264
buffer_load_dword v43, v16, s[12:15], s60 offen
s_mov_b32 s60, 2195456
buffer_load_dword v44, v16, s[12:15], s60 offen
s_mov_b32 s60, 2203648
buffer_load_dword v45, v16, s[12:15], s60 offen
s_mov_b32 s60, 2211840
buffer_load_dword v46, v16, s[12:15], s60 offen
s_mov_b32 s60, 2220032
buffer_load_dword v47, v16, s[12:15], s60 offen
s_waitcnt vmcnt(56)
v_perm_b32 v96, v49, v48, s44
v_accvgpr_write_b32 a8, v96
v_perm_b32 v97, v51, v50, s44
v_accvgpr_write_b32 a9, v97
v_perm_b32 v98, v53, v52, s44
v_accvgpr_write_b32 a10, v98
v_perm_b32 v99, v55, v54, s44
v_accvgpr_write_b32 a11, v99
v_perm_b32 v100, v49, v48, s45
v_accvgpr_write_b32 a72, v100
v_perm_b32 v101, v51, v50, s45
v_accvgpr_write_b32 a73, v101
v_perm_b32 v102, v53, v52, s45
v_accvgpr_write_b32 a74, v102
v_perm_b32 v103, v55, v54, s45
v_accvgpr_write_b32 a75, v103
s_mov_b32 s60, 2228224
buffer_load_dword v48, v16, s[12:15], s60 offen
s_mov_b32 s60, 2236416
buffer_load_dword v49, v16, s[12:15], s60 offen
s_mov_b32 s60, 2244608
buffer_load_dword v50, v16, s[12:15], s60 offen
s_mov_b32 s60, 2252800
buffer_load_dword v51, v16, s[12:15], s60 offen
s_mov_b32 s60, 2260992
buffer_load_dword v52, v16, s[12:15], s60 offen
s_mov_b32 s60, 2269184
buffer_load_dword v53, v16, s[12:15], s60 offen
s_mov_b32 s60, 2277376
buffer_load_dword v54, v16, s[12:15], s60 offen
s_mov_b32 s60, 2285568
buffer_load_dword v55, v16, s[12:15], s60 offen
s_waitcnt vmcnt(56)
v_perm_b32 v96, v57, v56, s44
v_accvgpr_write_b32 a12, v96
v_perm_b32 v97, v59, v58, s44
v_accvgpr_write_b32 a13, v97
v_perm_b32 v98, v61, v60, s44
v_accvgpr_write_b32 a14, v98
v_perm_b32 v99, v63, v62, s44
v_accvgpr_write_b32 a15, v99
v_perm_b32 v100, v57, v56, s45
v_accvgpr_write_b32 a76, v100
v_perm_b32 v101, v59, v58, s45
v_accvgpr_write_b32 a77, v101
v_perm_b32 v102, v61, v60, s45
v_accvgpr_write_b32 a78, v102
v_perm_b32 v103, v63, v62, s45
v_accvgpr_write_b32 a79, v103
s_mov_b32 s60, 2293760
buffer_load_dword v56, v16, s[12:15], s60 offen
s_mov_b32 s60, 2301952
buffer_load_dword v57, v16, s[12:15], s60 offen
s_mov_b32 s60, 2310144
buffer_load_dword v58, v16, s[12:15], s60 offen
s_mov_b32 s60, 2318336
buffer_load_dword v59, v16, s[12:15], s60 offen
s_mov_b32 s60, 2326528
buffer_load_dword v60, v16, s[12:15], s60 offen
s_mov_b32 s60, 2334720
buffer_load_dword v61, v16, s[12:15], s60 offen
s_mov_b32 s60, 2342912
buffer_load_dword v62, v16, s[12:15], s60 offen
s_mov_b32 s60, 2351104
buffer_load_dword v63, v16, s[12:15], s60 offen
s_waitcnt vmcnt(56)
v_perm_b32 v96, v65, v64, s44
v_accvgpr_write_b32 a16, v96
v_perm_b32 v97, v67, v66, s44
v_accvgpr_write_b32 a17, v97
v_perm_b32 v98, v69, v68, s44
v_accvgpr_write_b32 a18, v98
v_perm_b32 v99, v71, v70, s44
v_accvgpr_write_b32 a19, v99
v_perm_b32 v100, v65, v64, s45
v_accvgpr_write_b32 a80, v100
v_perm_b32 v101, v67, v66, s45
v_accvgpr_write_b32 a81, v101
v_perm_b32 v102, v69, v68, s45
v_accvgpr_write_b32 a82, v102
v_perm_b32 v103, v71, v70, s45
v_accvgpr_write_b32 a83, v103
s_mov_b32 s60, 3145728
buffer_load_dword v64, v16, s[12:15], s60 offen
s_mov_b32 s60, 3153920
buffer_load_dword v65, v16, s[12:15], s60 offen
s_mov_b32 s60, 3162112
buffer_load_dword v66, v16, s[12:15], s60 offen
s_mov_b32 s60, 3170304
buffer_load_dword v67, v16, s[12:15], s60 offen
s_mov_b32 s60, 3178496
buffer_load_dword v68, v16, s[12:15], s60 offen
s_mov_b32 s60, 3186688
buffer_load_dword v69, v16, s[12:15], s60 offen
s_mov_b32 s60, 3194880
buffer_load_dword v70, v16, s[12:15], s60 offen
s_mov_b32 s60, 3203072
buffer_load_dword v71, v16, s[12:15], s60 offen
s_waitcnt vmcnt(56)
v_perm_b32 v96, v73, v72, s44
v_accvgpr_write_b32 a20, v96
v_perm_b32 v97, v75, v74, s44
v_accvgpr_write_b32 a21, v97
v_perm_b32 v98, v77, v76, s44
v_accvgpr_write_b32 a22, v98
v_perm_b32 v99, v79, v78, s44
v_accvgpr_write_b32 a23, v99
v_perm_b32 v100, v73, v72, s45
v_accvgpr_write_b32 a84, v100
v_perm_b32 v101, v75, v74, s45
v_accvgpr_write_b32 a85, v101
v_perm_b32 v102, v77, v76, s45
v_accvgpr_write_b32 a86, v102
v_perm_b32 v103, v79, v78, s45
v_accvgpr_write_b32 a87, v103
s_mov_b32 s60, 3211264
buffer_load_dword v72, v16, s[12:15], s60 offen
s_mov_b32 s60, 3219456
buffer_load_dword v73, v16, s[12:15], s60 offen
s_mov_b32 s60, 3227648
buffer_load_dword v74, v16, s[12:15], s60 offen
s_mov_b32 s60, 3235840
buffer_load_dword v75, v16, s[12:15], s60 offen
s_mov_b32 s60, 3244032
buffer_load_dword v76, v16, s[12:15], s60 offen
s_mov_b32 s60, 3252224
buffer_load_dword v77, v16, s[12:15], s60 offen
s_mov_b32 s60, 3260416
buffer_load_dword v78, v16, s[12:15], s60 offen
s_mov_b32 s60, 3268608
buffer_load_dword v79, v16, s[12:15], s60 offen
s_waitcnt vmcnt(56)
v_perm_b32 v96, v81, v80, s44
v_accvgpr_write_b32 a24, v96
v_perm_b32 v97, v83, v82, s44
v_accvgpr_write_b32 a25, v97
v_perm_b32 v98, v85, v84, s44
v_accvgpr_write_b32 a26, v98
v_perm_b32 v99, v87, v86, s44
v_accvgpr_write_b32 a27, v99
v_perm_b32 v100, v81, v80, s45
v_accvgpr_write_b32 a88, v100
v_perm_b32 v101, v83, v82, s45
v_accvgpr_write_b32 a89, v101
v_perm_b32 v102, v85, v84, s45
v_accvgpr_write_b32 a90, v102
v_perm_b32 v103, v87, v86, s45
v_accvgpr_write_b32 a91, v103
s_mov_b32 s60, 3276800
buffer_load_dword v80, v16, s[12:15], s60 offen
s_mov_b32 s60, 3284992
buffer_load_dword v81, v16, s[12:15], s60 offen
s_mov_b32 s60, 3293184
buffer_load_dword v82, v16, s[12:15], s60 offen
s_mov_b32 s60, 3301376
buffer_load_dword v83, v16, s[12:15], s60 offen
s_mov_b32 s60, 3309568
buffer_load_dword v84, v16, s[12:15], s60 offen
s_mov_b32 s60, 3317760
buffer_load_dword v85, v16, s[12:15], s60 offen
s_mov_b32 s60, 3325952
buffer_load_dword v86, v16, s[12:15], s60 offen
s_mov_b32 s60, 3334144
buffer_load_dword v87, v16, s[12:15], s60 offen
s_waitcnt vmcnt(56)
v_perm_b32 v96, v89, v88, s44
v_accvgpr_write_b32 a28, v96
v_perm_b32 v97, v91, v90, s44
v_accvgpr_write_b32 a29, v97
v_perm_b32 v98, v93, v92, s44
v_accvgpr_write_b32 a30, v98
v_perm_b32 v99, v95, v94, s44
v_accvgpr_write_b32 a31, v99
v_perm_b32 v100, v89, v88, s45
v_accvgpr_write_b32 a92, v100
v_perm_b32 v101, v91, v90, s45
v_accvgpr_write_b32 a93, v101
v_perm_b32 v102, v93, v92, s45
v_accvgpr_write_b32 a94, v102
v_perm_b32 v103, v95, v94, s45
v_accvgpr_write_b32 a95, v103
s_mov_b32 s60, 3342336
buffer_load_dword v88, v16, s[12:15], s60 offen
s_mov_b32 s60, 3350528
buffer_load_dword v89, v16, s[12:15], s60 offen
s_mov_b32 s60, 3358720
buffer_load_dword v90, v16, s[12:15], s60 offen
s_mov_b32 s60, 3366912
buffer_load_dword v91, v16, s[12:15], s60 offen
s_mov_b32 s60, 3375104
buffer_load_dword v92, v16, s[12:15], s60 offen
s_mov_b32 s60, 3383296
buffer_load_dword v93, v16, s[12:15], s60 offen
s_mov_b32 s60, 3391488
buffer_load_dword v94, v16, s[12:15], s60 offen
s_mov_b32 s60, 3399680
buffer_load_dword v95, v16, s[12:15], s60 offen
s_waitcnt vmcnt(56)
v_perm_b32 v96, v33, v32, s44
v_accvgpr_write_b32 a32, v96
v_perm_b32 v97, v35, v34, s44
v_accvgpr_write_b32 a33, v97
v_perm_b32 v98, v37, v36, s44
v_accvgpr_write_b32 a34, v98
v_perm_b32 v99, v39, v38, s44
v_accvgpr_write_b32 a35, v99
v_perm_b32 v100, v33, v32, s45
v_accvgpr_write_b32 a96, v100
v_perm_b32 v101, v35, v34, s45
v_accvgpr_write_b32 a97, v101
v_perm_b32 v102, v37, v36, s45
v_accvgpr_write_b32 a98, v102
v_perm_b32 v103, v39, v38, s45
v_accvgpr_write_b32 a99, v103
s_mov_b32 s12, s22
s_mov_b32 s13, s23
s_mov_b32 s14, 4194304
s_mov_b32 s15, 0x00020000
buffer_load_dword v32, v16, s[12:15], 0 offen offset:0
s_mov_b32 s60, 8192
buffer_load_dword v33, v16, s[12:15], s60 offen
s_mov_b32 s60, 16384
buffer_load_dword v34, v16, s[12:15], s60 offen
s_mov_b32 s60, 24576
buffer_load_dword v35, v16, s[12:15], s60 offen
s_mov_b32 s60, 32768
buffer_load_dword v36, v16, s[12:15], s60 offen
s_mov_b32 s60, 40960
buffer_load_dword v37, v16, s[12:15], s60 offen
s_mov_b32 s60, 49152
buffer_load_dword v38, v16, s[12:15], s60 offen
s_mov_b32 s60, 57344
buffer_load_dword v39, v16, s[12:15], s60 offen
s_waitcnt vmcnt(56)
v_perm_b32 v96, v41, v40, s44
v_accvgpr_write_b32 a36, v96
v_perm_b32 v97, v43, v42, s44
v_accvgpr_write_b32 a37, v97
v_perm_b32 v98, v45, v44, s44
v_accvgpr_write_b32 a38, v98
v_perm_b32 v99, v47, v46, s44
v_accvgpr_write_b32 a39, v99
v_perm_b32 v100, v41, v40, s45
v_accvgpr_write_b32 a100, v100
v_perm_b32 v101, v43, v42, s45
v_accvgpr_write_b32 a101, v101
v_perm_b32 v102, v45, v44, s45
v_accvgpr_write_b32 a102, v102
v_perm_b32 v103, v47, v46, s45
v_accvgpr_write_b32 a103, v103
s_mov_b32 s60, 65536
buffer_load_dword v40, v16, s[12:15], s60 offen
s_mov_b32 s60, 73728
buffer_load_dword v41, v16, s[12:15], s60 offen
s_mov_b32 s60, 81920
buffer_load_dword v42, v16, s[12:15], s60 offen
s_mov_b32 s60, 90112
buffer_load_dword v43, v16, s[12:15], s60 offen
s_mov_b32 s60, 98304
buffer_load_dword v44, v16, s[12:15], s60 offen
s_mov_b32 s60, 106496
buffer_load_dword v45, v16, s[12:15], s60 offen
s_mov_b32 s60, 114688
buffer_load_dword v46, v16, s[12:15], s60 offen
s_mov_b32 s60, 122880
buffer_load_dword v47, v16, s[12:15], s60 offen
s_waitcnt vmcnt(56)
v_perm_b32 v96, v49, v48, s44
v_accvgpr_write_b32 a40, v96
v_perm_b32 v97, v51, v50, s44
v_accvgpr_write_b32 a41, v97
v_perm_b32 v98, v53, v52, s44
v_accvgpr_write_b32 a42, v98
v_perm_b32 v99, v55, v54, s44
v_accvgpr_write_b32 a43, v99
v_perm_b32 v100, v49, v48, s45
v_accvgpr_write_b32 a104, v100
v_perm_b32 v101, v51, v50, s45
v_accvgpr_write_b32 a105, v101
v_perm_b32 v102, v53, v52, s45
v_accvgpr_write_b32 a106, v102
v_perm_b32 v103, v55, v54, s45
v_accvgpr_write_b32 a107, v103
s_mov_b32 s60, 131072
buffer_load_dword v48, v16, s[12:15], s60 offen
s_mov_b32 s60, 139264
buffer_load_dword v49, v16, s[12:15], s60 offen
s_mov_b32 s60, 147456
buffer_load_dword v50, v16, s[12:15], s60 offen
s_mov_b32 s60, 155648
buffer_load_dword v51, v16, s[12:15], s60 offen
s_mov_b32 s60, 163840
buffer_load_dword v52, v16, s[12:15], s60 offen
s_mov_b32 s60, 172032
buffer_load_dword v53, v16, s[12:15], s60 offen
s_mov_b32 s60, 180224
buffer_load_dword v54, v16, s[12:15], s60 offen
s_mov_b32 s60, 188416
buffer_load_dword v55, v16, s[12:15], s60 offen
s_waitcnt vmcnt(56)
v_perm_b32 v96, v57, v56, s44
v_accvgpr_write_b32 a44, v96
v_perm_b32 v97, v59, v58, s44
v_accvgpr_write_b32 a45, v97
v_perm_b32 v98, v61, v60, s44
v_accvgpr_write_b32 a46, v98
v_perm_b32 v99, v63, v62, s44
v_accvgpr_write_b32 a47, v99
v_perm_b32 v100, v57, v56, s45
v_accvgpr_write_b32 a108, v100
v_perm_b32 v101, v59, v58, s45
v_accvgpr_write_b32 a109, v101
v_perm_b32 v102, v61, v60, s45
v_accvgpr_write_b32 a110, v102
v_perm_b32 v103, v63, v62, s45
v_accvgpr_write_b32 a111, v103
s_mov_b32 s60, 196608
buffer_load_dword v56, v16, s[12:15], s60 offen
s_mov_b32 s60, 204800
buffer_load_dword v57, v16, s[12:15], s60 offen
s_mov_b32 s60, 212992
buffer_load_dword v58, v16, s[12:15], s60 offen
s_mov_b32 s60, 221184
buffer_load_dword v59, v16, s[12:15], s60 offen
s_mov_b32 s60, 229376
buffer_load_dword v60, v16, s[12:15], s60 offen
s_mov_b32 s60, 237568
buffer_load_dword v61, v16, s[12:15], s60 offen
s_mov_b32 s60, 245760
buffer_load_dword v62, v16, s[12:15], s60 offen
s_mov_b32 s60, 253952
buffer_load_dword v63, v16, s[12:15], s60 offen
s_waitcnt vmcnt(56)
v_perm_b32 v96, v65, v64, s44
v_accvgpr_write_b32 a48, v96
v_perm_b32 v97, v67, v66, s44
v_accvgpr_write_b32 a49, v97
v_perm_b32 v98, v69, v68, s44
v_accvgpr_write_b32 a50, v98
v_perm_b32 v99, v71, v70, s44
v_accvgpr_write_b32 a51, v99
v_perm_b32 v100, v65, v64, s45
v_accvgpr_write_b32 a112, v100
v_perm_b32 v101, v67, v66, s45
v_accvgpr_write_b32 a113, v101
v_perm_b32 v102, v69, v68, s45
v_accvgpr_write_b32 a114, v102
v_perm_b32 v103, v71, v70, s45
v_accvgpr_write_b32 a115, v103
s_mov_b32 s60, 1048576
buffer_load_dword v64, v16, s[12:15], s60 offen
s_mov_b32 s60, 1056768
buffer_load_dword v65, v16, s[12:15], s60 offen
s_mov_b32 s60, 1064960
buffer_load_dword v66, v16, s[12:15], s60 offen
s_mov_b32 s60, 1073152
buffer_load_dword v67, v16, s[12:15], s60 offen
s_mov_b32 s60, 1081344
buffer_load_dword v68, v16, s[12:15], s60 offen
s_mov_b32 s60, 1089536
buffer_load_dword v69, v16, s[12:15], s60 offen
s_mov_b32 s60, 1097728
buffer_load_dword v70, v16, s[12:15], s60 offen
s_mov_b32 s60, 1105920
buffer_load_dword v71, v16, s[12:15], s60 offen
s_waitcnt vmcnt(56)
v_perm_b32 v96, v73, v72, s44
v_accvgpr_write_b32 a52, v96
v_perm_b32 v97, v75, v74, s44
v_accvgpr_write_b32 a53, v97
v_perm_b32 v98, v77, v76, s44
v_accvgpr_write_b32 a54, v98
v_perm_b32 v99, v79, v78, s44
v_accvgpr_write_b32 a55, v99
v_perm_b32 v100, v73, v72, s45
v_accvgpr_write_b32 a116, v100
v_perm_b32 v101, v75, v74, s45
v_accvgpr_write_b32 a117, v101
v_perm_b32 v102, v77, v76, s45
v_accvgpr_write_b32 a118, v102
v_perm_b32 v103, v79, v78, s45
v_accvgpr_write_b32 a119, v103
s_mov_b32 s60, 1114112
buffer_load_dword v72, v16, s[12:15], s60 offen
s_mov_b32 s60, 1122304
buffer_load_dword v73, v16, s[12:15], s60 offen
s_mov_b32 s60, 1130496
buffer_load_dword v74, v16, s[12:15], s60 offen
s_mov_b32 s60, 1138688
buffer_load_dword v75, v16, s[12:15], s60 offen
s_mov_b32 s60, 1146880
buffer_load_dword v76, v16, s[12:15], s60 offen
s_mov_b32 s60, 1155072
buffer_load_dword v77, v16, s[12:15], s60 offen
s_mov_b32 s60, 1163264
buffer_load_dword v78, v16, s[12:15], s60 offen
s_mov_b32 s60, 1171456
buffer_load_dword v79, v16, s[12:15], s60 offen
s_waitcnt vmcnt(56)
v_perm_b32 v96, v81, v80, s44
v_accvgpr_write_b32 a56, v96
v_perm_b32 v97, v83, v82, s44
v_accvgpr_write_b32 a57, v97
v_perm_b32 v98, v85, v84, s44
v_accvgpr_write_b32 a58, v98
v_perm_b32 v99, v87, v86, s44
v_accvgpr_write_b32 a59, v99
v_perm_b32 v100, v81, v80, s45
v_accvgpr_write_b32 a120, v100
v_perm_b32 v101, v83, v82, s45
v_accvgpr_write_b32 a121, v101
v_perm_b32 v102, v85, v84, s45
v_accvgpr_write_b32 a122, v102
v_perm_b32 v103, v87, v86, s45
v_accvgpr_write_b32 a123, v103
s_mov_b32 s60, 1179648
buffer_load_dword v80, v16, s[12:15], s60 offen
s_mov_b32 s60, 1187840
buffer_load_dword v81, v16, s[12:15], s60 offen
s_mov_b32 s60, 1196032
buffer_load_dword v82, v16, s[12:15], s60 offen
s_mov_b32 s60, 1204224
buffer_load_dword v83, v16, s[12:15], s60 offen
s_mov_b32 s60, 1212416
buffer_load_dword v84, v16, s[12:15], s60 offen
s_mov_b32 s60, 1220608
buffer_load_dword v85, v16, s[12:15], s60 offen
s_mov_b32 s60, 1228800
buffer_load_dword v86, v16, s[12:15], s60 offen
s_mov_b32 s60, 1236992
buffer_load_dword v87, v16, s[12:15], s60 offen
s_waitcnt vmcnt(56)
v_perm_b32 v96, v89, v88, s44
v_accvgpr_write_b32 a60, v96
v_perm_b32 v97, v91, v90, s44
v_accvgpr_write_b32 a61, v97
v_perm_b32 v98, v93, v92, s44
v_accvgpr_write_b32 a62, v98
v_perm_b32 v99, v95, v94, s44
v_accvgpr_write_b32 a63, v99
v_perm_b32 v100, v89, v88, s45
v_accvgpr_write_b32 a124, v100
v_perm_b32 v101, v91, v90, s45
v_accvgpr_write_b32 a125, v101
v_perm_b32 v102, v93, v92, s45
v_accvgpr_write_b32 a126, v102
v_perm_b32 v103, v95, v94, s45
v_accvgpr_write_b32 a127, v103
s_mov_b32 s60, 1245184
buffer_load_dword v88, v16, s[12:15], s60 offen
s_mov_b32 s60, 1253376
buffer_load_dword v89, v16, s[12:15], s60 offen
s_mov_b32 s60, 1261568
buffer_load_dword v90, v16, s[12:15], s60 offen
s_mov_b32 s60, 1269760
buffer_load_dword v91, v16, s[12:15], s60 offen
s_mov_b32 s60, 1277952
buffer_load_dword v92, v16, s[12:15], s60 offen
s_mov_b32 s60, 1286144
buffer_load_dword v93, v16, s[12:15], s60 offen
s_mov_b32 s60, 1294336
buffer_load_dword v94, v16, s[12:15], s60 offen
s_mov_b32 s60, 1302528
buffer_load_dword v95, v16, s[12:15], s60 offen
s_waitcnt vmcnt(56)
v_perm_b32 v96, v33, v32, s44
v_accvgpr_write_b32 a128, v96
v_perm_b32 v97, v35, v34, s44
v_accvgpr_write_b32 a129, v97
v_perm_b32 v98, v37, v36, s44
v_accvgpr_write_b32 a130, v98
v_perm_b32 v99, v39, v38, s44
v_accvgpr_write_b32 a131, v99
v_perm_b32 v100, v33, v32, s45
v_accvgpr_write_b32 a192, v100
v_perm_b32 v101, v35, v34, s45
v_accvgpr_write_b32 a193, v101
v_perm_b32 v102, v37, v36, s45
v_accvgpr_write_b32 a194, v102
v_perm_b32 v103, v39, v38, s45
v_accvgpr_write_b32 a195, v103
s_mov_b32 s60, 2097152
buffer_load_dword v32, v16, s[12:15], s60 offen
s_mov_b32 s60, 2105344
buffer_load_dword v33, v16, s[12:15], s60 offen
s_mov_b32 s60, 2113536
buffer_load_dword v34, v16, s[12:15], s60 offen
s_mov_b32 s60, 2121728
buffer_load_dword v35, v16, s[12:15], s60 offen
s_mov_b32 s60, 2129920
buffer_load_dword v36, v16, s[12:15], s60 offen
s_mov_b32 s60, 2138112
buffer_load_dword v37, v16, s[12:15], s60 offen
s_mov_b32 s60, 2146304
buffer_load_dword v38, v16, s[12:15], s60 offen
s_mov_b32 s60, 2154496
buffer_load_dword v39, v16, s[12:15], s60 offen
s_waitcnt vmcnt(56)
v_perm_b32 v96, v41, v40, s44
v_accvgpr_write_b32 a132, v96
v_perm_b32 v97, v43, v42, s44
v_accvgpr_write_b32 a133, v97
v_perm_b32 v98, v45, v44, s44
v_accvgpr_write_b32 a134, v98
v_perm_b32 v99, v47, v46, s44
v_accvgpr_write_b32 a135, v99
v_perm_b32 v100, v41, v40, s45
v_accvgpr_write_b32 a196, v100
v_perm_b32 v101, v43, v42, s45
v_accvgpr_write_b32 a197, v101
v_perm_b32 v102, v45, v44, s45
v_accvgpr_write_b32 a198, v102
v_perm_b32 v103, v47, v46, s45
v_accvgpr_write_b32 a199, v103
s_mov_b32 s60, 2162688
buffer_load_dword v40, v16, s[12:15], s60 offen
s_mov_b32 s60, 2170880
buffer_load_dword v41, v16, s[12:15], s60 offen
s_mov_b32 s60, 2179072
buffer_load_dword v42, v16, s[12:15], s60 offen
s_mov_b32 s60, 2187264
buffer_load_dword v43, v16, s[12:15], s60 offen
s_mov_b32 s60, 2195456
buffer_load_dword v44, v16, s[12:15], s60 offen
s_mov_b32 s60, 2203648
buffer_load_dword v45, v16, s[12:15], s60 offen
s_mov_b32 s60, 2211840
buffer_load_dword v46, v16, s[12:15], s60 offen
s_mov_b32 s60, 2220032
buffer_load_dword v47, v16, s[12:15], s60 offen
s_waitcnt vmcnt(56)
v_perm_b32 v96, v49, v48, s44
v_accvgpr_write_b32 a136, v96
v_perm_b32 v97, v51, v50, s44
v_accvgpr_write_b32 a137, v97
v_perm_b32 v98, v53, v52, s44
v_accvgpr_write_b32 a138, v98
v_perm_b32 v99, v55, v54, s44
v_accvgpr_write_b32 a139, v99
v_perm_b32 v100, v49, v48, s45
v_accvgpr_write_b32 a200, v100
v_perm_b32 v101, v51, v50, s45
v_accvgpr_write_b32 a201, v101
v_perm_b32 v102, v53, v52, s45
v_accvgpr_write_b32 a202, v102
v_perm_b32 v103, v55, v54, s45
v_accvgpr_write_b32 a203, v103
s_mov_b32 s60, 2228224
buffer_load_dword v48, v16, s[12:15], s60 offen
s_mov_b32 s60, 2236416
buffer_load_dword v49, v16, s[12:15], s60 offen
s_mov_b32 s60, 2244608
buffer_load_dword v50, v16, s[12:15], s60 offen
s_mov_b32 s60, 2252800
buffer_load_dword v51, v16, s[12:15], s60 offen
s_mov_b32 s60, 2260992
buffer_load_dword v52, v16, s[12:15], s60 offen
s_mov_b32 s60, 2269184
buffer_load_dword v53, v16, s[12:15], s60 offen
s_mov_b32 s60, 2277376
buffer_load_dword v54, v16, s[12:15], s60 offen
s_mov_b32 s60, 2285568
buffer_load_dword v55, v16, s[12:15], s60 offen
s_waitcnt vmcnt(56)
v_perm_b32 v96, v57, v56, s44
v_accvgpr_write_b32 a140, v96
v_perm_b32 v97, v59, v58, s44
v_accvgpr_write_b32 a141, v97
v_perm_b32 v98, v61, v60, s44
v_accvgpr_write_b32 a142, v98
v_perm_b32 v99, v63, v62, s44
v_accvgpr_write_b32 a143, v99
v_perm_b32 v100, v57, v56, s45
v_accvgpr_write_b32 a204, v100
v_perm_b32 v101, v59, v58, s45
v_accvgpr_write_b32 a205, v101
v_perm_b32 v102, v61, v60, s45
v_accvgpr_write_b32 a206, v102
v_perm_b32 v103, v63, v62, s45
v_accvgpr_write_b32 a207, v103
s_mov_b32 s60, 2293760
buffer_load_dword v56, v16, s[12:15], s60 offen
s_mov_b32 s60, 2301952
buffer_load_dword v57, v16, s[12:15], s60 offen
s_mov_b32 s60, 2310144
buffer_load_dword v58, v16, s[12:15], s60 offen
s_mov_b32 s60, 2318336
buffer_load_dword v59, v16, s[12:15], s60 offen
s_mov_b32 s60, 2326528
buffer_load_dword v60, v16, s[12:15], s60 offen
s_mov_b32 s60, 2334720
buffer_load_dword v61, v16, s[12:15], s60 offen
s_mov_b32 s60, 2342912
buffer_load_dword v62, v16, s[12:15], s60 offen
s_mov_b32 s60, 2351104
buffer_load_dword v63, v16, s[12:15], s60 offen
s_waitcnt vmcnt(56)
v_perm_b32 v96, v65, v64, s44
v_accvgpr_write_b32 a144, v96
v_perm_b32 v97, v67, v66, s44
v_accvgpr_write_b32 a145, v97
v_perm_b32 v98, v69, v68, s44
v_accvgpr_write_b32 a146, v98
v_perm_b32 v99, v71, v70, s44
v_accvgpr_write_b32 a147, v99
v_perm_b32 v100, v65, v64, s45
v_accvgpr_write_b32 a208, v100
v_perm_b32 v101, v67, v66, s45
v_accvgpr_write_b32 a209, v101
v_perm_b32 v102, v69, v68, s45
v_accvgpr_write_b32 a210, v102
v_perm_b32 v103, v71, v70, s45
v_accvgpr_write_b32 a211, v103
s_mov_b32 s60, 3145728
buffer_load_dword v64, v16, s[12:15], s60 offen
s_mov_b32 s60, 3153920
buffer_load_dword v65, v16, s[12:15], s60 offen
s_mov_b32 s60, 3162112
buffer_load_dword v66, v16, s[12:15], s60 offen
s_mov_b32 s60, 3170304
buffer_load_dword v67, v16, s[12:15], s60 offen
s_mov_b32 s60, 3178496
buffer_load_dword v68, v16, s[12:15], s60 offen
s_mov_b32 s60, 3186688
buffer_load_dword v69, v16, s[12:15], s60 offen
s_mov_b32 s60, 3194880
buffer_load_dword v70, v16, s[12:15], s60 offen
s_mov_b32 s60, 3203072
buffer_load_dword v71, v16, s[12:15], s60 offen
s_waitcnt vmcnt(56)
v_perm_b32 v96, v73, v72, s44
v_accvgpr_write_b32 a148, v96
v_perm_b32 v97, v75, v74, s44
v_accvgpr_write_b32 a149, v97
v_perm_b32 v98, v77, v76, s44
v_accvgpr_write_b32 a150, v98
v_perm_b32 v99, v79, v78, s44
v_accvgpr_write_b32 a151, v99
v_perm_b32 v100, v73, v72, s45
v_accvgpr_write_b32 a212, v100
v_perm_b32 v101, v75, v74, s45
v_accvgpr_write_b32 a213, v101
v_perm_b32 v102, v77, v76, s45
v_accvgpr_write_b32 a214, v102
v_perm_b32 v103, v79, v78, s45
v_accvgpr_write_b32 a215, v103
s_mov_b32 s60, 3211264
buffer_load_dword v72, v16, s[12:15], s60 offen
s_mov_b32 s60, 3219456
buffer_load_dword v73, v16, s[12:15], s60 offen
s_mov_b32 s60, 3227648
buffer_load_dword v74, v16, s[12:15], s60 offen
s_mov_b32 s60, 3235840
buffer_load_dword v75, v16, s[12:15], s60 offen
s_mov_b32 s60, 3244032
buffer_load_dword v76, v16, s[12:15], s60 offen
s_mov_b32 s60, 3252224
buffer_load_dword v77, v16, s[12:15], s60 offen
s_mov_b32 s60, 3260416
buffer_load_dword v78, v16, s[12:15], s60 offen
s_mov_b32 s60, 3268608
buffer_load_dword v79, v16, s[12:15], s60 offen
s_waitcnt vmcnt(56)
v_perm_b32 v96, v81, v80, s44
v_accvgpr_write_b32 a152, v96
v_perm_b32 v97, v83, v82, s44
v_accvgpr_write_b32 a153, v97
v_perm_b32 v98, v85, v84, s44
v_accvgpr_write_b32 a154, v98
v_perm_b32 v99, v87, v86, s44
v_accvgpr_write_b32 a155, v99
v_perm_b32 v100, v81, v80, s45
v_accvgpr_write_b32 a216, v100
v_perm_b32 v101, v83, v82, s45
v_accvgpr_write_b32 a217, v101
v_perm_b32 v102, v85, v84, s45
v_accvgpr_write_b32 a218, v102
v_perm_b32 v103, v87, v86, s45
v_accvgpr_write_b32 a219, v103
s_mov_b32 s60, 3276800
buffer_load_dword v80, v16, s[12:15], s60 offen
s_mov_b32 s60, 3284992
buffer_load_dword v81, v16, s[12:15], s60 offen
s_mov_b32 s60, 3293184
buffer_load_dword v82, v16, s[12:15], s60 offen
s_mov_b32 s60, 3301376
buffer_load_dword v83, v16, s[12:15], s60 offen
s_mov_b32 s60, 3309568
buffer_load_dword v84, v16, s[12:15], s60 offen
s_mov_b32 s60, 3317760
buffer_load_dword v85, v16, s[12:15], s60 offen
s_mov_b32 s60, 3325952
buffer_load_dword v86, v16, s[12:15], s60 offen
s_mov_b32 s60, 3334144
buffer_load_dword v87, v16, s[12:15], s60 offen
s_waitcnt vmcnt(56)
v_perm_b32 v96, v89, v88, s44
v_accvgpr_write_b32 a156, v96
v_perm_b32 v97, v91, v90, s44
v_accvgpr_write_b32 a157, v97
v_perm_b32 v98, v93, v92, s44
v_accvgpr_write_b32 a158, v98
v_perm_b32 v99, v95, v94, s44
v_accvgpr_write_b32 a159, v99
v_perm_b32 v100, v89, v88, s45
v_accvgpr_write_b32 a220, v100
v_perm_b32 v101, v91, v90, s45
v_accvgpr_write_b32 a221, v101
v_perm_b32 v102, v93, v92, s45
v_accvgpr_write_b32 a222, v102
v_perm_b32 v103, v95, v94, s45
v_accvgpr_write_b32 a223, v103
s_mov_b32 s60, 3342336
buffer_load_dword v88, v16, s[12:15], s60 offen
s_mov_b32 s60, 3350528
buffer_load_dword v89, v16, s[12:15], s60 offen
s_mov_b32 s60, 3358720
buffer_load_dword v90, v16, s[12:15], s60 offen
s_mov_b32 s60, 3366912
buffer_load_dword v91, v16, s[12:15], s60 offen
s_mov_b32 s60, 3375104
buffer_load_dword v92, v16, s[12:15], s60 offen
s_mov_b32 s60, 3383296
buffer_load_dword v93, v16, s[12:15], s60 offen
s_mov_b32 s60, 3391488
buffer_load_dword v94, v16, s[12:15], s60 offen
s_mov_b32 s60, 3399680
buffer_load_dword v95, v16, s[12:15], s60 offen
s_waitcnt vmcnt(56)
v_perm_b32 v96, v33, v32, s44
v_accvgpr_write_b32 a160, v96
v_perm_b32 v97, v35, v34, s44
v_accvgpr_write_b32 a161, v97
v_perm_b32 v98, v37, v36, s44
v_accvgpr_write_b32 a162, v98
v_perm_b32 v99, v39, v38, s44
v_accvgpr_write_b32 a163, v99
v_perm_b32 v100, v33, v32, s45
v_accvgpr_write_b32 a224, v100
v_perm_b32 v101, v35, v34, s45
v_accvgpr_write_b32 a225, v101
v_perm_b32 v102, v37, v36, s45
v_accvgpr_write_b32 a226, v102
v_perm_b32 v103, v39, v38, s45
v_accvgpr_write_b32 a227, v103
s_mov_b32 s12, s24
s_mov_b32 s13, s25
s_mov_b32 s14, 4194304
s_mov_b32 s15, 0x00020000
buffer_load_dword v32, v16, s[12:15], 0 offen offset:0
s_mov_b32 s60, 8192
buffer_load_dword v33, v16, s[12:15], s60 offen
s_mov_b32 s60, 16384
buffer_load_dword v34, v16, s[12:15], s60 offen
s_mov_b32 s60, 24576
buffer_load_dword v35, v16, s[12:15], s60 offen
s_mov_b32 s60, 32768
buffer_load_dword v36, v16, s[12:15], s60 offen
s_mov_b32 s60, 40960
buffer_load_dword v37, v16, s[12:15], s60 offen
s_mov_b32 s60, 49152
buffer_load_dword v38, v16, s[12:15], s60 offen
s_mov_b32 s60, 57344
buffer_load_dword v39, v16, s[12:15], s60 offen
s_waitcnt vmcnt(56)
v_perm_b32 v96, v41, v40, s44
v_accvgpr_write_b32 a164, v96
v_perm_b32 v97, v43, v42, s44
v_accvgpr_write_b32 a165, v97
v_perm_b32 v98, v45, v44, s44
v_accvgpr_write_b32 a166, v98
v_perm_b32 v99, v47, v46, s44
v_accvgpr_write_b32 a167, v99
v_perm_b32 v100, v41, v40, s45
v_accvgpr_write_b32 a228, v100
v_perm_b32 v101, v43, v42, s45
v_accvgpr_write_b32 a229, v101
v_perm_b32 v102, v45, v44, s45
v_accvgpr_write_b32 a230, v102
v_perm_b32 v103, v47, v46, s45
v_accvgpr_write_b32 a231, v103
s_mov_b32 s60, 65536
buffer_load_dword v40, v16, s[12:15], s60 offen
s_mov_b32 s60, 73728
buffer_load_dword v41, v16, s[12:15], s60 offen
s_mov_b32 s60, 81920
buffer_load_dword v42, v16, s[12:15], s60 offen
s_mov_b32 s60, 90112
buffer_load_dword v43, v16, s[12:15], s60 offen
s_mov_b32 s60, 98304
buffer_load_dword v44, v16, s[12:15], s60 offen
s_mov_b32 s60, 106496
buffer_load_dword v45, v16, s[12:15], s60 offen
s_mov_b32 s60, 114688
buffer_load_dword v46, v16, s[12:15], s60 offen
s_mov_b32 s60, 122880
buffer_load_dword v47, v16, s[12:15], s60 offen
s_waitcnt vmcnt(56)
v_perm_b32 v96, v49, v48, s44
v_accvgpr_write_b32 a168, v96
v_perm_b32 v97, v51, v50, s44
v_accvgpr_write_b32 a169, v97
v_perm_b32 v98, v53, v52, s44
v_accvgpr_write_b32 a170, v98
v_perm_b32 v99, v55, v54, s44
v_accvgpr_write_b32 a171, v99
v_perm_b32 v100, v49, v48, s45
v_accvgpr_write_b32 a232, v100
v_perm_b32 v101, v51, v50, s45
v_accvgpr_write_b32 a233, v101
v_perm_b32 v102, v53, v52, s45
v_accvgpr_write_b32 a234, v102
v_perm_b32 v103, v55, v54, s45
v_accvgpr_write_b32 a235, v103
s_mov_b32 s60, 131072
buffer_load_dword v48, v16, s[12:15], s60 offen
s_mov_b32 s60, 139264
buffer_load_dword v49, v16, s[12:15], s60 offen
s_mov_b32 s60, 147456
buffer_load_dword v50, v16, s[12:15], s60 offen
s_mov_b32 s60, 155648
buffer_load_dword v51, v16, s[12:15], s60 offen
s_mov_b32 s60, 163840
buffer_load_dword v52, v16, s[12:15], s60 offen
s_mov_b32 s60, 172032
buffer_load_dword v53, v16, s[12:15], s60 offen
s_mov_b32 s60, 180224
buffer_load_dword v54, v16, s[12:15], s60 offen
s_mov_b32 s60, 188416
buffer_load_dword v55, v16, s[12:15], s60 offen
s_waitcnt vmcnt(56)
v_perm_b32 v96, v57, v56, s44
v_accvgpr_write_b32 a172, v96
v_perm_b32 v97, v59, v58, s44
v_accvgpr_write_b32 a173, v97
v_perm_b32 v98, v61, v60, s44
v_accvgpr_write_b32 a174, v98
v_perm_b32 v99, v63, v62, s44
v_accvgpr_write_b32 a175, v99
v_perm_b32 v100, v57, v56, s45
v_accvgpr_write_b32 a236, v100
v_perm_b32 v101, v59, v58, s45
v_accvgpr_write_b32 a237, v101
v_perm_b32 v102, v61, v60, s45
v_accvgpr_write_b32 a238, v102
v_perm_b32 v103, v63, v62, s45
v_accvgpr_write_b32 a239, v103
s_mov_b32 s60, 196608
buffer_load_dword v56, v16, s[12:15], s60 offen
s_mov_b32 s60, 204800
buffer_load_dword v57, v16, s[12:15], s60 offen
s_mov_b32 s60, 212992
buffer_load_dword v58, v16, s[12:15], s60 offen
s_mov_b32 s60, 221184
buffer_load_dword v59, v16, s[12:15], s60 offen
s_mov_b32 s60, 229376
buffer_load_dword v60, v16, s[12:15], s60 offen
s_mov_b32 s60, 237568
buffer_load_dword v61, v16, s[12:15], s60 offen
s_mov_b32 s60, 245760
buffer_load_dword v62, v16, s[12:15], s60 offen
s_mov_b32 s60, 253952
buffer_load_dword v63, v16, s[12:15], s60 offen
s_waitcnt vmcnt(56)
v_perm_b32 v96, v65, v64, s44
v_accvgpr_write_b32 a176, v96
v_perm_b32 v97, v67, v66, s44
v_accvgpr_write_b32 a177, v97
v_perm_b32 v98, v69, v68, s44
v_accvgpr_write_b32 a178, v98
v_perm_b32 v99, v71, v70, s44
v_accvgpr_write_b32 a179, v99
v_perm_b32 v100, v65, v64, s45
v_accvgpr_write_b32 a240, v100
v_perm_b32 v101, v67, v66, s45
v_accvgpr_write_b32 a241, v101
v_perm_b32 v102, v69, v68, s45
v_accvgpr_write_b32 a242, v102
v_perm_b32 v103, v71, v70, s45
v_accvgpr_write_b32 a243, v103
s_mov_b32 s60, 1048576
buffer_load_dword v64, v16, s[12:15], s60 offen
s_mov_b32 s60, 1056768
buffer_load_dword v65, v16, s[12:15], s60 offen
s_mov_b32 s60, 1064960
buffer_load_dword v66, v16, s[12:15], s60 offen
s_mov_b32 s60, 1073152
buffer_load_dword v67, v16, s[12:15], s60 offen
s_mov_b32 s60, 1081344
buffer_load_dword v68, v16, s[12:15], s60 offen
s_mov_b32 s60, 1089536
buffer_load_dword v69, v16, s[12:15], s60 offen
s_mov_b32 s60, 1097728
buffer_load_dword v70, v16, s[12:15], s60 offen
s_mov_b32 s60, 1105920
buffer_load_dword v71, v16, s[12:15], s60 offen
s_waitcnt vmcnt(56)
v_perm_b32 v96, v73, v72, s44
v_accvgpr_write_b32 a180, v96
v_perm_b32 v97, v75, v74, s44
v_accvgpr_write_b32 a181, v97
v_perm_b32 v98, v77, v76, s44
v_accvgpr_write_b32 a182, v98
v_perm_b32 v99, v79, v78, s44
v_accvgpr_write_b32 a183, v99
v_perm_b32 v100, v73, v72, s45
v_accvgpr_write_b32 a244, v100
v_perm_b32 v101, v75, v74, s45
v_accvgpr_write_b32 a245, v101
v_perm_b32 v102, v77, v76, s45
v_accvgpr_write_b32 a246, v102
v_perm_b32 v103, v79, v78, s45
v_accvgpr_write_b32 a247, v103
s_mov_b32 s60, 1114112
buffer_load_dword v72, v16, s[12:15], s60 offen
s_mov_b32 s60, 1122304
buffer_load_dword v73, v16, s[12:15], s60 offen
s_mov_b32 s60, 1130496
buffer_load_dword v74, v16, s[12:15], s60 offen
s_mov_b32 s60, 1138688
buffer_load_dword v75, v16, s[12:15], s60 offen
s_mov_b32 s60, 1146880
buffer_load_dword v76, v16, s[12:15], s60 offen
s_mov_b32 s60, 1155072
buffer_load_dword v77, v16, s[12:15], s60 offen
s_mov_b32 s60, 1163264
buffer_load_dword v78, v16, s[12:15], s60 offen
s_mov_b32 s60, 1171456
buffer_load_dword v79, v16, s[12:15], s60 offen
s_waitcnt vmcnt(56)
v_perm_b32 v96, v81, v80, s44
v_accvgpr_write_b32 a184, v96
v_perm_b32 v97, v83, v82, s44
v_accvgpr_write_b32 a185, v97
v_perm_b32 v98, v85, v84, s44
v_accvgpr_write_b32 a186, v98
v_perm_b32 v99, v87, v86, s44
v_accvgpr_write_b32 a187, v99
v_perm_b32 v100, v81, v80, s45
v_accvgpr_write_b32 a248, v100
v_perm_b32 v101, v83, v82, s45
v_accvgpr_write_b32 a249, v101
v_perm_b32 v102, v85, v84, s45
v_accvgpr_write_b32 a250, v102
v_perm_b32 v103, v87, v86, s45
v_accvgpr_write_b32 a251, v103
s_mov_b32 s60, 1179648
buffer_load_dword v80, v16, s[12:15], s60 offen
s_mov_b32 s60, 1187840
buffer_load_dword v81, v16, s[12:15], s60 offen
s_mov_b32 s60, 1196032
buffer_load_dword v82, v16, s[12:15], s60 offen
s_mov_b32 s60, 1204224
buffer_load_dword v83, v16, s[12:15], s60 offen
s_mov_b32 s60, 1212416
buffer_load_dword v84, v16, s[12:15], s60 offen
s_mov_b32 s60, 1220608
buffer_load_dword v85, v16, s[12:15], s60 offen
s_mov_b32 s60, 1228800
buffer_load_dword v86, v16, s[12:15], s60 offen
s_mov_b32 s60, 1236992
buffer_load_dword v87, v16, s[12:15], s60 offen
s_waitcnt vmcnt(56)
v_perm_b32 v96, v89, v88, s44
v_accvgpr_write_b32 a188, v96
v_perm_b32 v97, v91, v90, s44
v_accvgpr_write_b32 a189, v97
v_perm_b32 v98, v93, v92, s44
v_accvgpr_write_b32 a190, v98
v_perm_b32 v99, v95, v94, s44
v_accvgpr_write_b32 a191, v99
v_perm_b32 v100, v89, v88, s45
v_accvgpr_write_b32 a252, v100
v_perm_b32 v101, v91, v90, s45
v_accvgpr_write_b32 a253, v101
v_perm_b32 v102, v93, v92, s45
v_accvgpr_write_b32 a254, v102
v_perm_b32 v103, v95, v94, s45
v_accvgpr_write_b32 a255, v103
s_mov_b32 s60, 1245184
buffer_load_dword v88, v16, s[12:15], s60 offen
s_mov_b32 s60, 1253376
buffer_load_dword v89, v16, s[12:15], s60 offen
s_mov_b32 s60, 1261568
buffer_load_dword v90, v16, s[12:15], s60 offen
s_mov_b32 s60, 1269760
buffer_load_dword v91, v16, s[12:15], s60 offen
s_mov_b32 s60, 1277952
buffer_load_dword v92, v16, s[12:15], s60 offen
s_mov_b32 s60, 1286144
buffer_load_dword v93, v16, s[12:15], s60 offen
s_mov_b32 s60, 1294336
buffer_load_dword v94, v16, s[12:15], s60 offen
s_mov_b32 s60, 1302528
buffer_load_dword v95, v16, s[12:15], s60 offen
s_waitcnt vmcnt(56)
v_perm_b32 v128, v33, v32, s44
v_perm_b32 v129, v35, v34, s44
v_perm_b32 v130, v37, v36, s44
v_perm_b32 v131, v39, v38, s44
v_perm_b32 v192, v33, v32, s45
v_perm_b32 v193, v35, v34, s45
v_perm_b32 v194, v37, v36, s45
v_perm_b32 v195, v39, v38, s45
s_mov_b32 s60, 2097152
buffer_load_dword v32, v16, s[12:15], s60 offen
s_mov_b32 s60, 2105344
buffer_load_dword v33, v16, s[12:15], s60 offen
s_mov_b32 s60, 2113536
buffer_load_dword v34, v16, s[12:15], s60 offen
s_mov_b32 s60, 2121728
buffer_load_dword v35, v16, s[12:15], s60 offen
s_mov_b32 s60, 2129920
buffer_load_dword v36, v16, s[12:15], s60 offen
s_mov_b32 s60, 2138112
buffer_load_dword v37, v16, s[12:15], s60 offen
s_mov_b32 s60, 2146304
buffer_load_dword v38, v16, s[12:15], s60 offen
s_mov_b32 s60, 2154496
buffer_load_dword v39, v16, s[12:15], s60 offen
s_waitcnt vmcnt(56)
v_perm_b32 v132, v41, v40, s44
v_perm_b32 v133, v43, v42, s44
v_perm_b32 v134, v45, v44, s44
v_perm_b32 v135, v47, v46, s44
v_perm_b32 v196, v41, v40, s45
v_perm_b32 v197, v43, v42, s45
v_perm_b32 v198, v45, v44, s45
v_perm_b32 v199, v47, v46, s45
s_mov_b32 s60, 2162688
buffer_load_dword v40, v16, s[12:15], s60 offen
s_mov_b32 s60, 2170880
buffer_load_dword v41, v16, s[12:15], s60 offen
s_mov_b32 s60, 2179072
buffer_load_dword v42, v16, s[12:15], s60 offen
s_mov_b32 s60, 2187264
buffer_load_dword v43, v16, s[12:15], s60 offen
s_mov_b32 s60, 2195456
buffer_load_dword v44, v16, s[12:15], s60 offen
s_mov_b32 s60, 2203648
buffer_load_dword v45, v16, s[12:15], s60 offen
s_mov_b32 s60, 2211840
buffer_load_dword v46, v16, s[12:15], s60 offen
s_mov_b32 s60, 2220032
buffer_load_dword v47, v16, s[12:15], s60 offen
s_waitcnt vmcnt(56)
v_perm_b32 v136, v49, v48, s44
v_perm_b32 v137, v51, v50, s44
v_perm_b32 v138, v53, v52, s44
v_perm_b32 v139, v55, v54, s44
v_perm_b32 v200, v49, v48, s45
v_perm_b32 v201, v51, v50, s45
v_perm_b32 v202, v53, v52, s45
v_perm_b32 v203, v55, v54, s45
s_mov_b32 s60, 2228224
buffer_load_dword v48, v16, s[12:15], s60 offen
s_mov_b32 s60, 2236416
buffer_load_dword v49, v16, s[12:15], s60 offen
s_mov_b32 s60, 2244608
buffer_load_dword v50, v16, s[12:15], s60 offen
s_mov_b32 s60, 2252800
buffer_load_dword v51, v16, s[12:15], s60 offen
s_mov_b32 s60, 2260992
buffer_load_dword v52, v16, s[12:15], s60 offen
s_mov_b32 s60, 2269184
buffer_load_dword v53, v16, s[12:15], s60 offen
s_mov_b32 s60, 2277376
buffer_load_dword v54, v16, s[12:15], s60 offen
s_mov_b32 s60, 2285568
buffer_load_dword v55, v16, s[12:15], s60 offen
s_waitcnt vmcnt(56)
v_perm_b32 v140, v57, v56, s44
v_perm_b32 v141, v59, v58, s44
v_perm_b32 v142, v61, v60, s44
v_perm_b32 v143, v63, v62, s44
v_perm_b32 v204, v57, v56, s45
v_perm_b32 v205, v59, v58, s45
v_perm_b32 v206, v61, v60, s45
v_perm_b32 v207, v63, v62, s45
s_mov_b32 s60, 2293760
buffer_load_dword v56, v16, s[12:15], s60 offen
s_mov_b32 s60, 2301952
buffer_load_dword v57, v16, s[12:15], s60 offen
s_mov_b32 s60, 2310144
buffer_load_dword v58, v16, s[12:15], s60 offen
s_mov_b32 s60, 2318336
buffer_load_dword v59, v16, s[12:15], s60 offen
s_mov_b32 s60, 2326528
buffer_load_dword v60, v16, s[12:15], s60 offen
s_mov_b32 s60, 2334720
buffer_load_dword v61, v16, s[12:15], s60 offen
s_mov_b32 s60, 2342912
buffer_load_dword v62, v16, s[12:15], s60 offen
s_mov_b32 s60, 2351104
buffer_load_dword v63, v16, s[12:15], s60 offen
s_waitcnt vmcnt(56)
v_perm_b32 v144, v65, v64, s44
v_perm_b32 v145, v67, v66, s44
v_perm_b32 v146, v69, v68, s44
v_perm_b32 v147, v71, v70, s44
v_perm_b32 v208, v65, v64, s45
v_perm_b32 v209, v67, v66, s45
v_perm_b32 v210, v69, v68, s45
v_perm_b32 v211, v71, v70, s45
s_mov_b32 s60, 3145728
buffer_load_dword v64, v16, s[12:15], s60 offen
s_mov_b32 s60, 3153920
buffer_load_dword v65, v16, s[12:15], s60 offen
s_mov_b32 s60, 3162112
buffer_load_dword v66, v16, s[12:15], s60 offen
s_mov_b32 s60, 3170304
buffer_load_dword v67, v16, s[12:15], s60 offen
s_mov_b32 s60, 3178496
buffer_load_dword v68, v16, s[12:15], s60 offen
s_mov_b32 s60, 3186688
buffer_load_dword v69, v16, s[12:15], s60 offen
s_mov_b32 s60, 3194880
buffer_load_dword v70, v16, s[12:15], s60 offen
s_mov_b32 s60, 3203072
buffer_load_dword v71, v16, s[12:15], s60 offen
s_waitcnt vmcnt(56)
v_perm_b32 v148, v73, v72, s44
v_perm_b32 v149, v75, v74, s44
v_perm_b32 v150, v77, v76, s44
v_perm_b32 v151, v79, v78, s44
v_perm_b32 v212, v73, v72, s45
v_perm_b32 v213, v75, v74, s45
v_perm_b32 v214, v77, v76, s45
v_perm_b32 v215, v79, v78, s45
s_mov_b32 s60, 3211264
buffer_load_dword v72, v16, s[12:15], s60 offen
s_mov_b32 s60, 3219456
buffer_load_dword v73, v16, s[12:15], s60 offen
s_mov_b32 s60, 3227648
buffer_load_dword v74, v16, s[12:15], s60 offen
s_mov_b32 s60, 3235840
buffer_load_dword v75, v16, s[12:15], s60 offen
s_mov_b32 s60, 3244032
buffer_load_dword v76, v16, s[12:15], s60 offen
s_mov_b32 s60, 3252224
buffer_load_dword v77, v16, s[12:15], s60 offen
s_mov_b32 s60, 3260416
buffer_load_dword v78, v16, s[12:15], s60 offen
s_mov_b32 s60, 3268608
buffer_load_dword v79, v16, s[12:15], s60 offen
s_waitcnt vmcnt(56)
v_perm_b32 v152, v81, v80, s44
v_perm_b32 v153, v83, v82, s44
v_perm_b32 v154, v85, v84, s44
v_perm_b32 v155, v87, v86, s44
v_perm_b32 v216, v81, v80, s45
v_perm_b32 v217, v83, v82, s45
v_perm_b32 v218, v85, v84, s45
v_perm_b32 v219, v87, v86, s45
s_mov_b32 s60, 3276800
buffer_load_dword v80, v16, s[12:15], s60 offen
s_mov_b32 s60, 3284992
buffer_load_dword v81, v16, s[12:15], s60 offen
s_mov_b32 s60, 3293184
buffer_load_dword v82, v16, s[12:15], s60 offen
s_mov_b32 s60, 3301376
buffer_load_dword v83, v16, s[12:15], s60 offen
s_mov_b32 s60, 3309568
buffer_load_dword v84, v16, s[12:15], s60 offen
s_mov_b32 s60, 3317760
buffer_load_dword v85, v16, s[12:15], s60 offen
s_mov_b32 s60, 3325952
buffer_load_dword v86, v16, s[12:15], s60 offen
s_mov_b32 s60, 3334144
buffer_load_dword v87, v16, s[12:15], s60 offen
s_waitcnt vmcnt(56)
v_perm_b32 v156, v89, v88, s44
v_perm_b32 v157, v91, v90, s44
v_perm_b32 v158, v93, v92, s44
v_perm_b32 v159, v95, v94, s44
v_perm_b32 v220, v89, v88, s45
v_perm_b32 v221, v91, v90, s45
v_perm_b32 v222, v93, v92, s45
v_perm_b32 v223, v95, v94, s45
s_mov_b32 s60, 3342336
buffer_load_dword v88, v16, s[12:15], s60 offen
s_mov_b32 s60, 3350528
buffer_load_dword v89, v16, s[12:15], s60 offen
s_mov_b32 s60, 3358720
buffer_load_dword v90, v16, s[12:15], s60 offen
s_mov_b32 s60, 3366912
buffer_load_dword v91, v16, s[12:15], s60 offen
s_mov_b32 s60, 3375104
buffer_load_dword v92, v16, s[12:15], s60 offen
s_mov_b32 s60, 3383296
buffer_load_dword v93, v16, s[12:15], s60 offen
s_mov_b32 s60, 3391488
buffer_load_dword v94, v16, s[12:15], s60 offen
s_mov_b32 s60, 3399680
buffer_load_dword v95, v16, s[12:15], s60 offen
s_waitcnt vmcnt(56)
v_perm_b32 v160, v33, v32, s44
v_perm_b32 v161, v35, v34, s44
v_perm_b32 v162, v37, v36, s44
v_perm_b32 v163, v39, v38, s44
v_perm_b32 v224, v33, v32, s45
v_perm_b32 v225, v35, v34, s45
v_perm_b32 v226, v37, v36, s45
v_perm_b32 v227, v39, v38, s45
s_waitcnt vmcnt(48)
v_perm_b32 v164, v41, v40, s44
v_perm_b32 v165, v43, v42, s44
v_perm_b32 v166, v45, v44, s44
v_perm_b32 v167, v47, v46, s44
v_perm_b32 v228, v41, v40, s45
v_perm_b32 v229, v43, v42, s45
v_perm_b32 v230, v45, v44, s45
v_perm_b32 v231, v47, v46, s45
s_waitcnt vmcnt(40)
v_perm_b32 v168, v49, v48, s44
v_perm_b32 v169, v51, v50, s44
v_perm_b32 v170, v53, v52, s44
v_perm_b32 v171, v55, v54, s44
v_perm_b32 v232, v49, v48, s45
v_perm_b32 v233, v51, v50, s45
v_perm_b32 v234, v53, v52, s45
v_perm_b32 v235, v55, v54, s45
s_waitcnt vmcnt(32)
v_perm_b32 v172, v57, v56, s44
v_perm_b32 v173, v59, v58, s44
v_perm_b32 v174, v61, v60, s44
v_perm_b32 v175, v63, v62, s44
v_perm_b32 v236, v57, v56, s45
v_perm_b32 v237, v59, v58, s45
v_perm_b32 v238, v61, v60, s45
v_perm_b32 v239, v63, v62, s45
s_waitcnt vmcnt(24)
v_perm_b32 v176, v65, v64, s44
v_perm_b32 v177, v67, v66, s44
v_perm_b32 v178, v69, v68, s44
v_perm_b32 v179, v71, v70, s44
v_perm_b32 v240, v65, v64, s45
v_perm_b32 v241, v67, v66, s45
v_perm_b32 v242, v69, v68, s45
v_perm_b32 v243, v71, v70, s45
s_waitcnt vmcnt(16)
v_perm_b32 v180, v73, v72, s44
v_perm_b32 v181, v75, v74, s44
v_perm_b32 v182, v77, v76, s44
v_perm_b32 v183, v79, v78, s44
v_perm_b32 v244, v73, v72, s45
v_perm_b32 v245, v75, v74, s45
v_perm_b32 v246, v77, v76, s45
v_perm_b32 v247, v79, v78, s45
s_waitcnt vmcnt(8)
v_perm_b32 v184, v81, v80, s44
v_perm_b32 v185, v83, v82, s44
v_perm_b32 v186, v85, v84, s44
v_perm_b32 v187, v87, v86, s44
v_perm_b32 v248, v81, v80, s45
v_perm_b32 v249, v83, v82, s45
v_perm_b32 v250, v85, v84, s45
v_perm_b32 v251, v87, v86, s45
s_waitcnt vmcnt(0)
v_perm_b32 v188, v89, v88, s44
v_perm_b32 v189, v91, v90, s44
v_perm_b32 v190, v93, v92, s44
v_perm_b32 v191, v95, v94, s44
v_perm_b32 v252, v89, v88, s45
v_perm_b32 v253, v91, v90, s45
v_perm_b32 v254, v93, v92, s45
v_perm_b32 v255, v95, v94, s45
v_mov_b32 v32, s71
v_mov_b32 v33, s71
v_mov_b32 v34, s71
v_mov_b32 v35, s71
s_nop 1
v_mfma_f32_16x16x32_bf16 v[64:67], a[0:3], v[32:35], 0
v_mfma_f32_16x16x32_bf16 v[68:71], a[64:67], v[32:35], 0
v_mfma_f32_16x16x32_bf16 v[72:75], a[128:131], v[32:35], 0
v_mfma_f32_16x16x32_bf16 v[76:79], a[192:195], v[32:35], 0
v_mfma_f32_16x16x32_bf16 v[80:83], v[32:35], v[128:131], 0
v_mfma_f32_16x16x32_bf16 v[84:87], v[32:35], v[192:195], 0
v_mfma_f32_16x16x32_bf16 v[64:67], a[4:7], v[32:35], v[64:67]
v_mfma_f32_16x16x32_bf16 v[68:71], a[68:71], v[32:35], v[68:71]
v_mfma_f32_16x16x32_bf16 v[72:75], a[132:135], v[32:35], v[72:75]
v_mfma_f32_16x16x32_bf16 v[76:79], a[196:199], v[32:35], v[76:79]
v_mfma_f32_16x16x32_bf16 v[80:83], v[32:35], v[132:135], v[80:83]
v_mfma_f32_16x16x32_bf16 v[84:87], v[32:35], v[196:199], v[84:87]
v_mfma_f32_16x16x32_bf16 v[64:67], a[8:11], v[32:35], v[64:67]
v_mfma_f32_16x16x32_bf16 v[68:71], a[72:75], v[32:35], v[68:71]
v_mfma_f32_16x16x32_bf16 v[72:75], a[136:139], v[32:35], v[72:75]
v_mfma_f32_16x16x32_bf16 v[76:79], a[200:203], v[32:35], v[76:79]
v_mfma_f32_16x16x32_bf16 v[80:83], v[32:35], v[136:139], v[80:83]
v_mfma_f32_16x16x32_bf16 v[84:87], v[32:35], v[200:203], v[84:87]
v_mfma_f32_16x16x32_bf16 v[64:67], a[12:15], v[32:35], v[64:67]
v_mfma_f32_16x16x32_bf16 v[68:71], a[76:79], v[32:35], v[68:71]
v_mfma_f32_16x16x32_bf16 v[72:75], a[140:143], v[32:35], v[72:75]
v_mfma_f32_16x16x32_bf16 v[76:79], a[204:207], v[32:35], v[76:79]
v_mfma_f32_16x16x32_bf16 v[80:83], v[32:35], v[140:143], v[80:83]
v_mfma_f32_16x16x32_bf16 v[84:87], v[32:35], v[204:207], v[84:87]
v_mfma_f32_16x16x32_bf16 v[64:67], a[16:19], v[32:35], v[64:67]
v_mfma_f32_16x16x32_bf16 v[68:71], a[80:83], v[32:35], v[68:71]
v_mfma_f32_16x16x32_bf16 v[72:75], a[144:147], v[32:35], v[72:75]
v_mfma_f32_16x16x32_bf16 v[76:79], a[208:211], v[32:35], v[76:79]
v_mfma_f32_16x16x32_bf16 v[80:83], v[32:35], v[144:147], v[80:83]
v_mfma_f32_16x16x32_bf16 v[84:87], v[32:35], v[208:211], v[84:87]
v_mfma_f32_16x16x32_bf16 v[64:67], a[20:23], v[32:35], v[64:67]
v_mfma_f32_16x16x32_bf16 v[68:71], a[84:87], v[32:35], v[68:71]
v_mfma_f32_16x16x32_bf16 v[72:75], a[148:151], v[32:35], v[72:75]
v_mfma_f32_16x16x32_bf16 v[76:79], a[212:215], v[32:35], v[76:79]
v_mfma_f32_16x16x32_bf16 v[80:83], v[32:35], v[148:151], v[80:83]
v_mfma_f32_16x16x32_bf16 v[84:87], v[32:35], v[212:215], v[84:87]
v_mfma_f32_16x16x32_bf16 v[64:67], a[24:27], v[32:35], v[64:67]
v_mfma_f32_16x16x32_bf16 v[68:71], a[88:91], v[32:35], v[68:71]
v_mfma_f32_16x16x32_bf16 v[72:75], a[152:155], v[32:35], v[72:75]
v_mfma_f32_16x16x32_bf16 v[76:79], a[216:219], v[32:35], v[76:79]
v_mfma_f32_16x16x32_bf16 v[80:83], v[32:35], v[152:155], v[80:83]
v_mfma_f32_16x16x32_bf16 v[84:87], v[32:35], v[216:219], v[84:87]
v_mfma_f32_16x16x32_bf16 v[64:67], a[28:31], v[32:35], v[64:67]
v_mfma_f32_16x16x32_bf16 v[68:71], a[92:95], v[32:35], v[68:71]
v_mfma_f32_16x16x32_bf16 v[72:75], a[156:159], v[32:35], v[72:75]
v_mfma_f32_16x16x32_bf16 v[76:79], a[220:223], v[32:35], v[76:79]
v_mfma_f32_16x16x32_bf16 v[80:83], v[32:35], v[156:159], v[80:83]
v_mfma_f32_16x16x32_bf16 v[84:87], v[32:35], v[220:223], v[84:87]
v_mfma_f32_16x16x32_bf16 v[64:67], a[32:35], v[32:35], v[64:67]
v_mfma_f32_16x16x32_bf16 v[68:71], a[96:99], v[32:35], v[68:71]
v_mfma_f32_16x16x32_bf16 v[72:75], a[160:163], v[32:35], v[72:75]
v_mfma_f32_16x16x32_bf16 v[76:79], a[224:227], v[32:35], v[76:79]
v_mfma_f32_16x16x32_bf16 v[80:83], v[32:35], v[160:163], v[80:83]
v_mfma_f32_16x16x32_bf16 v[84:87], v[32:35], v[224:227], v[84:87]
v_mfma_f32_16x16x32_bf16 v[64:67], a[36:39], v[32:35], v[64:67]
v_mfma_f32_16x16x32_bf16 v[68:71], a[100:103], v[32:35], v[68:71]
v_mfma_f32_16x16x32_bf16 v[72:75], a[164:167], v[32:35], v[72:75]
v_mfma_f32_16x16x32_bf16 v[76:79], a[228:231], v[32:35], v[76:79]
v_mfma_f32_16x16x32_bf16 v[80:83], v[32:35], v[164:167], v[80:83]
v_mfma_f32_16x16x32_bf16 v[84:87], v[32:35], v[228:231], v[84:87]
v_mfma_f32_16x16x32_bf16 v[64:67], a[40:43], v[32:35], v[64:67]
v_mfma_f32_16x16x32_bf16 v[68:71], a[104:107], v[32:35], v[68:71]
v_mfma_f32_16x16x32_bf16 v[72:75], a[168:171], v[32:35], v[72:75]
v_mfma_f32_16x16x32_bf16 v[76:79], a[232:235], v[32:35], v[76:79]
v_mfma_f32_16x16x32_bf16 v[80:83], v[32:35], v[168:171], v[80:83]
v_mfma_f32_16x16x32_bf16 v[84:87], v[32:35], v[232:235], v[84:87]
v_mfma_f32_16x16x32_bf16 v[64:67], a[44:47], v[32:35], v[64:67]
v_mfma_f32_16x16x32_bf16 v[68:71], a[108:111], v[32:35], v[68:71]
v_mfma_f32_16x16x32_bf16 v[72:75], a[172:175], v[32:35], v[72:75]
v_mfma_f32_16x16x32_bf16 v[76:79], a[236:239], v[32:35], v[76:79]
v_mfma_f32_16x16x32_bf16 v[80:83], v[32:35], v[172:175], v[80:83]
v_mfma_f32_16x16x32_bf16 v[84:87], v[32:35], v[236:239], v[84:87]
v_mfma_f32_16x16x32_bf16 v[64:67], a[48:51], v[32:35], v[64:67]
v_mfma_f32_16x16x32_bf16 v[68:71], a[112:115], v[32:35], v[68:71]
v_mfma_f32_16x16x32_bf16 v[72:75], a[176:179], v[32:35], v[72:75]
v_mfma_f32_16x16x32_bf16 v[76:79], a[240:243], v[32:35], v[76:79]
v_mfma_f32_16x16x32_bf16 v[80:83], v[32:35], v[176:179], v[80:83]
v_mfma_f32_16x16x32_bf16 v[84:87], v[32:35], v[240:243], v[84:87]
v_mfma_f32_16x16x32_bf16 v[64:67], a[52:55], v[32:35], v[64:67]
v_mfma_f32_16x16x32_bf16 v[68:71], a[116:119], v[32:35], v[68:71]
v_mfma_f32_16x16x32_bf16 v[72:75], a[180:183], v[32:35], v[72:75]
v_mfma_f32_16x16x32_bf16 v[76:79], a[244:247], v[32:35], v[76:79]
v_mfma_f32_16x16x32_bf16 v[80:83], v[32:35], v[180:183], v[80:83]
v_mfma_f32_16x16x32_bf16 v[84:87], v[32:35], v[244:247], v[84:87]
v_mfma_f32_16x16x32_bf16 v[64:67], a[56:59], v[32:35], v[64:67]
v_mfma_f32_16x16x32_bf16 v[68:71], a[120:123], v[32:35], v[68:71]
v_mfma_f32_16x16x32_bf16 v[72:75], a[184:187], v[32:35], v[72:75]
v_mfma_f32_16x16x32_bf16 v[76:79], a[248:251], v[32:35], v[76:79]
v_mfma_f32_16x16x32_bf16 v[80:83], v[32:35], v[184:187], v[80:83]
v_mfma_f32_16x16x32_bf16 v[84:87], v[32:35], v[248:251], v[84:87]
v_mfma_f32_16x16x32_bf16 v[64:67], a[60:63], v[32:35], v[64:67]
v_mfma_f32_16x16x32_bf16 v[68:71], a[124:127], v[32:35], v[68:71]
v_mfma_f32_16x16x32_bf16 v[72:75], a[188:191], v[32:35], v[72:75]
v_mfma_f32_16x16x32_bf16 v[76:79], a[252:255], v[32:35], v[76:79]
v_mfma_f32_16x16x32_bf16 v[80:83], v[32:35], v[188:191], v[80:83]
v_mfma_f32_16x16x32_bf16 v[84:87], v[32:35], v[252:255], v[84:87]
s_lshl_b32 s60, s47, 12
s_add_u32 s60, s60, 49152
v_add_u32 v11, s60, v1
ds_write_b128 v11, v[64:67] offset:0
ds_write_b128 v11, v[68:71] offset:1024
ds_write_b128 v11, v[72:75] offset:2048
ds_write_b128 v11, v[76:79] offset:3072
v_mov_b32 v12, v80
v_mov_b32 v13, v84
s_and_b32 s72, s47, 1
s_mul_i32 s60, s47, 3072
s_add_u32 s60, s60, 65536
v_add_u32 v16, s60, v1
v_mov_b32 v40, 0xf149f2ca
v_cmp_gt_u32 vcc, 2, v15
s_nop 1
v_cndmask_b32 v32, 0, v40, vcc
v_mov_b32 v33, v32
v_mov_b32 v34, v32
v_mov_b32 v35, v32
ds_write_b128 v16, v[32:35]
v_lshlrev_b32 v41, 2, v15
v_add_u32 v42, 0, v41
v_cmp_gt_u32 vcc, v42, v14
s_nop 1
v_cndmask_b32 v36, 0, v40, vcc
v_add_u32 v42, 1, v41
v_cmp_gt_u32 vcc, v42, v14
s_nop 1
v_cndmask_b32 v37, 0, v40, vcc
v_add_u32 v42, 2, v41
v_cmp_gt_u32 vcc, v42, v14
s_nop 1
v_cndmask_b32 v38, 0, v40, vcc
v_add_u32 v42, 3, v41
v_cmp_gt_u32 vcc, v42, v14
s_nop 1
v_cndmask_b32 v39, 0, v40, vcc
s_cmp_eq_u32 s72, 0
s_cselect_b64 vcc, -1, 0
v_cndmask_b32 v44, 0, v36, vcc
v_cndmask_b32 v48, v36, v40, vcc
v_cndmask_b32 v45, 0, v37, vcc
v_cndmask_b32 v49, v37, v40, vcc
v_cndmask_b32 v46, 0, v38, vcc
v_cndmask_b32 v50, v38, v40, vcc
v_cndmask_b32 v47, 0, v39, vcc
v_cndmask_b32 v51, v39, v40, vcc
ds_write_b128 v16, v[44:47] offset:1024
ds_write_b128 v16, v[48:51] offset:2048
s_waitcnt lgkmcnt(0)
s_lshl_b32 s78, s47, 12
s_mov_b32 s77, 81920
s_mov_b32 s75, 0
v_mov_b32 v122, -1
v_mov_b32 v123, -1
s_nop 1
s_cmp_eq_u32 s57, 1
s_cbranch_scc1 L_H1_main
L_H0_main:
s_mov_b64 exec, 1
v_mov_b32 v33, 136
s_nop 1
Lgb_68:
buffer_load_dword v32, v33, s[8:11], 0 offen sc1
s_memtime s[60:61]
s_waitcnt lgkmcnt(0)
s_sub_u32 s60, s60, s46
s_mov_b32 s61, 2
s_cmp_gt_u32 s60, 67108864
s_cbranch_scc1 L_abortH
s_waitcnt vmcnt(0)
v_readfirstlane_b32 s60, v32
s_and_b32 s61, s60, 0xffff
s_cmp_lt_u32 s61, 256
s_cbranch_scc1 Lgb_68
s_mov_b64 exec, -1
s_mov_b32 s74, -2
s_mov_b32 s76, 0
s_add_u32 s94, s93, s92
s_add_u32 s94, s94, 1572864
L_H0_loop:
s_add_u32 s63, s74, 2
s_cmp_lt_i32 s74, 0
s_cbranch_scc1 L_H0_noatt
s_lshl_b32 s68, s74, 1
s_add_u32 s68, s68, s59
s_and_b32 s73, s74, 1
s_mul_i32 s73, s73, 24576
s_lshl_b32 s69, s68, 5
s_add_u32 s69, s69, s58
s_add_u32 s69, s69, 0
s_lshl_b32 s69, s69, 4
s_and_b32 s66, s74, 3
s_lshl_b32 s66, s66, 19
s_add_u32 s66, s66, s93
s_add_u32 s94, s66, s92
s_waitcnt lgkmcnt(0)
s_barrier
s_mul_i32 s60, s47, 3072
s_add_u32 s60, s60, 65536
v_add_u32 v124, s60, v1
ds_read_b128 v[104:107], v124
ds_read_b128 v[108:111], v124 offset:1024
ds_read_b128 v[112:115], v124 offset:2048
s_lshl_b32 s60, s72, 10
s_add_u32 s60, s60, s73
v_add_u32 v124, s60, v1
v_add_u32 v125, s73, v1
s_lshr_b32 s67, s47, 1
s_lshl_b32 s60, s67, 12
s_add_u32 s60, s60, s73
v_add_u32 v126, s60, v1
ds_read_b128 v[32:35], v124 offset:0
ds_read_b128 v[48:51], v125 offset:8192
ds_read_b128 v[52:55], v125 offset:9216
ds_read_b128 v[36:39], v124 offset:2048
ds_read_b128 v[56:59], v125 offset:10240
ds_read_b128 v[60:63], v125 offset:11264
ds_read_b128 v[40:43], v124 offset:4096
ds_read_b128 v[64:67], v125 offset:12288
ds_read_b128 v[68:71], v125 offset:13312
ds_read_b128 v[44:47], v124 offset:6144
ds_read_b128 v[72:75], v125 offset:14336
ds_read_b128 v[76:79], v125 offset:15360
ds_read_b128 v[80:83], v126 offset:16384
ds_read_b128 v[84:87], v126 offset:17408
ds_read_b128 v[88:91], v126 offset:18432
ds_read_b128 v[92:95], v126 offset:19456
s_waitcnt lgkmcnt(0)
v_mfma_f32_16x16x32_bf16 v[108:111], v[48:51], v[32:35], v[108:111]
v_mfma_f32_16x16x32_bf16 v[112:115], v[52:55], v[32:35], v[112:115]
v_mfma_f32_16x16x32_bf16 v[108:111], v[56:59], v[36:39], v[108:111]
v_mfma_f32_16x16x32_bf16 v[112:115], v[60:63], v[36:39], v[112:115]
v_mfma_f32_16x16x32_bf16 v[108:111], v[64:67], v[40:43], v[108:111]
v_mfma_f32_16x16x32_bf16 v[112:115], v[68:71], v[40:43], v[112:115]
v_mfma_f32_16x16x32_bf16 v[108:111], v[72:75], v[44:47], v[108:111]
v_mfma_f32_16x16x32_bf16 v[112:115], v[76:79], v[44:47], v[112:115]
v_lshlrev_b32 v124, 11, v0
s_mov_b64 exec, 0xf
s_branch Lzp_70
s_nop 4
Lzp_69:
s_sleep 1
Lzp_70:
buffer_load_dword v125, v124, s[4:7], s66 offen offset:1020 sc1
s_memtime s[60:61]
s_waitcnt lgkmcnt(0)
s_sub_u32 s60, s60, s46
s_mov_b32 s61, 11
s_cmp_gt_u32 s60, 67108864
s_cbranch_scc1 L_abortH
s_waitcnt vmcnt(0)
s_cmp_eq_u32 s75, 0
s_cbranch_scc1 Lnp_74
s_mov_b64 s[98:99], exec
s_mov_b64 exec, 1
buffer_store_dword v4, off, s[4:7], s75 sc1
s_mov_b64 exec, s[98:99]
s_mov_b32 s75, 0
Lnp_74:
v_cmp_eq_u32 vcc, -1, v125
s_cbranch_vccnz Lzp_69
s_mov_b64 exec, -1
s_nop 2
Lzp_71:
s_add_u32 s60, s66, 0
buffer_load_dwordx4 v[16:19], v1, s[4:7], s60 offen sc1
s_add_u32 s60, s66, 2048
buffer_load_dwordx4 v[20:23], v1, s[4:7], s60 offen sc1
s_add_u32 s60, s66, 4096
buffer_load_dwordx4 v[24:27], v1, s[4:7], s60 offen sc1
s_add_u32 s60, s66, 6144
buffer_load_dwordx4 v[28:31], v1, s[4:7], s60 offen sc1
s_lshl_b32 s60, s67, 12
s_add_u32 s60, s60, s66
buffer_load_dwordx2 v[96:97], v7, s[4:7], s60 offen offset:1024 sc1
buffer_load_dwordx2 v[98:99], v7, s[4:7], s60 offen offset:1280 sc1
buffer_load_dwordx2 v[100:101], v7, s[4:7], s60 offen offset:3072 sc1
buffer_load_dwordx2 v[102:103], v7, s[4:7], s60 offen offset:3328 sc1
s_memtime s[60:61]
s_waitcnt lgkmcnt(0)
s_sub_u32 s60, s60, s46
s_mov_b32 s61, 12
s_cmp_gt_u32 s60, 67108864
s_cbranch_scc1 L_abortH
s_waitcnt vmcnt(4)
v_max3_u32 v124, v16, v17, v18
v_max3_u32 v125, v19, v20, v21
v_max3_u32 v124, v124, v22, v23
v_max3_u32 v125, v125, v24, v25
v_max3_u32 v124, v124, v26, v27
v_max3_u32 v125, v125, v28, v29
v_max3_u32 v124, v124, v30, v31
v_max_u32 v124, v124, v125
v_cmp_eq_u32 vcc, -1, v124
s_cbranch_vccnz Lzp_71
v_mfma_f32_16x16x32_bf16 v[104:107], v[16:19], v[32:35], v[104:107]
v_mfma_f32_16x16x32_bf16 v[104:107], v[20:23], v[36:39], v[104:107]
v_mfma_f32_16x16x32_bf16 v[104:107], v[24:27], v[40:43], v[104:107]
v_mfma_f32_16x16x32_bf16 v[104:107], v[28:31], v[44:47], v[104:107]
s_cmp_ge_u32 s63, 32
s_cbranch_scc1 Lzp_72
s_lshl_b32 s62, s63, 1
s_add_u32 s62, s62, s59
s_lshl_b32 s64, s62, 15
s_add_u32 s64, s64, 10485760
s_lshl_b32 s65, s62, 12
s_add_u32 s65, s65, 12582912
s_add_u32 s100, s77, s92
s_add_u32 m0, s100, 0
s_add_u32 s100, s64, s92
s_add_u32 s100, s100, 0
buffer_load_dwordx4 v1, s[4:7], s100 offen offset:0 sc1 lds
buffer_load_dwordx4 v1, s[4:7], s100 offen offset:1024 sc1 lds
s_add_u32 s100, s77, s92
s_add_u32 m0, s100, 8192
s_add_u32 s100, s64, s92
s_add_u32 s100, s100, 8192
buffer_load_dwordx4 v1, s[4:7], s100 offen offset:0 sc1 lds
buffer_load_dwordx4 v1, s[4:7], s100 offen offset:1024 sc1 lds
s_add_u32 s100, s77, s78
s_add_u32 m0, s100, 16384
s_add_u32 s100, s64, s78
s_add_u32 s100, s100, 16384
buffer_load_dwordx4 v1, s[4:7], s100 offen offset:0 sc1 lds
buffer_load_dwordx4 v1, s[4:7], s100 offen offset:1024 sc1 lds
buffer_load_dwordx4 v1, s[4:7], s100 offen offset:2048 sc1 lds
buffer_load_dwordx4 v1, s[4:7], s100 offen offset:3072 sc1 lds
buffer_load_dwordx4 v[48:51], v1, s[4:7], s65 offen offset:0 sc1
buffer_load_dwordx4 v[52:55], v1, s[4:7], s65 offen offset:1024 sc1
buffer_load_dwordx4 v[56:59], v1, s[4:7], s65 offen offset:2048 sc1
buffer_load_dwordx4 v[60:63], v1, s[4:7], s65 offen offset:3072 sc1
s_mov_b32 s76, 1
s_waitcnt vmcnt(12)
s_branch Lzp_73
Lzp_72:
s_waitcnt vmcnt(0)
Lzp_73:
v_max3_f32 v124, v104, v105, v106
v_max3_f32 v125, v107, v108, v109
v_max3_f32 v124, v124, v110, v111
v_max3_f32 v125, v125, v112, v113
v_max3_f32 v124, v124, v114, v115
v_max_f32 v124, v124, v125
v_mov_b32 v125, v124
s_nop 1
v_permlane16_swap_b32 v124, v125
v_max_f32 v124, v124, v125
v_mov_b32 v125, v124
s_nop 1
v_permlane32_swap_b32 v124, v125
v_max_f32 v124, v124, v125
v_mul_f32 v124, s70, v124
v_fma_f32 v104, v104, s70, -v124
v_fma_f32 v105, v105, s70, -v124
v_fma_f32 v106, v106, s70, -v124
v_fma_f32 v107, v107, s70, -v124
v_fma_f32 v108, v108, s70, -v124
v_fma_f32 v109, v109, s70, -v124
v_fma_f32 v110, v110, s70, -v124
v_fma_f32 v111, v111, s70, -v124
v_fma_f32 v112, v112, s70, -v124
v_fma_f32 v113, v113, s70, -v124
v_fma_f32 v114, v114, s70, -v124
v_fma_f32 v115, v115, s70, -v124
v_exp_f32 v104, v104
v_exp_f32 v105, v105
v_exp_f32 v106, v106
v_exp_f32 v107, v107
v_exp_f32 v108, v108
v_exp_f32 v109, v109
v_exp_f32 v110, v110
v_exp_f32 v111, v111
v_exp_f32 v112, v112
v_exp_f32 v113, v113
v_exp_f32 v114, v114
v_exp_f32 v115, v115
v_cvt_pk_bf16_f32 v120, v104, v105
v_cvt_pk_bf16_f32 v121, v106, v107
v_cvt_pk_bf16_f32 v116, v108, v109
v_cvt_pk_bf16_f32 v117, v110, v111
v_cvt_pk_bf16_f32 v118, v112, v113
v_cvt_pk_bf16_f32 v119, v114, v115
s_nop 1
Lvp_75:
v_max3_u32 v124, v96, v97, v98
v_max3_u32 v125, v99, v100, v101
v_max3_u32 v124, v124, v102, v103
v_max_u32 v124, v124, v125
v_cmp_eq_u32 vcc, -1, v124
s_cbranch_vccz Lvp_76
s_lshl_b32 s60, s67, 12
s_add_u32 s60, s60, s66
buffer_load_dwordx2 v[96:97], v7, s[4:7], s60 offen offset:1024 sc1
buffer_load_dwordx2 v[98:99], v7, s[4:7], s60 offen offset:1280 sc1
buffer_load_dwordx2 v[100:101], v7, s[4:7], s60 offen offset:3072 sc1
buffer_load_dwordx2 v[102:103], v7, s[4:7], s60 offen offset:3328 sc1
s_memtime s[60:61]
s_waitcnt lgkmcnt(0)
s_sub_u32 s60, s60, s46
s_mov_b32 s61, 13
s_cmp_gt_u32 s60, 67108864
s_cbranch_scc1 L_abortH
s_waitcnt vmcnt(0)
s_branch Lvp_75
Lvp_76:
v_mfma_f32_16x16x32_bf16 v[32:35], v[2:5], v[116:119], 0
s_nop 5
v_mfma_f32_16x16x16_bf16 v[32:35], v[2:3], v[120:121], v[32:35]
v_mfma_f32_16x16x32_bf16 v[16:19], v[80:83], v[116:119], 0
v_mfma_f32_16x16x32_bf16 v[20:23], v[84:87], v[116:119], 0
v_mfma_f32_16x16x32_bf16 v[24:27], v[88:91], v[116:119], 0
v_mfma_f32_16x16x32_bf16 v[28:31], v[92:95], v[116:119], 0
s_nop 2
v_mfma_f32_16x16x16_bf16 v[16:19], v[96:97], v[120:121], v[16:19]
v_mfma_f32_16x16x16_bf16 v[20:23], v[98:99], v[120:121], v[20:23]
v_mfma_f32_16x16x16_bf16 v[24:27], v[100:101], v[120:121], v[24:27]
v_mfma_f32_16x16x16_bf16 v[28:31], v[102:103], v[120:121], v[28:31]
v_rcp_f32 v32, v32
s_nop 3
v_pk_mul_f32 v[16:17], v[16:17], v[32:33] op_sel_hi:[1,0]
v_pk_mul_f32 v[18:19], v[18:19], v[32:33] op_sel_hi:[1,0]
v_pk_mul_f32 v[20:21], v[20:21], v[32:33] op_sel_hi:[1,0]
v_pk_mul_f32 v[22:23], v[22:23], v[32:33] op_sel_hi:[1,0]
v_pk_mul_f32 v[24:25], v[24:25], v[32:33] op_sel_hi:[1,0]
v_pk_mul_f32 v[26:27], v[26:27], v[32:33] op_sel_hi:[1,0]
v_pk_mul_f32 v[28:29], v[28:29], v[32:33] op_sel_hi:[1,0]
v_pk_mul_f32 v[30:31], v[30:31], v[32:33] op_sel_hi:[1,0]
v_cvt_pk_bf16_f32 v40, v16, v20
v_cvt_pk_bf16_f32 v41, v17, v21
v_cvt_pk_bf16_f32 v42, v18, v22
v_cvt_pk_bf16_f32 v43, v19, v23
v_cvt_pk_bf16_f32 v44, v24, v28
v_cvt_pk_bf16_f32 v45, v25, v29
v_cvt_pk_bf16_f32 v46, v26, v30
v_cvt_pk_bf16_f32 v47, v27, v31
s_lshl_b32 s60, s68, 18
s_add_u32 s60, s60, 134217728
s_lshl_b32 s61, s58, 13
s_add_u32 s60, s60, s61
s_lshl_b32 s61, s67, 12
s_add_u32 s60, s60, s61
s_lshl_b32 s61, s72, 10
s_add_u32 s60, s60, s61
buffer_store_dwordx4 v[40:43], v1, s[4:7], s60 offen sc1
buffer_store_dwordx4 v[44:47], v1, s[4:7], s60 offen offset:2048 sc1
s_lshl_b32 s61, s47, 2
s_add_u32 s69, s69, s61
s_add_u32 s75, s69, 131072
s_branch L_H0_q
L_H0_noatt:
s_barrier
L_H0_q:
s_cmp_ge_u32 s63, 32
s_cbranch_scc1 L_H0_skip
s_cmp_lg_u32 s76, 0
s_cbranch_scc1 Learly_77
s_waitcnt vmcnt(0)
s_cmp_eq_u32 s75, 0
s_cbranch_scc1 Lnp_78
s_mov_b64 s[98:99], exec
s_mov_b64 exec, 1
buffer_store_dword v4, off, s[4:7], s75 sc1
s_mov_b64 exec, s[98:99]
s_mov_b32 s75, 0
Lnp_78:
s_lshl_b32 s62, s63, 1
s_add_u32 s62, s62, s59
s_lshl_b32 s64, s62, 15
s_add_u32 s64, s64, 10485760
s_lshl_b32 s65, s62, 12
s_add_u32 s65, s65, 12582912
s_add_u32 s100, s77, s92
s_add_u32 m0, s100, 0
s_add_u32 s100, s64, s92
s_add_u32 s100, s100, 0
buffer_load_dwordx4 v1, s[4:7], s100 offen offset:0 sc1 lds
buffer_load_dwordx4 v1, s[4:7], s100 offen offset:1024 sc1 lds
s_add_u32 s100, s77, s92
s_add_u32 m0, s100, 8192
s_add_u32 s100, s64, s92
s_add_u32 s100, s100, 8192
buffer_load_dwordx4 v1, s[4:7], s100 offen offset:0 sc1 lds
buffer_load_dwordx4 v1, s[4:7], s100 offen offset:1024 sc1 lds
s_add_u32 s100, s77, s78
s_add_u32 m0, s100, 16384
s_add_u32 s100, s64, s78
s_add_u32 s100, s100, 16384
buffer_load_dwordx4 v1, s[4:7], s100 offen offset:0 sc1 lds
buffer_load_dwordx4 v1, s[4:7], s100 offen offset:1024 sc1 lds
buffer_load_dwordx4 v1, s[4:7], s100 offen offset:2048 sc1 lds
buffer_load_dwordx4 v1, s[4:7], s100 offen offset:3072 sc1 lds
buffer_load_dwordx4 v[48:51], v1, s[4:7], s65 offen offset:0 sc1
buffer_load_dwordx4 v[52:55], v1, s[4:7], s65 offen offset:1024 sc1
buffer_load_dwordx4 v[56:59], v1, s[4:7], s65 offen offset:2048 sc1
buffer_load_dwordx4 v[60:63], v1, s[4:7], s65 offen offset:3072 sc1
Learly_77:
s_lshl_b32 s62, s63, 1
s_add_u32 s62, s62, s59
s_and_b32 s73, s63, 1
s_mul_i32 s73, s73, 24576
s_mov_b32 s76, 0
v_add_u32 v127, 81920, v1
s_waitcnt vmcnt(10)
s_barrier
v_lshlrev_b32 v124, 3, v0
buffer_store_dwordx2 v[122:123], v124, s[4:7], s94 offen sc1
buffer_store_dwordx2 v[122:123], v124, s[4:7], s94 offen offset:512 sc1
buffer_store_dwordx2 v[122:123], v124, s[4:7], s94 offen offset:1024 sc1
ds_read_b128 v[32:35], v127 offset:0
ds_read_b128 v[36:39], v127 offset:1024
ds_read_b128 v[40:43], v127 offset:2048
ds_read_b128 v[44:47], v127 offset:3072
s_waitcnt lgkmcnt(3)
v_mfma_f32_16x16x32_bf16 v[80:83], a[128:131], v[32:35], 0
v_mfma_f32_16x16x32_bf16 v[88:91], a[192:195], v[32:35], 0
v_mfma_f32_16x16x32_bf16 v[96:99], v[32:35], v[128:131], 0
v_mfma_f32_16x16x32_bf16 v[104:107], v[32:35], v[192:195], 0
ds_read_b128 v[32:35], v127 offset:4096
s_waitcnt lgkmcnt(3)
v_mfma_f32_16x16x32_bf16 v[84:87], a[128:131], v[36:39], 0
v_mfma_f32_16x16x32_bf16 v[92:95], a[192:195], v[36:39], 0
v_mfma_f32_16x16x32_bf16 v[100:103], v[36:39], v[128:131], 0
v_mfma_f32_16x16x32_bf16 v[108:111], v[36:39], v[192:195], 0
ds_read_b128 v[36:39], v127 offset:5120
s_waitcnt lgkmcnt(3)
v_mfma_f32_16x16x32_bf16 v[80:83], a[132:135], v[40:43], v[80:83]
v_mfma_f32_16x16x32_bf16 v[88:91], a[196:199], v[40:43], v[88:91]
v_mfma_f32_16x16x32_bf16 v[96:99], v[40:43], v[132:135], v[96:99]
v_mfma_f32_16x16x32_bf16 v[104:107], v[40:43], v[196:199], v[104:107]
ds_read_b128 v[40:43], v127 offset:6144
s_waitcnt lgkmcnt(3)
v_mfma_f32_16x16x32_bf16 v[84:87], a[132:135], v[44:47], v[84:87]
v_mfma_f32_16x16x32_bf16 v[92:95], a[196:199], v[44:47], v[92:95]
v_mfma_f32_16x16x32_bf16 v[100:103], v[44:47], v[132:135], v[100:103]
v_mfma_f32_16x16x32_bf16 v[108:111], v[44:47], v[196:199], v[108:111]
ds_read_b128 v[44:47], v127 offset:7168
s_waitcnt lgkmcnt(3)
v_mfma_f32_16x16x32_bf16 v[80:83], a[136:139], v[32:35], v[80:83]
v_mfma_f32_16x16x32_bf16 v[88:91], a[200:203], v[32:35], v[88:91]
v_mfma_f32_16x16x32_bf16 v[96:99], v[32:35], v[136:139], v[96:99]
v_mfma_f32_16x16x32_bf16 v[104:107], v[32:35], v[200:203], v[104:107]
s_waitcnt vmcnt(11)
s_barrier
ds_read_b128 v[32:35], v127 offset:8192
s_waitcnt lgkmcnt(3)
v_mfma_f32_16x16x32_bf16 v[84:87], a[136:139], v[36:39], v[84:87]
v_mfma_f32_16x16x32_bf16 v[92:95], a[200:203], v[36:39], v[92:95]
v_mfma_f32_16x16x32_bf16 v[100:103], v[36:39], v[136:139], v[100:103]
v_mfma_f32_16x16x32_bf16 v[108:111], v[36:39], v[200:203], v[108:111]
ds_read_b128 v[36:39], v127 offset:9216
s_waitcnt lgkmcnt(3)
v_mfma_f32_16x16x32_bf16 v[80:83], a[140:143], v[40:43], v[80:83]
v_mfma_f32_16x16x32_bf16 v[88:91], a[204:207], v[40:43], v[88:91]
v_mfma_f32_16x16x32_bf16 v[96:99], v[40:43], v[140:143], v[96:99]
v_mfma_f32_16x16x32_bf16 v[104:107], v[40:43], v[204:207], v[104:107]
ds_read_b128 v[40:43], v127 offset:10240
s_waitcnt lgkmcnt(3)
v_mfma_f32_16x16x32_bf16 v[84:87], a[140:143], v[44:47], v[84:87]
v_mfma_f32_16x16x32_bf16 v[92:95], a[204:207], v[44:47], v[92:95]
v_mfma_f32_16x16x32_bf16 v[100:103], v[44:47], v[140:143], v[100:103]
v_mfma_f32_16x16x32_bf16 v[108:111], v[44:47], v[204:207], v[108:111]
ds_read_b128 v[44:47], v127 offset:11264
s_waitcnt lgkmcnt(3)
v_mfma_f32_16x16x32_bf16 v[80:83], a[144:147], v[32:35], v[80:83]
s_cmp_eq_u32 s75, 0
s_cbranch_scc1 Lnf_79
s_waitcnt vmcnt(3)
s_cmp_eq_u32 s75, 0
s_cbranch_scc1 Lnp_80
s_mov_b64 s[98:99], exec
s_mov_b64 exec, 1
buffer_store_dword v4, off, s[4:7], s75 sc1
s_mov_b64 exec, s[98:99]
s_mov_b32 s75, 0
Lnp_80:
Lnf_79:
v_mfma_f32_16x16x32_bf16 v[88:91], a[208:211], v[32:35], v[88:91]
v_mfma_f32_16x16x32_bf16 v[96:99], v[32:35], v[144:147], v[96:99]
v_mfma_f32_16x16x32_bf16 v[104:107], v[32:35], v[208:211], v[104:107]
ds_read_b128 v[32:35], v127 offset:12288
s_waitcnt lgkmcnt(3)
v_mfma_f32_16x16x32_bf16 v[84:87], a[144:147], v[36:39], v[84:87]
v_mfma_f32_16x16x32_bf16 v[92:95], a[208:211], v[36:39], v[92:95]
v_mfma_f32_16x16x32_bf16 v[100:103], v[36:39], v[144:147], v[100:103]
v_mfma_f32_16x16x32_bf16 v[108:111], v[36:39], v[208:211], v[108:111]
ds_read_b128 v[36:39], v127 offset:13312
s_waitcnt lgkmcnt(3)
v_mfma_f32_16x16x32_bf16 v[80:83], a[148:151], v[40:43], v[80:83]
v_mfma_f32_16x16x32_bf16 v[88:91], a[212:215], v[40:43], v[88:91]
v_mfma_f32_16x16x32_bf16 v[96:99], v[40:43], v[148:151], v[96:99]
v_mfma_f32_16x16x32_bf16 v[104:107], v[40:43], v[212:215], v[104:107]
ds_read_b128 v[40:43], v127 offset:14336
s_waitcnt lgkmcnt(3)
v_mfma_f32_16x16x32_bf16 v[84:87], a[148:151], v[44:47], v[84:87]
v_mfma_f32_16x16x32_bf16 v[92:95], a[212:215], v[44:47], v[92:95]
v_mfma_f32_16x16x32_bf16 v[100:103], v[44:47], v[148:151], v[100:103]
v_mfma_f32_16x16x32_bf16 v[108:111], v[44:47], v[212:215], v[108:111]
ds_read_b128 v[44:47], v127 offset:15360
s_waitcnt lgkmcnt(3)
v_mfma_f32_16x16x32_bf16 v[80:83], a[152:155], v[32:35], v[80:83]
v_mfma_f32_16x16x32_bf16 v[88:91], a[216:219], v[32:35], v[88:91]
v_mfma_f32_16x16x32_bf16 v[96:99], v[32:35], v[152:155], v[96:99]
v_mfma_f32_16x16x32_bf16 v[104:107], v[32:35], v[216:219], v[104:107]
s_waitcnt vmcnt(7)
s_barrier
ds_read_b128 v[32:35], v127 offset:16384
s_waitcnt lgkmcnt(3)
v_mfma_f32_16x16x32_bf16 v[84:87], a[152:155], v[36:39], v[84:87]
v_mfma_f32_16x16x32_bf16 v[92:95], a[216:219], v[36:39], v[92:95]
v_mfma_f32_16x16x32_bf16 v[100:103], v[36:39], v[152:155], v[100:103]
v_mfma_f32_16x16x32_bf16 v[108:111], v[36:39], v[216:219], v[108:111]
ds_read_b128 v[36:39], v127 offset:17408
s_waitcnt lgkmcnt(3)
v_mfma_f32_16x16x32_bf16 v[80:83], a[156:159], v[40:43], v[80:83]
v_mfma_f32_16x16x32_bf16 v[88:91], a[220:223], v[40:43], v[88:91]
v_mfma_f32_16x16x32_bf16 v[96:99], v[40:43], v[156:159], v[96:99]
v_mfma_f32_16x16x32_bf16 v[104:107], v[40:43], v[220:223], v[104:107]
ds_read_b128 v[40:43], v127 offset:18432
s_waitcnt lgkmcnt(3)
v_mfma_f32_16x16x32_bf16 v[84:87], a[156:159], v[44:47], v[84:87]
v_mfma_f32_16x16x32_bf16 v[92:95], a[220:223], v[44:47], v[92:95]
v_mfma_f32_16x16x32_bf16 v[100:103], v[44:47], v[156:159], v[100:103]
v_mfma_f32_16x16x32_bf16 v[108:111], v[44:47], v[220:223], v[108:111]
ds_read_b128 v[44:47], v127 offset:19456
s_waitcnt lgkmcnt(3)
v_mfma_f32_16x16x32_bf16 v[80:83], a[160:163], v[32:35], v[80:83]
s_waitcnt vmcnt(3)
v_add_f32 v48, v48, v49
v_mfma_f32_16x16x32_bf16 v[88:91], a[224:227], v[32:35], v[88:91]
v_add_f32 v50, v50, v51
v_mfma_f32_16x16x32_bf16 v[96:99], v[32:35], v[160:163], v[96:99]
v_add_f32 v52, v52, v53
v_mfma_f32_16x16x32_bf16 v[104:107], v[32:35], v[224:227], v[104:107]
v_add_f32 v54, v54, v55
ds_read_b128 v[32:35], v127 offset:20480
s_waitcnt lgkmcnt(3)
v_mfma_f32_16x16x32_bf16 v[84:87], a[160:163], v[36:39], v[84:87]
v_add_f32 v56, v56, v57
v_mfma_f32_16x16x32_bf16 v[92:95], a[224:227], v[36:39], v[92:95]
v_add_f32 v58, v58, v59
v_mfma_f32_16x16x32_bf16 v[100:103], v[36:39], v[160:163], v[100:103]
v_add_f32 v60, v60, v61
v_mfma_f32_16x16x32_bf16 v[108:111], v[36:39], v[224:227], v[108:111]
v_add_f32 v62, v62, v63
ds_read_b128 v[36:39], v127 offset:21504
s_waitcnt lgkmcnt(3)
v_mfma_f32_16x16x32_bf16 v[80:83], a[164:167], v[40:43], v[80:83]
v_add_f32 v48, v48, v50
v_mfma_f32_16x16x32_bf16 v[88:91], a[228:231], v[40:43], v[88:91]
v_add_f32 v52, v52, v54
v_mfma_f32_16x16x32_bf16 v[96:99], v[40:43], v[164:167], v[96:99]
v_add_f32 v56, v56, v58
v_mfma_f32_16x16x32_bf16 v[104:107], v[40:43], v[228:231], v[104:107]
v_add_f32 v60, v60, v62
ds_read_b128 v[40:43], v127 offset:22528
s_waitcnt lgkmcnt(3)
v_mfma_f32_16x16x32_bf16 v[84:87], a[164:167], v[44:47], v[84:87]
v_add_f32 v48, v48, v52
v_mfma_f32_16x16x32_bf16 v[92:95], a[228:231], v[44:47], v[92:95]
v_add_f32 v56, v56, v60
v_mfma_f32_16x16x32_bf16 v[100:103], v[44:47], v[164:167], v[100:103]
v_add_f32 v112, v48, v56
v_mfma_f32_16x16x32_bf16 v[108:111], v[44:47], v[228:231], v[108:111]
ds_read_b128 v[44:47], v127 offset:23552
s_waitcnt lgkmcnt(3)
v_mfma_f32_16x16x32_bf16 v[80:83], a[168:171], v[32:35], v[80:83]
v_mfma_f32_16x16x32_bf16 v[88:91], a[232:235], v[32:35], v[88:91]
v_mfma_f32_16x16x32_bf16 v[96:99], v[32:35], v[168:171], v[96:99]
v_mfma_f32_16x16x32_bf16 v[104:107], v[32:35], v[232:235], v[104:107]
ds_read_b128 v[32:35], v127 offset:24576
s_waitcnt lgkmcnt(3)
v_mfma_f32_16x16x32_bf16 v[84:87], a[168:171], v[36:39], v[84:87]
v_mfma_f32_16x16x32_bf16 v[92:95], a[232:235], v[36:39], v[92:95]
v_mfma_f32_16x16x32_bf16 v[100:103], v[36:39], v[168:171], v[100:103]
v_mfma_f32_16x16x32_bf16 v[108:111], v[36:39], v[232:235], v[108:111]
ds_read_b128 v[36:39], v127 offset:25600
s_waitcnt lgkmcnt(3)
v_mfma_f32_16x16x32_bf16 v[80:83], a[172:175], v[40:43], v[80:83]
v_mfma_f32_16x16x32_bf16 v[88:91], a[236:239], v[40:43], v[88:91]
v_mfma_f32_16x16x32_bf16 v[96:99], v[40:43], v[172:175], v[96:99]
v_mfma_f32_16x16x32_bf16 v[104:107], v[40:43], v[236:239], v[104:107]
ds_read_b128 v[40:43], v127 offset:26624
s_waitcnt lgkmcnt(3)
v_mfma_f32_16x16x32_bf16 v[84:87], a[172:175], v[44:47], v[84:87]
v_mfma_f32_16x16x32_bf16 v[92:95], a[236:239], v[44:47], v[92:95]
v_mfma_f32_16x16x32_bf16 v[100:103], v[44:47], v[172:175], v[100:103]
v_mfma_f32_16x16x32_bf16 v[108:111], v[44:47], v[236:239], v[108:111]
ds_read_b128 v[44:47], v127 offset:27648
s_waitcnt lgkmcnt(3)
v_mfma_f32_16x16x32_bf16 v[80:83], a[176:179], v[32:35], v[80:83]
v_mov_b32 v113, v112
s_nop 1
v_permlane32_swap_b32 v112, v113
v_mul_f32 v112, 0x3b000000, v112
v_mul_f32 v113, 0x3b000000, v113
v_fma_f32 v113, -v112, v112, v113
v_max_f32 v113, 0, v113
v_add_f32 v113, 0x3727c5ac, v113
v_rsq_f32 v113, v113
s_nop 0
v_mul_f32 v112, -v112, v113
ds_write_b32 v10, v113
ds_write_b32 v10, v112 offset:128
v_mfma_f32_16x16x32_bf16 v[88:91], a[240:243], v[32:35], v[88:91]
v_mfma_f32_16x16x32_bf16 v[96:99], v[32:35], v[176:179], v[96:99]
v_mfma_f32_16x16x32_bf16 v[104:107], v[32:35], v[240:243], v[104:107]
ds_read_b128 v[32:35], v127 offset:28672
s_waitcnt lgkmcnt(3)
v_mfma_f32_16x16x32_bf16 v[84:87], a[176:179], v[36:39], v[84:87]
v_mfma_f32_16x16x32_bf16 v[92:95], a[240:243], v[36:39], v[92:95]
v_mfma_f32_16x16x32_bf16 v[100:103], v[36:39], v[176:179], v[100:103]
v_mfma_f32_16x16x32_bf16 v[108:111], v[36:39], v[240:243], v[108:111]
ds_read_b128 v[36:39], v127 offset:29696
s_waitcnt lgkmcnt(3)
v_mfma_f32_16x16x32_bf16 v[80:83], a[180:183], v[40:43], v[80:83]
v_mfma_f32_16x16x32_bf16 v[88:91], a[244:247], v[40:43], v[88:91]
v_mfma_f32_16x16x32_bf16 v[96:99], v[40:43], v[180:183], v[96:99]
v_mfma_f32_16x16x32_bf16 v[104:107], v[40:43], v[244:247], v[104:107]
ds_read_b128 v[40:43], v127 offset:30720
s_waitcnt lgkmcnt(3)
v_mfma_f32_16x16x32_bf16 v[84:87], a[180:183], v[44:47], v[84:87]
v_mfma_f32_16x16x32_bf16 v[92:95], a[244:247], v[44:47], v[92:95]
v_mfma_f32_16x16x32_bf16 v[100:103], v[44:47], v[180:183], v[100:103]
v_mfma_f32_16x16x32_bf16 v[108:111], v[44:47], v[244:247], v[108:111]
ds_read_b128 v[44:47], v127 offset:31744
s_waitcnt lgkmcnt(3)
v_mfma_f32_16x16x32_bf16 v[80:83], a[184:187], v[32:35], v[80:83]
v_mfma_f32_16x16x32_bf16 v[88:91], a[248:251], v[32:35], v[88:91]
v_mfma_f32_16x16x32_bf16 v[96:99], v[32:35], v[184:187], v[96:99]
v_mfma_f32_16x16x32_bf16 v[104:107], v[32:35], v[248:251], v[104:107]
s_waitcnt lgkmcnt(2)
v_mfma_f32_16x16x32_bf16 v[84:87], a[184:187], v[36:39], v[84:87]
v_mfma_f32_16x16x32_bf16 v[92:95], a[248:251], v[36:39], v[92:95]
v_mfma_f32_16x16x32_bf16 v[100:103], v[36:39], v[184:187], v[100:103]
v_mfma_f32_16x16x32_bf16 v[108:111], v[36:39], v[248:251], v[108:111]
s_waitcnt lgkmcnt(1)
v_mfma_f32_16x16x32_bf16 v[80:83], a[188:191], v[40:43], v[80:83]
v_mfma_f32_16x16x32_bf16 v[88:91], a[252:255], v[40:43], v[88:91]
v_mfma_f32_16x16x32_bf16 v[96:99], v[40:43], v[188:191], v[96:99]
v_mfma_f32_16x16x32_bf16 v[104:107], v[40:43], v[252:255], v[104:107]
s_waitcnt lgkmcnt(0)
v_mfma_f32_16x16x32_bf16 v[84:87], a[188:191], v[44:47], v[84:87]
v_mfma_f32_16x16x32_bf16 v[92:95], a[252:255], v[44:47], v[92:95]
v_mfma_f32_16x16x32_bf16 v[100:103], v[44:47], v[188:191], v[100:103]
v_mfma_f32_16x16x32_bf16 v[108:111], v[44:47], v[252:255], v[108:111]
ds_read_b128 v[16:19], v11 offset:0
ds_read_b128 v[20:23], v11 offset:1024
ds_read_b128 v[24:27], v11 offset:2048
ds_read_b128 v[28:31], v11 offset:3072
ds_read_b32 v116, v8
ds_read_b32 v117, v8 offset:128
ds_read_b32 v118, v8 offset:64
ds_read_b32 v119, v8 offset:192
ds_read_b128 v[32:35], v9
ds_read_b128 v[36:39], v9 offset:64
ds_read_b128 v[40:43], v9 offset:128
ds_read_b128 v[44:47], v9 offset:192
s_lshl_b32 s64, s62, 5
s_add_u32 s64, s64, s58
s_lshl_b32 s64, s64, 2
s_add_u32 s64, s64, s47
s_add_u32 s64, s64, 0
s_lshl_b32 s65, s64, 12
s_add_u32 s65, s65, 33554432
s_and_b32 s65, s65, 0xfe3fffff
s_lshl_b32 s64, s64, 2
s_lshl_b32 s60, s47, 11
s_add_u32 s60, s60, s73
v_add_u32 v125, s60, v1
s_waitcnt lgkmcnt(4)
v_pk_mul_f32 v[120:121], v[24:25], v[116:117] op_sel:[0,1] op_sel_hi:[1,1]
v_pk_fma_f32 v[80:81], v[80:81], v[116:117], v[120:121] op_sel:[0,0,0] op_sel_hi:[1,0,1]
v_pk_mul_f32 v[120:121], v[26:27], v[116:117] op_sel:[0,1] op_sel_hi:[1,1]
v_pk_fma_f32 v[82:83], v[82:83], v[116:117], v[120:121] op_sel:[0,0,0] op_sel_hi:[1,0,1]
v_pk_mul_f32 v[120:121], v[24:25], v[118:119] op_sel:[0,1] op_sel_hi:[1,1]
v_pk_fma_f32 v[84:85], v[84:85], v[118:119], v[120:121] op_sel:[0,0,0] op_sel_hi:[1,0,1]
v_pk_mul_f32 v[120:121], v[26:27], v[118:119] op_sel:[0,1] op_sel_hi:[1,1]
v_pk_fma_f32 v[86:87], v[86:87], v[118:119], v[120:121] op_sel:[0,0,0] op_sel_hi:[1,0,1]
v_pk_mul_f32 v[120:121], v[28:29], v[116:117] op_sel:[0,1] op_sel_hi:[1,1]
v_pk_fma_f32 v[88:89], v[88:89], v[116:117], v[120:121] op_sel:[0,0,0] op_sel_hi:[1,0,1]
v_pk_mul_f32 v[120:121], v[30:31], v[116:117] op_sel:[0,1] op_sel_hi:[1,1]
v_pk_fma_f32 v[90:91], v[90:91], v[116:117], v[120:121] op_sel:[0,0,0] op_sel_hi:[1,0,1]
v_pk_mul_f32 v[120:121], v[28:29], v[118:119] op_sel:[0,1] op_sel_hi:[1,1]
v_pk_fma_f32 v[92:93], v[92:93], v[118:119], v[120:121] op_sel:[0,0,0] op_sel_hi:[1,0,1]
v_pk_mul_f32 v[120:121], v[30:31], v[118:119] op_sel:[0,1] op_sel_hi:[1,1]
v_pk_fma_f32 v[94:95], v[94:95], v[118:119], v[120:121] op_sel:[0,0,0] op_sel_hi:[1,0,1]
v_cvt_pk_bf16_f32 v56, v80, v88
v_cvt_pk_bf16_f32 v57, v81, v89
v_cvt_pk_bf16_f32 v58, v82, v90
v_cvt_pk_bf16_f32 v59, v83, v91
v_cvt_pk_bf16_f32 v60, v84, v92
v_cvt_pk_bf16_f32 v61, v85, v93
v_cvt_pk_bf16_f32 v62, v86, v94
v_cvt_pk_bf16_f32 v63, v87, v95
buffer_store_dwordx4 v[56:59], v1, s[4:7], s65 offen sc1
buffer_store_dwordx4 v[60:63], v1, s[4:7], s65 offen offset:1024 sc1
s_waitcnt lgkmcnt(0)
ds_write_b128 v125, v[56:59] offset:8192
ds_write_b128 v125, v[60:63] offset:9216
v_pk_mul_f32 v[120:121], v[40:41], v[12:13] op_sel:[0,0] op_sel_hi:[1,0]
v_pk_fma_f32 v[96:97], v[96:97], v[32:33], v[120:121]
v_pk_mul_f32 v[120:121], v[42:43], v[12:13] op_sel:[0,0] op_sel_hi:[1,0]
v_pk_fma_f32 v[98:99], v[98:99], v[34:35], v[120:121]
v_pk_mul_f32 v[120:121], v[44:45], v[12:13] op_sel:[0,0] op_sel_hi:[1,0]
v_pk_fma_f32 v[100:101], v[100:101], v[36:37], v[120:121]
v_pk_mul_f32 v[120:121], v[46:47], v[12:13] op_sel:[0,0] op_sel_hi:[1,0]
v_pk_fma_f32 v[102:103], v[102:103], v[38:39], v[120:121]
v_cvt_pk_bf16_f32 v24, v96, v97
v_cvt_pk_bf16_f32 v25, v98, v99
v_cvt_pk_bf16_f32 v26, v100, v101
v_cvt_pk_bf16_f32 v27, v102, v103
buffer_store_dwordx4 v[24:27], v1, s[4:7], s65 offen offset:2048 sc1
ds_write_b128 v125, v[24:27] offset:16384
v_pk_mul_f32 v[120:121], v[40:41], v[12:13] op_sel:[0,1] op_sel_hi:[1,1]
v_pk_fma_f32 v[104:105], v[104:105], v[32:33], v[120:121]
v_pk_mul_f32 v[120:121], v[42:43], v[12:13] op_sel:[0,1] op_sel_hi:[1,1]
v_pk_fma_f32 v[106:107], v[106:107], v[34:35], v[120:121]
v_pk_mul_f32 v[120:121], v[44:45], v[12:13] op_sel:[0,1] op_sel_hi:[1,1]
v_pk_fma_f32 v[108:109], v[108:109], v[36:37], v[120:121]
v_pk_mul_f32 v[120:121], v[46:47], v[12:13] op_sel:[0,1] op_sel_hi:[1,1]
v_pk_fma_f32 v[110:111], v[110:111], v[38:39], v[120:121]
v_cvt_pk_bf16_f32 v28, v104, v105
v_cvt_pk_bf16_f32 v29, v106, v107
v_cvt_pk_bf16_f32 v30, v108, v109
v_cvt_pk_bf16_f32 v31, v110, v111
buffer_store_dwordx4 v[28:31], v1, s[4:7], s65 offen offset:3072 sc1
ds_write_b128 v125, v[28:31] offset:17408
s_add_u32 s75, s64, 65536
ds_read_b128 v[32:35], v127 offset:0
ds_read_b128 v[36:39], v127 offset:1024
ds_read_b128 v[40:43], v127 offset:2048
ds_read_b128 v[44:47], v127 offset:3072
s_waitcnt lgkmcnt(3)
v_mfma_f32_16x16x32_bf16 v[64:67], a[0:3], v[32:35], 0
v_mfma_f32_16x16x32_bf16 v[72:75], a[64:67], v[32:35], 0
ds_read_b128 v[32:35], v127 offset:4096
s_waitcnt lgkmcnt(3)
v_mfma_f32_16x16x32_bf16 v[68:71], a[0:3], v[36:39], 0
v_mfma_f32_16x16x32_bf16 v[76:79], a[64:67], v[36:39], 0
ds_read_b128 v[36:39], v127 offset:5120
s_waitcnt lgkmcnt(3)
v_mfma_f32_16x16x32_bf16 v[64:67], a[4:7], v[40:43], v[64:67]
v_mfma_f32_16x16x32_bf16 v[72:75], a[68:71], v[40:43], v[72:75]
ds_read_b128 v[40:43], v127 offset:6144
s_waitcnt lgkmcnt(3)
v_mfma_f32_16x16x32_bf16 v[68:71], a[4:7], v[44:47], v[68:71]
v_mfma_f32_16x16x32_bf16 v[76:79], a[68:71], v[44:47], v[76:79]
ds_read_b128 v[44:47], v127 offset:7168
s_waitcnt lgkmcnt(3)
v_mfma_f32_16x16x32_bf16 v[64:67], a[8:11], v[32:35], v[64:67]
v_mfma_f32_16x16x32_bf16 v[72:75], a[72:75], v[32:35], v[72:75]
ds_read_b128 v[32:35], v127 offset:8192
s_waitcnt lgkmcnt(3)
v_mfma_f32_16x16x32_bf16 v[68:71], a[8:11], v[36:39], v[68:71]
v_mfma_f32_16x16x32_bf16 v[76:79], a[72:75], v[36:39], v[76:79]
ds_read_b128 v[36:39], v127 offset:9216
s_waitcnt lgkmcnt(3)
v_mfma_f32_16x16x32_bf16 v[64:67], a[12:15], v[40:43], v[64:67]
v_mfma_f32_16x16x32_bf16 v[72:75], a[76:79], v[40:43], v[72:75]
ds_read_b128 v[40:43], v127 offset:10240
s_waitcnt lgkmcnt(3)
v_mfma_f32_16x16x32_bf16 v[68:71], a[12:15], v[44:47], v[68:71]
v_mfma_f32_16x16x32_bf16 v[76:79], a[76:79], v[44:47], v[76:79]
ds_read_b128 v[44:47], v127 offset:11264
s_waitcnt lgkmcnt(3)
v_mfma_f32_16x16x32_bf16 v[64:67], a[16:19], v[32:35], v[64:67]
v_mfma_f32_16x16x32_bf16 v[72:75], a[80:83], v[32:35], v[72:75]
ds_read_b128 v[32:35], v127 offset:12288
s_waitcnt lgkmcnt(3)
v_mfma_f32_16x16x32_bf16 v[68:71], a[16:19], v[36:39], v[68:71]
v_mfma_f32_16x16x32_bf16 v[76:79], a[80:83], v[36:39], v[76:79]
ds_read_b128 v[36:39], v127 offset:13312
s_waitcnt lgkmcnt(3)
v_mfma_f32_16x16x32_bf16 v[64:67], a[20:23], v[40:43], v[64:67]
v_mfma_f32_16x16x32_bf16 v[72:75], a[84:87], v[40:43], v[72:75]
ds_read_b128 v[40:43], v127 offset:14336
s_waitcnt lgkmcnt(3)
v_mfma_f32_16x16x32_bf16 v[68:71], a[20:23], v[44:47], v[68:71]
v_mfma_f32_16x16x32_bf16 v[76:79], a[84:87], v[44:47], v[76:79]
ds_read_b128 v[44:47], v127 offset:15360
s_waitcnt lgkmcnt(3)
v_mfma_f32_16x16x32_bf16 v[64:67], a[24:27], v[32:35], v[64:67]
v_mfma_f32_16x16x32_bf16 v[72:75], a[88:91], v[32:35], v[72:75]
ds_read_b128 v[32:35], v127 offset:16384
s_waitcnt lgkmcnt(3)
v_mfma_f32_16x16x32_bf16 v[68:71], a[24:27], v[36:39], v[68:71]
v_mfma_f32_16x16x32_bf16 v[76:79], a[88:91], v[36:39], v[76:79]
ds_read_b128 v[36:39], v127 offset:17408
s_waitcnt lgkmcnt(3)
v_mfma_f32_16x16x32_bf16 v[64:67], a[28:31], v[40:43], v[64:67]
v_mfma_f32_16x16x32_bf16 v[72:75], a[92:95], v[40:43], v[72:75]
ds_read_b128 v[40:43], v127 offset:18432
s_waitcnt lgkmcnt(3)
v_mfma_f32_16x16x32_bf16 v[68:71], a[28:31], v[44:47], v[68:71]
v_mfma_f32_16x16x32_bf16 v[76:79], a[92:95], v[44:47], v[76:79]
ds_read_b128 v[44:47], v127 offset:19456
s_waitcnt lgkmcnt(3)
v_mfma_f32_16x16x32_bf16 v[64:67], a[32:35], v[32:35], v[64:67]
v_mfma_f32_16x16x32_bf16 v[72:75], a[96:99], v[32:35], v[72:75]
ds_read_b128 v[32:35], v127 offset:20480
s_waitcnt lgkmcnt(3)
v_mfma_f32_16x16x32_bf16 v[68:71], a[32:35], v[36:39], v[68:71]
v_mfma_f32_16x16x32_bf16 v[76:79], a[96:99], v[36:39], v[76:79]
ds_read_b128 v[36:39], v127 offset:21504
s_waitcnt lgkmcnt(3)
v_mfma_f32_16x16x32_bf16 v[64:67], a[36:39], v[40:43], v[64:67]
v_mfma_f32_16x16x32_bf16 v[72:75], a[100:103], v[40:43], v[72:75]
ds_read_b128 v[40:43], v127 offset:22528
s_waitcnt lgkmcnt(3)
v_mfma_f32_16x16x32_bf16 v[68:71], a[36:39], v[44:47], v[68:71]
v_mfma_f32_16x16x32_bf16 v[76:79], a[100:103], v[44:47], v[76:79]
ds_read_b128 v[44:47], v127 offset:23552
s_waitcnt lgkmcnt(3)
v_mfma_f32_16x16x32_bf16 v[64:67], a[40:43], v[32:35], v[64:67]
v_mfma_f32_16x16x32_bf16 v[72:75], a[104:107], v[32:35], v[72:75]
ds_read_b128 v[32:35], v127 offset:24576
s_waitcnt lgkmcnt(3)
v_mfma_f32_16x16x32_bf16 v[68:71], a[40:43], v[36:39], v[68:71]
v_mfma_f32_16x16x32_bf16 v[76:79], a[104:107], v[36:39], v[76:79]
ds_read_b128 v[36:39], v127 offset:25600
s_waitcnt lgkmcnt(3)
v_mfma_f32_16x16x32_bf16 v[64:67], a[44:47], v[40:43], v[64:67]
v_mfma_f32_16x16x32_bf16 v[72:75], a[108:111], v[40:43], v[72:75]
ds_read_b128 v[40:43], v127 offset:26624
s_waitcnt lgkmcnt(3)
v_mfma_f32_16x16x32_bf16 v[68:71], a[44:47], v[44:47], v[68:71]
v_mfma_f32_16x16x32_bf16 v[76:79], a[108:111], v[44:47], v[76:79]
ds_read_b128 v[44:47], v127 offset:27648
s_waitcnt lgkmcnt(3)
v_mfma_f32_16x16x32_bf16 v[64:67], a[48:51], v[32:35], v[64:67]
v_mfma_f32_16x16x32_bf16 v[72:75], a[112:115], v[32:35], v[72:75]
ds_read_b128 v[32:35], v127 offset:28672
s_waitcnt lgkmcnt(3)
v_mfma_f32_16x16x32_bf16 v[68:71], a[48:51], v[36:39], v[68:71]
v_mfma_f32_16x16x32_bf16 v[76:79], a[112:115], v[36:39], v[76:79]
ds_read_b128 v[36:39], v127 offset:29696
s_waitcnt lgkmcnt(3)
v_mfma_f32_16x16x32_bf16 v[64:67], a[52:55], v[40:43], v[64:67]
v_mfma_f32_16x16x32_bf16 v[72:75], a[116:119], v[40:43], v[72:75]
ds_read_b128 v[40:43], v127 offset:30720
s_waitcnt lgkmcnt(3)
v_mfma_f32_16x16x32_bf16 v[68:71], a[52:55], v[44:47], v[68:71]
v_mfma_f32_16x16x32_bf16 v[76:79], a[116:119], v[44:47], v[76:79]
ds_read_b128 v[44:47], v127 offset:31744
s_waitcnt lgkmcnt(3)
v_mfma_f32_16x16x32_bf16 v[64:67], a[56:59], v[32:35], v[64:67]
s_waitcnt vmcnt(0)
s_cmp_eq_u32 s75, 0
s_cbranch_scc1 Lnp_81
s_mov_b64 s[98:99], exec
s_mov_b64 exec, 1
buffer_store_dword v4, off, s[4:7], s75 sc1
s_mov_b64 exec, s[98:99]
s_mov_b32 s75, 0
Lnp_81:
v_mfma_f32_16x16x32_bf16 v[72:75], a[120:123], v[32:35], v[72:75]
s_waitcnt lgkmcnt(2)
v_mfma_f32_16x16x32_bf16 v[68:71], a[56:59], v[36:39], v[68:71]
v_mfma_f32_16x16x32_bf16 v[76:79], a[120:123], v[36:39], v[76:79]
s_waitcnt lgkmcnt(1)
v_mfma_f32_16x16x32_bf16 v[64:67], a[60:63], v[40:43], v[64:67]
v_mfma_f32_16x16x32_bf16 v[72:75], a[124:127], v[40:43], v[72:75]
s_waitcnt lgkmcnt(0)
v_mfma_f32_16x16x32_bf16 v[68:71], a[60:63], v[44:47], v[68:71]
v_mfma_f32_16x16x32_bf16 v[76:79], a[124:127], v[44:47], v[76:79]
v_pk_mul_f32 v[120:121], v[16:17], v[116:117] op_sel:[0,1] op_sel_hi:[1,1]
s_nop 2
v_pk_fma_f32 v[64:65], v[64:65], v[116:117], v[120:121] op_sel:[0,0,0] op_sel_hi:[1,0,1]
v_pk_mul_f32 v[120:121], v[18:19], v[116:117] op_sel:[0,1] op_sel_hi:[1,1]
v_pk_fma_f32 v[66:67], v[66:67], v[116:117], v[120:121] op_sel:[0,0,0] op_sel_hi:[1,0,1]
v_pk_mul_f32 v[120:121], v[16:17], v[118:119] op_sel:[0,1] op_sel_hi:[1,1]
v_pk_fma_f32 v[68:69], v[68:69], v[118:119], v[120:121] op_sel:[0,0,0] op_sel_hi:[1,0,1]
v_pk_mul_f32 v[120:121], v[18:19], v[118:119] op_sel:[0,1] op_sel_hi:[1,1]
v_pk_fma_f32 v[70:71], v[70:71], v[118:119], v[120:121] op_sel:[0,0,0] op_sel_hi:[1,0,1]
v_pk_mul_f32 v[120:121], v[20:21], v[116:117] op_sel:[0,1] op_sel_hi:[1,1]
v_pk_fma_f32 v[72:73], v[72:73], v[116:117], v[120:121] op_sel:[0,0,0] op_sel_hi:[1,0,1]
v_pk_mul_f32 v[120:121], v[22:23], v[116:117] op_sel:[0,1] op_sel_hi:[1,1]
v_pk_fma_f32 v[74:75], v[74:75], v[116:117], v[120:121] op_sel:[0,0,0] op_sel_hi:[1,0,1]
v_pk_mul_f32 v[120:121], v[20:21], v[118:119] op_sel:[0,1] op_sel_hi:[1,1]
v_pk_fma_f32 v[76:77], v[76:77], v[118:119], v[120:121] op_sel:[0,0,0] op_sel_hi:[1,0,1]
v_pk_mul_f32 v[120:121], v[22:23], v[118:119] op_sel:[0,1] op_sel_hi:[1,1]
v_pk_fma_f32 v[78:79], v[78:79], v[118:119], v[120:121] op_sel:[0,0,0] op_sel_hi:[1,0,1]
v_cvt_pk_bf16_f32 v48, v64, v72
v_cvt_pk_bf16_f32 v49, v65, v73
v_cvt_pk_bf16_f32 v50, v66, v74
v_cvt_pk_bf16_f32 v51, v67, v75
v_cvt_pk_bf16_f32 v52, v68, v76
v_cvt_pk_bf16_f32 v53, v69, v77
v_cvt_pk_bf16_f32 v54, v70, v78
v_cvt_pk_bf16_f32 v55, v71, v79
ds_write_b128 v125, v[48:51]
ds_write_b128 v125, v[52:55] offset:1024
L_H0_skip:
s_add_u32 s74, s74, 1
s_cmp_lt_i32 s74, 32
s_cbranch_scc1 L_H0_loop
s_waitcnt vmcnt(0)
s_cmp_eq_u32 s75, 0
s_cbranch_scc1 Lnp_82
s_mov_b64 s[98:99], exec
s_mov_b64 exec, 1
buffer_store_dword v4, off, s[4:7], s75 sc1
s_mov_b64 exec, s[98:99]
s_mov_b32 s75, 0
Lnp_82:
s_endpgm
L_H1_main:
s_mov_b64 exec, 1
v_mov_b32 v33, 136
s_nop 1
Lgb_85:
buffer_load_dword v32, v33, s[8:11], 0 offen sc1
s_memtime s[60:61]
s_waitcnt lgkmcnt(0)
s_sub_u32 s60, s60, s46
s_mov_b32 s61, 2
s_cmp_gt_u32 s60, 67108864
s_cbranch_scc1 L_abortH
s_waitcnt vmcnt(0)
v_readfirstlane_b32 s60, v32
s_and_b32 s61, s60, 0xffff
s_cmp_lt_u32 s61, 256
s_cbranch_scc1 Lgb_85
s_mov_b64 exec, -1
s_lshl_b32 s61, s58, 1
s_add_u32 s61, s61, s59
s_lshl_b32 s61, s61, 2
s_add_u32 s61, s61, s47
s_mul_i32 s60, s61, 8192
v_mul_u32_u24 v32, 128, v0
v_add_u32 v32, s60, v32
s_sleep 64
s_sleep 64
s_sleep 64
s_sleep 64
s_sleep 64
s_sleep 64
v_and_b32 v32, 0xfffff, v32
s_cmp_ge_u32 s61, 128
s_mov_b32 s60, 0x400000
s_cselect_b32 s60, 0xd00000, s60
buffer_load_dword v33, v32, s[4:7], s60 offen sc1
s_waitcnt vmcnt(12)
s_mov_b32 s60, 0x1000000
s_cselect_b32 s60, 0x800000, s60
buffer_load_dword v33, v32, s[4:7], s60 offen sc1
s_waitcnt vmcnt(12)
s_mov_b32 s60, 0xc00000
s_cselect_b32 s60, 0x2200000, s60
buffer_load_dword v33, v32, s[4:7], s60 offen sc1
s_waitcnt vmcnt(12)
s_mov_b32 s60, 0x2300000
s_cselect_b32 s60, 0x1100000, s60
buffer_load_dword v33, v32, s[4:7], s60 offen sc1
s_waitcnt vmcnt(12)
s_waitcnt vmcnt(0)
s_mov_b32 s74, -2
s_mov_b32 s76, 0
s_add_u32 s94, s93, s92
s_add_u32 s94, s94, 1572864
L_H1_loop:
s_add_u32 s63, s74, 2
s_cmp_lt_i32 s74, 0
s_cbranch_scc1 L_H1_noatt
s_lshl_b32 s68, s74, 1
s_add_u32 s68, s68, s59
s_and_b32 s73, s74, 1
s_mul_i32 s73, s73, 24576
s_lshl_b32 s69, s68, 5
s_add_u32 s69, s69, s58
s_add_u32 s69, s69, 2048
s_lshl_b32 s69, s69, 4
s_and_b32 s66, s74, 3
s_lshl_b32 s66, s66, 19
s_add_u32 s66, s66, s93
s_add_u32 s94, s66, s92
s_waitcnt lgkmcnt(0)
s_barrier
s_mul_i32 s60, s47, 3072
s_add_u32 s60, s60, 65536
v_add_u32 v124, s60, v1
ds_read_b128 v[104:107], v124
ds_read_b128 v[108:111], v124 offset:1024
ds_read_b128 v[112:115], v124 offset:2048
s_lshl_b32 s60, s72, 10
s_add_u32 s60, s60, s73
v_add_u32 v124, s60, v1
v_add_u32 v125, s73, v1
s_lshr_b32 s67, s47, 1
s_lshl_b32 s60, s67, 12
s_add_u32 s60, s60, s73
v_add_u32 v126, s60, v1
ds_read_b128 v[32:35], v124 offset:0
ds_read_b128 v[48:51], v125 offset:8192
ds_read_b128 v[52:55], v125 offset:9216
ds_read_b128 v[36:39], v124 offset:2048
ds_read_b128 v[56:59], v125 offset:10240
ds_read_b128 v[60:63], v125 offset:11264
ds_read_b128 v[40:43], v124 offset:4096
ds_read_b128 v[64:67], v125 offset:12288
ds_read_b128 v[68:71], v125 offset:13312
ds_read_b128 v[44:47], v124 offset:6144
ds_read_b128 v[72:75], v125 offset:14336
ds_read_b128 v[76:79], v125 offset:15360
ds_read_b128 v[80:83], v126 offset:16384
ds_read_b128 v[84:87], v126 offset:17408
ds_read_b128 v[88:91], v126 offset:18432
ds_read_b128 v[92:95], v126 offset:19456
s_waitcnt lgkmcnt(0)
v_mfma_f32_16x16x32_bf16 v[108:111], v[48:51], v[32:35], v[108:111]
v_mfma_f32_16x16x32_bf16 v[112:115], v[52:55], v[32:35], v[112:115]
v_mfma_f32_16x16x32_bf16 v[108:111], v[56:59], v[36:39], v[108:111]
v_mfma_f32_16x16x32_bf16 v[112:115], v[60:63], v[36:39], v[112:115]
v_mfma_f32_16x16x32_bf16 v[108:111], v[64:67], v[40:43], v[108:111]
v_mfma_f32_16x16x32_bf16 v[112:115], v[68:71], v[40:43], v[112:115]
v_mfma_f32_16x16x32_bf16 v[108:111], v[72:75], v[44:47], v[108:111]
v_mfma_f32_16x16x32_bf16 v[112:115], v[76:79], v[44:47], v[112:115]
v_lshlrev_b32 v124, 11, v0
s_mov_b64 exec, 0xf
s_branch Lzp_87
s_nop 4
Lzp_86:
s_sleep 1
Lzp_87:
buffer_load_dword v125, v124, s[4:7], s66 offen offset:1020 sc1
s_memtime s[60:61]
s_waitcnt lgkmcnt(0)
s_sub_u32 s60, s60, s46
s_mov_b32 s61, 11
s_cmp_gt_u32 s60, 67108864
s_cbranch_scc1 L_abortH
s_waitcnt vmcnt(0)
s_cmp_eq_u32 s75, 0
s_cbranch_scc1 Lnp_91
s_mov_b64 s[98:99], exec
s_mov_b64 exec, 1
buffer_store_dword v4, off, s[4:7], s75 sc1
s_mov_b64 exec, s[98:99]
s_mov_b32 s75, 0
Lnp_91:
v_cmp_eq_u32 vcc, -1, v125
s_cbranch_vccnz Lzp_86
s_mov_b64 exec, -1
s_nop 2
Lzp_88:
s_lshl_b32 s64, s63, 8
s_lshl_b32 s60, s59, 7
s_add_u32 s64, s64, s60
s_add_u32 s64, s64, 32768
v_and_b32 v124, 124, v6
buffer_load_dword v126, v124, s[4:7], s64 offen sc1
s_add_u32 s60, s66, 0
buffer_load_dwordx4 v[16:19], v1, s[4:7], s60 offen sc1
s_add_u32 s60, s66, 2048
buffer_load_dwordx4 v[20:23], v1, s[4:7], s60 offen sc1
s_add_u32 s60, s66, 4096
buffer_load_dwordx4 v[24:27], v1, s[4:7], s60 offen sc1
s_add_u32 s60, s66, 6144
buffer_load_dwordx4 v[28:31], v1, s[4:7], s60 offen sc1
s_lshl_b32 s60, s67, 12
s_add_u32 s60, s60, s66
buffer_load_dwordx2 v[96:97], v7, s[4:7], s60 offen offset:1024 sc1
buffer_load_dwordx2 v[98:99], v7, s[4:7], s60 offen offset:1280 sc1
buffer_load_dwordx2 v[100:101], v7, s[4:7], s60 offen offset:3072 sc1
buffer_load_dwordx2 v[102:103], v7, s[4:7], s60 offen offset:3328 sc1
s_memtime s[60:61]
s_waitcnt lgkmcnt(0)
s_sub_u32 s60, s60, s46
s_mov_b32 s61, 12
s_cmp_gt_u32 s60, 67108864
s_cbranch_scc1 L_abortH
s_waitcnt vmcnt(4)
v_max3_u32 v124, v16, v17, v18
v_max3_u32 v125, v19, v20, v21
v_max3_u32 v124, v124, v22, v23
v_max3_u32 v125, v125, v24, v25
v_max3_u32 v124, v124, v26, v27
v_max3_u32 v125, v125, v28, v29
v_max3_u32 v124, v124, v30, v31
v_max_u32 v124, v124, v125
v_cmp_eq_u32 vcc, -1, v124
s_cbranch_vccnz Lzp_88
v_mfma_f32_16x16x32_bf16 v[104:107], v[16:19], v[32:35], v[104:107]
v_mfma_f32_16x16x32_bf16 v[104:107], v[20:23], v[36:39], v[104:107]
v_mfma_f32_16x16x32_bf16 v[104:107], v[24:27], v[40:43], v[104:107]
v_mfma_f32_16x16x32_bf16 v[104:107], v[28:31], v[44:47], v[104:107]
s_cmp_ge_u32 s63, 32
s_cbranch_scc1 Lzp_89
v_cmp_eq_u32 vcc, 0, v126
s_cbranch_vccnz Lzp_89
s_lshl_b32 s62, s63, 1
s_add_u32 s62, s62, s59
s_lshl_b32 s64, s62, 15
s_add_u32 s64, s64, 8388608
s_lshl_b32 s65, s62, 12
s_add_u32 s65, s65, 13369344
s_add_u32 s100, s77, s92
s_add_u32 m0, s100, 0
s_add_u32 s100, s64, s92
s_add_u32 s100, s100, 0
buffer_load_dwordx4 v1, s[4:7], s100 offen offset:0 sc1 lds
buffer_load_dwordx4 v1, s[4:7], s100 offen offset:1024 sc1 lds
s_add_u32 s100, s77, s92
s_add_u32 m0, s100, 8192
s_add_u32 s100, s64, s92
s_add_u32 s100, s100, 8192
buffer_load_dwordx4 v1, s[4:7], s100 offen offset:0 sc1 lds
buffer_load_dwordx4 v1, s[4:7], s100 offen offset:1024 sc1 lds
s_add_u32 s100, s77, s78
s_add_u32 m0, s100, 16384
s_add_u32 s100, s64, s78
s_add_u32 s100, s100, 16384
buffer_load_dwordx4 v1, s[4:7], s100 offen offset:0 sc1 lds
buffer_load_dwordx4 v1, s[4:7], s100 offen offset:1024 sc1 lds
buffer_load_dwordx4 v1, s[4:7], s100 offen offset:2048 sc1 lds
buffer_load_dwordx4 v1, s[4:7], s100 offen offset:3072 sc1 lds
buffer_load_dwordx4 v[48:51], v1, s[4:7], s65 offen offset:0 sc1
buffer_load_dwordx4 v[52:55], v1, s[4:7], s65 offen offset:1024 sc1
buffer_load_dwordx4 v[56:59], v1, s[4:7], s65 offen offset:2048 sc1
buffer_load_dwordx4 v[60:63], v1, s[4:7], s65 offen offset:3072 sc1
s_mov_b32 s76, 1
s_waitcnt vmcnt(12)
s_branch Lzp_90
Lzp_89:
s_waitcnt vmcnt(0)
Lzp_90:
v_max3_f32 v124, v104, v105, v106
v_max3_f32 v125, v107, v108, v109
v_max3_f32 v124, v124, v110, v111
v_max3_f32 v125, v125, v112, v113
v_max3_f32 v124, v124, v114, v115
v_max_f32 v124, v124, v125
v_mov_b32 v125, v124
s_nop 1
v_permlane16_swap_b32 v124, v125
v_max_f32 v124, v124, v125
v_mov_b32 v125, v124
s_nop 1
v_permlane32_swap_b32 v124, v125
v_max_f32 v124, v124, v125
v_mul_f32 v124, s70, v124
v_fma_f32 v104, v104, s70, -v124
v_fma_f32 v105, v105, s70, -v124
v_fma_f32 v106, v106, s70, -v124
v_fma_f32 v107, v107, s70, -v124
v_fma_f32 v108, v108, s70, -v124
v_fma_f32 v109, v109, s70, -v124
v_fma_f32 v110, v110, s70, -v124
v_fma_f32 v111, v111, s70, -v124
v_fma_f32 v112, v112, s70, -v124
v_fma_f32 v113, v113, s70, -v124
v_fma_f32 v114, v114, s70, -v124
v_fma_f32 v115, v115, s70, -v124
v_exp_f32 v104, v104
v_exp_f32 v105, v105
v_exp_f32 v106, v106
v_exp_f32 v107, v107
v_exp_f32 v108, v108
v_exp_f32 v109, v109
v_exp_f32 v110, v110
v_exp_f32 v111, v111
v_exp_f32 v112, v112
v_exp_f32 v113, v113
v_exp_f32 v114, v114
v_exp_f32 v115, v115
v_cvt_pk_bf16_f32 v120, v104, v105
v_cvt_pk_bf16_f32 v121, v106, v107
v_cvt_pk_bf16_f32 v116, v108, v109
v_cvt_pk_bf16_f32 v117, v110, v111
v_cvt_pk_bf16_f32 v118, v112, v113
v_cvt_pk_bf16_f32 v119, v114, v115
s_nop 1
Lvp_92:
v_max3_u32 v124, v96, v97, v98
v_max3_u32 v125, v99, v100, v101
v_max3_u32 v124, v124, v102, v103
v_max_u32 v124, v124, v125
v_cmp_eq_u32 vcc, -1, v124
s_cbranch_vccz Lvp_93
s_lshl_b32 s60, s67, 12
s_add_u32 s60, s60, s66
buffer_load_dwordx2 v[96:97], v7, s[4:7], s60 offen offset:1024 sc1
buffer_load_dwordx2 v[98:99], v7, s[4:7], s60 offen offset:1280 sc1
buffer_load_dwordx2 v[100:101], v7, s[4:7], s60 offen offset:3072 sc1
buffer_load_dwordx2 v[102:103], v7, s[4:7], s60 offen offset:3328 sc1
s_memtime s[60:61]
s_waitcnt lgkmcnt(0)
s_sub_u32 s60, s60, s46
s_mov_b32 s61, 13
s_cmp_gt_u32 s60, 67108864
s_cbranch_scc1 L_abortH
s_waitcnt vmcnt(0)
s_branch Lvp_92
Lvp_93:
v_mfma_f32_16x16x32_bf16 v[32:35], v[2:5], v[116:119], 0
s_nop 5
v_mfma_f32_16x16x16_bf16 v[32:35], v[2:3], v[120:121], v[32:35]
v_mfma_f32_16x16x32_bf16 v[16:19], v[80:83], v[116:119], 0
v_mfma_f32_16x16x32_bf16 v[20:23], v[84:87], v[116:119], 0
v_mfma_f32_16x16x32_bf16 v[24:27], v[88:91], v[116:119], 0
v_mfma_f32_16x16x32_bf16 v[28:31], v[92:95], v[116:119], 0
s_nop 2
v_mfma_f32_16x16x16_bf16 v[16:19], v[96:97], v[120:121], v[16:19]
v_mfma_f32_16x16x16_bf16 v[20:23], v[98:99], v[120:121], v[20:23]
v_mfma_f32_16x16x16_bf16 v[24:27], v[100:101], v[120:121], v[24:27]
v_mfma_f32_16x16x16_bf16 v[28:31], v[102:103], v[120:121], v[28:31]
v_rcp_f32 v32, v32
s_nop 3
v_pk_mul_f32 v[16:17], v[16:17], v[32:33] op_sel_hi:[1,0]
v_pk_mul_f32 v[18:19], v[18:19], v[32:33] op_sel_hi:[1,0]
v_pk_mul_f32 v[20:21], v[20:21], v[32:33] op_sel_hi:[1,0]
v_pk_mul_f32 v[22:23], v[22:23], v[32:33] op_sel_hi:[1,0]
v_pk_mul_f32 v[24:25], v[24:25], v[32:33] op_sel_hi:[1,0]
v_pk_mul_f32 v[26:27], v[26:27], v[32:33] op_sel_hi:[1,0]
v_pk_mul_f32 v[28:29], v[28:29], v[32:33] op_sel_hi:[1,0]
v_pk_mul_f32 v[30:31], v[30:31], v[32:33] op_sel_hi:[1,0]
v_cvt_pk_bf16_f32 v40, v16, v20
v_cvt_pk_bf16_f32 v41, v17, v21
v_cvt_pk_bf16_f32 v42, v18, v22
v_cvt_pk_bf16_f32 v43, v19, v23
v_cvt_pk_bf16_f32 v44, v24, v28
v_cvt_pk_bf16_f32 v45, v25, v29
v_cvt_pk_bf16_f32 v46, v26, v30
v_cvt_pk_bf16_f32 v47, v27, v31
s_lshl_b32 s60, s68, 18
s_add_u32 s60, s60, 134217728
s_lshl_b32 s61, s58, 13
s_add_u32 s60, s60, s61
s_lshl_b32 s61, s67, 12
s_add_u32 s60, s60, s61
s_lshl_b32 s61, s72, 10
s_add_u32 s60, s60, s61
buffer_store_dwordx4 v[40:43], v1, s[4:7], s60 offen sc1
buffer_store_dwordx4 v[44:47], v1, s[4:7], s60 offen offset:2048 sc1
s_lshl_b32 s61, s47, 2
s_add_u32 s69, s69, s61
s_add_u32 s75, s69, 131072
s_branch L_H1_q
L_H1_noatt:
s_barrier
L_H1_q:
s_cmp_ge_u32 s63, 32
s_cbranch_scc1 L_H1_skip
s_cmp_lg_u32 s76, 0
s_cbranch_scc1 Learly_94
s_lshl_b32 s64, s63, 8
s_lshl_b32 s60, s59, 7
s_add_u32 s64, s64, s60
s_add_u32 s64, s64, 32768
s_mov_b64 exec, 0xffffffff
s_branch Lpoll_96
Lpoll_95:
s_sleep 1
Lpoll_96:
buffer_load_dword v32, v6, s[4:7], s64 offen sc1
s_memtime s[60:61]
s_waitcnt lgkmcnt(0)
s_sub_u32 s60, s60, s46
s_mov_b32 s61, 10
s_cmp_gt_u32 s60, 67108864
s_cbranch_scc1 L_abortH
s_waitcnt vmcnt(0)
s_cmp_eq_u32 s75, 0
s_cbranch_scc1 Lnp_97
s_mov_b64 s[98:99], exec
s_mov_b64 exec, 1
buffer_store_dword v4, off, s[4:7], s75 sc1
s_mov_b64 exec, s[98:99]
s_mov_b32 s75, 0
Lnp_97:
v_cmp_eq_u32 vcc, 0, v32
s_cbranch_vccnz Lpoll_95
s_mov_b64 exec, -1
s_lshl_b32 s62, s63, 1
s_add_u32 s62, s62, s59
s_lshl_b32 s64, s62, 15
s_add_u32 s64, s64, 8388608
s_lshl_b32 s65, s62, 12
s_add_u32 s65, s65, 13369344
s_add_u32 s100, s77, s92
s_add_u32 m0, s100, 0
s_add_u32 s100, s64, s92
s_add_u32 s100, s100, 0
buffer_load_dwordx4 v1, s[4:7], s100 offen offset:0 sc1 lds
buffer_load_dwordx4 v1, s[4:7], s100 offen offset:1024 sc1 lds
s_add_u32 s100, s77, s92
s_add_u32 m0, s100, 8192
s_add_u32 s100, s64, s92
s_add_u32 s100, s100, 8192
buffer_load_dwordx4 v1, s[4:7], s100 offen offset:0 sc1 lds
buffer_load_dwordx4 v1, s[4:7], s100 offen offset:1024 sc1 lds
s_add_u32 s100, s77, s78
s_add_u32 m0, s100, 16384
s_add_u32 s100, s64, s78
s_add_u32 s100, s100, 16384
buffer_load_dwordx4 v1, s[4:7], s100 offen offset:0 sc1 lds
buffer_load_dwordx4 v1, s[4:7], s100 offen offset:1024 sc1 lds
buffer_load_dwordx4 v1, s[4:7], s100 offen offset:2048 sc1 lds
buffer_load_dwordx4 v1, s[4:7], s100 offen offset:3072 sc1 lds
buffer_load_dwordx4 v[48:51], v1, s[4:7], s65 offen offset:0 sc1
buffer_load_dwordx4 v[52:55], v1, s[4:7], s65 offen offset:1024 sc1
buffer_load_dwordx4 v[56:59], v1, s[4:7], s65 offen offset:2048 sc1
buffer_load_dwordx4 v[60:63], v1, s[4:7], s65 offen offset:3072 sc1
Learly_94:
s_lshl_b32 s62, s63, 1
s_add_u32 s62, s62, s59
s_and_b32 s73, s63, 1
s_mul_i32 s73, s73, 24576
s_mov_b32 s76, 0
v_add_u32 v127, 81920, v1
s_waitcnt vmcnt(10)
s_barrier
v_lshlrev_b32 v124, 3, v0
buffer_store_dwordx2 v[122:123], v124, s[4:7], s94 offen sc1
buffer_store_dwordx2 v[122:123], v124, s[4:7], s94 offen offset:512 sc1
buffer_store_dwordx2 v[122:123], v124, s[4:7], s94 offen offset:1024 sc1
ds_read_b128 v[32:35], v127 offset:0
ds_read_b128 v[36:39], v127 offset:1024
ds_read_b128 v[40:43], v127 offset:2048
ds_read_b128 v[44:47], v127 offset:3072
s_waitcnt lgkmcnt(3)
v_mfma_f32_16x16x32_bf16 v[80:83], a[128:131], v[32:35], 0
v_mfma_f32_16x16x32_bf16 v[88:91], a[192:195], v[32:35], 0
v_mfma_f32_16x16x32_bf16 v[96:99], v[32:35], v[128:131], 0
v_mfma_f32_16x16x32_bf16 v[104:107], v[32:35], v[192:195], 0
ds_read_b128 v[32:35], v127 offset:4096
s_waitcnt lgkmcnt(3)
v_mfma_f32_16x16x32_bf16 v[84:87], a[128:131], v[36:39], 0
v_mfma_f32_16x16x32_bf16 v[92:95], a[192:195], v[36:39], 0
v_mfma_f32_16x16x32_bf16 v[100:103], v[36:39], v[128:131], 0
v_mfma_f32_16x16x32_bf16 v[108:111], v[36:39], v[192:195], 0
ds_read_b128 v[36:39], v127 offset:5120
s_waitcnt lgkmcnt(3)
v_mfma_f32_16x16x32_bf16 v[80:83], a[132:135], v[40:43], v[80:83]
v_mfma_f32_16x16x32_bf16 v[88:91], a[196:199], v[40:43], v[88:91]
v_mfma_f32_16x16x32_bf16 v[96:99], v[40:43], v[132:135], v[96:99]
v_mfma_f32_16x16x32_bf16 v[104:107], v[40:43], v[196:199], v[104:107]
ds_read_b128 v[40:43], v127 offset:6144
s_waitcnt lgkmcnt(3)
v_mfma_f32_16x16x32_bf16 v[84:87], a[132:135], v[44:47], v[84:87]
v_mfma_f32_16x16x32_bf16 v[92:95], a[196:199], v[44:47], v[92:95]
v_mfma_f32_16x16x32_bf16 v[100:103], v[44:47], v[132:135], v[100:103]
v_mfma_f32_16x16x32_bf16 v[108:111], v[44:47], v[196:199], v[108:111]
ds_read_b128 v[44:47], v127 offset:7168
s_waitcnt lgkmcnt(3)
v_mfma_f32_16x16x32_bf16 v[80:83], a[136:139], v[32:35], v[80:83]
v_mfma_f32_16x16x32_bf16 v[88:91], a[200:203], v[32:35], v[88:91]
v_mfma_f32_16x16x32_bf16 v[96:99], v[32:35], v[136:139], v[96:99]
v_mfma_f32_16x16x32_bf16 v[104:107], v[32:35], v[200:203], v[104:107]
s_waitcnt vmcnt(11)
s_barrier
ds_read_b128 v[32:35], v127 offset:8192
s_waitcnt lgkmcnt(3)
v_mfma_f32_16x16x32_bf16 v[84:87], a[136:139], v[36:39], v[84:87]
v_mfma_f32_16x16x32_bf16 v[92:95], a[200:203], v[36:39], v[92:95]
v_mfma_f32_16x16x32_bf16 v[100:103], v[36:39], v[136:139], v[100:103]
v_mfma_f32_16x16x32_bf16 v[108:111], v[36:39], v[200:203], v[108:111]
ds_read_b128 v[36:39], v127 offset:9216
s_waitcnt lgkmcnt(3)
v_mfma_f32_16x16x32_bf16 v[80:83], a[140:143], v[40:43], v[80:83]
v_mfma_f32_16x16x32_bf16 v[88:91], a[204:207], v[40:43], v[88:91]
v_mfma_f32_16x16x32_bf16 v[96:99], v[40:43], v[140:143], v[96:99]
v_mfma_f32_16x16x32_bf16 v[104:107], v[40:43], v[204:207], v[104:107]
ds_read_b128 v[40:43], v127 offset:10240
s_waitcnt lgkmcnt(3)
v_mfma_f32_16x16x32_bf16 v[84:87], a[140:143], v[44:47], v[84:87]
v_mfma_f32_16x16x32_bf16 v[92:95], a[204:207], v[44:47], v[92:95]
v_mfma_f32_16x16x32_bf16 v[100:103], v[44:47], v[140:143], v[100:103]
v_mfma_f32_16x16x32_bf16 v[108:111], v[44:47], v[204:207], v[108:111]
ds_read_b128 v[44:47], v127 offset:11264
s_waitcnt lgkmcnt(3)
v_mfma_f32_16x16x32_bf16 v[80:83], a[144:147], v[32:35], v[80:83]
s_cmp_eq_u32 s75, 0
s_cbranch_scc1 Lnf_98
s_waitcnt vmcnt(3)
s_cmp_eq_u32 s75, 0
s_cbranch_scc1 Lnp_99
s_mov_b64 s[98:99], exec
s_mov_b64 exec, 1
buffer_store_dword v4, off, s[4:7], s75 sc1
s_mov_b64 exec, s[98:99]
s_mov_b32 s75, 0
Lnp_99:
Lnf_98:
v_mfma_f32_16x16x32_bf16 v[88:91], a[208:211], v[32:35], v[88:91]
v_mfma_f32_16x16x32_bf16 v[96:99], v[32:35], v[144:147], v[96:99]
v_mfma_f32_16x16x32_bf16 v[104:107], v[32:35], v[208:211], v[104:107]
ds_read_b128 v[32:35], v127 offset:12288
s_waitcnt lgkmcnt(3)
v_mfma_f32_16x16x32_bf16 v[84:87], a[144:147], v[36:39], v[84:87]
v_mfma_f32_16x16x32_bf16 v[92:95], a[208:211], v[36:39], v[92:95]
v_mfma_f32_16x16x32_bf16 v[100:103], v[36:39], v[144:147], v[100:103]
v_mfma_f32_16x16x32_bf16 v[108:111], v[36:39], v[208:211], v[108:111]
ds_read_b128 v[36:39], v127 offset:13312
s_waitcnt lgkmcnt(3)
v_mfma_f32_16x16x32_bf16 v[80:83], a[148:151], v[40:43], v[80:83]
v_mfma_f32_16x16x32_bf16 v[88:91], a[212:215], v[40:43], v[88:91]
v_mfma_f32_16x16x32_bf16 v[96:99], v[40:43], v[148:151], v[96:99]
v_mfma_f32_16x16x32_bf16 v[104:107], v[40:43], v[212:215], v[104:107]
ds_read_b128 v[40:43], v127 offset:14336
s_waitcnt lgkmcnt(3)
v_mfma_f32_16x16x32_bf16 v[84:87], a[148:151], v[44:47], v[84:87]
v_mfma_f32_16x16x32_bf16 v[92:95], a[212:215], v[44:47], v[92:95]
v_mfma_f32_16x16x32_bf16 v[100:103], v[44:47], v[148:151], v[100:103]
v_mfma_f32_16x16x32_bf16 v[108:111], v[44:47], v[212:215], v[108:111]
ds_read_b128 v[44:47], v127 offset:15360
s_waitcnt lgkmcnt(3)
v_mfma_f32_16x16x32_bf16 v[80:83], a[152:155], v[32:35], v[80:83]
v_mfma_f32_16x16x32_bf16 v[88:91], a[216:219], v[32:35], v[88:91]
v_mfma_f32_16x16x32_bf16 v[96:99], v[32:35], v[152:155], v[96:99]
v_mfma_f32_16x16x32_bf16 v[104:107], v[32:35], v[216:219], v[104:107]
s_waitcnt vmcnt(7)
s_barrier
ds_read_b128 v[32:35], v127 offset:16384
s_waitcnt lgkmcnt(3)
v_mfma_f32_16x16x32_bf16 v[84:87], a[152:155], v[36:39], v[84:87]
v_mfma_f32_16x16x32_bf16 v[92:95], a[216:219], v[36:39], v[92:95]
v_mfma_f32_16x16x32_bf16 v[100:103], v[36:39], v[152:155], v[100:103]
v_mfma_f32_16x16x32_bf16 v[108:111], v[36:39], v[216:219], v[108:111]
ds_read_b128 v[36:39], v127 offset:17408
s_waitcnt lgkmcnt(3)
v_mfma_f32_16x16x32_bf16 v[80:83], a[156:159], v[40:43], v[80:83]
v_mfma_f32_16x16x32_bf16 v[88:91], a[220:223], v[40:43], v[88:91]
v_mfma_f32_16x16x32_bf16 v[96:99], v[40:43], v[156:159], v[96:99]
v_mfma_f32_16x16x32_bf16 v[104:107], v[40:43], v[220:223], v[104:107]
ds_read_b128 v[40:43], v127 offset:18432
s_waitcnt lgkmcnt(3)
v_mfma_f32_16x16x32_bf16 v[84:87], a[156:159], v[44:47], v[84:87]
v_mfma_f32_16x16x32_bf16 v[92:95], a[220:223], v[44:47], v[92:95]
v_mfma_f32_16x16x32_bf16 v[100:103], v[44:47], v[156:159], v[100:103]
v_mfma_f32_16x16x32_bf16 v[108:111], v[44:47], v[220:223], v[108:111]
ds_read_b128 v[44:47], v127 offset:19456
s_waitcnt lgkmcnt(3)
v_mfma_f32_16x16x32_bf16 v[80:83], a[160:163], v[32:35], v[80:83]
s_waitcnt vmcnt(3)
v_add_f32 v48, v48, v49
v_mfma_f32_16x16x32_bf16 v[88:91], a[224:227], v[32:35], v[88:91]
v_add_f32 v50, v50, v51
v_mfma_f32_16x16x32_bf16 v[96:99], v[32:35], v[160:163], v[96:99]
v_add_f32 v52, v52, v53
v_mfma_f32_16x16x32_bf16 v[104:107], v[32:35], v[224:227], v[104:107]
v_add_f32 v54, v54, v55
ds_read_b128 v[32:35], v127 offset:20480
s_waitcnt lgkmcnt(3)
v_mfma_f32_16x16x32_bf16 v[84:87], a[160:163], v[36:39], v[84:87]
v_add_f32 v56, v56, v57
v_mfma_f32_16x16x32_bf16 v[92:95], a[224:227], v[36:39], v[92:95]
v_add_f32 v58, v58, v59
v_mfma_f32_16x16x32_bf16 v[100:103], v[36:39], v[160:163], v[100:103]
v_add_f32 v60, v60, v61
v_mfma_f32_16x16x32_bf16 v[108:111], v[36:39], v[224:227], v[108:111]
v_add_f32 v62, v62, v63
ds_read_b128 v[36:39], v127 offset:21504
s_waitcnt lgkmcnt(3)
v_mfma_f32_16x16x32_bf16 v[80:83], a[164:167], v[40:43], v[80:83]
v_add_f32 v48, v48, v50
v_mfma_f32_16x16x32_bf16 v[88:91], a[228:231], v[40:43], v[88:91]
v_add_f32 v52, v52, v54
v_mfma_f32_16x16x32_bf16 v[96:99], v[40:43], v[164:167], v[96:99]
v_add_f32 v56, v56, v58
v_mfma_f32_16x16x32_bf16 v[104:107], v[40:43], v[228:231], v[104:107]
v_add_f32 v60, v60, v62
ds_read_b128 v[40:43], v127 offset:22528
s_waitcnt lgkmcnt(3)
v_mfma_f32_16x16x32_bf16 v[84:87], a[164:167], v[44:47], v[84:87]
v_add_f32 v48, v48, v52
v_mfma_f32_16x16x32_bf16 v[92:95], a[228:231], v[44:47], v[92:95]
v_add_f32 v56, v56, v60
v_mfma_f32_16x16x32_bf16 v[100:103], v[44:47], v[164:167], v[100:103]
v_add_f32 v112, v48, v56
v_mfma_f32_16x16x32_bf16 v[108:111], v[44:47], v[228:231], v[108:111]
ds_read_b128 v[44:47], v127 offset:23552
s_waitcnt lgkmcnt(3)
v_mfma_f32_16x16x32_bf16 v[80:83], a[168:171], v[32:35], v[80:83]
v_mfma_f32_16x16x32_bf16 v[88:91], a[232:235], v[32:35], v[88:91]
v_mfma_f32_16x16x32_bf16 v[96:99], v[32:35], v[168:171], v[96:99]
v_mfma_f32_16x16x32_bf16 v[104:107], v[32:35], v[232:235], v[104:107]
ds_read_b128 v[32:35], v127 offset:24576
s_waitcnt lgkmcnt(3)
v_mfma_f32_16x16x32_bf16 v[84:87], a[168:171], v[36:39], v[84:87]
v_mfma_f32_16x16x32_bf16 v[92:95], a[232:235], v[36:39], v[92:95]
v_mfma_f32_16x16x32_bf16 v[100:103], v[36:39], v[168:171], v[100:103]
v_mfma_f32_16x16x32_bf16 v[108:111], v[36:39], v[232:235], v[108:111]
ds_read_b128 v[36:39], v127 offset:25600
s_waitcnt lgkmcnt(3)
v_mfma_f32_16x16x32_bf16 v[80:83], a[172:175], v[40:43], v[80:83]
v_mfma_f32_16x16x32_bf16 v[88:91], a[236:239], v[40:43], v[88:91]
v_mfma_f32_16x16x32_bf16 v[96:99], v[40:43], v[172:175], v[96:99]
v_mfma_f32_16x16x32_bf16 v[104:107], v[40:43], v[236:239], v[104:107]
ds_read_b128 v[40:43], v127 offset:26624
s_waitcnt lgkmcnt(3)
v_mfma_f32_16x16x32_bf16 v[84:87], a[172:175], v[44:47], v[84:87]
v_mfma_f32_16x16x32_bf16 v[92:95], a[236:239], v[44:47], v[92:95]
v_mfma_f32_16x16x32_bf16 v[100:103], v[44:47], v[172:175], v[100:103]
v_mfma_f32_16x16x32_bf16 v[108:111], v[44:47], v[236:239], v[108:111]
ds_read_b128 v[44:47], v127 offset:27648
s_waitcnt lgkmcnt(3)
v_mfma_f32_16x16x32_bf16 v[80:83], a[176:179], v[32:35], v[80:83]
v_mov_b32 v113, v112
s_nop 1
v_permlane32_swap_b32 v112, v113
v_mul_f32 v112, 0x3b000000, v112
v_mul_f32 v113, 0x3b000000, v113
v_fma_f32 v113, -v112, v112, v113
v_max_f32 v113, 0, v113
v_add_f32 v113, 0x3727c5ac, v113
v_rsq_f32 v113, v113
s_nop 0
v_mul_f32 v112, -v112, v113
ds_write_b32 v10, v113
ds_write_b32 v10, v112 offset:128
v_mfma_f32_16x16x32_bf16 v[88:91], a[240:243], v[32:35], v[88:91]
v_mfma_f32_16x16x32_bf16 v[96:99], v[32:35], v[176:179], v[96:99]
v_mfma_f32_16x16x32_bf16 v[104:107], v[32:35], v[240:243], v[104:107]
ds_read_b128 v[32:35], v127 offset:28672
s_waitcnt lgkmcnt(3)
v_mfma_f32_16x16x32_bf16 v[84:87], a[176:179], v[36:39], v[84:87]
v_mfma_f32_16x16x32_bf16 v[92:95], a[240:243], v[36:39], v[92:95]
v_mfma_f32_16x16x32_bf16 v[100:103], v[36:39], v[176:179], v[100:103]
v_mfma_f32_16x16x32_bf16 v[108:111], v[36:39], v[240:243], v[108:111]
ds_read_b128 v[36:39], v127 offset:29696
s_waitcnt lgkmcnt(3)
v_mfma_f32_16x16x32_bf16 v[80:83], a[180:183], v[40:43], v[80:83]
v_mfma_f32_16x16x32_bf16 v[88:91], a[244:247], v[40:43], v[88:91]
v_mfma_f32_16x16x32_bf16 v[96:99], v[40:43], v[180:183], v[96:99]
v_mfma_f32_16x16x32_bf16 v[104:107], v[40:43], v[244:247], v[104:107]
ds_read_b128 v[40:43], v127 offset:30720
s_waitcnt lgkmcnt(3)
v_mfma_f32_16x16x32_bf16 v[84:87], a[180:183], v[44:47], v[84:87]
v_mfma_f32_16x16x32_bf16 v[92:95], a[244:247], v[44:47], v[92:95]
v_mfma_f32_16x16x32_bf16 v[100:103], v[44:47], v[180:183], v[100:103]
v_mfma_f32_16x16x32_bf16 v[108:111], v[44:47], v[244:247], v[108:111]
ds_read_b128 v[44:47], v127 offset:31744
s_waitcnt lgkmcnt(3)
v_mfma_f32_16x16x32_bf16 v[80:83], a[184:187], v[32:35], v[80:83]
v_mfma_f32_16x16x32_bf16 v[88:91], a[248:251], v[32:35], v[88:91]
v_mfma_f32_16x16x32_bf16 v[96:99], v[32:35], v[184:187], v[96:99]
v_mfma_f32_16x16x32_bf16 v[104:107], v[32:35], v[248:251], v[104:107]
s_waitcnt lgkmcnt(2)
v_mfma_f32_16x16x32_bf16 v[84:87], a[184:187], v[36:39], v[84:87]
v_mfma_f32_16x16x32_bf16 v[92:95], a[248:251], v[36:39], v[92:95]
v_mfma_f32_16x16x32_bf16 v[100:103], v[36:39], v[184:187], v[100:103]
v_mfma_f32_16x16x32_bf16 v[108:111], v[36:39], v[248:251], v[108:111]
s_waitcnt lgkmcnt(1)
v_mfma_f32_16x16x32_bf16 v[80:83], a[188:191], v[40:43], v[80:83]
v_mfma_f32_16x16x32_bf16 v[88:91], a[252:255], v[40:43], v[88:91]
v_mfma_f32_16x16x32_bf16 v[96:99], v[40:43], v[188:191], v[96:99]
v_mfma_f32_16x16x32_bf16 v[104:107], v[40:43], v[252:255], v[104:107]
s_waitcnt lgkmcnt(0)
v_mfma_f32_16x16x32_bf16 v[84:87], a[188:191], v[44:47], v[84:87]
v_mfma_f32_16x16x32_bf16 v[92:95], a[252:255], v[44:47], v[92:95]
v_mfma_f32_16x16x32_bf16 v[100:103], v[44:47], v[188:191], v[100:103]
v_mfma_f32_16x16x32_bf16 v[108:111], v[44:47], v[252:255], v[108:111]
ds_read_b128 v[16:19], v11 offset:0
ds_read_b128 v[20:23], v11 offset:1024
ds_read_b128 v[24:27], v11 offset:2048
ds_read_b128 v[28:31], v11 offset:3072
ds_read_b32 v116, v8
ds_read_b32 v117, v8 offset:128
ds_read_b32 v118, v8 offset:64
ds_read_b32 v119, v8 offset:192
ds_read_b128 v[32:35], v9
ds_read_b128 v[36:39], v9 offset:64
ds_read_b128 v[40:43], v9 offset:128
ds_read_b128 v[44:47], v9 offset:192
s_lshl_b32 s64, s62, 5
s_add_u32 s64, s64, s58
s_lshl_b32 s64, s64, 2
s_add_u32 s64, s64, s47
s_add_u32 s64, s64, 8192
s_lshl_b32 s65, s64, 12
s_add_u32 s65, s65, 33554432
s_and_b32 s65, s65, 0xfe3fffff
s_lshl_b32 s64, s64, 2
s_lshl_b32 s60, s47, 11
s_add_u32 s60, s60, s73
v_add_u32 v125, s60, v1
s_waitcnt lgkmcnt(4)
v_pk_mul_f32 v[120:121], v[24:25], v[116:117] op_sel:[0,1] op_sel_hi:[1,1]
v_pk_fma_f32 v[80:81], v[80:81], v[116:117], v[120:121] op_sel:[0,0,0] op_sel_hi:[1,0,1]
v_pk_mul_f32 v[120:121], v[26:27], v[116:117] op_sel:[0,1] op_sel_hi:[1,1]
v_pk_fma_f32 v[82:83], v[82:83], v[116:117], v[120:121] op_sel:[0,0,0] op_sel_hi:[1,0,1]
v_pk_mul_f32 v[120:121], v[24:25], v[118:119] op_sel:[0,1] op_sel_hi:[1,1]
v_pk_fma_f32 v[84:85], v[84:85], v[118:119], v[120:121] op_sel:[0,0,0] op_sel_hi:[1,0,1]
v_pk_mul_f32 v[120:121], v[26:27], v[118:119] op_sel:[0,1] op_sel_hi:[1,1]
v_pk_fma_f32 v[86:87], v[86:87], v[118:119], v[120:121] op_sel:[0,0,0] op_sel_hi:[1,0,1]
v_pk_mul_f32 v[120:121], v[28:29], v[116:117] op_sel:[0,1] op_sel_hi:[1,1]
v_pk_fma_f32 v[88:89], v[88:89], v[116:117], v[120:121] op_sel:[0,0,0] op_sel_hi:[1,0,1]
v_pk_mul_f32 v[120:121], v[30:31], v[116:117] op_sel:[0,1] op_sel_hi:[1,1]
v_pk_fma_f32 v[90:91], v[90:91], v[116:117], v[120:121] op_sel:[0,0,0] op_sel_hi:[1,0,1]
v_pk_mul_f32 v[120:121], v[28:29], v[118:119] op_sel:[0,1] op_sel_hi:[1,1]
v_pk_fma_f32 v[92:93], v[92:93], v[118:119], v[120:121] op_sel:[0,0,0] op_sel_hi:[1,0,1]
v_pk_mul_f32 v[120:121], v[30:31], v[118:119] op_sel:[0,1] op_sel_hi:[1,1]
v_pk_fma_f32 v[94:95], v[94:95], v[118:119], v[120:121] op_sel:[0,0,0] op_sel_hi:[1,0,1]
v_cvt_pk_bf16_f32 v56, v80, v88
v_cvt_pk_bf16_f32 v57, v81, v89
v_cvt_pk_bf16_f32 v58, v82, v90
v_cvt_pk_bf16_f32 v59, v83, v91
v_cvt_pk_bf16_f32 v60, v84, v92
v_cvt_pk_bf16_f32 v61, v85, v93
v_cvt_pk_bf16_f32 v62, v86, v94
v_cvt_pk_bf16_f32 v63, v87, v95
buffer_store_dwordx4 v[56:59], v1, s[4:7], s65 offen sc1
buffer_store_dwordx4 v[60:63], v1, s[4:7], s65 offen offset:1024 sc1
s_waitcnt lgkmcnt(0)
ds_write_b128 v125, v[56:59] offset:8192
ds_write_b128 v125, v[60:63] offset:9216
v_pk_mul_f32 v[120:121], v[40:41], v[12:13] op_sel:[0,0] op_sel_hi:[1,0]
v_pk_fma_f32 v[96:97], v[96:97], v[32:33], v[120:121]
v_pk_mul_f32 v[120:121], v[42:43], v[12:13] op_sel:[0,0] op_sel_hi:[1,0]
v_pk_fma_f32 v[98:99], v[98:99], v[34:35], v[120:121]
v_pk_mul_f32 v[120:121], v[44:45], v[12:13] op_sel:[0,0] op_sel_hi:[1,0]
v_pk_fma_f32 v[100:101], v[100:101], v[36:37], v[120:121]
v_pk_mul_f32 v[120:121], v[46:47], v[12:13] op_sel:[0,0] op_sel_hi:[1,0]
v_pk_fma_f32 v[102:103], v[102:103], v[38:39], v[120:121]
v_cvt_pk_bf16_f32 v24, v96, v97
v_cvt_pk_bf16_f32 v25, v98, v99
v_cvt_pk_bf16_f32 v26, v100, v101
v_cvt_pk_bf16_f32 v27, v102, v103
buffer_store_dwordx4 v[24:27], v1, s[4:7], s65 offen offset:2048 sc1
ds_write_b128 v125, v[24:27] offset:16384
v_pk_mul_f32 v[120:121], v[40:41], v[12:13] op_sel:[0,1] op_sel_hi:[1,1]
v_pk_fma_f32 v[104:105], v[104:105], v[32:33], v[120:121]
v_pk_mul_f32 v[120:121], v[42:43], v[12:13] op_sel:[0,1] op_sel_hi:[1,1]
v_pk_fma_f32 v[106:107], v[106:107], v[34:35], v[120:121]
v_pk_mul_f32 v[120:121], v[44:45], v[12:13] op_sel:[0,1] op_sel_hi:[1,1]
v_pk_fma_f32 v[108:109], v[108:109], v[36:37], v[120:121]
v_pk_mul_f32 v[120:121], v[46:47], v[12:13] op_sel:[0,1] op_sel_hi:[1,1]
v_pk_fma_f32 v[110:111], v[110:111], v[38:39], v[120:121]
v_cvt_pk_bf16_f32 v28, v104, v105
v_cvt_pk_bf16_f32 v29, v106, v107
v_cvt_pk_bf16_f32 v30, v108, v109
v_cvt_pk_bf16_f32 v31, v110, v111
buffer_store_dwordx4 v[28:31], v1, s[4:7], s65 offen offset:3072 sc1
ds_write_b128 v125, v[28:31] offset:17408
s_add_u32 s75, s64, 65536
ds_read_b128 v[32:35], v127 offset:0
ds_read_b128 v[36:39], v127 offset:1024
ds_read_b128 v[40:43], v127 offset:2048
ds_read_b128 v[44:47], v127 offset:3072
s_waitcnt lgkmcnt(3)
v_mfma_f32_16x16x32_bf16 v[64:67], a[0:3], v[32:35], 0
v_mfma_f32_16x16x32_bf16 v[72:75], a[64:67], v[32:35], 0
ds_read_b128 v[32:35], v127 offset:4096
s_waitcnt lgkmcnt(3)
v_mfma_f32_16x16x32_bf16 v[68:71], a[0:3], v[36:39], 0
v_mfma_f32_16x16x32_bf16 v[76:79], a[64:67], v[36:39], 0
ds_read_b128 v[36:39], v127 offset:5120
s_waitcnt lgkmcnt(3)
v_mfma_f32_16x16x32_bf16 v[64:67], a[4:7], v[40:43], v[64:67]
v_mfma_f32_16x16x32_bf16 v[72:75], a[68:71], v[40:43], v[72:75]
ds_read_b128 v[40:43], v127 offset:6144
s_waitcnt lgkmcnt(3)
v_mfma_f32_16x16x32_bf16 v[68:71], a[4:7], v[44:47], v[68:71]
v_mfma_f32_16x16x32_bf16 v[76:79], a[68:71], v[44:47], v[76:79]
ds_read_b128 v[44:47], v127 offset:7168
s_waitcnt lgkmcnt(3)
v_mfma_f32_16x16x32_bf16 v[64:67], a[8:11], v[32:35], v[64:67]
v_mfma_f32_16x16x32_bf16 v[72:75], a[72:75], v[32:35], v[72:75]
ds_read_b128 v[32:35], v127 offset:8192
s_waitcnt lgkmcnt(3)
v_mfma_f32_16x16x32_bf16 v[68:71], a[8:11], v[36:39], v[68:71]
v_mfma_f32_16x16x32_bf16 v[76:79], a[72:75], v[36:39], v[76:79]
ds_read_b128 v[36:39], v127 offset:9216
s_waitcnt lgkmcnt(3)
v_mfma_f32_16x16x32_bf16 v[64:67], a[12:15], v[40:43], v[64:67]
v_mfma_f32_16x16x32_bf16 v[72:75], a[76:79], v[40:43], v[72:75]
ds_read_b128 v[40:43], v127 offset:10240
s_waitcnt lgkmcnt(3)
v_mfma_f32_16x16x32_bf16 v[68:71], a[12:15], v[44:47], v[68:71]
v_mfma_f32_16x16x32_bf16 v[76:79], a[76:79], v[44:47], v[76:79]
ds_read_b128 v[44:47], v127 offset:11264
s_waitcnt lgkmcnt(3)
v_mfma_f32_16x16x32_bf16 v[64:67], a[16:19], v[32:35], v[64:67]
v_mfma_f32_16x16x32_bf16 v[72:75], a[80:83], v[32:35], v[72:75]
ds_read_b128 v[32:35], v127 offset:12288
s_waitcnt lgkmcnt(3)
v_mfma_f32_16x16x32_bf16 v[68:71], a[16:19], v[36:39], v[68:71]
v_mfma_f32_16x16x32_bf16 v[76:79], a[80:83], v[36:39], v[76:79]
ds_read_b128 v[36:39], v127 offset:13312
s_waitcnt lgkmcnt(3)
v_mfma_f32_16x16x32_bf16 v[64:67], a[20:23], v[40:43], v[64:67]
v_mfma_f32_16x16x32_bf16 v[72:75], a[84:87], v[40:43], v[72:75]
ds_read_b128 v[40:43], v127 offset:14336
s_waitcnt lgkmcnt(3)
v_mfma_f32_16x16x32_bf16 v[68:71], a[20:23], v[44:47], v[68:71]
v_mfma_f32_16x16x32_bf16 v[76:79], a[84:87], v[44:47], v[76:79]
ds_read_b128 v[44:47], v127 offset:15360
s_waitcnt lgkmcnt(3)
v_mfma_f32_16x16x32_bf16 v[64:67], a[24:27], v[32:35], v[64:67]
v_mfma_f32_16x16x32_bf16 v[72:75], a[88:91], v[32:35], v[72:75]
ds_read_b128 v[32:35], v127 offset:16384
s_waitcnt lgkmcnt(3)
v_mfma_f32_16x16x32_bf16 v[68:71], a[24:27], v[36:39], v[68:71]
v_mfma_f32_16x16x32_bf16 v[76:79], a[88:91], v[36:39], v[76:79]
ds_read_b128 v[36:39], v127 offset:17408
s_waitcnt lgkmcnt(3)
v_mfma_f32_16x16x32_bf16 v[64:67], a[28:31], v[40:43], v[64:67]
v_mfma_f32_16x16x32_bf16 v[72:75], a[92:95], v[40:43], v[72:75]
ds_read_b128 v[40:43], v127 offset:18432
s_waitcnt lgkmcnt(3)
v_mfma_f32_16x16x32_bf16 v[68:71], a[28:31], v[44:47], v[68:71]
v_mfma_f32_16x16x32_bf16 v[76:79], a[92:95], v[44:47], v[76:79]
ds_read_b128 v[44:47], v127 offset:19456
s_waitcnt lgkmcnt(3)
v_mfma_f32_16x16x32_bf16 v[64:67], a[32:35], v[32:35], v[64:67]
v_mfma_f32_16x16x32_bf16 v[72:75], a[96:99], v[32:35], v[72:75]
ds_read_b128 v[32:35], v127 offset:20480
s_waitcnt lgkmcnt(3)
v_mfma_f32_16x16x32_bf16 v[68:71], a[32:35], v[36:39], v[68:71]
v_mfma_f32_16x16x32_bf16 v[76:79], a[96:99], v[36:39], v[76:79]
ds_read_b128 v[36:39], v127 offset:21504
s_waitcnt lgkmcnt(3)
v_mfma_f32_16x16x32_bf16 v[64:67], a[36:39], v[40:43], v[64:67]
v_mfma_f32_16x16x32_bf16 v[72:75], a[100:103], v[40:43], v[72:75]
ds_read_b128 v[40:43], v127 offset:22528
s_waitcnt lgkmcnt(3)
v_mfma_f32_16x16x32_bf16 v[68:71], a[36:39], v[44:47], v[68:71]
v_mfma_f32_16x16x32_bf16 v[76:79], a[100:103], v[44:47], v[76:79]
ds_read_b128 v[44:47], v127 offset:23552
s_waitcnt lgkmcnt(3)
v_mfma_f32_16x16x32_bf16 v[64:67], a[40:43], v[32:35], v[64:67]
v_mfma_f32_16x16x32_bf16 v[72:75], a[104:107], v[32:35], v[72:75]
ds_read_b128 v[32:35], v127 offset:24576
s_waitcnt lgkmcnt(3)
v_mfma_f32_16x16x32_bf16 v[68:71], a[40:43], v[36:39], v[68:71]
v_mfma_f32_16x16x32_bf16 v[76:79], a[104:107], v[36:39], v[76:79]
ds_read_b128 v[36:39], v127 offset:25600
s_waitcnt lgkmcnt(3)
v_mfma_f32_16x16x32_bf16 v[64:67], a[44:47], v[40:43], v[64:67]
v_mfma_f32_16x16x32_bf16 v[72:75], a[108:111], v[40:43], v[72:75]
ds_read_b128 v[40:43], v127 offset:26624
s_waitcnt lgkmcnt(3)
v_mfma_f32_16x16x32_bf16 v[68:71], a[44:47], v[44:47], v[68:71]
v_mfma_f32_16x16x32_bf16 v[76:79], a[108:111], v[44:47], v[76:79]
ds_read_b128 v[44:47], v127 offset:27648
s_waitcnt lgkmcnt(3)
v_mfma_f32_16x16x32_bf16 v[64:67], a[48:51], v[32:35], v[64:67]
v_mfma_f32_16x16x32_bf16 v[72:75], a[112:115], v[32:35], v[72:75]
ds_read_b128 v[32:35], v127 offset:28672
s_waitcnt lgkmcnt(3)
v_mfma_f32_16x16x32_bf16 v[68:71], a[48:51], v[36:39], v[68:71]
v_mfma_f32_16x16x32_bf16 v[76:79], a[112:115], v[36:39], v[76:79]
ds_read_b128 v[36:39], v127 offset:29696
s_waitcnt lgkmcnt(3)
v_mfma_f32_16x16x32_bf16 v[64:67], a[52:55], v[40:43], v[64:67]
v_mfma_f32_16x16x32_bf16 v[72:75], a[116:119], v[40:43], v[72:75]
ds_read_b128 v[40:43], v127 offset:30720
s_waitcnt lgkmcnt(3)
v_mfma_f32_16x16x32_bf16 v[68:71], a[52:55], v[44:47], v[68:71]
v_mfma_f32_16x16x32_bf16 v[76:79], a[116:119], v[44:47], v[76:79]
ds_read_b128 v[44:47], v127 offset:31744
s_waitcnt lgkmcnt(3)
v_mfma_f32_16x16x32_bf16 v[64:67], a[56:59], v[32:35], v[64:67]
s_waitcnt vmcnt(0)
s_cmp_eq_u32 s75, 0
s_cbranch_scc1 Lnp_100
s_mov_b64 s[98:99], exec
s_mov_b64 exec, 1
buffer_store_dword v4, off, s[4:7], s75 sc1
s_mov_b64 exec, s[98:99]
s_mov_b32 s75, 0
Lnp_100:
v_mfma_f32_16x16x32_bf16 v[72:75], a[120:123], v[32:35], v[72:75]
s_waitcnt lgkmcnt(2)
v_mfma_f32_16x16x32_bf16 v[68:71], a[56:59], v[36:39], v[68:71]
v_mfma_f32_16x16x32_bf16 v[76:79], a[120:123], v[36:39], v[76:79]
s_waitcnt lgkmcnt(1)
v_mfma_f32_16x16x32_bf16 v[64:67], a[60:63], v[40:43], v[64:67]
v_mfma_f32_16x16x32_bf16 v[72:75], a[124:127], v[40:43], v[72:75]
s_waitcnt lgkmcnt(0)
v_mfma_f32_16x16x32_bf16 v[68:71], a[60:63], v[44:47], v[68:71]
v_mfma_f32_16x16x32_bf16 v[76:79], a[124:127], v[44:47], v[76:79]
v_pk_mul_f32 v[120:121], v[16:17], v[116:117] op_sel:[0,1] op_sel_hi:[1,1]
s_nop 2
v_pk_fma_f32 v[64:65], v[64:65], v[116:117], v[120:121] op_sel:[0,0,0] op_sel_hi:[1,0,1]
v_pk_mul_f32 v[120:121], v[18:19], v[116:117] op_sel:[0,1] op_sel_hi:[1,1]
v_pk_fma_f32 v[66:67], v[66:67], v[116:117], v[120:121] op_sel:[0,0,0] op_sel_hi:[1,0,1]
v_pk_mul_f32 v[120:121], v[16:17], v[118:119] op_sel:[0,1] op_sel_hi:[1,1]
v_pk_fma_f32 v[68:69], v[68:69], v[118:119], v[120:121] op_sel:[0,0,0] op_sel_hi:[1,0,1]
v_pk_mul_f32 v[120:121], v[18:19], v[118:119] op_sel:[0,1] op_sel_hi:[1,1]
v_pk_fma_f32 v[70:71], v[70:71], v[118:119], v[120:121] op_sel:[0,0,0] op_sel_hi:[1,0,1]
v_pk_mul_f32 v[120:121], v[20:21], v[116:117] op_sel:[0,1] op_sel_hi:[1,1]
v_pk_fma_f32 v[72:73], v[72:73], v[116:117], v[120:121] op_sel:[0,0,0] op_sel_hi:[1,0,1]
v_pk_mul_f32 v[120:121], v[22:23], v[116:117] op_sel:[0,1] op_sel_hi:[1,1]
v_pk_fma_f32 v[74:75], v[74:75], v[116:117], v[120:121] op_sel:[0,0,0] op_sel_hi:[1,0,1]
v_pk_mul_f32 v[120:121], v[20:21], v[118:119] op_sel:[0,1] op_sel_hi:[1,1]
v_pk_fma_f32 v[76:77], v[76:77], v[118:119], v[120:121] op_sel:[0,0,0] op_sel_hi:[1,0,1]
v_pk_mul_f32 v[120:121], v[22:23], v[118:119] op_sel:[0,1] op_sel_hi:[1,1]
v_pk_fma_f32 v[78:79], v[78:79], v[118:119], v[120:121] op_sel:[0,0,0] op_sel_hi:[1,0,1]
v_cvt_pk_bf16_f32 v48, v64, v72
v_cvt_pk_bf16_f32 v49, v65, v73
v_cvt_pk_bf16_f32 v50, v66, v74
v_cvt_pk_bf16_f32 v51, v67, v75
v_cvt_pk_bf16_f32 v52, v68, v76
v_cvt_pk_bf16_f32 v53, v69, v77
v_cvt_pk_bf16_f32 v54, v70, v78
v_cvt_pk_bf16_f32 v55, v71, v79
ds_write_b128 v125, v[48:51]
ds_write_b128 v125, v[52:55] offset:1024
L_H1_skip:
s_add_u32 s74, s74, 1
s_cmp_lt_i32 s74, 32
s_cbranch_scc1 L_H1_loop
s_waitcnt vmcnt(0)
s_cmp_eq_u32 s75, 0
s_cbranch_scc1 Lnp_101
s_mov_b64 s[98:99], exec
s_mov_b64 exec, 1
buffer_store_dword v4, off, s[4:7], s75 sc1
s_mov_b64 exec, s[98:99]
s_mov_b32 s75, 0
Lnp_101:
s_endpgm
L_abortH:
s_mov_b64 exec, 1
s_lshl_b32 s60, s56, 8
s_or_b32 s60, s60, s61
s_lshl_b32 s61, s47, 16
s_or_b32 s60, s60, s61
s_or_b32 s60, s60, 0x40000000
v_mov_b32 v1, s60
v_mov_b32 v2, 160
buffer_store_dword v1, v2, s[8:11], 0 offen sc1
s_waitcnt vmcnt(0)
s_endpgm
L_O0:
L_O1:
v_lshlrev_b32 v1, 4, v0
v_lshlrev_b32 v6, 2, v0
v_and_b32 v14, 15, v0
v_lshrrev_b32 v15, 4, v0
v_mov_b32 v4, 1
v_mov_b32 v5, 0
s_lshr_b32 s62, s58, 2
s_and_b32 s63, s58, 3
s_lshl_b32 s60, s63, 2
s_add_u32 s60, s60, s47
s_lshl_b32 s60, s60, 14
s_lshl_b32 s61, s57, 21
s_add_u32 s60, s60, s61
s_add_u32 s60, s60, 167772160
s_lshl_b32 s61, s62, 12
s_add_u32 s73, s60, s61
s_xor_b32 s61, s62, 1
s_lshl_b32 s61, s61, 12
s_add_u32 s70, s60, s61
s_xor_b32 s61, s62, 2
s_lshl_b32 s61, s61, 12
s_add_u32 s71, s60, s61
s_xor_b32 s61, s62, 3
s_lshl_b32 s61, s61, 12
s_add_u32 s72, s60, s61
v_mov_b32 v100, -1
v_mov_b32 v101, -1
v_mov_b32 v102, -1
v_mov_b32 v103, -1
s_mov_b32 s60, s73
buffer_store_dwordx4 v[100:103], v1, s[4:7], s60 offen offset:1024 sc1
buffer_store_dwordx4 v[100:103], v1, s[4:7], s60 offen offset:2048 sc1
buffer_store_dwordx4 v[100:103], v1, s[4:7], s60 offen offset:3072 sc1
s_add_u32 s60, s60, 0x40000
buffer_store_dwordx4 v[100:103], v1, s[4:7], s60 offen offset:1024 sc1
buffer_store_dwordx4 v[100:103], v1, s[4:7], s60 offen offset:2048 sc1
buffer_store_dwordx4 v[100:103], v1, s[4:7], s60 offen offset:3072 sc1
s_add_u32 s60, s60, 0x40000
buffer_store_dwordx4 v[100:103], v1, s[4:7], s60 offen offset:1024 sc1
buffer_store_dwordx4 v[100:103], v1, s[4:7], s60 offen offset:2048 sc1
buffer_store_dwordx4 v[100:103], v1, s[4:7], s60 offen offset:3072 sc1
s_add_u32 s60, s60, 0x40000
buffer_store_dwordx4 v[100:103], v1, s[4:7], s60 offen offset:1024 sc1
buffer_store_dwordx4 v[100:103], v1, s[4:7], s60 offen offset:2048 sc1
buffer_store_dwordx4 v[100:103], v1, s[4:7], s60 offen offset:3072 sc1
s_add_u32 s60, s60, 0x40000
buffer_store_dwordx4 v[100:103], v1, s[4:7], s60 offen offset:1024 sc1
buffer_store_dwordx4 v[100:103], v1, s[4:7], s60 offen offset:2048 sc1
buffer_store_dwordx4 v[100:103], v1, s[4:7], s60 offen offset:3072 sc1
s_add_u32 s60, s60, 0x40000
buffer_store_dwordx4 v[100:103], v1, s[4:7], s60 offen offset:1024 sc1
buffer_store_dwordx4 v[100:103], v1, s[4:7], s60 offen offset:2048 sc1
buffer_store_dwordx4 v[100:103], v1, s[4:7], s60 offen offset:3072 sc1
s_add_u32 s60, s60, 0x40000
buffer_store_dwordx4 v[100:103], v1, s[4:7], s60 offen offset:1024 sc1
buffer_store_dwordx4 v[100:103], v1, s[4:7], s60 offen offset:2048 sc1
buffer_store_dwordx4 v[100:103], v1, s[4:7], s60 offen offset:3072 sc1
s_add_u32 s60, s60, 0x40000
buffer_store_dwordx4 v[100:103], v1, s[4:7], s60 offen offset:1024 sc1
buffer_store_dwordx4 v[100:103], v1, s[4:7], s60 offen offset:2048 sc1
buffer_store_dwordx4 v[100:103], v1, s[4:7], s60 offen offset:3072 sc1
s_add_u32 s60, s60, 0x40000
s_waitcnt vmcnt(0)
s_barrier
s_cmp_lg_u32 s47, 0
s_cbranch_scc1 Larr_102
s_getreg_b32 s60, hwreg(HW_REG_XCC_ID)
s_and_b32 s60, s60, 7
s_lshr_b32 s61, s56, 5
s_cmp_eq_u32 s60, s61
s_cselect_b32 s60, 1, 0x10001
s_mov_b64 exec, 1
v_mov_b32 v1, s60
v_mov_b32 v2, 136
buffer_atomic_add v1, v2, s[8:11], 0 offen sc1
s_mov_b64 exec, -1
Larr_102:
v_lshlrev_b32 v1, 4, v0
v_lshlrev_b32 v6, 2, v0
v_and_b32 v14, 15, v0
v_lshrrev_b32 v15, 4, v0
v_mov_b32 v4, 1
v_mov_b32 v5, 0
s_cmp_ge_u32 s62, 2
s_cselect_b32 s44, 0x07060302, s44
s_cselect_b32 s45, 0x05040100, s45
s_mov_b32 s93, 0x01000c0c
s_cselect_b32 s93, 0x03020c0c, s93
v_lshlrev_b32 v7, 13, v15
v_lshrrev_b32 v8, 2, v14
v_lshl_add_u32 v7, v8, 6, v7
v_and_b32 v8, 3, v14
v_lshl_add_u32 v7, v8, 2, v7
s_lshl_b32 s60, s63, 8
s_lshl_b32 s61, s47, 4
s_add_u32 s60, s60, s61
v_add_u32 v7, s60, v7
s_lshl_b32 s60, s62, 20
v_add_u32 v7, s60, v7
s_mov_b32 s12, s26
s_mov_b32 s13, s27
s_mov_b32 s14, 4194304
s_mov_b32 s15, 0x00020000
s_lshl_b32 s67, s63, 18
s_xor_b32 s60, s67, 0
buffer_load_dword v16, v7, s[12:15], s60 offen
s_xor_b32 s60, s67, 1024
buffer_load_dword v17, v7, s[12:15], s60 offen
s_xor_b32 s60, s67, 2048
buffer_load_dword v18, v7, s[12:15], s60 offen
s_xor_b32 s60, s67, 3072
buffer_load_dword v19, v7, s[12:15], s60 offen
s_xor_b32 s60, s67, 4096
buffer_load_dword v20, v7, s[12:15], s60 offen
s_xor_b32 s60, s67, 5120
buffer_load_dword v21, v7, s[12:15], s60 offen
s_xor_b32 s60, s67, 6144
buffer_load_dword v22, v7, s[12:15], s60 offen
s_xor_b32 s60, s67, 7168
buffer_load_dword v23, v7, s[12:15], s60 offen
s_xor_b32 s60, s67, 32768
buffer_load_dword v24, v7, s[12:15], s60 offen
s_xor_b32 s60, s67, 33792
buffer_load_dword v25, v7, s[12:15], s60 offen
s_xor_b32 s60, s67, 34816
buffer_load_dword v26, v7, s[12:15], s60 offen
s_xor_b32 s60, s67, 35840
buffer_load_dword v27, v7, s[12:15], s60 offen
s_xor_b32 s60, s67, 36864
buffer_load_dword v28, v7, s[12:15], s60 offen
s_xor_b32 s60, s67, 37888
buffer_load_dword v29, v7, s[12:15], s60 offen
s_xor_b32 s60, s67, 38912
buffer_load_dword v30, v7, s[12:15], s60 offen
s_xor_b32 s60, s67, 39936
buffer_load_dword v31, v7, s[12:15], s60 offen
s_xor_b32 s60, s67, 65536
buffer_load_dword v32, v7, s[12:15], s60 offen
s_xor_b32 s60, s67, 66560
buffer_load_dword v33, v7, s[12:15], s60 offen
s_xor_b32 s60, s67, 67584
buffer_load_dword v34, v7, s[12:15], s60 offen
s_xor_b32 s60, s67, 68608
buffer_load_dword v35, v7, s[12:15], s60 offen
s_xor_b32 s60, s67, 69632
buffer_load_dword v36, v7, s[12:15], s60 offen
s_xor_b32 s60, s67, 70656
buffer_load_dword v37, v7, s[12:15], s60 offen
s_xor_b32 s60, s67, 71680
buffer_load_dword v38, v7, s[12:15], s60 offen
s_xor_b32 s60, s67, 72704
buffer_load_dword v39, v7, s[12:15], s60 offen
s_xor_b32 s60, s67, 98304
buffer_load_dword v40, v7, s[12:15], s60 offen
s_xor_b32 s60, s67, 99328
buffer_load_dword v41, v7, s[12:15], s60 offen
s_xor_b32 s60, s67, 100352
buffer_load_dword v42, v7, s[12:15], s60 offen
s_xor_b32 s60, s67, 101376
buffer_load_dword v43, v7, s[12:15], s60 offen
s_xor_b32 s60, s67, 102400
buffer_load_dword v44, v7, s[12:15], s60 offen
s_xor_b32 s60, s67, 103424
buffer_load_dword v45, v7, s[12:15], s60 offen
s_xor_b32 s60, s67, 104448
buffer_load_dword v46, v7, s[12:15], s60 offen
s_xor_b32 s60, s67, 105472
buffer_load_dword v47, v7, s[12:15], s60 offen
s_xor_b32 s60, s67, 131072
buffer_load_dword v48, v7, s[12:15], s60 offen
s_xor_b32 s60, s67, 132096
buffer_load_dword v49, v7, s[12:15], s60 offen
s_xor_b32 s60, s67, 133120
buffer_load_dword v50, v7, s[12:15], s60 offen
s_xor_b32 s60, s67, 134144
buffer_load_dword v51, v7, s[12:15], s60 offen
s_xor_b32 s60, s67, 135168
buffer_load_dword v52, v7, s[12:15], s60 offen
s_xor_b32 s60, s67, 136192
buffer_load_dword v53, v7, s[12:15], s60 offen
s_xor_b32 s60, s67, 137216
buffer_load_dword v54, v7, s[12:15], s60 offen
s_xor_b32 s60, s67, 138240
buffer_load_dword v55, v7, s[12:15], s60 offen
s_xor_b32 s60, s67, 163840
buffer_load_dword v56, v7, s[12:15], s60 offen
s_xor_b32 s60, s67, 164864
buffer_load_dword v57, v7, s[12:15], s60 offen
s_xor_b32 s60, s67, 165888
buffer_load_dword v58, v7, s[12:15], s60 offen
s_xor_b32 s60, s67, 166912
buffer_load_dword v59, v7, s[12:15], s60 offen
s_xor_b32 s60, s67, 167936
buffer_load_dword v60, v7, s[12:15], s60 offen
s_xor_b32 s60, s67, 168960
buffer_load_dword v61, v7, s[12:15], s60 offen
s_xor_b32 s60, s67, 169984
buffer_load_dword v62, v7, s[12:15], s60 offen
s_xor_b32 s60, s67, 171008
buffer_load_dword v63, v7, s[12:15], s60 offen
s_xor_b32 s60, s67, 196608
buffer_load_dword v64, v7, s[12:15], s60 offen
s_xor_b32 s60, s67, 197632
buffer_load_dword v65, v7, s[12:15], s60 offen
s_xor_b32 s60, s67, 198656
buffer_load_dword v66, v7, s[12:15], s60 offen
s_xor_b32 s60, s67, 199680
buffer_load_dword v67, v7, s[12:15], s60 offen
s_xor_b32 s60, s67, 200704
buffer_load_dword v68, v7, s[12:15], s60 offen
s_xor_b32 s60, s67, 201728
buffer_load_dword v69, v7, s[12:15], s60 offen
s_xor_b32 s60, s67, 202752
buffer_load_dword v70, v7, s[12:15], s60 offen
s_xor_b32 s60, s67, 203776
buffer_load_dword v71, v7, s[12:15], s60 offen
s_xor_b32 s60, s67, 229376
buffer_load_dword v72, v7, s[12:15], s60 offen
s_xor_b32 s60, s67, 230400
buffer_load_dword v73, v7, s[12:15], s60 offen
s_xor_b32 s60, s67, 231424
buffer_load_dword v74, v7, s[12:15], s60 offen
s_xor_b32 s60, s67, 232448
buffer_load_dword v75, v7, s[12:15], s60 offen
s_xor_b32 s60, s67, 233472
buffer_load_dword v76, v7, s[12:15], s60 offen
s_xor_b32 s60, s67, 234496
buffer_load_dword v77, v7, s[12:15], s60 offen
s_xor_b32 s60, s67, 235520
buffer_load_dword v78, v7, s[12:15], s60 offen
s_xor_b32 s60, s67, 236544
buffer_load_dword v79, v7, s[12:15], s60 offen
s_waitcnt vmcnt(48)
v_perm_b32 v80, v17, v16, s44
v_accvgpr_write_b32 a0, v80
v_perm_b32 v81, v19, v18, s44
v_accvgpr_write_b32 a1, v81
v_perm_b32 v82, v21, v20, s44
v_accvgpr_write_b32 a2, v82
v_perm_b32 v83, v23, v22, s44
v_accvgpr_write_b32 a3, v83
v_perm_b32 v84, v17, v16, s45
v_accvgpr_write_b32 a128, v84
v_perm_b32 v85, v19, v18, s45
v_accvgpr_write_b32 a129, v85
v_perm_b32 v86, v21, v20, s45
v_accvgpr_write_b32 a130, v86
v_perm_b32 v87, v23, v22, s45
v_accvgpr_write_b32 a131, v87
v_perm_b32 v80, v25, v24, s44
v_accvgpr_write_b32 a4, v80
v_perm_b32 v81, v27, v26, s44
v_accvgpr_write_b32 a5, v81
v_perm_b32 v82, v29, v28, s44
v_accvgpr_write_b32 a6, v82
v_perm_b32 v83, v31, v30, s44
v_accvgpr_write_b32 a7, v83
v_perm_b32 v84, v25, v24, s45
v_accvgpr_write_b32 a132, v84
v_perm_b32 v85, v27, v26, s45
v_accvgpr_write_b32 a133, v85
v_perm_b32 v86, v29, v28, s45
v_accvgpr_write_b32 a134, v86
v_perm_b32 v87, v31, v30, s45
v_accvgpr_write_b32 a135, v87
s_xor_b32 s60, s67, 262144
buffer_load_dword v16, v7, s[12:15], s60 offen
s_xor_b32 s60, s67, 263168
buffer_load_dword v17, v7, s[12:15], s60 offen
s_xor_b32 s60, s67, 264192
buffer_load_dword v18, v7, s[12:15], s60 offen
s_xor_b32 s60, s67, 265216
buffer_load_dword v19, v7, s[12:15], s60 offen
s_xor_b32 s60, s67, 266240
buffer_load_dword v20, v7, s[12:15], s60 offen
s_xor_b32 s60, s67, 267264
buffer_load_dword v21, v7, s[12:15], s60 offen
s_xor_b32 s60, s67, 268288
buffer_load_dword v22, v7, s[12:15], s60 offen
s_xor_b32 s60, s67, 269312
buffer_load_dword v23, v7, s[12:15], s60 offen
s_xor_b32 s60, s67, 294912
buffer_load_dword v24, v7, s[12:15], s60 offen
s_xor_b32 s60, s67, 295936
buffer_load_dword v25, v7, s[12:15], s60 offen
s_xor_b32 s60, s67, 296960
buffer_load_dword v26, v7, s[12:15], s60 offen
s_xor_b32 s60, s67, 297984
buffer_load_dword v27, v7, s[12:15], s60 offen
s_xor_b32 s60, s67, 299008
buffer_load_dword v28, v7, s[12:15], s60 offen
s_xor_b32 s60, s67, 300032
buffer_load_dword v29, v7, s[12:15], s60 offen
s_xor_b32 s60, s67, 301056
buffer_load_dword v30, v7, s[12:15], s60 offen
s_xor_b32 s60, s67, 302080
buffer_load_dword v31, v7, s[12:15], s60 offen
s_waitcnt vmcnt(48)
v_perm_b32 v80, v33, v32, s44
v_accvgpr_write_b32 a8, v80
v_perm_b32 v81, v35, v34, s44
v_accvgpr_write_b32 a9, v81
v_perm_b32 v82, v37, v36, s44
v_accvgpr_write_b32 a10, v82
v_perm_b32 v83, v39, v38, s44
v_accvgpr_write_b32 a11, v83
v_perm_b32 v84, v33, v32, s45
v_accvgpr_write_b32 a136, v84
v_perm_b32 v85, v35, v34, s45
v_accvgpr_write_b32 a137, v85
v_perm_b32 v86, v37, v36, s45
v_accvgpr_write_b32 a138, v86
v_perm_b32 v87, v39, v38, s45
v_accvgpr_write_b32 a139, v87
v_perm_b32 v80, v41, v40, s44
v_accvgpr_write_b32 a12, v80
v_perm_b32 v81, v43, v42, s44
v_accvgpr_write_b32 a13, v81
v_perm_b32 v82, v45, v44, s44
v_accvgpr_write_b32 a14, v82
v_perm_b32 v83, v47, v46, s44
v_accvgpr_write_b32 a15, v83
v_perm_b32 v84, v41, v40, s45
v_accvgpr_write_b32 a140, v84
v_perm_b32 v85, v43, v42, s45
v_accvgpr_write_b32 a141, v85
v_perm_b32 v86, v45, v44, s45
v_accvgpr_write_b32 a142, v86
v_perm_b32 v87, v47, v46, s45
v_accvgpr_write_b32 a143, v87
s_xor_b32 s60, s67, 327680
buffer_load_dword v32, v7, s[12:15], s60 offen
s_xor_b32 s60, s67, 328704
buffer_load_dword v33, v7, s[12:15], s60 offen
s_xor_b32 s60, s67, 329728
buffer_load_dword v34, v7, s[12:15], s60 offen
s_xor_b32 s60, s67, 330752
buffer_load_dword v35, v7, s[12:15], s60 offen
s_xor_b32 s60, s67, 331776
buffer_load_dword v36, v7, s[12:15], s60 offen
s_xor_b32 s60, s67, 332800
buffer_load_dword v37, v7, s[12:15], s60 offen
s_xor_b32 s60, s67, 333824
buffer_load_dword v38, v7, s[12:15], s60 offen
s_xor_b32 s60, s67, 334848
buffer_load_dword v39, v7, s[12:15], s60 offen
s_xor_b32 s60, s67, 360448
buffer_load_dword v40, v7, s[12:15], s60 offen
s_xor_b32 s60, s67, 361472
buffer_load_dword v41, v7, s[12:15], s60 offen
s_xor_b32 s60, s67, 362496
buffer_load_dword v42, v7, s[12:15], s60 offen
s_xor_b32 s60, s67, 363520
buffer_load_dword v43, v7, s[12:15], s60 offen
s_xor_b32 s60, s67, 364544
buffer_load_dword v44, v7, s[12:15], s60 offen
s_xor_b32 s60, s67, 365568
buffer_load_dword v45, v7, s[12:15], s60 offen
s_xor_b32 s60, s67, 366592
buffer_load_dword v46, v7, s[12:15], s60 offen
s_xor_b32 s60, s67, 367616
buffer_load_dword v47, v7, s[12:15], s60 offen
s_waitcnt vmcnt(48)
v_perm_b32 v80, v49, v48, s44
v_accvgpr_write_b32 a16, v80
v_perm_b32 v81, v51, v50, s44
v_accvgpr_write_b32 a17, v81
v_perm_b32 v82, v53, v52, s44
v_accvgpr_write_b32 a18, v82
v_perm_b32 v83, v55, v54, s44
v_accvgpr_write_b32 a19, v83
v_perm_b32 v84, v49, v48, s45
v_accvgpr_write_b32 a144, v84
v_perm_b32 v85, v51, v50, s45
v_accvgpr_write_b32 a145, v85
v_perm_b32 v86, v53, v52, s45
v_accvgpr_write_b32 a146, v86
v_perm_b32 v87, v55, v54, s45
v_accvgpr_write_b32 a147, v87
v_perm_b32 v80, v57, v56, s44
v_accvgpr_write_b32 a20, v80
v_perm_b32 v81, v59, v58, s44
v_accvgpr_write_b32 a21, v81
v_perm_b32 v82, v61, v60, s44
v_accvgpr_write_b32 a22, v82
v_perm_b32 v83, v63, v62, s44
v_accvgpr_write_b32 a23, v83
v_perm_b32 v84, v57, v56, s45
v_accvgpr_write_b32 a148, v84
v_perm_b32 v85, v59, v58, s45
v_accvgpr_write_b32 a149, v85
v_perm_b32 v86, v61, v60, s45
v_accvgpr_write_b32 a150, v86
v_perm_b32 v87, v63, v62, s45
v_accvgpr_write_b32 a151, v87
s_xor_b32 s60, s67, 393216
buffer_load_dword v48, v7, s[12:15], s60 offen
s_xor_b32 s60, s67, 394240
buffer_load_dword v49, v7, s[12:15], s60 offen
s_xor_b32 s60, s67, 395264
buffer_load_dword v50, v7, s[12:15], s60 offen
s_xor_b32 s60, s67, 396288
buffer_load_dword v51, v7, s[12:15], s60 offen
s_xor_b32 s60, s67, 397312
buffer_load_dword v52, v7, s[12:15], s60 offen
s_xor_b32 s60, s67, 398336
buffer_load_dword v53, v7, s[12:15], s60 offen
s_xor_b32 s60, s67, 399360
buffer_load_dword v54, v7, s[12:15], s60 offen
s_xor_b32 s60, s67, 400384
buffer_load_dword v55, v7, s[12:15], s60 offen
s_xor_b32 s60, s67, 425984
buffer_load_dword v56, v7, s[12:15], s60 offen
s_xor_b32 s60, s67, 427008
buffer_load_dword v57, v7, s[12:15], s60 offen
s_xor_b32 s60, s67, 428032
buffer_load_dword v58, v7, s[12:15], s60 offen
s_xor_b32 s60, s67, 429056
buffer_load_dword v59, v7, s[12:15], s60 offen
s_xor_b32 s60, s67, 430080
buffer_load_dword v60, v7, s[12:15], s60 offen
s_xor_b32 s60, s67, 431104
buffer_load_dword v61, v7, s[12:15], s60 offen
s_xor_b32 s60, s67, 432128
buffer_load_dword v62, v7, s[12:15], s60 offen
s_xor_b32 s60, s67, 433152
buffer_load_dword v63, v7, s[12:15], s60 offen
s_waitcnt vmcnt(48)
v_perm_b32 v80, v65, v64, s44
v_accvgpr_write_b32 a24, v80
v_perm_b32 v81, v67, v66, s44
v_accvgpr_write_b32 a25, v81
v_perm_b32 v82, v69, v68, s44
v_accvgpr_write_b32 a26, v82
v_perm_b32 v83, v71, v70, s44
v_accvgpr_write_b32 a27, v83
v_perm_b32 v84, v65, v64, s45
v_accvgpr_write_b32 a152, v84
v_perm_b32 v85, v67, v66, s45
v_accvgpr_write_b32 a153, v85
v_perm_b32 v86, v69, v68, s45
v_accvgpr_write_b32 a154, v86
v_perm_b32 v87, v71, v70, s45
v_accvgpr_write_b32 a155, v87
v_perm_b32 v80, v73, v72, s44
v_accvgpr_write_b32 a28, v80
v_perm_b32 v81, v75, v74, s44
v_accvgpr_write_b32 a29, v81
v_perm_b32 v82, v77, v76, s44
v_accvgpr_write_b32 a30, v82
v_perm_b32 v83, v79, v78, s44
v_accvgpr_write_b32 a31, v83
v_perm_b32 v84, v73, v72, s45
v_accvgpr_write_b32 a156, v84
v_perm_b32 v85, v75, v74, s45
v_accvgpr_write_b32 a157, v85
v_perm_b32 v86, v77, v76, s45
v_accvgpr_write_b32 a158, v86
v_perm_b32 v87, v79, v78, s45
v_accvgpr_write_b32 a159, v87
s_xor_b32 s60, s67, 458752
buffer_load_dword v64, v7, s[12:15], s60 offen
s_xor_b32 s60, s67, 459776
buffer_load_dword v65, v7, s[12:15], s60 offen
s_xor_b32 s60, s67, 460800
buffer_load_dword v66, v7, s[12:15], s60 offen
s_xor_b32 s60, s67, 461824
buffer_load_dword v67, v7, s[12:15], s60 offen
s_xor_b32 s60, s67, 462848
buffer_load_dword v68, v7, s[12:15], s60 offen
s_xor_b32 s60, s67, 463872
buffer_load_dword v69, v7, s[12:15], s60 offen
s_xor_b32 s60, s67, 464896
buffer_load_dword v70, v7, s[12:15], s60 offen
s_xor_b32 s60, s67, 465920
buffer_load_dword v71, v7, s[12:15], s60 offen
s_xor_b32 s60, s67, 491520
buffer_load_dword v72, v7, s[12:15], s60 offen
s_xor_b32 s60, s67, 492544
buffer_load_dword v73, v7, s[12:15], s60 offen
s_xor_b32 s60, s67, 493568
buffer_load_dword v74, v7, s[12:15], s60 offen
s_xor_b32 s60, s67, 494592
buffer_load_dword v75, v7, s[12:15], s60 offen
s_xor_b32 s60, s67, 495616
buffer_load_dword v76, v7, s[12:15], s60 offen
s_xor_b32 s60, s67, 496640
buffer_load_dword v77, v7, s[12:15], s60 offen
s_xor_b32 s60, s67, 497664
buffer_load_dword v78, v7, s[12:15], s60 offen
s_xor_b32 s60, s67, 498688
buffer_load_dword v79, v7, s[12:15], s60 offen
s_waitcnt vmcnt(48)
v_perm_b32 v80, v17, v16, s44
v_accvgpr_write_b32 a32, v80
v_perm_b32 v81, v19, v18, s44
v_accvgpr_write_b32 a33, v81
v_perm_b32 v82, v21, v20, s44
v_accvgpr_write_b32 a34, v82
v_perm_b32 v83, v23, v22, s44
v_accvgpr_write_b32 a35, v83
v_perm_b32 v84, v17, v16, s45
v_accvgpr_write_b32 a160, v84
v_perm_b32 v85, v19, v18, s45
v_accvgpr_write_b32 a161, v85
v_perm_b32 v86, v21, v20, s45
v_accvgpr_write_b32 a162, v86
v_perm_b32 v87, v23, v22, s45
v_accvgpr_write_b32 a163, v87
v_perm_b32 v80, v25, v24, s44
v_accvgpr_write_b32 a36, v80
v_perm_b32 v81, v27, v26, s44
v_accvgpr_write_b32 a37, v81
v_perm_b32 v82, v29, v28, s44
v_accvgpr_write_b32 a38, v82
v_perm_b32 v83, v31, v30, s44
v_accvgpr_write_b32 a39, v83
v_perm_b32 v84, v25, v24, s45
v_accvgpr_write_b32 a164, v84
v_perm_b32 v85, v27, v26, s45
v_accvgpr_write_b32 a165, v85
v_perm_b32 v86, v29, v28, s45
v_accvgpr_write_b32 a166, v86
v_perm_b32 v87, v31, v30, s45
v_accvgpr_write_b32 a167, v87
s_xor_b32 s60, s67, 524288
buffer_load_dword v16, v7, s[12:15], s60 offen
s_xor_b32 s60, s67, 525312
buffer_load_dword v17, v7, s[12:15], s60 offen
s_xor_b32 s60, s67, 526336
buffer_load_dword v18, v7, s[12:15], s60 offen
s_xor_b32 s60, s67, 527360
buffer_load_dword v19, v7, s[12:15], s60 offen
s_xor_b32 s60, s67, 528384
buffer_load_dword v20, v7, s[12:15], s60 offen
s_xor_b32 s60, s67, 529408
buffer_load_dword v21, v7, s[12:15], s60 offen
s_xor_b32 s60, s67, 530432
buffer_load_dword v22, v7, s[12:15], s60 offen
s_xor_b32 s60, s67, 531456
buffer_load_dword v23, v7, s[12:15], s60 offen
s_xor_b32 s60, s67, 557056
buffer_load_dword v24, v7, s[12:15], s60 offen
s_xor_b32 s60, s67, 558080
buffer_load_dword v25, v7, s[12:15], s60 offen
s_xor_b32 s60, s67, 559104
buffer_load_dword v26, v7, s[12:15], s60 offen
s_xor_b32 s60, s67, 560128
buffer_load_dword v27, v7, s[12:15], s60 offen
s_xor_b32 s60, s67, 561152
buffer_load_dword v28, v7, s[12:15], s60 offen
s_xor_b32 s60, s67, 562176
buffer_load_dword v29, v7, s[12:15], s60 offen
s_xor_b32 s60, s67, 563200
buffer_load_dword v30, v7, s[12:15], s60 offen
s_xor_b32 s60, s67, 564224
buffer_load_dword v31, v7, s[12:15], s60 offen
s_waitcnt vmcnt(48)
v_perm_b32 v80, v33, v32, s44
v_accvgpr_write_b32 a40, v80
v_perm_b32 v81, v35, v34, s44
v_accvgpr_write_b32 a41, v81
v_perm_b32 v82, v37, v36, s44
v_accvgpr_write_b32 a42, v82
v_perm_b32 v83, v39, v38, s44
v_accvgpr_write_b32 a43, v83
v_perm_b32 v84, v33, v32, s45
v_accvgpr_write_b32 a168, v84
v_perm_b32 v85, v35, v34, s45
v_accvgpr_write_b32 a169, v85
v_perm_b32 v86, v37, v36, s45
v_accvgpr_write_b32 a170, v86
v_perm_b32 v87, v39, v38, s45
v_accvgpr_write_b32 a171, v87
v_perm_b32 v80, v41, v40, s44
v_accvgpr_write_b32 a44, v80
v_perm_b32 v81, v43, v42, s44
v_accvgpr_write_b32 a45, v81
v_perm_b32 v82, v45, v44, s44
v_accvgpr_write_b32 a46, v82
v_perm_b32 v83, v47, v46, s44
v_accvgpr_write_b32 a47, v83
v_perm_b32 v84, v41, v40, s45
v_accvgpr_write_b32 a172, v84
v_perm_b32 v85, v43, v42, s45
v_accvgpr_write_b32 a173, v85
v_perm_b32 v86, v45, v44, s45
v_accvgpr_write_b32 a174, v86
v_perm_b32 v87, v47, v46, s45
v_accvgpr_write_b32 a175, v87
s_xor_b32 s60, s67, 589824
buffer_load_dword v32, v7, s[12:15], s60 offen
s_xor_b32 s60, s67, 590848
buffer_load_dword v33, v7, s[12:15], s60 offen
s_xor_b32 s60, s67, 591872
buffer_load_dword v34, v7, s[12:15], s60 offen
s_xor_b32 s60, s67, 592896
buffer_load_dword v35, v7, s[12:15], s60 offen
s_xor_b32 s60, s67, 593920
buffer_load_dword v36, v7, s[12:15], s60 offen
s_xor_b32 s60, s67, 594944
buffer_load_dword v37, v7, s[12:15], s60 offen
s_xor_b32 s60, s67, 595968
buffer_load_dword v38, v7, s[12:15], s60 offen
s_xor_b32 s60, s67, 596992
buffer_load_dword v39, v7, s[12:15], s60 offen
s_xor_b32 s60, s67, 622592
buffer_load_dword v40, v7, s[12:15], s60 offen
s_xor_b32 s60, s67, 623616
buffer_load_dword v41, v7, s[12:15], s60 offen
s_xor_b32 s60, s67, 624640
buffer_load_dword v42, v7, s[12:15], s60 offen
s_xor_b32 s60, s67, 625664
buffer_load_dword v43, v7, s[12:15], s60 offen
s_xor_b32 s60, s67, 626688
buffer_load_dword v44, v7, s[12:15], s60 offen
s_xor_b32 s60, s67, 627712
buffer_load_dword v45, v7, s[12:15], s60 offen
s_xor_b32 s60, s67, 628736
buffer_load_dword v46, v7, s[12:15], s60 offen
s_xor_b32 s60, s67, 629760
buffer_load_dword v47, v7, s[12:15], s60 offen
s_waitcnt vmcnt(48)
v_perm_b32 v80, v49, v48, s44
v_accvgpr_write_b32 a48, v80
v_perm_b32 v81, v51, v50, s44
v_accvgpr_write_b32 a49, v81
v_perm_b32 v82, v53, v52, s44
v_accvgpr_write_b32 a50, v82
v_perm_b32 v83, v55, v54, s44
v_accvgpr_write_b32 a51, v83
v_perm_b32 v84, v49, v48, s45
v_accvgpr_write_b32 a176, v84
v_perm_b32 v85, v51, v50, s45
v_accvgpr_write_b32 a177, v85
v_perm_b32 v86, v53, v52, s45
v_accvgpr_write_b32 a178, v86
v_perm_b32 v87, v55, v54, s45
v_accvgpr_write_b32 a179, v87
v_perm_b32 v80, v57, v56, s44
v_accvgpr_write_b32 a52, v80
v_perm_b32 v81, v59, v58, s44
v_accvgpr_write_b32 a53, v81
v_perm_b32 v82, v61, v60, s44
v_accvgpr_write_b32 a54, v82
v_perm_b32 v83, v63, v62, s44
v_accvgpr_write_b32 a55, v83
v_perm_b32 v84, v57, v56, s45
v_accvgpr_write_b32 a180, v84
v_perm_b32 v85, v59, v58, s45
v_accvgpr_write_b32 a181, v85
v_perm_b32 v86, v61, v60, s45
v_accvgpr_write_b32 a182, v86
v_perm_b32 v87, v63, v62, s45
v_accvgpr_write_b32 a183, v87
s_xor_b32 s60, s67, 655360
buffer_load_dword v48, v7, s[12:15], s60 offen
s_xor_b32 s60, s67, 656384
buffer_load_dword v49, v7, s[12:15], s60 offen
s_xor_b32 s60, s67, 657408
buffer_load_dword v50, v7, s[12:15], s60 offen
s_xor_b32 s60, s67, 658432
buffer_load_dword v51, v7, s[12:15], s60 offen
s_xor_b32 s60, s67, 659456
buffer_load_dword v52, v7, s[12:15], s60 offen
s_xor_b32 s60, s67, 660480
buffer_load_dword v53, v7, s[12:15], s60 offen
s_xor_b32 s60, s67, 661504
buffer_load_dword v54, v7, s[12:15], s60 offen
s_xor_b32 s60, s67, 662528
buffer_load_dword v55, v7, s[12:15], s60 offen
s_xor_b32 s60, s67, 688128
buffer_load_dword v56, v7, s[12:15], s60 offen
s_xor_b32 s60, s67, 689152
buffer_load_dword v57, v7, s[12:15], s60 offen
s_xor_b32 s60, s67, 690176
buffer_load_dword v58, v7, s[12:15], s60 offen
s_xor_b32 s60, s67, 691200
buffer_load_dword v59, v7, s[12:15], s60 offen
s_xor_b32 s60, s67, 692224
buffer_load_dword v60, v7, s[12:15], s60 offen
s_xor_b32 s60, s67, 693248
buffer_load_dword v61, v7, s[12:15], s60 offen
s_xor_b32 s60, s67, 694272
buffer_load_dword v62, v7, s[12:15], s60 offen
s_xor_b32 s60, s67, 695296
buffer_load_dword v63, v7, s[12:15], s60 offen
s_waitcnt vmcnt(48)
v_perm_b32 v80, v65, v64, s44
v_accvgpr_write_b32 a56, v80
v_perm_b32 v81, v67, v66, s44
v_accvgpr_write_b32 a57, v81
v_perm_b32 v82, v69, v68, s44
v_accvgpr_write_b32 a58, v82
v_perm_b32 v83, v71, v70, s44
v_accvgpr_write_b32 a59, v83
v_perm_b32 v84, v65, v64, s45
v_accvgpr_write_b32 a184, v84
v_perm_b32 v85, v67, v66, s45
v_accvgpr_write_b32 a185, v85
v_perm_b32 v86, v69, v68, s45
v_accvgpr_write_b32 a186, v86
v_perm_b32 v87, v71, v70, s45
v_accvgpr_write_b32 a187, v87
v_perm_b32 v80, v73, v72, s44
v_accvgpr_write_b32 a60, v80
v_perm_b32 v81, v75, v74, s44
v_accvgpr_write_b32 a61, v81
v_perm_b32 v82, v77, v76, s44
v_accvgpr_write_b32 a62, v82
v_perm_b32 v83, v79, v78, s44
v_accvgpr_write_b32 a63, v83
v_perm_b32 v84, v73, v72, s45
v_accvgpr_write_b32 a188, v84
v_perm_b32 v85, v75, v74, s45
v_accvgpr_write_b32 a189, v85
v_perm_b32 v86, v77, v76, s45
v_accvgpr_write_b32 a190, v86
v_perm_b32 v87, v79, v78, s45
v_accvgpr_write_b32 a191, v87
s_xor_b32 s60, s67, 720896
buffer_load_dword v64, v7, s[12:15], s60 offen
s_xor_b32 s60, s67, 721920
buffer_load_dword v65, v7, s[12:15], s60 offen
s_xor_b32 s60, s67, 722944
buffer_load_dword v66, v7, s[12:15], s60 offen
s_xor_b32 s60, s67, 723968
buffer_load_dword v67, v7, s[12:15], s60 offen
s_xor_b32 s60, s67, 724992
buffer_load_dword v68, v7, s[12:15], s60 offen
s_xor_b32 s60, s67, 726016
buffer_load_dword v69, v7, s[12:15], s60 offen
s_xor_b32 s60, s67, 727040
buffer_load_dword v70, v7, s[12:15], s60 offen
s_xor_b32 s60, s67, 728064
buffer_load_dword v71, v7, s[12:15], s60 offen
s_xor_b32 s60, s67, 753664
buffer_load_dword v72, v7, s[12:15], s60 offen
s_xor_b32 s60, s67, 754688
buffer_load_dword v73, v7, s[12:15], s60 offen
s_xor_b32 s60, s67, 755712
buffer_load_dword v74, v7, s[12:15], s60 offen
s_xor_b32 s60, s67, 756736
buffer_load_dword v75, v7, s[12:15], s60 offen
s_xor_b32 s60, s67, 757760
buffer_load_dword v76, v7, s[12:15], s60 offen
s_xor_b32 s60, s67, 758784
buffer_load_dword v77, v7, s[12:15], s60 offen
s_xor_b32 s60, s67, 759808
buffer_load_dword v78, v7, s[12:15], s60 offen
s_xor_b32 s60, s67, 760832
buffer_load_dword v79, v7, s[12:15], s60 offen
s_waitcnt vmcnt(48)
v_perm_b32 v80, v17, v16, s44
v_accvgpr_write_b32 a64, v80
v_perm_b32 v81, v19, v18, s44
v_accvgpr_write_b32 a65, v81
v_perm_b32 v82, v21, v20, s44
v_accvgpr_write_b32 a66, v82
v_perm_b32 v83, v23, v22, s44
v_accvgpr_write_b32 a67, v83
v_perm_b32 v84, v17, v16, s45
v_accvgpr_write_b32 a192, v84
v_perm_b32 v85, v19, v18, s45
v_accvgpr_write_b32 a193, v85
v_perm_b32 v86, v21, v20, s45
v_accvgpr_write_b32 a194, v86
v_perm_b32 v87, v23, v22, s45
v_accvgpr_write_b32 a195, v87
v_perm_b32 v80, v25, v24, s44
v_accvgpr_write_b32 a68, v80
v_perm_b32 v81, v27, v26, s44
v_accvgpr_write_b32 a69, v81
v_perm_b32 v82, v29, v28, s44
v_accvgpr_write_b32 a70, v82
v_perm_b32 v83, v31, v30, s44
v_accvgpr_write_b32 a71, v83
v_perm_b32 v84, v25, v24, s45
v_accvgpr_write_b32 a196, v84
v_perm_b32 v85, v27, v26, s45
v_accvgpr_write_b32 a197, v85
v_perm_b32 v86, v29, v28, s45
v_accvgpr_write_b32 a198, v86
v_perm_b32 v87, v31, v30, s45
v_accvgpr_write_b32 a199, v87
s_xor_b32 s60, s67, 786432
buffer_load_dword v16, v7, s[12:15], s60 offen
s_xor_b32 s60, s67, 787456
buffer_load_dword v17, v7, s[12:15], s60 offen
s_xor_b32 s60, s67, 788480
buffer_load_dword v18, v7, s[12:15], s60 offen
s_xor_b32 s60, s67, 789504
buffer_load_dword v19, v7, s[12:15], s60 offen
s_xor_b32 s60, s67, 790528
buffer_load_dword v20, v7, s[12:15], s60 offen
s_xor_b32 s60, s67, 791552
buffer_load_dword v21, v7, s[12:15], s60 offen
s_xor_b32 s60, s67, 792576
buffer_load_dword v22, v7, s[12:15], s60 offen
s_xor_b32 s60, s67, 793600
buffer_load_dword v23, v7, s[12:15], s60 offen
s_xor_b32 s60, s67, 819200
buffer_load_dword v24, v7, s[12:15], s60 offen
s_xor_b32 s60, s67, 820224
buffer_load_dword v25, v7, s[12:15], s60 offen
s_xor_b32 s60, s67, 821248
buffer_load_dword v26, v7, s[12:15], s60 offen
s_xor_b32 s60, s67, 822272
buffer_load_dword v27, v7, s[12:15], s60 offen
s_xor_b32 s60, s67, 823296
buffer_load_dword v28, v7, s[12:15], s60 offen
s_xor_b32 s60, s67, 824320
buffer_load_dword v29, v7, s[12:15], s60 offen
s_xor_b32 s60, s67, 825344
buffer_load_dword v30, v7, s[12:15], s60 offen
s_xor_b32 s60, s67, 826368
buffer_load_dword v31, v7, s[12:15], s60 offen
s_waitcnt vmcnt(48)
v_perm_b32 v80, v33, v32, s44
v_accvgpr_write_b32 a72, v80
v_perm_b32 v81, v35, v34, s44
v_accvgpr_write_b32 a73, v81
v_perm_b32 v82, v37, v36, s44
v_accvgpr_write_b32 a74, v82
v_perm_b32 v83, v39, v38, s44
v_accvgpr_write_b32 a75, v83
v_perm_b32 v84, v33, v32, s45
v_accvgpr_write_b32 a200, v84
v_perm_b32 v85, v35, v34, s45
v_accvgpr_write_b32 a201, v85
v_perm_b32 v86, v37, v36, s45
v_accvgpr_write_b32 a202, v86
v_perm_b32 v87, v39, v38, s45
v_accvgpr_write_b32 a203, v87
v_perm_b32 v80, v41, v40, s44
v_accvgpr_write_b32 a76, v80
v_perm_b32 v81, v43, v42, s44
v_accvgpr_write_b32 a77, v81
v_perm_b32 v82, v45, v44, s44
v_accvgpr_write_b32 a78, v82
v_perm_b32 v83, v47, v46, s44
v_accvgpr_write_b32 a79, v83
v_perm_b32 v84, v41, v40, s45
v_accvgpr_write_b32 a204, v84
v_perm_b32 v85, v43, v42, s45
v_accvgpr_write_b32 a205, v85
v_perm_b32 v86, v45, v44, s45
v_accvgpr_write_b32 a206, v86
v_perm_b32 v87, v47, v46, s45
v_accvgpr_write_b32 a207, v87
s_xor_b32 s60, s67, 851968
buffer_load_dword v32, v7, s[12:15], s60 offen
s_xor_b32 s60, s67, 852992
buffer_load_dword v33, v7, s[12:15], s60 offen
s_xor_b32 s60, s67, 854016
buffer_load_dword v34, v7, s[12:15], s60 offen
s_xor_b32 s60, s67, 855040
buffer_load_dword v35, v7, s[12:15], s60 offen
s_xor_b32 s60, s67, 856064
buffer_load_dword v36, v7, s[12:15], s60 offen
s_xor_b32 s60, s67, 857088
buffer_load_dword v37, v7, s[12:15], s60 offen
s_xor_b32 s60, s67, 858112
buffer_load_dword v38, v7, s[12:15], s60 offen
s_xor_b32 s60, s67, 859136
buffer_load_dword v39, v7, s[12:15], s60 offen
s_xor_b32 s60, s67, 884736
buffer_load_dword v40, v7, s[12:15], s60 offen
s_xor_b32 s60, s67, 885760
buffer_load_dword v41, v7, s[12:15], s60 offen
s_xor_b32 s60, s67, 886784
buffer_load_dword v42, v7, s[12:15], s60 offen
s_xor_b32 s60, s67, 887808
buffer_load_dword v43, v7, s[12:15], s60 offen
s_xor_b32 s60, s67, 888832
buffer_load_dword v44, v7, s[12:15], s60 offen
s_xor_b32 s60, s67, 889856
buffer_load_dword v45, v7, s[12:15], s60 offen
s_xor_b32 s60, s67, 890880
buffer_load_dword v46, v7, s[12:15], s60 offen
s_xor_b32 s60, s67, 891904
buffer_load_dword v47, v7, s[12:15], s60 offen
s_waitcnt vmcnt(48)
v_perm_b32 v80, v49, v48, s44
v_accvgpr_write_b32 a80, v80
v_perm_b32 v81, v51, v50, s44
v_accvgpr_write_b32 a81, v81
v_perm_b32 v82, v53, v52, s44
v_accvgpr_write_b32 a82, v82
v_perm_b32 v83, v55, v54, s44
v_accvgpr_write_b32 a83, v83
v_perm_b32 v84, v49, v48, s45
v_accvgpr_write_b32 a208, v84
v_perm_b32 v85, v51, v50, s45
v_accvgpr_write_b32 a209, v85
v_perm_b32 v86, v53, v52, s45
v_accvgpr_write_b32 a210, v86
v_perm_b32 v87, v55, v54, s45
v_accvgpr_write_b32 a211, v87
v_perm_b32 v80, v57, v56, s44
v_accvgpr_write_b32 a84, v80
v_perm_b32 v81, v59, v58, s44
v_accvgpr_write_b32 a85, v81
v_perm_b32 v82, v61, v60, s44
v_accvgpr_write_b32 a86, v82
v_perm_b32 v83, v63, v62, s44
v_accvgpr_write_b32 a87, v83
v_perm_b32 v84, v57, v56, s45
v_accvgpr_write_b32 a212, v84
v_perm_b32 v85, v59, v58, s45
v_accvgpr_write_b32 a213, v85
v_perm_b32 v86, v61, v60, s45
v_accvgpr_write_b32 a214, v86
v_perm_b32 v87, v63, v62, s45
v_accvgpr_write_b32 a215, v87
s_xor_b32 s60, s67, 917504
buffer_load_dword v48, v7, s[12:15], s60 offen
s_xor_b32 s60, s67, 918528
buffer_load_dword v49, v7, s[12:15], s60 offen
s_xor_b32 s60, s67, 919552
buffer_load_dword v50, v7, s[12:15], s60 offen
s_xor_b32 s60, s67, 920576
buffer_load_dword v51, v7, s[12:15], s60 offen
s_xor_b32 s60, s67, 921600
buffer_load_dword v52, v7, s[12:15], s60 offen
s_xor_b32 s60, s67, 922624
buffer_load_dword v53, v7, s[12:15], s60 offen
s_xor_b32 s60, s67, 923648
buffer_load_dword v54, v7, s[12:15], s60 offen
s_xor_b32 s60, s67, 924672
buffer_load_dword v55, v7, s[12:15], s60 offen
s_xor_b32 s60, s67, 950272
buffer_load_dword v56, v7, s[12:15], s60 offen
s_xor_b32 s60, s67, 951296
buffer_load_dword v57, v7, s[12:15], s60 offen
s_xor_b32 s60, s67, 952320
buffer_load_dword v58, v7, s[12:15], s60 offen
s_xor_b32 s60, s67, 953344
buffer_load_dword v59, v7, s[12:15], s60 offen
s_xor_b32 s60, s67, 954368
buffer_load_dword v60, v7, s[12:15], s60 offen
s_xor_b32 s60, s67, 955392
buffer_load_dword v61, v7, s[12:15], s60 offen
s_xor_b32 s60, s67, 956416
buffer_load_dword v62, v7, s[12:15], s60 offen
s_xor_b32 s60, s67, 957440
buffer_load_dword v63, v7, s[12:15], s60 offen
s_waitcnt vmcnt(48)
v_perm_b32 v80, v65, v64, s44
v_accvgpr_write_b32 a88, v80
v_perm_b32 v81, v67, v66, s44
v_accvgpr_write_b32 a89, v81
v_perm_b32 v82, v69, v68, s44
v_accvgpr_write_b32 a90, v82
v_perm_b32 v83, v71, v70, s44
v_accvgpr_write_b32 a91, v83
v_perm_b32 v84, v65, v64, s45
v_accvgpr_write_b32 a216, v84
v_perm_b32 v85, v67, v66, s45
v_accvgpr_write_b32 a217, v85
v_perm_b32 v86, v69, v68, s45
v_accvgpr_write_b32 a218, v86
v_perm_b32 v87, v71, v70, s45
v_accvgpr_write_b32 a219, v87
v_perm_b32 v80, v73, v72, s44
v_accvgpr_write_b32 a92, v80
v_perm_b32 v81, v75, v74, s44
v_accvgpr_write_b32 a93, v81
v_perm_b32 v82, v77, v76, s44
v_accvgpr_write_b32 a94, v82
v_perm_b32 v83, v79, v78, s44
v_accvgpr_write_b32 a95, v83
v_perm_b32 v84, v73, v72, s45
v_accvgpr_write_b32 a220, v84
v_perm_b32 v85, v75, v74, s45
v_accvgpr_write_b32 a221, v85
v_perm_b32 v86, v77, v76, s45
v_accvgpr_write_b32 a222, v86
v_perm_b32 v87, v79, v78, s45
v_accvgpr_write_b32 a223, v87
s_xor_b32 s60, s67, 983040
buffer_load_dword v64, v7, s[12:15], s60 offen
s_xor_b32 s60, s67, 984064
buffer_load_dword v65, v7, s[12:15], s60 offen
s_xor_b32 s60, s67, 985088
buffer_load_dword v66, v7, s[12:15], s60 offen
s_xor_b32 s60, s67, 986112
buffer_load_dword v67, v7, s[12:15], s60 offen
s_xor_b32 s60, s67, 987136
buffer_load_dword v68, v7, s[12:15], s60 offen
s_xor_b32 s60, s67, 988160
buffer_load_dword v69, v7, s[12:15], s60 offen
s_xor_b32 s60, s67, 989184
buffer_load_dword v70, v7, s[12:15], s60 offen
s_xor_b32 s60, s67, 990208
buffer_load_dword v71, v7, s[12:15], s60 offen
s_xor_b32 s60, s67, 1015808
buffer_load_dword v72, v7, s[12:15], s60 offen
s_xor_b32 s60, s67, 1016832
buffer_load_dword v73, v7, s[12:15], s60 offen
s_xor_b32 s60, s67, 1017856
buffer_load_dword v74, v7, s[12:15], s60 offen
s_xor_b32 s60, s67, 1018880
buffer_load_dword v75, v7, s[12:15], s60 offen
s_xor_b32 s60, s67, 1019904
buffer_load_dword v76, v7, s[12:15], s60 offen
s_xor_b32 s60, s67, 1020928
buffer_load_dword v77, v7, s[12:15], s60 offen
s_xor_b32 s60, s67, 1021952
buffer_load_dword v78, v7, s[12:15], s60 offen
s_xor_b32 s60, s67, 1022976
buffer_load_dword v79, v7, s[12:15], s60 offen
s_waitcnt vmcnt(48)
v_perm_b32 v80, v17, v16, s44
v_accvgpr_write_b32 a96, v80
v_perm_b32 v81, v19, v18, s44
v_accvgpr_write_b32 a97, v81
v_perm_b32 v82, v21, v20, s44
v_accvgpr_write_b32 a98, v82
v_perm_b32 v83, v23, v22, s44
v_accvgpr_write_b32 a99, v83
v_perm_b32 v84, v17, v16, s45
v_accvgpr_write_b32 a224, v84
v_perm_b32 v85, v19, v18, s45
v_accvgpr_write_b32 a225, v85
v_perm_b32 v86, v21, v20, s45
v_accvgpr_write_b32 a226, v86
v_perm_b32 v87, v23, v22, s45
v_accvgpr_write_b32 a227, v87
v_perm_b32 v80, v25, v24, s44
v_accvgpr_write_b32 a100, v80
v_perm_b32 v81, v27, v26, s44
v_accvgpr_write_b32 a101, v81
v_perm_b32 v82, v29, v28, s44
v_accvgpr_write_b32 a102, v82
v_perm_b32 v83, v31, v30, s44
v_accvgpr_write_b32 a103, v83
v_perm_b32 v84, v25, v24, s45
v_accvgpr_write_b32 a228, v84
v_perm_b32 v85, v27, v26, s45
v_accvgpr_write_b32 a229, v85
v_perm_b32 v86, v29, v28, s45
v_accvgpr_write_b32 a230, v86
v_perm_b32 v87, v31, v30, s45
v_accvgpr_write_b32 a231, v87
s_waitcnt vmcnt(32)
v_perm_b32 v80, v33, v32, s44
v_accvgpr_write_b32 a104, v80
v_perm_b32 v81, v35, v34, s44
v_accvgpr_write_b32 a105, v81
v_perm_b32 v82, v37, v36, s44
v_accvgpr_write_b32 a106, v82
v_perm_b32 v83, v39, v38, s44
v_accvgpr_write_b32 a107, v83
v_perm_b32 v84, v33, v32, s45
v_accvgpr_write_b32 a232, v84
v_perm_b32 v85, v35, v34, s45
v_accvgpr_write_b32 a233, v85
v_perm_b32 v86, v37, v36, s45
v_accvgpr_write_b32 a234, v86
v_perm_b32 v87, v39, v38, s45
v_accvgpr_write_b32 a235, v87
v_perm_b32 v80, v41, v40, s44
v_accvgpr_write_b32 a108, v80
v_perm_b32 v81, v43, v42, s44
v_accvgpr_write_b32 a109, v81
v_perm_b32 v82, v45, v44, s44
v_accvgpr_write_b32 a110, v82
v_perm_b32 v83, v47, v46, s44
v_accvgpr_write_b32 a111, v83
v_perm_b32 v84, v41, v40, s45
v_accvgpr_write_b32 a236, v84
v_perm_b32 v85, v43, v42, s45
v_accvgpr_write_b32 a237, v85
v_perm_b32 v86, v45, v44, s45
v_accvgpr_write_b32 a238, v86
v_perm_b32 v87, v47, v46, s45
v_accvgpr_write_b32 a239, v87
s_waitcnt vmcnt(16)
v_perm_b32 v80, v49, v48, s44
v_accvgpr_write_b32 a112, v80
v_perm_b32 v81, v51, v50, s44
v_accvgpr_write_b32 a113, v81
v_perm_b32 v82, v53, v52, s44
v_accvgpr_write_b32 a114, v82
v_perm_b32 v83, v55, v54, s44
v_accvgpr_write_b32 a115, v83
v_perm_b32 v84, v49, v48, s45
v_accvgpr_write_b32 a240, v84
v_perm_b32 v85, v51, v50, s45
v_accvgpr_write_b32 a241, v85
v_perm_b32 v86, v53, v52, s45
v_accvgpr_write_b32 a242, v86
v_perm_b32 v87, v55, v54, s45
v_accvgpr_write_b32 a243, v87
v_perm_b32 v80, v57, v56, s44
v_accvgpr_write_b32 a116, v80
v_perm_b32 v81, v59, v58, s44
v_accvgpr_write_b32 a117, v81
v_perm_b32 v82, v61, v60, s44
v_accvgpr_write_b32 a118, v82
v_perm_b32 v83, v63, v62, s44
v_accvgpr_write_b32 a119, v83
v_perm_b32 v84, v57, v56, s45
v_accvgpr_write_b32 a244, v84
v_perm_b32 v85, v59, v58, s45
v_accvgpr_write_b32 a245, v85
v_perm_b32 v86, v61, v60, s45
v_accvgpr_write_b32 a246, v86
v_perm_b32 v87, v63, v62, s45
v_accvgpr_write_b32 a247, v87
s_waitcnt vmcnt(0)
v_perm_b32 v80, v65, v64, s44
v_accvgpr_write_b32 a120, v80
v_perm_b32 v81, v67, v66, s44
v_accvgpr_write_b32 a121, v81
v_perm_b32 v82, v69, v68, s44
v_accvgpr_write_b32 a122, v82
v_perm_b32 v83, v71, v70, s44
v_accvgpr_write_b32 a123, v83
v_perm_b32 v84, v65, v64, s45
v_accvgpr_write_b32 a248, v84
v_perm_b32 v85, v67, v66, s45
v_accvgpr_write_b32 a249, v85
v_perm_b32 v86, v69, v68, s45
v_accvgpr_write_b32 a250, v86
v_perm_b32 v87, v71, v70, s45
v_accvgpr_write_b32 a251, v87
v_perm_b32 v80, v73, v72, s44
v_accvgpr_write_b32 a124, v80
v_perm_b32 v81, v75, v74, s44
v_accvgpr_write_b32 a125, v81
v_perm_b32 v82, v77, v76, s44
v_accvgpr_write_b32 a126, v82
v_perm_b32 v83, v79, v78, s44
v_accvgpr_write_b32 a127, v83
v_perm_b32 v84, v73, v72, s45
v_accvgpr_write_b32 a252, v84
v_perm_b32 v85, v75, v74, s45
v_accvgpr_write_b32 a253, v85
v_perm_b32 v86, v77, v76, s45
v_accvgpr_write_b32 a254, v86
v_perm_b32 v87, v79, v78, s45
v_accvgpr_write_b32 a255, v87
s_nop 1
s_cmp_eq_u32 s57, 1
s_cbranch_scc1 L_O1_main
L_O0_main:
s_lshl_b32 s69, s62, 16
s_add_u32 s69, s69, 134217728
s_lshl_b32 s78, s47, 13
s_lshl_b32 s94, s47, 12
s_lshl_b32 s101, s47, 11
s_lshl_b32 s61, s62, 7
s_add_u32 s61, s61, 131072
v_and_b32 v8, 31, v0
v_lshl_add_u32 v2, v8, 2, s61
v_lshlrev_b32 v3, 9, v15
v_lshl_add_u32 v3, v14, 4, v3
s_lshl_b32 s60, s63, 2
s_add_u32 s60, s60, s47
s_and_b32 s96, s62, 1
s_lshr_b32 s97, s62, 1
s_lshl_b32 s61, s60, 11
s_lshl_b32 s95, s96, 10
s_add_u32 s61, s61, s95
s_add_u32 s74, s61, 10485760
s_lshl_b32 s95, s97, 3
s_add_u32 s61, s61, s95
s_add_u32 s75, s61, 4194304
s_lshl_b32 s61, s96, 12
s_bfe_u32 s95, s60, 0x20001
s_lshl_b32 s95, s95, 10
s_add_u32 s61, s61, s95
s_lshr_b32 s95, s60, 3
s_lshl_b32 s95, s95, 8
s_add_u32 s61, s61, s95
s_and_b32 s95, s60, 1
s_lshl_b32 s95, s95, 3
s_add_u32 s61, s61, s95
s_lshl_b32 s95, s97, 2
s_add_u32 s61, s61, s95
s_add_u32 s76, s61, 13631488
s_lshl_b32 s61, s60, 2
s_add_u32 s61, s61, s62
s_lshl_b32 s61, s61, 2
s_add_u32 s77, s61, 196608
s_lshl_b32 s95, s96, 10
v_add_u32 v10, s95, v1
v_xor_b32 v11, 0x400, v10
s_mov_b32 s64, 0
s_mov_b32 s66, 0
s_mov_b32 s68, 0
s_lshl_b32 s67, s63, 14
s_mov_b32 s92, 0
s_mov_b32 s95, 0
s_mov_b32 s96, 0
v_mov_b32 v100, -1
v_mov_b32 v101, -1
v_mov_b32 v102, -1
v_mov_b32 v103, -1
s_mov_b64 exec, 1
v_mov_b32 v9, 136
s_nop 1
Lgb_144:
buffer_load_dword v8, v9, s[8:11], 0 offen sc1
s_memtime s[60:61]
s_waitcnt lgkmcnt(0)
s_sub_u32 s60, s60, s46
s_mov_b32 s61, 2
s_cmp_gt_u32 s60, 67108864
s_cbranch_scc1 L_abortO
s_waitcnt vmcnt(0)
v_readfirstlane_b32 s60, v8
s_and_b32 s61, s60, 0xffff
s_cmp_lt_u32 s61, 256
s_cbranch_scc1 Lgb_144
s_mov_b64 exec, -1
s_cmp_lt_u32 s60, 0x10000
s_cselect_b32 s65, 1, 0
s_branch L_O0_poll
L_O0_slp:
s_sleep 1
L_O0_poll:
buffer_load_dword v12, v2, s[4:7], 0 offen sc1
s_memtime s[60:61]
s_waitcnt lgkmcnt(0)
s_sub_u32 s60, s60, s46
s_mov_b32 s61, 30
s_cmp_gt_u32 s60, 67108864
s_cbranch_scc1 L_abortO
s_waitcnt vmcnt(0)
s_cmp_eq_u32 s68, 0
s_cbranch_scc1 Lnp_145
s_mov_b64 s[98:99], exec
s_mov_b64 exec, 1
s_cmp_eq_u32 s65, 0
s_cbranch_scc1 Lslow_146
buffer_store_dword v4, off, s[4:7], s68
s_branch Ljoin_147
Lslow_146:
buffer_store_dword v4, off, s[4:7], s68 sc1
Ljoin_147:
s_mov_b64 exec, s[98:99]
s_mov_b32 s68, 0
Lnp_145:
v_cmp_eq_u32 vcc, 0, v12
s_cbranch_vccnz L_O0_slp
s_nop 3
L_O0_iss:
buffer_load_dwordx4 v[76:79], v1, s[4:7], s74 offen sc1
s_add_u32 s100, s92, s101
s_add_u32 m0, s100, 0
s_add_u32 s100, s69, s101
s_add_u32 s100, s100, 0
s_xor_b32 s100, s100, s67
buffer_load_dwordx4 v1, s[4:7], s100 offen offset:0 sc1 lds
buffer_load_dwordx4 v1, s[4:7], s100 offen offset:1024 sc1 lds
s_add_u32 s100, s92, s101
s_add_u32 m0, s100, 8192
s_add_u32 s100, s69, s101
s_add_u32 s100, s100, 8192
s_xor_b32 s100, s100, s67
buffer_load_dwordx4 v1, s[4:7], s100 offen offset:0 sc1 lds
buffer_load_dwordx4 v1, s[4:7], s100 offen offset:1024 sc1 lds
s_add_u32 s100, s92, s94
s_add_u32 m0, s100, 16384
s_add_u32 s100, s69, s94
s_add_u32 s100, s100, 16384
s_xor_b32 s100, s100, s67
buffer_load_dwordx4 v1, s[4:7], s100 offen offset:0 sc1 lds
buffer_load_dwordx4 v1, s[4:7], s100 offen offset:1024 sc1 lds
buffer_load_dwordx4 v1, s[4:7], s100 offen offset:2048 sc1 lds
buffer_load_dwordx4 v1, s[4:7], s100 offen offset:3072 sc1 lds
s_add_u32 s100, s92, s78
s_add_u32 m0, s100, 32768
s_add_u32 s100, s69, s78
s_add_u32 s100, s100, 32768
s_xor_b32 s100, s100, s67
buffer_load_dwordx4 v1, s[4:7], s100 offen offset:0 sc1 lds
buffer_load_dwordx4 v1, s[4:7], s100 offen offset:1024 sc1 lds
buffer_load_dwordx4 v1, s[4:7], s100 offen offset:2048 sc1 lds
buffer_load_dwordx4 v1, s[4:7], s100 offen offset:3072 sc1 lds
s_add_u32 s100, s92, s78
s_add_u32 m0, s100, 36864
s_add_u32 s100, s69, s78
s_add_u32 s100, s100, 36864
s_xor_b32 s100, s100, s67
buffer_load_dwordx4 v1, s[4:7], s100 offen offset:0 sc1 lds
buffer_load_dwordx4 v1, s[4:7], s100 offen offset:1024 sc1 lds
buffer_load_dwordx4 v1, s[4:7], s100 offen offset:2048 sc1 lds
buffer_load_dwordx4 v1, s[4:7], s100 offen offset:3072 sc1 lds
L_O0_go:
buffer_load_dword v12, v2, s[4:7], 0 offen offset:512 sc1
s_add_u32 s69, s69, 262144
s_add_u32 s74, s74, 32768
s_xor_b32 s92, s92, 0x10000
s_waitcnt vmcnt(15)
s_barrier
v_perm_b32 v16, v76, v76, s93
v_perm_b32 v17, v77, v77, s93
v_perm_b32 v18, v78, v78, s93
v_perm_b32 v19, v79, v79, s93
s_cmp_lg_u32 s66, 0
s_cbranch_scc1 Lm_148
s_cmp_eq_u32 s68, 0
s_cbranch_scc1 Lnp_149
s_mov_b64 s[98:99], exec
s_mov_b64 exec, 1
s_cmp_eq_u32 s65, 0
s_cbranch_scc1 Lslow_150
buffer_store_dword v4, off, s[4:7], s68
s_branch Ljoin_151
Lslow_150:
buffer_store_dword v4, off, s[4:7], s68 sc1
Ljoin_151:
s_mov_b64 exec, s[98:99]
s_mov_b32 s68, 0
Lnp_149:
Lm_148:
ds_read_b128 v[32:35], v10 offset:0
ds_read_b128 v[36:39], v11 offset:0
ds_read_b128 v[40:43], v10 offset:2048
ds_read_b128 v[44:47], v11 offset:2048
ds_read_b128 v[48:51], v10 offset:4096
ds_read_b128 v[52:55], v11 offset:4096
ds_read_b128 v[56:59], v10 offset:6144
ds_read_b128 v[60:63], v11 offset:6144
s_waitcnt lgkmcnt(7)
v_mfma_f32_16x16x32_bf16 v[24:27], a[128:131], v[32:35], 0
s_waitcnt vmcnt(13)
s_barrier
ds_read_b128 v[32:35], v10 offset:8192
s_waitcnt lgkmcnt(7)
v_mfma_f32_16x16x32_bf16 v[20:23], a[0:3], v[36:39], 0
v_mfma_f32_16x16x32_bf16 v[28:31], a[128:131], v[36:39], 0
ds_read_b128 v[36:39], v11 offset:8192
s_waitcnt lgkmcnt(7)
v_mfma_f32_16x16x32_bf16 v[24:27], a[132:135], v[40:43], v[24:27]
ds_read_b128 v[40:43], v10 offset:10240
s_waitcnt lgkmcnt(7)
v_mfma_f32_16x16x32_bf16 v[20:23], a[4:7], v[44:47], v[20:23]
v_mfma_f32_16x16x32_bf16 v[28:31], a[132:135], v[44:47], v[28:31]
ds_read_b128 v[44:47], v11 offset:10240
s_waitcnt lgkmcnt(7)
v_mfma_f32_16x16x32_bf16 v[24:27], a[136:139], v[48:51], v[24:27]
ds_read_b128 v[48:51], v10 offset:12288
s_waitcnt lgkmcnt(7)
v_mfma_f32_16x16x32_bf16 v[20:23], a[8:11], v[52:55], v[20:23]
v_mfma_f32_16x16x32_bf16 v[28:31], a[136:139], v[52:55], v[28:31]
ds_read_b128 v[52:55], v11 offset:12288
s_waitcnt lgkmcnt(7)
v_mfma_f32_16x16x32_bf16 v[24:27], a[140:143], v[56:59], v[24:27]
ds_read_b128 v[56:59], v10 offset:14336
s_waitcnt lgkmcnt(7)
v_mfma_f32_16x16x32_bf16 v[20:23], a[12:15], v[60:63], v[20:23]
v_mfma_f32_16x16x32_bf16 v[28:31], a[140:143], v[60:63], v[28:31]
ds_read_b128 v[60:63], v11 offset:14336
s_waitcnt lgkmcnt(7)
v_mfma_f32_16x16x32_bf16 v[24:27], a[144:147], v[32:35], v[24:27]
s_waitcnt vmcnt(9)
s_barrier
ds_read_b128 v[32:35], v10 offset:16384
s_waitcnt lgkmcnt(7)
v_mfma_f32_16x16x32_bf16 v[20:23], a[16:19], v[36:39], v[20:23]
v_mfma_f32_16x16x32_bf16 v[28:31], a[144:147], v[36:39], v[28:31]
ds_read_b128 v[36:39], v11 offset:16384
s_waitcnt lgkmcnt(7)
v_mfma_f32_16x16x32_bf16 v[24:27], a[148:151], v[40:43], v[24:27]
ds_read_b128 v[40:43], v10 offset:18432
s_waitcnt lgkmcnt(7)
v_mfma_f32_16x16x32_bf16 v[20:23], a[20:23], v[44:47], v[20:23]
v_mfma_f32_16x16x32_bf16 v[28:31], a[148:151], v[44:47], v[28:31]
ds_read_b128 v[44:47], v11 offset:18432
s_waitcnt lgkmcnt(7)
v_mfma_f32_16x16x32_bf16 v[24:27], a[152:155], v[48:51], v[24:27]
s_cmp_eq_u32 s68, 0
s_cbranch_scc1 Lm_152
s_waitcnt vmcnt(4)
s_cmp_eq_u32 s68, 0
s_cbranch_scc1 Lnp_153
s_mov_b64 s[98:99], exec
s_mov_b64 exec, 1
s_cmp_eq_u32 s65, 0
s_cbranch_scc1 Lslow_154
buffer_store_dword v4, off, s[4:7], s68
s_branch Ljoin_155
Lslow_154:
buffer_store_dword v4, off, s[4:7], s68 sc1
Ljoin_155:
s_mov_b64 exec, s[98:99]
s_mov_b32 s68, 0
Lnp_153:
Lm_152:
ds_read_b128 v[48:51], v10 offset:20480
s_waitcnt lgkmcnt(7)
v_mfma_f32_16x16x32_bf16 v[20:23], a[24:27], v[52:55], v[20:23]
v_mfma_f32_16x16x32_bf16 v[28:31], a[152:155], v[52:55], v[28:31]
ds_read_b128 v[52:55], v11 offset:20480
s_waitcnt lgkmcnt(7)
v_mfma_f32_16x16x32_bf16 v[24:27], a[156:159], v[56:59], v[24:27]
ds_read_b128 v[56:59], v10 offset:22528
s_waitcnt lgkmcnt(7)
v_mfma_f32_16x16x32_bf16 v[20:23], a[28:31], v[60:63], v[20:23]
v_mfma_f32_16x16x32_bf16 v[28:31], a[156:159], v[60:63], v[28:31]
ds_read_b128 v[60:63], v11 offset:22528
s_waitcnt lgkmcnt(7)
v_mfma_f32_16x16x32_bf16 v[24:27], a[160:163], v[32:35], v[24:27]
ds_read_b128 v[32:35], v10 offset:24576
s_waitcnt lgkmcnt(7)
v_mfma_f32_16x16x32_bf16 v[20:23], a[32:35], v[36:39], v[20:23]
v_mfma_f32_16x16x32_bf16 v[28:31], a[160:163], v[36:39], v[28:31]
ds_read_b128 v[36:39], v11 offset:24576
s_waitcnt lgkmcnt(7)
v_mfma_f32_16x16x32_bf16 v[24:27], a[164:167], v[40:43], v[24:27]
ds_read_b128 v[40:43], v10 offset:26624
s_waitcnt lgkmcnt(7)
v_mfma_f32_16x16x32_bf16 v[20:23], a[36:39], v[44:47], v[20:23]
v_mfma_f32_16x16x32_bf16 v[28:31], a[164:167], v[44:47], v[28:31]
ds_read_b128 v[44:47], v11 offset:26624
s_waitcnt lgkmcnt(7)
v_mfma_f32_16x16x32_bf16 v[24:27], a[168:171], v[48:51], v[24:27]
ds_read_b128 v[48:51], v10 offset:28672
s_waitcnt lgkmcnt(7)
v_mfma_f32_16x16x32_bf16 v[20:23], a[40:43], v[52:55], v[20:23]
v_mfma_f32_16x16x32_bf16 v[28:31], a[168:171], v[52:55], v[28:31]
ds_read_b128 v[52:55], v11 offset:28672
s_waitcnt lgkmcnt(7)
v_mfma_f32_16x16x32_bf16 v[24:27], a[172:175], v[56:59], v[24:27]
ds_read_b128 v[56:59], v10 offset:30720
s_waitcnt lgkmcnt(7)
v_mfma_f32_16x16x32_bf16 v[20:23], a[44:47], v[60:63], v[20:23]
v_mfma_f32_16x16x32_bf16 v[28:31], a[172:175], v[60:63], v[28:31]
ds_read_b128 v[60:63], v11 offset:30720
s_waitcnt lgkmcnt(7)
v_mfma_f32_16x16x32_bf16 v[24:27], a[176:179], v[32:35], v[24:27]
s_waitcnt vmcnt(1)
s_barrier
s_waitcnt vmcnt(0)
v_cmp_eq_u32 vcc, 0, v12
s_cmp_ge_u32 s64, 63
s_cselect_b64 s[60:61], -1, 0
s_or_b64 vcc, vcc, s[60:61]
s_cselect_b32 s66, 0, 1
ds_read_b128 v[32:35], v10 offset:32768
s_waitcnt lgkmcnt(7)
v_mfma_f32_16x16x32_bf16 v[20:23], a[48:51], v[36:39], v[20:23]
v_mfma_f32_16x16x32_bf16 v[28:31], a[176:179], v[36:39], v[28:31]
s_cbranch_vccnz Ld_156
buffer_load_dwordx4 v[76:79], v1, s[4:7], s74 offen sc1
Ld_156:
ds_read_b128 v[36:39], v11 offset:32768
s_waitcnt lgkmcnt(7)
v_mfma_f32_16x16x32_bf16 v[24:27], a[180:183], v[40:43], v[24:27]
ds_read_b128 v[40:43], v10 offset:34816
s_waitcnt lgkmcnt(7)
v_mfma_f32_16x16x32_bf16 v[20:23], a[52:55], v[44:47], v[20:23]
s_add_u32 s100, s92, s101
s_add_u32 m0, s100, 0
s_add_u32 s100, s69, s101
s_add_u32 s100, s100, 0
s_xor_b32 s100, s100, s67
s_cbranch_vccnz Ld_157
buffer_load_dwordx4 v1, s[4:7], s100 offen offset:0 sc1 lds
Ld_157:
v_mfma_f32_16x16x32_bf16 v[28:31], a[180:183], v[44:47], v[28:31]
ds_read_b128 v[44:47], v11 offset:34816
s_waitcnt lgkmcnt(7)
v_mfma_f32_16x16x32_bf16 v[24:27], a[184:187], v[48:51], v[24:27]
s_cbranch_vccnz Ld_158
buffer_load_dwordx4 v1, s[4:7], s100 offen offset:1024 sc1 lds
Ld_158:
ds_read_b128 v[48:51], v10 offset:36864
s_waitcnt lgkmcnt(7)
v_mfma_f32_16x16x32_bf16 v[20:23], a[56:59], v[52:55], v[20:23]
v_mfma_f32_16x16x32_bf16 v[28:31], a[184:187], v[52:55], v[28:31]
s_add_u32 s100, s92, s101
s_add_u32 m0, s100, 8192
s_add_u32 s100, s69, s101
s_add_u32 s100, s100, 8192
s_xor_b32 s100, s100, s67
s_cbranch_vccnz Ld_159
buffer_load_dwordx4 v1, s[4:7], s100 offen offset:0 sc1 lds
Ld_159:
ds_read_b128 v[52:55], v11 offset:36864
s_waitcnt lgkmcnt(7)
v_mfma_f32_16x16x32_bf16 v[24:27], a[188:191], v[56:59], v[24:27]
ds_read_b128 v[56:59], v10 offset:38912
s_waitcnt lgkmcnt(7)
v_mfma_f32_16x16x32_bf16 v[20:23], a[60:63], v[60:63], v[20:23]
s_cbranch_vccnz Ld_160
buffer_load_dwordx4 v1, s[4:7], s100 offen offset:1024 sc1 lds
Ld_160:
v_mfma_f32_16x16x32_bf16 v[28:31], a[188:191], v[60:63], v[28:31]
ds_read_b128 v[60:63], v11 offset:38912
s_waitcnt lgkmcnt(7)
v_mfma_f32_16x16x32_bf16 v[24:27], a[192:195], v[32:35], v[24:27]
s_add_u32 s100, s92, s94
s_add_u32 m0, s100, 16384
s_add_u32 s100, s69, s94
s_add_u32 s100, s100, 16384
s_xor_b32 s100, s100, s67
s_cbranch_vccnz Ld_161
buffer_load_dwordx4 v1, s[4:7], s100 offen offset:0 sc1 lds
Ld_161:
ds_read_b128 v[32:35], v10 offset:40960
s_waitcnt lgkmcnt(7)
v_mfma_f32_16x16x32_bf16 v[20:23], a[64:67], v[36:39], v[20:23]
v_mfma_f32_16x16x32_bf16 v[28:31], a[192:195], v[36:39], v[28:31]
s_cbranch_vccnz Ld_162
buffer_load_dwordx4 v1, s[4:7], s100 offen offset:1024 sc1 lds
Ld_162:
ds_read_b128 v[36:39], v11 offset:40960
s_waitcnt lgkmcnt(7)
v_mfma_f32_16x16x32_bf16 v[24:27], a[196:199], v[40:43], v[24:27]
ds_read_b128 v[40:43], v10 offset:43008
s_waitcnt lgkmcnt(7)
v_mfma_f32_16x16x32_bf16 v[20:23], a[68:71], v[44:47], v[20:23]
s_cbranch_vccnz Ld_163
buffer_load_dwordx4 v1, s[4:7], s100 offen offset:2048 sc1 lds
Ld_163:
v_mfma_f32_16x16x32_bf16 v[28:31], a[196:199], v[44:47], v[28:31]
ds_read_b128 v[44:47], v11 offset:43008
s_waitcnt lgkmcnt(7)
v_mfma_f32_16x16x32_bf16 v[24:27], a[200:203], v[48:51], v[24:27]
s_cbranch_vccnz Ld_164
buffer_load_dwordx4 v1, s[4:7], s100 offen offset:3072 sc1 lds
Ld_164:
ds_read_b128 v[48:51], v10 offset:45056
s_waitcnt lgkmcnt(7)
v_mfma_f32_16x16x32_bf16 v[20:23], a[72:75], v[52:55], v[20:23]
v_mfma_f32_16x16x32_bf16 v[28:31], a[200:203], v[52:55], v[28:31]
s_add_u32 s100, s92, s78
s_add_u32 m0, s100, 32768
s_add_u32 s100, s69, s78
s_add_u32 s100, s100, 32768
s_xor_b32 s100, s100, s67
s_cbranch_vccnz Ld_165
buffer_load_dwordx4 v1, s[4:7], s100 offen offset:0 sc1 lds
Ld_165:
ds_read_b128 v[52:55], v11 offset:45056
s_waitcnt lgkmcnt(7)
v_mfma_f32_16x16x32_bf16 v[24:27], a[204:207], v[56:59], v[24:27]
ds_read_b128 v[56:59], v10 offset:47104
s_waitcnt lgkmcnt(7)
v_mfma_f32_16x16x32_bf16 v[20:23], a[76:79], v[60:63], v[20:23]
s_cbranch_vccnz Ld_166
buffer_load_dwordx4 v1, s[4:7], s100 offen offset:1024 sc1 lds
Ld_166:
v_mfma_f32_16x16x32_bf16 v[28:31], a[204:207], v[60:63], v[28:31]
ds_read_b128 v[60:63], v11 offset:47104
s_waitcnt lgkmcnt(7)
v_mfma_f32_16x16x32_bf16 v[24:27], a[208:211], v[32:35], v[24:27]
s_cbranch_vccnz Ld_167
buffer_load_dwordx4 v1, s[4:7], s100 offen offset:2048 sc1 lds
Ld_167:
ds_read_b128 v[32:35], v10 offset:49152
s_waitcnt lgkmcnt(7)
v_mfma_f32_16x16x32_bf16 v[20:23], a[80:83], v[36:39], v[20:23]
v_mfma_f32_16x16x32_bf16 v[28:31], a[208:211], v[36:39], v[28:31]
s_cbranch_vccnz Ld_168
buffer_load_dwordx4 v1, s[4:7], s100 offen offset:3072 sc1 lds
Ld_168:
ds_read_b128 v[36:39], v11 offset:49152
s_waitcnt lgkmcnt(7)
v_mfma_f32_16x16x32_bf16 v[24:27], a[212:215], v[40:43], v[24:27]
ds_read_b128 v[40:43], v10 offset:51200
s_waitcnt lgkmcnt(7)
v_mfma_f32_16x16x32_bf16 v[20:23], a[84:87], v[44:47], v[20:23]
s_add_u32 s100, s92, s78
s_add_u32 m0, s100, 36864
s_add_u32 s100, s69, s78
s_add_u32 s100, s100, 36864
s_xor_b32 s100, s100, s67
s_cbranch_vccnz Ld_169
buffer_load_dwordx4 v1, s[4:7], s100 offen offset:0 sc1 lds
Ld_169:
v_mfma_f32_16x16x32_bf16 v[28:31], a[212:215], v[44:47], v[28:31]
ds_read_b128 v[44:47], v11 offset:51200
s_waitcnt lgkmcnt(7)
v_mfma_f32_16x16x32_bf16 v[24:27], a[216:219], v[48:51], v[24:27]
s_cbranch_vccnz Ld_170
buffer_load_dwordx4 v1, s[4:7], s100 offen offset:1024 sc1 lds
Ld_170:
ds_read_b128 v[48:51], v10 offset:53248
s_waitcnt lgkmcnt(7)
v_mfma_f32_16x16x32_bf16 v[20:23], a[88:91], v[52:55], v[20:23]
v_mfma_f32_16x16x32_bf16 v[28:31], a[216:219], v[52:55], v[28:31]
s_cbranch_vccnz Ld_171
buffer_load_dwordx4 v1, s[4:7], s100 offen offset:2048 sc1 lds
Ld_171:
ds_read_b128 v[52:55], v11 offset:53248
s_waitcnt lgkmcnt(7)
v_mfma_f32_16x16x32_bf16 v[24:27], a[220:223], v[56:59], v[24:27]
ds_read_b128 v[56:59], v10 offset:55296
s_waitcnt lgkmcnt(7)
v_mfma_f32_16x16x32_bf16 v[20:23], a[92:95], v[60:63], v[20:23]
s_cbranch_vccnz Ld_172
buffer_load_dwordx4 v1, s[4:7], s100 offen offset:3072 sc1 lds
Ld_172:
v_mfma_f32_16x16x32_bf16 v[28:31], a[220:223], v[60:63], v[28:31]
ds_read_b128 v[60:63], v11 offset:55296
s_waitcnt lgkmcnt(7)
v_mfma_f32_16x16x32_bf16 v[24:27], a[224:227], v[32:35], v[24:27]
ds_read_b128 v[32:35], v10 offset:57344
s_waitcnt lgkmcnt(7)
v_mfma_f32_16x16x32_bf16 v[20:23], a[96:99], v[36:39], v[20:23]
v_mfma_f32_16x16x32_bf16 v[28:31], a[224:227], v[36:39], v[28:31]
ds_read_b128 v[36:39], v11 offset:57344
s_waitcnt lgkmcnt(7)
v_mfma_f32_16x16x32_bf16 v[24:27], a[228:231], v[40:43], v[24:27]
ds_read_b128 v[40:43], v10 offset:59392
s_waitcnt lgkmcnt(7)
v_mfma_f32_16x16x32_bf16 v[20:23], a[100:103], v[44:47], v[20:23]
v_mfma_f32_16x16x32_bf16 v[28:31], a[228:231], v[44:47], v[28:31]
ds_read_b128 v[44:47], v11 offset:59392
s_waitcnt lgkmcnt(7)
v_mfma_f32_16x16x32_bf16 v[24:27], a[232:235], v[48:51], v[24:27]
ds_read_b128 v[48:51], v10 offset:61440
s_waitcnt lgkmcnt(7)
v_mfma_f32_16x16x32_bf16 v[20:23], a[104:107], v[52:55], v[20:23]
v_mfma_f32_16x16x32_bf16 v[28:31], a[232:235], v[52:55], v[28:31]
ds_read_b128 v[52:55], v11 offset:61440
s_waitcnt lgkmcnt(7)
v_mfma_f32_16x16x32_bf16 v[24:27], a[236:239], v[56:59], v[24:27]
ds_read_b128 v[56:59], v10 offset:63488
s_waitcnt lgkmcnt(7)
v_mfma_f32_16x16x32_bf16 v[20:23], a[108:111], v[60:63], v[20:23]
v_mfma_f32_16x16x32_bf16 v[28:31], a[236:239], v[60:63], v[28:31]
ds_read_b128 v[60:63], v11 offset:63488
s_waitcnt lgkmcnt(7)
v_mfma_f32_16x16x32_bf16 v[24:27], a[240:243], v[32:35], v[24:27]
ds_read_b128 v[32:35], v10 offset:0
s_waitcnt lgkmcnt(7)
v_mfma_f32_16x16x32_bf16 v[20:23], a[112:115], v[36:39], v[20:23]
v_mfma_f32_16x16x32_bf16 v[28:31], a[240:243], v[36:39], v[28:31]
ds_read_b128 v[36:39], v10 offset:2048
s_waitcnt lgkmcnt(7)
v_mfma_f32_16x16x32_bf16 v[24:27], a[244:247], v[40:43], v[24:27]
ds_read_b128 v[40:43], v10 offset:4096
s_waitcnt lgkmcnt(7)
v_mfma_f32_16x16x32_bf16 v[20:23], a[116:119], v[44:47], v[20:23]
v_mfma_f32_16x16x32_bf16 v[28:31], a[244:247], v[44:47], v[28:31]
ds_read_b128 v[44:47], v10 offset:6144
s_waitcnt lgkmcnt(7)
v_mfma_f32_16x16x32_bf16 v[24:27], a[248:251], v[48:51], v[24:27]
ds_read_b128 v[48:51], v10 offset:8192
s_waitcnt lgkmcnt(7)
v_mfma_f32_16x16x32_bf16 v[20:23], a[120:123], v[52:55], v[20:23]
v_mfma_f32_16x16x32_bf16 v[28:31], a[248:251], v[52:55], v[28:31]
ds_read_b128 v[52:55], v10 offset:10240
s_waitcnt lgkmcnt(7)
v_mfma_f32_16x16x32_bf16 v[24:27], a[252:255], v[56:59], v[24:27]
ds_read_b128 v[56:59], v10 offset:12288
s_waitcnt lgkmcnt(7)
v_mfma_f32_16x16x32_bf16 v[20:23], a[124:127], v[60:63], v[20:23]
v_mfma_f32_16x16x32_bf16 v[28:31], a[252:255], v[60:63], v[28:31]
ds_read_b128 v[60:63], v10 offset:14336
s_waitcnt lgkmcnt(7)
v_mfma_f32_16x16x32_bf16 v[16:19], a[0:3], v[32:35], v[16:19]
s_add_u32 s60, s70, s95
s_add_u32 s61, s71, s95
s_add_u32 s100, s72, s95
s_add_u32 s96, s73, s95
s_nop 3
s_cmp_eq_u32 s65, 0
s_cbranch_scc1 Lslow_173
buffer_store_dwordx4 v[24:27], v1, s[4:7], s61 offen offset:2048
buffer_store_dwordx4 v[20:23], v1, s[4:7], s60 offen offset:1024
buffer_store_dwordx4 v[28:31], v1, s[4:7], s100 offen offset:3072
s_branch Ljoin_174
Lslow_173:
buffer_store_dwordx4 v[24:27], v1, s[4:7], s61 offen offset:2048 sc1
buffer_store_dwordx4 v[20:23], v1, s[4:7], s60 offen offset:1024 sc1
buffer_store_dwordx4 v[28:31], v1, s[4:7], s100 offen offset:3072 sc1
Ljoin_174:
ds_read_b128 v[32:35], v10 offset:16384
s_waitcnt lgkmcnt(7)
v_mfma_f32_16x16x32_bf16 v[104:107], a[4:7], v[36:39], 0
ds_read_b128 v[36:39], v10 offset:18432
s_waitcnt lgkmcnt(7)
v_mfma_f32_16x16x32_bf16 v[16:19], a[8:11], v[40:43], v[16:19]
ds_read_b128 v[40:43], v10 offset:20480
s_waitcnt lgkmcnt(7)
v_mfma_f32_16x16x32_bf16 v[104:107], a[12:15], v[44:47], v[104:107]
ds_read_b128 v[44:47], v10 offset:22528
s_waitcnt lgkmcnt(7)
v_mfma_f32_16x16x32_bf16 v[16:19], a[16:19], v[48:51], v[16:19]
ds_read_b128 v[48:51], v10 offset:24576
s_waitcnt lgkmcnt(7)
v_mfma_f32_16x16x32_bf16 v[104:107], a[20:23], v[52:55], v[104:107]
ds_read_b128 v[52:55], v10 offset:26624
s_waitcnt lgkmcnt(7)
v_mfma_f32_16x16x32_bf16 v[16:19], a[24:27], v[56:59], v[16:19]
ds_read_b128 v[56:59], v10 offset:28672
s_waitcnt lgkmcnt(7)
v_mfma_f32_16x16x32_bf16 v[104:107], a[28:31], v[60:63], v[104:107]
ds_read_b128 v[60:63], v10 offset:30720
s_waitcnt lgkmcnt(7)
v_mfma_f32_16x16x32_bf16 v[16:19], a[32:35], v[32:35], v[16:19]
ds_read_b128 v[32:35], v10 offset:32768
s_waitcnt lgkmcnt(7)
v_mfma_f32_16x16x32_bf16 v[104:107], a[36:39], v[36:39], v[104:107]
ds_read_b128 v[36:39], v10 offset:34816
s_waitcnt lgkmcnt(7)
v_mfma_f32_16x16x32_bf16 v[16:19], a[40:43], v[40:43], v[16:19]
ds_read_b128 v[40:43], v10 offset:36864
s_waitcnt lgkmcnt(7)
v_mfma_f32_16x16x32_bf16 v[104:107], a[44:47], v[44:47], v[104:107]
ds_read_b128 v[44:47], v10 offset:38912
s_waitcnt lgkmcnt(7)
v_mfma_f32_16x16x32_bf16 v[16:19], a[48:51], v[48:51], v[16:19]
ds_read_b128 v[48:51], v10 offset:40960
s_waitcnt lgkmcnt(7)
v_mfma_f32_16x16x32_bf16 v[104:107], a[52:55], v[52:55], v[104:107]
ds_read_b128 v[52:55], v10 offset:43008
s_waitcnt lgkmcnt(7)
v_mfma_f32_16x16x32_bf16 v[16:19], a[56:59], v[56:59], v[16:19]
ds_read_b128 v[56:59], v10 offset:45056
s_waitcnt lgkmcnt(7)
v_mfma_f32_16x16x32_bf16 v[104:107], a[60:63], v[60:63], v[104:107]
ds_read_b128 v[60:63], v10 offset:47104
s_waitcnt lgkmcnt(7)
v_mfma_f32_16x16x32_bf16 v[16:19], a[64:67], v[32:35], v[16:19]
ds_read_b128 v[32:35], v10 offset:49152
s_waitcnt lgkmcnt(7)
v_mfma_f32_16x16x32_bf16 v[104:107], a[68:71], v[36:39], v[104:107]
ds_read_b128 v[36:39], v10 offset:51200
s_waitcnt lgkmcnt(7)
v_mfma_f32_16x16x32_bf16 v[16:19], a[72:75], v[40:43], v[16:19]
ds_read_b128 v[40:43], v10 offset:53248
s_waitcnt lgkmcnt(7)
v_mfma_f32_16x16x32_bf16 v[104:107], a[76:79], v[44:47], v[104:107]
ds_read_b128 v[44:47], v10 offset:55296
s_waitcnt lgkmcnt(7)
v_mfma_f32_16x16x32_bf16 v[16:19], a[80:83], v[48:51], v[16:19]
ds_read_b128 v[48:51], v10 offset:57344
s_waitcnt lgkmcnt(7)
v_mfma_f32_16x16x32_bf16 v[104:107], a[84:87], v[52:55], v[104:107]
ds_read_b128 v[52:55], v10 offset:59392
s_waitcnt lgkmcnt(7)
v_mfma_f32_16x16x32_bf16 v[16:19], a[88:91], v[56:59], v[16:19]
ds_read_b128 v[56:59], v10 offset:61440
s_waitcnt lgkmcnt(7)
v_mfma_f32_16x16x32_bf16 v[104:107], a[92:95], v[60:63], v[104:107]
ds_read_b128 v[60:63], v10 offset:63488
s_waitcnt lgkmcnt(7)
v_mfma_f32_16x16x32_bf16 v[16:19], a[96:99], v[32:35], v[16:19]
s_waitcnt lgkmcnt(6)
v_mfma_f32_16x16x32_bf16 v[104:107], a[100:103], v[36:39], v[104:107]
s_waitcnt lgkmcnt(5)
v_mfma_f32_16x16x32_bf16 v[16:19], a[104:107], v[40:43], v[16:19]
s_waitcnt lgkmcnt(4)
v_mfma_f32_16x16x32_bf16 v[104:107], a[108:111], v[44:47], v[104:107]
s_waitcnt lgkmcnt(3)
v_mfma_f32_16x16x32_bf16 v[16:19], a[112:115], v[48:51], v[16:19]
buffer_load_dwordx4 v[64:67], v1, s[4:7], s96 offen offset:1024 sc1
buffer_load_dwordx4 v[68:71], v1, s[4:7], s96 offen offset:2048 sc1
buffer_load_dwordx4 v[72:75], v1, s[4:7], s96 offen offset:3072 sc1
buffer_load_dword v12, v2, s[4:7], 0 offen offset:512 sc1
s_waitcnt lgkmcnt(2)
v_mfma_f32_16x16x32_bf16 v[104:107], a[116:119], v[52:55], v[104:107]
s_waitcnt lgkmcnt(1)
v_mfma_f32_16x16x32_bf16 v[16:19], a[120:123], v[56:59], v[16:19]
s_waitcnt lgkmcnt(0)
v_mfma_f32_16x16x32_bf16 v[104:107], a[124:127], v[60:63], v[104:107]
v_xor_b32 v10, 0x10000, v10
v_xor_b32 v11, 0x10000, v11
v_add_u32 v2, 512, v2
s_add_u32 s95, s95, 0x40000
s_and_b32 s95, s95, 0x1fffff
s_nop 2
v_add_f32 v16, v16, v104
v_add_f32 v17, v17, v105
v_add_f32 v18, v18, v106
v_add_f32 v19, v19, v107
s_branch L_O0_xp1
s_nop 0
L_O0_xp:
buffer_load_dwordx4 v[64:67], v1, s[4:7], s96 offen offset:1024 sc1
buffer_load_dwordx4 v[68:71], v1, s[4:7], s96 offen offset:2048 sc1
buffer_load_dwordx4 v[72:75], v1, s[4:7], s96 offen offset:3072 sc1
buffer_load_dword v12, v2, s[4:7], 0 offen sc1
s_memtime s[60:61]
s_waitcnt lgkmcnt(0)
s_sub_u32 s60, s60, s46
s_mov_b32 s61, 31
s_cmp_gt_u32 s60, 67108864
s_cbranch_scc1 L_abortO
L_O0_xp1:
s_waitcnt vmcnt(1)
v_max3_u32 v88, v64, v65, v66
v_max3_u32 v89, v67, v68, v69
v_max3_u32 v88, v88, v70, v71
v_max3_u32 v89, v89, v72, v73
v_max3_u32 v88, v88, v74, v75
v_max_u32 v88, v88, v89
v_cmp_eq_u32 vcc, -1, v88
s_cbranch_vccnz L_O0_xp
v_add_f32 v16, v16, v64
v_add_f32 v68, v68, v72
v_add_f32 v17, v17, v65
v_add_f32 v69, v69, v73
v_add_f32 v18, v18, v66
v_add_f32 v70, v70, v74
v_add_f32 v19, v19, v67
v_add_f32 v71, v71, v75
v_add_f32 v16, v16, v68
v_add_f32 v17, v17, v69
v_add_f32 v18, v18, v70
v_add_f32 v19, v19, v71
v_cvt_pk_bf16_f32 v84, v16, v17
v_cvt_pk_bf16_f32 v85, v18, v19
s_cmp_eq_u32 s65, 0
s_cbranch_scc1 Lslow_175
buffer_store_dwordx2 v[84:85], v1, s[4:7], s75 offen
s_branch Ljoin_176
Lslow_175:
buffer_store_dwordx2 v[84:85], v1, s[4:7], s75 offen sc1
Ljoin_176:
v_lshlrev_b32 v88, 16, v84
v_and_b32 v89, 0xffff0000, v84
v_lshlrev_b32 v90, 16, v85
v_and_b32 v91, 0xffff0000, v85
v_mul_f32 v93, v88, v88
v_add_f32 v92, v88, v89
v_fmac_f32 v93, v89, v89
v_add_f32 v92, v92, v90
v_fmac_f32 v93, v90, v90
v_add_f32 v92, v92, v91
v_fmac_f32 v93, v91, v91
s_nop 1
v_permlane16_swap_b32 v92, v93
v_add_f32 v92, v92, v93
v_mov_b32 v93, v92
s_nop 1
v_permlane32_swap_b32 v92, v93
v_add_f32 v92, v92, v93
s_cmp_eq_u32 s65, 0
s_cbranch_scc1 Lslow_177
s_mov_b64 exec, 0xffffffff
buffer_store_dword v92, v3, s[4:7], s76 offen
s_mov_b64 exec, -1
buffer_store_dwordx4 v[100:103], v1, s[4:7], s96 offen offset:1024
buffer_store_dwordx4 v[100:103], v1, s[4:7], s96 offen offset:2048
buffer_store_dwordx4 v[100:103], v1, s[4:7], s96 offen offset:3072
s_branch Ljoin_178
Lslow_177:
s_mov_b64 exec, 0xffffffff
buffer_store_dword v92, v3, s[4:7], s76 offen sc1
s_mov_b64 exec, -1
buffer_store_dwordx4 v[100:103], v1, s[4:7], s96 offen offset:1024 sc1
buffer_store_dwordx4 v[100:103], v1, s[4:7], s96 offen offset:2048 sc1
buffer_store_dwordx4 v[100:103], v1, s[4:7], s96 offen offset:3072 sc1
Ljoin_178:
s_mov_b32 s68, s77
s_add_u32 s75, s75, 32768
s_add_u32 s76, s76, 8192
s_add_u32 s77, s77, 256
s_add_u32 s64, s64, 1
s_cmp_lg_u32 s66, 0
s_cbranch_scc1 L_O0_go
s_cmp_ge_u32 s64, 64
s_cbranch_scc1 L_O0_end
s_waitcnt vmcnt(5)
v_cmp_eq_u32 vcc, 0, v12
s_cbranch_vccnz L_O0_poll
s_branch L_O0_iss
s_nop 2
L_O0_end:
s_waitcnt vmcnt(0)
s_cmp_eq_u32 s68, 0
s_cbranch_scc1 Lnp_179
s_mov_b64 s[98:99], exec
s_mov_b64 exec, 1
s_cmp_eq_u32 s65, 0
s_cbranch_scc1 Lslow_180
buffer_store_dword v4, off, s[4:7], s68
s_branch Ljoin_181
Lslow_180:
buffer_store_dword v4, off, s[4:7], s68 sc1
Ljoin_181:
s_mov_b64 exec, s[98:99]
s_mov_b32 s68, 0
Lnp_179:
s_endpgm
L_O1_main:
s_lshl_b32 s69, s62, 16
s_add_u32 s69, s69, 134217728
s_lshl_b32 s78, s47, 13
s_lshl_b32 s94, s47, 12
s_lshl_b32 s101, s47, 11
s_lshl_b32 s61, s62, 7
s_add_u32 s61, s61, 163840
v_and_b32 v8, 31, v0
v_lshl_add_u32 v2, v8, 2, s61
v_lshlrev_b32 v3, 9, v15
v_lshl_add_u32 v3, v14, 4, v3
s_lshl_b32 s60, s63, 2
s_add_u32 s60, s60, s47
s_and_b32 s96, s62, 1
s_lshr_b32 s97, s62, 1
s_lshl_b32 s61, s60, 11
s_lshl_b32 s95, s96, 10
s_add_u32 s61, s61, s95
s_add_u32 s74, s61, 8388608
s_lshl_b32 s95, s97, 3
s_add_u32 s61, s61, s95
s_add_u32 s75, s61, 6291456
s_lshl_b32 s61, s96, 12
s_bfe_u32 s95, s60, 0x20001
s_lshl_b32 s95, s95, 10
s_add_u32 s61, s61, s95
s_lshr_b32 s95, s60, 3
s_lshl_b32 s95, s95, 8
s_add_u32 s61, s61, s95
s_and_b32 s95, s60, 1
s_lshl_b32 s95, s95, 3
s_add_u32 s61, s61, s95
s_lshl_b32 s95, s97, 2
s_add_u32 s61, s61, s95
s_add_u32 s76, s61, 14155776
s_lshl_b32 s61, s60, 2
s_add_u32 s61, s61, s62
s_lshl_b32 s61, s61, 2
s_add_u32 s77, s61, 212992
s_lshl_b32 s95, s96, 10
v_add_u32 v10, s95, v1
v_xor_b32 v11, 0x400, v10
s_mov_b32 s64, 0
s_mov_b32 s66, 0
s_mov_b32 s68, 0
s_lshl_b32 s67, s63, 14
s_mov_b32 s92, 0
s_mov_b32 s95, 0
s_mov_b32 s96, 0
v_mov_b32 v100, -1
v_mov_b32 v101, -1
v_mov_b32 v102, -1
v_mov_b32 v103, -1
s_mov_b64 exec, 1
v_mov_b32 v9, 136
s_nop 1
Lgb_184:
buffer_load_dword v8, v9, s[8:11], 0 offen sc1
s_memtime s[60:61]
s_waitcnt lgkmcnt(0)
s_sub_u32 s60, s60, s46
s_mov_b32 s61, 2
s_cmp_gt_u32 s60, 67108864
s_cbranch_scc1 L_abortO
s_waitcnt vmcnt(0)
v_readfirstlane_b32 s60, v8
s_and_b32 s61, s60, 0xffff
s_cmp_lt_u32 s61, 256
s_cbranch_scc1 Lgb_184
s_mov_b64 exec, -1
s_cmp_lt_u32 s60, 0x10000
s_cselect_b32 s65, 1, 0
s_and_b32 s61, s56, 31
s_mov_b32 s52, s40
s_mov_b32 s53, s41
s_mov_b32 s54, 2097152
s_mov_b32 s55, 0x00020000
s_lshl_b32 s61, s61, 2
s_add_u32 s61, s61, s47
s_mul_i32 s60, s61, 8192
v_mul_u32_u24 v8, 128, v0
v_add_u32 v8, s60, v8
s_sleep 64
s_sleep 64
s_sleep 64
s_sleep 64
s_sleep 64
s_sleep 64
s_mov_b32 s60, 0x600000
buffer_load_dword v9, v8, s[4:7], s60 offen sc1
s_waitcnt vmcnt(12)
s_mov_b32 s60, 0x1500000
buffer_load_dword v9, v8, s[4:7], s60 offen sc1
s_waitcnt vmcnt(12)
s_mov_b32 s60, 0x1600000
buffer_load_dword v9, v8, s[4:7], s60 offen sc1
s_waitcnt vmcnt(12)
s_mov_b32 s60, 0x0
buffer_load_dword v9, v8, s[52:55], s60 offen sc1
s_waitcnt vmcnt(12)
s_mov_b32 s60, 0x1700000
buffer_load_dword v9, v8, s[4:7], s60 offen sc1
s_waitcnt vmcnt(12)
s_mov_b32 s60, 0x1800000
buffer_load_dword v9, v8, s[4:7], s60 offen sc1
s_waitcnt vmcnt(12)
s_mov_b32 s60, 0x1900000
buffer_load_dword v9, v8, s[4:7], s60 offen sc1
s_waitcnt vmcnt(12)
s_mov_b32 s60, 0x1a00000
buffer_load_dword v9, v8, s[4:7], s60 offen sc1
s_waitcnt vmcnt(12)
s_mov_b32 s60, 0x700000
buffer_load_dword v9, v8, s[4:7], s60 offen sc1
s_waitcnt vmcnt(12)
s_mov_b32 s60, 0x100000
buffer_load_dword v9, v8, s[52:55], s60 offen sc1
s_waitcnt vmcnt(12)
s_waitcnt vmcnt(0)
s_branch L_O1_poll
L_O1_slp:
s_sleep 1
L_O1_poll:
buffer_load_dword v12, v2, s[4:7], 0 offen sc1
s_memtime s[60:61]
s_waitcnt lgkmcnt(0)
s_sub_u32 s60, s60, s46
s_mov_b32 s61, 30
s_cmp_gt_u32 s60, 67108864
s_cbranch_scc1 L_abortO
s_waitcnt vmcnt(0)
s_cmp_eq_u32 s68, 0
s_cbranch_scc1 Lnp_185
s_mov_b64 s[98:99], exec
s_mov_b64 exec, 1
s_cmp_eq_u32 s65, 0
s_cbranch_scc1 Lslow_186
buffer_store_dword v4, off, s[4:7], s68
s_branch Ljoin_187
Lslow_186:
buffer_store_dword v4, off, s[4:7], s68 sc1
Ljoin_187:
s_mov_b64 exec, s[98:99]
s_mov_b32 s68, 0
Lnp_185:
v_cmp_eq_u32 vcc, 0, v12
s_cbranch_vccnz L_O1_slp
s_nop 3
L_O1_iss:
buffer_load_dwordx4 v[76:79], v1, s[4:7], s74 offen sc1
s_add_u32 s100, s92, s101
s_add_u32 m0, s100, 0
s_add_u32 s100, s69, s101
s_add_u32 s100, s100, 0
s_xor_b32 s100, s100, s67
buffer_load_dwordx4 v1, s[4:7], s100 offen offset:0 sc1 lds
buffer_load_dwordx4 v1, s[4:7], s100 offen offset:1024 sc1 lds
s_add_u32 s100, s92, s101
s_add_u32 m0, s100, 8192
s_add_u32 s100, s69, s101
s_add_u32 s100, s100, 8192
s_xor_b32 s100, s100, s67
buffer_load_dwordx4 v1, s[4:7], s100 offen offset:0 sc1 lds
buffer_load_dwordx4 v1, s[4:7], s100 offen offset:1024 sc1 lds
s_add_u32 s100, s92, s94
s_add_u32 m0, s100, 16384
s_add_u32 s100, s69, s94
s_add_u32 s100, s100, 16384
s_xor_b32 s100, s100, s67
buffer_load_dwordx4 v1, s[4:7], s100 offen offset:0 sc1 lds
buffer_load_dwordx4 v1, s[4:7], s100 offen offset:1024 sc1 lds
buffer_load_dwordx4 v1, s[4:7], s100 offen offset:2048 sc1 lds
buffer_load_dwordx4 v1, s[4:7], s100 offen offset:3072 sc1 lds
s_add_u32 s100, s92, s78
s_add_u32 m0, s100, 32768
s_add_u32 s100, s69, s78
s_add_u32 s100, s100, 32768
s_xor_b32 s100, s100, s67
buffer_load_dwordx4 v1, s[4:7], s100 offen offset:0 sc1 lds
buffer_load_dwordx4 v1, s[4:7], s100 offen offset:1024 sc1 lds
buffer_load_dwordx4 v1, s[4:7], s100 offen offset:2048 sc1 lds
buffer_load_dwordx4 v1, s[4:7], s100 offen offset:3072 sc1 lds
s_add_u32 s100, s92, s78
s_add_u32 m0, s100, 36864
s_add_u32 s100, s69, s78
s_add_u32 s100, s100, 36864
s_xor_b32 s100, s100, s67
buffer_load_dwordx4 v1, s[4:7], s100 offen offset:0 sc1 lds
buffer_load_dwordx4 v1, s[4:7], s100 offen offset:1024 sc1 lds
buffer_load_dwordx4 v1, s[4:7], s100 offen offset:2048 sc1 lds
buffer_load_dwordx4 v1, s[4:7], s100 offen offset:3072 sc1 lds
L_O1_go:
buffer_load_dword v12, v2, s[4:7], 0 offen offset:512 sc1
s_add_u32 s69, s69, 262144
s_add_u32 s74, s74, 32768
s_xor_b32 s92, s92, 0x10000
s_waitcnt vmcnt(15)
s_barrier
v_perm_b32 v16, v76, v76, s93
v_perm_b32 v17, v77, v77, s93
v_perm_b32 v18, v78, v78, s93
v_perm_b32 v19, v79, v79, s93
s_cmp_lg_u32 s66, 0
s_cbranch_scc1 Lm_188
s_cmp_eq_u32 s68, 0
s_cbranch_scc1 Lnp_189
s_mov_b64 s[98:99], exec
s_mov_b64 exec, 1
s_cmp_eq_u32 s65, 0
s_cbranch_scc1 Lslow_190
buffer_store_dword v4, off, s[4:7], s68
s_branch Ljoin_191
Lslow_190:
buffer_store_dword v4, off, s[4:7], s68 sc1
Ljoin_191:
s_mov_b64 exec, s[98:99]
s_mov_b32 s68, 0
Lnp_189:
Lm_188:
ds_read_b128 v[32:35], v10 offset:0
ds_read_b128 v[36:39], v11 offset:0
ds_read_b128 v[40:43], v10 offset:2048
ds_read_b128 v[44:47], v11 offset:2048
ds_read_b128 v[48:51], v10 offset:4096
ds_read_b128 v[52:55], v11 offset:4096
ds_read_b128 v[56:59], v10 offset:6144
ds_read_b128 v[60:63], v11 offset:6144
s_waitcnt lgkmcnt(7)
v_mfma_f32_16x16x32_bf16 v[24:27], a[128:131], v[32:35], 0
s_waitcnt vmcnt(13)
s_barrier
ds_read_b128 v[32:35], v10 offset:8192
s_waitcnt lgkmcnt(7)
v_mfma_f32_16x16x32_bf16 v[20:23], a[0:3], v[36:39], 0
v_mfma_f32_16x16x32_bf16 v[28:31], a[128:131], v[36:39], 0
ds_read_b128 v[36:39], v11 offset:8192
s_waitcnt lgkmcnt(7)
v_mfma_f32_16x16x32_bf16 v[24:27], a[132:135], v[40:43], v[24:27]
ds_read_b128 v[40:43], v10 offset:10240
s_waitcnt lgkmcnt(7)
v_mfma_f32_16x16x32_bf16 v[20:23], a[4:7], v[44:47], v[20:23]
v_mfma_f32_16x16x32_bf16 v[28:31], a[132:135], v[44:47], v[28:31]
ds_read_b128 v[44:47], v11 offset:10240
s_waitcnt lgkmcnt(7)
v_mfma_f32_16x16x32_bf16 v[24:27], a[136:139], v[48:51], v[24:27]
ds_read_b128 v[48:51], v10 offset:12288
s_waitcnt lgkmcnt(7)
v_mfma_f32_16x16x32_bf16 v[20:23], a[8:11], v[52:55], v[20:23]
v_mfma_f32_16x16x32_bf16 v[28:31], a[136:139], v[52:55], v[28:31]
ds_read_b128 v[52:55], v11 offset:12288
s_waitcnt lgkmcnt(7)
v_mfma_f32_16x16x32_bf16 v[24:27], a[140:143], v[56:59], v[24:27]
ds_read_b128 v[56:59], v10 offset:14336
s_waitcnt lgkmcnt(7)
v_mfma_f32_16x16x32_bf16 v[20:23], a[12:15], v[60:63], v[20:23]
v_mfma_f32_16x16x32_bf16 v[28:31], a[140:143], v[60:63], v[28:31]
ds_read_b128 v[60:63], v11 offset:14336
s_waitcnt lgkmcnt(7)
v_mfma_f32_16x16x32_bf16 v[24:27], a[144:147], v[32:35], v[24:27]
s_waitcnt vmcnt(9)
s_barrier
ds_read_b128 v[32:35], v10 offset:16384
s_waitcnt lgkmcnt(7)
v_mfma_f32_16x16x32_bf16 v[20:23], a[16:19], v[36:39], v[20:23]
v_mfma_f32_16x16x32_bf16 v[28:31], a[144:147], v[36:39], v[28:31]
ds_read_b128 v[36:39], v11 offset:16384
s_waitcnt lgkmcnt(7)
v_mfma_f32_16x16x32_bf16 v[24:27], a[148:151], v[40:43], v[24:27]
ds_read_b128 v[40:43], v10 offset:18432
s_waitcnt lgkmcnt(7)
v_mfma_f32_16x16x32_bf16 v[20:23], a[20:23], v[44:47], v[20:23]
v_mfma_f32_16x16x32_bf16 v[28:31], a[148:151], v[44:47], v[28:31]
ds_read_b128 v[44:47], v11 offset:18432
s_waitcnt lgkmcnt(7)
v_mfma_f32_16x16x32_bf16 v[24:27], a[152:155], v[48:51], v[24:27]
s_cmp_eq_u32 s68, 0
s_cbranch_scc1 Lm_192
s_waitcnt vmcnt(4)
s_cmp_eq_u32 s68, 0
s_cbranch_scc1 Lnp_193
s_mov_b64 s[98:99], exec
s_mov_b64 exec, 1
s_cmp_eq_u32 s65, 0
s_cbranch_scc1 Lslow_194
buffer_store_dword v4, off, s[4:7], s68
s_branch Ljoin_195
Lslow_194:
buffer_store_dword v4, off, s[4:7], s68 sc1
Ljoin_195:
s_mov_b64 exec, s[98:99]
s_mov_b32 s68, 0
Lnp_193:
Lm_192:
ds_read_b128 v[48:51], v10 offset:20480
s_waitcnt lgkmcnt(7)
v_mfma_f32_16x16x32_bf16 v[20:23], a[24:27], v[52:55], v[20:23]
v_mfma_f32_16x16x32_bf16 v[28:31], a[152:155], v[52:55], v[28:31]
ds_read_b128 v[52:55], v11 offset:20480
s_waitcnt lgkmcnt(7)
v_mfma_f32_16x16x32_bf16 v[24:27], a[156:159], v[56:59], v[24:27]
ds_read_b128 v[56:59], v10 offset:22528
s_waitcnt lgkmcnt(7)
v_mfma_f32_16x16x32_bf16 v[20:23], a[28:31], v[60:63], v[20:23]
v_mfma_f32_16x16x32_bf16 v[28:31], a[156:159], v[60:63], v[28:31]
ds_read_b128 v[60:63], v11 offset:22528
s_waitcnt lgkmcnt(7)
v_mfma_f32_16x16x32_bf16 v[24:27], a[160:163], v[32:35], v[24:27]
ds_read_b128 v[32:35], v10 offset:24576
s_waitcnt lgkmcnt(7)
v_mfma_f32_16x16x32_bf16 v[20:23], a[32:35], v[36:39], v[20:23]
v_mfma_f32_16x16x32_bf16 v[28:31], a[160:163], v[36:39], v[28:31]
ds_read_b128 v[36:39], v11 offset:24576
s_waitcnt lgkmcnt(7)
v_mfma_f32_16x16x32_bf16 v[24:27], a[164:167], v[40:43], v[24:27]
ds_read_b128 v[40:43], v10 offset:26624
s_waitcnt lgkmcnt(7)
v_mfma_f32_16x16x32_bf16 v[20:23], a[36:39], v[44:47], v[20:23]
v_mfma_f32_16x16x32_bf16 v[28:31], a[164:167], v[44:47], v[28:31]
ds_read_b128 v[44:47], v11 offset:26624
s_waitcnt lgkmcnt(7)
v_mfma_f32_16x16x32_bf16 v[24:27], a[168:171], v[48:51], v[24:27]
ds_read_b128 v[48:51], v10 offset:28672
s_waitcnt lgkmcnt(7)
v_mfma_f32_16x16x32_bf16 v[20:23], a[40:43], v[52:55], v[20:23]
v_mfma_f32_16x16x32_bf16 v[28:31], a[168:171], v[52:55], v[28:31]
ds_read_b128 v[52:55], v11 offset:28672
s_waitcnt lgkmcnt(7)
v_mfma_f32_16x16x32_bf16 v[24:27], a[172:175], v[56:59], v[24:27]
ds_read_b128 v[56:59], v10 offset:30720
s_waitcnt lgkmcnt(7)
v_mfma_f32_16x16x32_bf16 v[20:23], a[44:47], v[60:63], v[20:23]
v_mfma_f32_16x16x32_bf16 v[28:31], a[172:175], v[60:63], v[28:31]
ds_read_b128 v[60:63], v11 offset:30720
s_waitcnt lgkmcnt(7)
v_mfma_f32_16x16x32_bf16 v[24:27], a[176:179], v[32:35], v[24:27]
s_waitcnt vmcnt(1)
s_barrier
s_waitcnt vmcnt(0)
v_cmp_eq_u32 vcc, 0, v12
s_cmp_ge_u32 s64, 63
s_cselect_b64 s[60:61], -1, 0
s_or_b64 vcc, vcc, s[60:61]
s_cselect_b32 s66, 0, 1
ds_read_b128 v[32:35], v10 offset:32768
s_waitcnt lgkmcnt(7)
v_mfma_f32_16x16x32_bf16 v[20:23], a[48:51], v[36:39], v[20:23]
v_mfma_f32_16x16x32_bf16 v[28:31], a[176:179], v[36:39], v[28:31]
s_cbranch_vccnz Ld_196
buffer_load_dwordx4 v[76:79], v1, s[4:7], s74 offen sc1
Ld_196:
ds_read_b128 v[36:39], v11 offset:32768
s_waitcnt lgkmcnt(7)
v_mfma_f32_16x16x32_bf16 v[24:27], a[180:183], v[40:43], v[24:27]
ds_read_b128 v[40:43], v10 offset:34816
s_waitcnt lgkmcnt(7)
v_mfma_f32_16x16x32_bf16 v[20:23], a[52:55], v[44:47], v[20:23]
s_add_u32 s100, s92, s101
s_add_u32 m0, s100, 0
s_add_u32 s100, s69, s101
s_add_u32 s100, s100, 0
s_xor_b32 s100, s100, s67
s_cbranch_vccnz Ld_197
buffer_load_dwordx4 v1, s[4:7], s100 offen offset:0 sc1 lds
Ld_197:
v_mfma_f32_16x16x32_bf16 v[28:31], a[180:183], v[44:47], v[28:31]
ds_read_b128 v[44:47], v11 offset:34816
s_waitcnt lgkmcnt(7)
v_mfma_f32_16x16x32_bf16 v[24:27], a[184:187], v[48:51], v[24:27]
s_cbranch_vccnz Ld_198
buffer_load_dwordx4 v1, s[4:7], s100 offen offset:1024 sc1 lds
Ld_198:
ds_read_b128 v[48:51], v10 offset:36864
s_waitcnt lgkmcnt(7)
v_mfma_f32_16x16x32_bf16 v[20:23], a[56:59], v[52:55], v[20:23]
v_mfma_f32_16x16x32_bf16 v[28:31], a[184:187], v[52:55], v[28:31]
s_add_u32 s100, s92, s101
s_add_u32 m0, s100, 8192
s_add_u32 s100, s69, s101
s_add_u32 s100, s100, 8192
s_xor_b32 s100, s100, s67
s_cbranch_vccnz Ld_199
buffer_load_dwordx4 v1, s[4:7], s100 offen offset:0 sc1 lds
Ld_199:
ds_read_b128 v[52:55], v11 offset:36864
s_waitcnt lgkmcnt(7)
v_mfma_f32_16x16x32_bf16 v[24:27], a[188:191], v[56:59], v[24:27]
ds_read_b128 v[56:59], v10 offset:38912
s_waitcnt lgkmcnt(7)
v_mfma_f32_16x16x32_bf16 v[20:23], a[60:63], v[60:63], v[20:23]
s_cbranch_vccnz Ld_200
buffer_load_dwordx4 v1, s[4:7], s100 offen offset:1024 sc1 lds
Ld_200:
v_mfma_f32_16x16x32_bf16 v[28:31], a[188:191], v[60:63], v[28:31]
ds_read_b128 v[60:63], v11 offset:38912
s_waitcnt lgkmcnt(7)
v_mfma_f32_16x16x32_bf16 v[24:27], a[192:195], v[32:35], v[24:27]
s_add_u32 s100, s92, s94
s_add_u32 m0, s100, 16384
s_add_u32 s100, s69, s94
s_add_u32 s100, s100, 16384
s_xor_b32 s100, s100, s67
s_cbranch_vccnz Ld_201
buffer_load_dwordx4 v1, s[4:7], s100 offen offset:0 sc1 lds
Ld_201:
ds_read_b128 v[32:35], v10 offset:40960
s_waitcnt lgkmcnt(7)
v_mfma_f32_16x16x32_bf16 v[20:23], a[64:67], v[36:39], v[20:23]
v_mfma_f32_16x16x32_bf16 v[28:31], a[192:195], v[36:39], v[28:31]
s_cbranch_vccnz Ld_202
buffer_load_dwordx4 v1, s[4:7], s100 offen offset:1024 sc1 lds
Ld_202:
ds_read_b128 v[36:39], v11 offset:40960
s_waitcnt lgkmcnt(7)
v_mfma_f32_16x16x32_bf16 v[24:27], a[196:199], v[40:43], v[24:27]
ds_read_b128 v[40:43], v10 offset:43008
s_waitcnt lgkmcnt(7)
v_mfma_f32_16x16x32_bf16 v[20:23], a[68:71], v[44:47], v[20:23]
s_cbranch_vccnz Ld_203
buffer_load_dwordx4 v1, s[4:7], s100 offen offset:2048 sc1 lds
Ld_203:
v_mfma_f32_16x16x32_bf16 v[28:31], a[196:199], v[44:47], v[28:31]
ds_read_b128 v[44:47], v11 offset:43008
s_waitcnt lgkmcnt(7)
v_mfma_f32_16x16x32_bf16 v[24:27], a[200:203], v[48:51], v[24:27]
s_cbranch_vccnz Ld_204
buffer_load_dwordx4 v1, s[4:7], s100 offen offset:3072 sc1 lds
Ld_204:
ds_read_b128 v[48:51], v10 offset:45056
s_waitcnt lgkmcnt(7)
v_mfma_f32_16x16x32_bf16 v[20:23], a[72:75], v[52:55], v[20:23]
v_mfma_f32_16x16x32_bf16 v[28:31], a[200:203], v[52:55], v[28:31]
s_add_u32 s100, s92, s78
s_add_u32 m0, s100, 32768
s_add_u32 s100, s69, s78
s_add_u32 s100, s100, 32768
s_xor_b32 s100, s100, s67
s_cbranch_vccnz Ld_205
buffer_load_dwordx4 v1, s[4:7], s100 offen offset:0 sc1 lds
Ld_205:
ds_read_b128 v[52:55], v11 offset:45056
s_waitcnt lgkmcnt(7)
v_mfma_f32_16x16x32_bf16 v[24:27], a[204:207], v[56:59], v[24:27]
ds_read_b128 v[56:59], v10 offset:47104
s_waitcnt lgkmcnt(7)
v_mfma_f32_16x16x32_bf16 v[20:23], a[76:79], v[60:63], v[20:23]
s_cbranch_vccnz Ld_206
buffer_load_dwordx4 v1, s[4:7], s100 offen offset:1024 sc1 lds
Ld_206:
v_mfma_f32_16x16x32_bf16 v[28:31], a[204:207], v[60:63], v[28:31]
ds_read_b128 v[60:63], v11 offset:47104
s_waitcnt lgkmcnt(7)
v_mfma_f32_16x16x32_bf16 v[24:27], a[208:211], v[32:35], v[24:27]
s_cbranch_vccnz Ld_207
buffer_load_dwordx4 v1, s[4:7], s100 offen offset:2048 sc1 lds
Ld_207:
ds_read_b128 v[32:35], v10 offset:49152
s_waitcnt lgkmcnt(7)
v_mfma_f32_16x16x32_bf16 v[20:23], a[80:83], v[36:39], v[20:23]
v_mfma_f32_16x16x32_bf16 v[28:31], a[208:211], v[36:39], v[28:31]
s_cbranch_vccnz Ld_208
buffer_load_dwordx4 v1, s[4:7], s100 offen offset:3072 sc1 lds
Ld_208:
ds_read_b128 v[36:39], v11 offset:49152
s_waitcnt lgkmcnt(7)
v_mfma_f32_16x16x32_bf16 v[24:27], a[212:215], v[40:43], v[24:27]
ds_read_b128 v[40:43], v10 offset:51200
s_waitcnt lgkmcnt(7)
v_mfma_f32_16x16x32_bf16 v[20:23], a[84:87], v[44:47], v[20:23]
s_add_u32 s100, s92, s78
s_add_u32 m0, s100, 36864
s_add_u32 s100, s69, s78
s_add_u32 s100, s100, 36864
s_xor_b32 s100, s100, s67
s_cbranch_vccnz Ld_209
buffer_load_dwordx4 v1, s[4:7], s100 offen offset:0 sc1 lds
Ld_209:
v_mfma_f32_16x16x32_bf16 v[28:31], a[212:215], v[44:47], v[28:31]
ds_read_b128 v[44:47], v11 offset:51200
s_waitcnt lgkmcnt(7)
v_mfma_f32_16x16x32_bf16 v[24:27], a[216:219], v[48:51], v[24:27]
s_cbranch_vccnz Ld_210
buffer_load_dwordx4 v1, s[4:7], s100 offen offset:1024 sc1 lds
Ld_210:
ds_read_b128 v[48:51], v10 offset:53248
s_waitcnt lgkmcnt(7)
v_mfma_f32_16x16x32_bf16 v[20:23], a[88:91], v[52:55], v[20:23]
v_mfma_f32_16x16x32_bf16 v[28:31], a[216:219], v[52:55], v[28:31]
s_cbranch_vccnz Ld_211
buffer_load_dwordx4 v1, s[4:7], s100 offen offset:2048 sc1 lds
Ld_211:
ds_read_b128 v[52:55], v11 offset:53248
s_waitcnt lgkmcnt(7)
v_mfma_f32_16x16x32_bf16 v[24:27], a[220:223], v[56:59], v[24:27]
ds_read_b128 v[56:59], v10 offset:55296
s_waitcnt lgkmcnt(7)
v_mfma_f32_16x16x32_bf16 v[20:23], a[92:95], v[60:63], v[20:23]
s_cbranch_vccnz Ld_212
buffer_load_dwordx4 v1, s[4:7], s100 offen offset:3072 sc1 lds
Ld_212:
v_mfma_f32_16x16x32_bf16 v[28:31], a[220:223], v[60:63], v[28:31]
ds_read_b128 v[60:63], v11 offset:55296
s_waitcnt lgkmcnt(7)
v_mfma_f32_16x16x32_bf16 v[24:27], a[224:227], v[32:35], v[24:27]
ds_read_b128 v[32:35], v10 offset:57344
s_waitcnt lgkmcnt(7)
v_mfma_f32_16x16x32_bf16 v[20:23], a[96:99], v[36:39], v[20:23]
v_mfma_f32_16x16x32_bf16 v[28:31], a[224:227], v[36:39], v[28:31]
ds_read_b128 v[36:39], v11 offset:57344
s_waitcnt lgkmcnt(7)
v_mfma_f32_16x16x32_bf16 v[24:27], a[228:231], v[40:43], v[24:27]
ds_read_b128 v[40:43], v10 offset:59392
s_waitcnt lgkmcnt(7)
v_mfma_f32_16x16x32_bf16 v[20:23], a[100:103], v[44:47], v[20:23]
v_mfma_f32_16x16x32_bf16 v[28:31], a[228:231], v[44:47], v[28:31]
ds_read_b128 v[44:47], v11 offset:59392
s_waitcnt lgkmcnt(7)
v_mfma_f32_16x16x32_bf16 v[24:27], a[232:235], v[48:51], v[24:27]
ds_read_b128 v[48:51], v10 offset:61440
s_waitcnt lgkmcnt(7)
v_mfma_f32_16x16x32_bf16 v[20:23], a[104:107], v[52:55], v[20:23]
v_mfma_f32_16x16x32_bf16 v[28:31], a[232:235], v[52:55], v[28:31]
ds_read_b128 v[52:55], v11 offset:61440
s_waitcnt lgkmcnt(7)
v_mfma_f32_16x16x32_bf16 v[24:27], a[236:239], v[56:59], v[24:27]
ds_read_b128 v[56:59], v10 offset:63488
s_waitcnt lgkmcnt(7)
v_mfma_f32_16x16x32_bf16 v[20:23], a[108:111], v[60:63], v[20:23]
v_mfma_f32_16x16x32_bf16 v[28:31], a[236:239], v[60:63], v[28:31]
ds_read_b128 v[60:63], v11 offset:63488
s_waitcnt lgkmcnt(7)
v_mfma_f32_16x16x32_bf16 v[24:27], a[240:243], v[32:35], v[24:27]
ds_read_b128 v[32:35], v10 offset:0
s_waitcnt lgkmcnt(7)
v_mfma_f32_16x16x32_bf16 v[20:23], a[112:115], v[36:39], v[20:23]
v_mfma_f32_16x16x32_bf16 v[28:31], a[240:243], v[36:39], v[28:31]
ds_read_b128 v[36:39], v10 offset:2048
s_waitcnt lgkmcnt(7)
v_mfma_f32_16x16x32_bf16 v[24:27], a[244:247], v[40:43], v[24:27]
ds_read_b128 v[40:43], v10 offset:4096
s_waitcnt lgkmcnt(7)
v_mfma_f32_16x16x32_bf16 v[20:23], a[116:119], v[44:47], v[20:23]
v_mfma_f32_16x16x32_bf16 v[28:31], a[244:247], v[44:47], v[28:31]
ds_read_b128 v[44:47], v10 offset:6144
s_waitcnt lgkmcnt(7)
v_mfma_f32_16x16x32_bf16 v[24:27], a[248:251], v[48:51], v[24:27]
ds_read_b128 v[48:51], v10 offset:8192
s_waitcnt lgkmcnt(7)
v_mfma_f32_16x16x32_bf16 v[20:23], a[120:123], v[52:55], v[20:23]
v_mfma_f32_16x16x32_bf16 v[28:31], a[248:251], v[52:55], v[28:31]
ds_read_b128 v[52:55], v10 offset:10240
s_waitcnt lgkmcnt(7)
v_mfma_f32_16x16x32_bf16 v[24:27], a[252:255], v[56:59], v[24:27]
ds_read_b128 v[56:59], v10 offset:12288
s_waitcnt lgkmcnt(7)
v_mfma_f32_16x16x32_bf16 v[20:23], a[124:127], v[60:63], v[20:23]
v_mfma_f32_16x16x32_bf16 v[28:31], a[252:255], v[60:63], v[28:31]
ds_read_b128 v[60:63], v10 offset:14336
s_waitcnt lgkmcnt(7)
v_mfma_f32_16x16x32_bf16 v[16:19], a[0:3], v[32:35], v[16:19]
s_add_u32 s60, s70, s95
s_add_u32 s61, s71, s95
s_add_u32 s100, s72, s95
s_add_u32 s96, s73, s95
s_nop 3
s_cmp_eq_u32 s65, 0
s_cbranch_scc1 Lslow_213
buffer_store_dwordx4 v[24:27], v1, s[4:7], s61 offen offset:2048
buffer_store_dwordx4 v[20:23], v1, s[4:7], s60 offen offset:1024
buffer_store_dwordx4 v[28:31], v1, s[4:7], s100 offen offset:3072
s_branch Ljoin_214
Lslow_213:
buffer_store_dwordx4 v[24:27], v1, s[4:7], s61 offen offset:2048 sc1
buffer_store_dwordx4 v[20:23], v1, s[4:7], s60 offen offset:1024 sc1
buffer_store_dwordx4 v[28:31], v1, s[4:7], s100 offen offset:3072 sc1
Ljoin_214:
ds_read_b128 v[32:35], v10 offset:16384
s_waitcnt lgkmcnt(7)
v_mfma_f32_16x16x32_bf16 v[104:107], a[4:7], v[36:39], 0
ds_read_b128 v[36:39], v10 offset:18432
s_waitcnt lgkmcnt(7)
v_mfma_f32_16x16x32_bf16 v[16:19], a[8:11], v[40:43], v[16:19]
ds_read_b128 v[40:43], v10 offset:20480
s_waitcnt lgkmcnt(7)
v_mfma_f32_16x16x32_bf16 v[104:107], a[12:15], v[44:47], v[104:107]
ds_read_b128 v[44:47], v10 offset:22528
s_waitcnt lgkmcnt(7)
v_mfma_f32_16x16x32_bf16 v[16:19], a[16:19], v[48:51], v[16:19]
ds_read_b128 v[48:51], v10 offset:24576
s_waitcnt lgkmcnt(7)
v_mfma_f32_16x16x32_bf16 v[104:107], a[20:23], v[52:55], v[104:107]
ds_read_b128 v[52:55], v10 offset:26624
s_waitcnt lgkmcnt(7)
v_mfma_f32_16x16x32_bf16 v[16:19], a[24:27], v[56:59], v[16:19]
ds_read_b128 v[56:59], v10 offset:28672
s_waitcnt lgkmcnt(7)
v_mfma_f32_16x16x32_bf16 v[104:107], a[28:31], v[60:63], v[104:107]
ds_read_b128 v[60:63], v10 offset:30720
s_waitcnt lgkmcnt(7)
v_mfma_f32_16x16x32_bf16 v[16:19], a[32:35], v[32:35], v[16:19]
ds_read_b128 v[32:35], v10 offset:32768
s_waitcnt lgkmcnt(7)
v_mfma_f32_16x16x32_bf16 v[104:107], a[36:39], v[36:39], v[104:107]
ds_read_b128 v[36:39], v10 offset:34816
s_waitcnt lgkmcnt(7)
v_mfma_f32_16x16x32_bf16 v[16:19], a[40:43], v[40:43], v[16:19]
ds_read_b128 v[40:43], v10 offset:36864
s_waitcnt lgkmcnt(7)
v_mfma_f32_16x16x32_bf16 v[104:107], a[44:47], v[44:47], v[104:107]
ds_read_b128 v[44:47], v10 offset:38912
s_waitcnt lgkmcnt(7)
v_mfma_f32_16x16x32_bf16 v[16:19], a[48:51], v[48:51], v[16:19]
ds_read_b128 v[48:51], v10 offset:40960
s_waitcnt lgkmcnt(7)
v_mfma_f32_16x16x32_bf16 v[104:107], a[52:55], v[52:55], v[104:107]
ds_read_b128 v[52:55], v10 offset:43008
s_waitcnt lgkmcnt(7)
v_mfma_f32_16x16x32_bf16 v[16:19], a[56:59], v[56:59], v[16:19]
ds_read_b128 v[56:59], v10 offset:45056
s_waitcnt lgkmcnt(7)
v_mfma_f32_16x16x32_bf16 v[104:107], a[60:63], v[60:63], v[104:107]
ds_read_b128 v[60:63], v10 offset:47104
s_waitcnt lgkmcnt(7)
v_mfma_f32_16x16x32_bf16 v[16:19], a[64:67], v[32:35], v[16:19]
ds_read_b128 v[32:35], v10 offset:49152
s_waitcnt lgkmcnt(7)
v_mfma_f32_16x16x32_bf16 v[104:107], a[68:71], v[36:39], v[104:107]
ds_read_b128 v[36:39], v10 offset:51200
s_waitcnt lgkmcnt(7)
v_mfma_f32_16x16x32_bf16 v[16:19], a[72:75], v[40:43], v[16:19]
ds_read_b128 v[40:43], v10 offset:53248
s_waitcnt lgkmcnt(7)
v_mfma_f32_16x16x32_bf16 v[104:107], a[76:79], v[44:47], v[104:107]
ds_read_b128 v[44:47], v10 offset:55296
s_waitcnt lgkmcnt(7)
v_mfma_f32_16x16x32_bf16 v[16:19], a[80:83], v[48:51], v[16:19]
ds_read_b128 v[48:51], v10 offset:57344
s_waitcnt lgkmcnt(7)
v_mfma_f32_16x16x32_bf16 v[104:107], a[84:87], v[52:55], v[104:107]
ds_read_b128 v[52:55], v10 offset:59392
s_waitcnt lgkmcnt(7)
v_mfma_f32_16x16x32_bf16 v[16:19], a[88:91], v[56:59], v[16:19]
ds_read_b128 v[56:59], v10 offset:61440
s_waitcnt lgkmcnt(7)
v_mfma_f32_16x16x32_bf16 v[104:107], a[92:95], v[60:63], v[104:107]
ds_read_b128 v[60:63], v10 offset:63488
s_waitcnt lgkmcnt(7)
v_mfma_f32_16x16x32_bf16 v[16:19], a[96:99], v[32:35], v[16:19]
s_waitcnt lgkmcnt(6)
v_mfma_f32_16x16x32_bf16 v[104:107], a[100:103], v[36:39], v[104:107]
s_waitcnt lgkmcnt(5)
v_mfma_f32_16x16x32_bf16 v[16:19], a[104:107], v[40:43], v[16:19]
s_waitcnt lgkmcnt(4)
v_mfma_f32_16x16x32_bf16 v[104:107], a[108:111], v[44:47], v[104:107]
s_waitcnt lgkmcnt(3)
v_mfma_f32_16x16x32_bf16 v[16:19], a[112:115], v[48:51], v[16:19]
buffer_load_dwordx4 v[64:67], v1, s[4:7], s96 offen offset:1024 sc1
buffer_load_dwordx4 v[68:71], v1, s[4:7], s96 offen offset:2048 sc1
buffer_load_dwordx4 v[72:75], v1, s[4:7], s96 offen offset:3072 sc1
buffer_load_dword v12, v2, s[4:7], 0 offen offset:512 sc1
s_waitcnt lgkmcnt(2)
v_mfma_f32_16x16x32_bf16 v[104:107], a[116:119], v[52:55], v[104:107]
s_waitcnt lgkmcnt(1)
v_mfma_f32_16x16x32_bf16 v[16:19], a[120:123], v[56:59], v[16:19]
s_waitcnt lgkmcnt(0)
v_mfma_f32_16x16x32_bf16 v[104:107], a[124:127], v[60:63], v[104:107]
v_xor_b32 v10, 0x10000, v10
v_xor_b32 v11, 0x10000, v11
v_add_u32 v2, 512, v2
s_add_u32 s95, s95, 0x40000
s_and_b32 s95, s95, 0x1fffff
s_nop 2
v_add_f32 v16, v16, v104
v_add_f32 v17, v17, v105
v_add_f32 v18, v18, v106
v_add_f32 v19, v19, v107
s_branch L_O1_xp1
s_nop 0
L_O1_xp:
buffer_load_dwordx4 v[64:67], v1, s[4:7], s96 offen offset:1024 sc1
buffer_load_dwordx4 v[68:71], v1, s[4:7], s96 offen offset:2048 sc1
buffer_load_dwordx4 v[72:75], v1, s[4:7], s96 offen offset:3072 sc1
buffer_load_dword v12, v2, s[4:7], 0 offen sc1
s_memtime s[60:61]
s_waitcnt lgkmcnt(0)
s_sub_u32 s60, s60, s46
s_mov_b32 s61, 31
s_cmp_gt_u32 s60, 67108864
s_cbranch_scc1 L_abortO
L_O1_xp1:
s_waitcnt vmcnt(1)
v_max3_u32 v88, v64, v65, v66
v_max3_u32 v89, v67, v68, v69
v_max3_u32 v88, v88, v70, v71
v_max3_u32 v89, v89, v72, v73
v_max3_u32 v88, v88, v74, v75
v_max_u32 v88, v88, v89
v_cmp_eq_u32 vcc, -1, v88
s_cbranch_vccnz L_O1_xp
v_add_f32 v16, v16, v64
v_add_f32 v68, v68, v72
v_add_f32 v17, v17, v65
v_add_f32 v69, v69, v73
v_add_f32 v18, v18, v66
v_add_f32 v70, v70, v74
v_add_f32 v19, v19, v67
v_add_f32 v71, v71, v75
v_add_f32 v16, v16, v68
v_add_f32 v17, v17, v69
v_add_f32 v18, v18, v70
v_add_f32 v19, v19, v71
v_cvt_pk_bf16_f32 v84, v16, v17
v_cvt_pk_bf16_f32 v85, v18, v19
s_cmp_eq_u32 s65, 0
s_cbranch_scc1 Lslow_215
buffer_store_dwordx2 v[84:85], v1, s[4:7], s75 offen
s_branch Ljoin_216
Lslow_215:
buffer_store_dwordx2 v[84:85], v1, s[4:7], s75 offen sc1
Ljoin_216:
v_lshlrev_b32 v88, 16, v84
v_and_b32 v89, 0xffff0000, v84
v_lshlrev_b32 v90, 16, v85
v_and_b32 v91, 0xffff0000, v85
v_mul_f32 v93, v88, v88
v_add_f32 v92, v88, v89
v_fmac_f32 v93, v89, v89
v_add_f32 v92, v92, v90
v_fmac_f32 v93, v90, v90
v_add_f32 v92, v92, v91
v_fmac_f32 v93, v91, v91
s_nop 1
v_permlane16_swap_b32 v92, v93
v_add_f32 v92, v92, v93
v_mov_b32 v93, v92
s_nop 1
v_permlane32_swap_b32 v92, v93
v_add_f32 v92, v92, v93
s_cmp_eq_u32 s65, 0
s_cbranch_scc1 Lslow_217
s_mov_b64 exec, 0xffffffff
buffer_store_dword v92, v3, s[4:7], s76 offen
s_mov_b64 exec, -1
buffer_store_dwordx4 v[100:103], v1, s[4:7], s96 offen offset:1024
buffer_store_dwordx4 v[100:103], v1, s[4:7], s96 offen offset:2048
buffer_store_dwordx4 v[100:103], v1, s[4:7], s96 offen offset:3072
s_branch Ljoin_218
Lslow_217:
s_mov_b64 exec, 0xffffffff
buffer_store_dword v92, v3, s[4:7], s76 offen sc1
s_mov_b64 exec, -1
buffer_store_dwordx4 v[100:103], v1, s[4:7], s96 offen offset:1024 sc1
buffer_store_dwordx4 v[100:103], v1, s[4:7], s96 offen offset:2048 sc1
buffer_store_dwordx4 v[100:103], v1, s[4:7], s96 offen offset:3072 sc1
Ljoin_218:
s_mov_b32 s68, s77
s_add_u32 s75, s75, 32768
s_add_u32 s76, s76, 8192
s_add_u32 s77, s77, 256
s_add_u32 s64, s64, 1
s_cmp_lg_u32 s66, 0
s_cbranch_scc1 L_O1_go
s_cmp_ge_u32 s64, 64
s_cbranch_scc1 L_O1_end
s_waitcnt vmcnt(5)
v_cmp_eq_u32 vcc, 0, v12
s_cbranch_vccnz L_O1_poll
s_branch L_O1_iss
s_nop 2
L_O1_end:
s_waitcnt vmcnt(0)
s_cmp_eq_u32 s68, 0
s_cbranch_scc1 Lnp_219
s_mov_b64 s[98:99], exec
s_mov_b64 exec, 1
s_cmp_eq_u32 s65, 0
s_cbranch_scc1 Lslow_220
buffer_store_dword v4, off, s[4:7], s68
s_branch Ljoin_221
Lslow_220:
buffer_store_dword v4, off, s[4:7], s68 sc1
Ljoin_221:
s_mov_b64 exec, s[98:99]
s_mov_b32 s68, 0
Lnp_219:
s_endpgm
L_abortO:
s_mov_b64 exec, 1
s_lshl_b32 s60, s56, 8
s_or_b32 s60, s60, s61
s_lshl_b32 s61, s47, 16
s_or_b32 s60, s60, s61
s_or_b32 s60, s60, 0x40000000
v_mov_b32 v1, s60
v_mov_b32 v2, 160
buffer_store_dword v1, v2, s[8:11], 0 offen sc1
s_waitcnt vmcnt(0)
s_endpgm
L_F0:
L_F1:
s_waitcnt vmcnt(0)
s_barrier
s_cmp_lg_u32 s47, 0
s_cbranch_scc1 Larr_222
s_getreg_b32 s60, hwreg(HW_REG_XCC_ID)
s_and_b32 s60, s60, 7
s_lshr_b32 s61, s56, 5
s_cmp_eq_u32 s60, s61
s_cselect_b32 s60, 1, 0x10001
s_mov_b64 exec, 1
v_mov_b32 v1, s60
v_mov_b32 v2, 136
buffer_atomic_add v1, v2, s[8:11], 0 offen sc1
s_mov_b64 exec, -1
Larr_222:
v_lshlrev_b32 v1, 4, v0
v_lshlrev_b32 v6, 2, v0
v_and_b32 v14, 15, v0
v_lshrrev_b32 v15, 4, v0
v_mov_b32 v4, 1
v_mov_b32 v5, 0
s_sub_u32 s60, s58, 16
s_lshr_b32 s60, s60, 1
s_lshl_b32 s60, s60, 2
s_add_u32 s62, s60, s47
s_mov_b32 s63, s62
s_add_u32 s66, s62, 16
s_add_u32 s67, s62, 32
s_min_u32 s67, s67, 42
v_and_b32 v7, 31, v0
v_lshlrev_b32 v10, 2, v7
s_lshl_b32 s60, s47, 8
s_add_u32 s60, s60, 49152
v_add_u32 v10, s60, v10
v_lshl_add_u32 v8, v14, 2, s60
s_mul_i32 s60, s47, 6144
v_add_u32 v11, s60, v1
s_mov_b32 s71, 0x3f803f80
s_mov_b32 s70, 0xc0135761
s_mov_b32 s72, 0xbdd2d3e8
s_mov_b32 s73, s72
v_mov_b32 v12, s70
v_mov_b32 v13, s70
v_mul_u32_u24 v9, 88064, v15
v_lshl_add_u32 v9, v14, 2, v9
s_mov_b32 s12, s32
s_mov_b32 s13, s33
s_mov_b32 s14, 1409024
s_mov_b32 s15, 0x00020000
s_lshl_b32 s60, s63, 6
v_add_u32 v16, s60, v9
buffer_load_dword v32, v16, s[12:15], 0 offen offset:0
s_mov_b32 s60, 5504
buffer_load_dword v33, v16, s[12:15], s60 offen
s_mov_b32 s60, 11008
buffer_load_dword v34, v16, s[12:15], s60 offen
s_mov_b32 s60, 16512
buffer_load_dword v35, v16, s[12:15], s60 offen
buffer_load_dword v36, v16, s[12:15], 0 offen offset:2752
s_mov_b32 s60, 8256
buffer_load_dword v37, v16, s[12:15], s60 offen
s_mov_b32 s60, 13760
buffer_load_dword v38, v16, s[12:15], s60 offen
s_mov_b32 s60, 19264
buffer_load_dword v39, v16, s[12:15], s60 offen
s_mov_b32 s60, 22016
buffer_load_dword v40, v16, s[12:15], s60 offen
s_mov_b32 s60, 27520
buffer_load_dword v41, v16, s[12:15], s60 offen
s_mov_b32 s60, 33024
buffer_load_dword v42, v16, s[12:15], s60 offen
s_mov_b32 s60, 38528
buffer_load_dword v43, v16, s[12:15], s60 offen
s_mov_b32 s60, 24768
buffer_load_dword v44, v16, s[12:15], s60 offen
s_mov_b32 s60, 30272
buffer_load_dword v45, v16, s[12:15], s60 offen
s_mov_b32 s60, 35776
buffer_load_dword v46, v16, s[12:15], s60 offen
s_mov_b32 s60, 41280
buffer_load_dword v47, v16, s[12:15], s60 offen
s_mov_b32 s60, 44032
buffer_load_dword v48, v16, s[12:15], s60 offen
s_mov_b32 s60, 49536
buffer_load_dword v49, v16, s[12:15], s60 offen
s_mov_b32 s60, 55040
buffer_load_dword v50, v16, s[12:15], s60 offen
s_mov_b32 s60, 60544
buffer_load_dword v51, v16, s[12:15], s60 offen
s_mov_b32 s60, 46784
buffer_load_dword v52, v16, s[12:15], s60 offen
s_mov_b32 s60, 52288
buffer_load_dword v53, v16, s[12:15], s60 offen
s_mov_b32 s60, 57792
buffer_load_dword v54, v16, s[12:15], s60 offen
s_mov_b32 s60, 63296
buffer_load_dword v55, v16, s[12:15], s60 offen
s_mov_b32 s60, 66048
buffer_load_dword v56, v16, s[12:15], s60 offen
s_mov_b32 s60, 71552
buffer_load_dword v57, v16, s[12:15], s60 offen
s_mov_b32 s60, 77056
buffer_load_dword v58, v16, s[12:15], s60 offen
s_mov_b32 s60, 82560
buffer_load_dword v59, v16, s[12:15], s60 offen
s_mov_b32 s60, 68800
buffer_load_dword v60, v16, s[12:15], s60 offen
s_mov_b32 s60, 74304
buffer_load_dword v61, v16, s[12:15], s60 offen
s_mov_b32 s60, 79808
buffer_load_dword v62, v16, s[12:15], s60 offen
s_mov_b32 s60, 85312
buffer_load_dword v63, v16, s[12:15], s60 offen
s_mov_b32 s60, 352256
buffer_load_dword v64, v16, s[12:15], s60 offen
s_mov_b32 s60, 357760
buffer_load_dword v65, v16, s[12:15], s60 offen
s_mov_b32 s60, 363264
buffer_load_dword v66, v16, s[12:15], s60 offen
s_mov_b32 s60, 368768
buffer_load_dword v67, v16, s[12:15], s60 offen
s_mov_b32 s60, 355008
buffer_load_dword v68, v16, s[12:15], s60 offen
s_mov_b32 s60, 360512
buffer_load_dword v69, v16, s[12:15], s60 offen
s_mov_b32 s60, 366016
buffer_load_dword v70, v16, s[12:15], s60 offen
s_mov_b32 s60, 371520
buffer_load_dword v71, v16, s[12:15], s60 offen
s_mov_b32 s60, 374272
buffer_load_dword v72, v16, s[12:15], s60 offen
s_mov_b32 s60, 379776
buffer_load_dword v73, v16, s[12:15], s60 offen
s_mov_b32 s60, 385280
buffer_load_dword v74, v16, s[12:15], s60 offen
s_mov_b32 s60, 390784
buffer_load_dword v75, v16, s[12:15], s60 offen
s_mov_b32 s60, 377024
buffer_load_dword v76, v16, s[12:15], s60 offen
s_mov_b32 s60, 382528
buffer_load_dword v77, v16, s[12:15], s60 offen
s_mov_b32 s60, 388032
buffer_load_dword v78, v16, s[12:15], s60 offen
s_mov_b32 s60, 393536
buffer_load_dword v79, v16, s[12:15], s60 offen
s_waitcnt vmcnt(32)
v_perm_b32 v80, v33, v32, s44
v_accvgpr_write_b32 a0, v80
v_perm_b32 v81, v35, v34, s44
v_accvgpr_write_b32 a1, v81
v_perm_b32 v82, v37, v36, s44
v_accvgpr_write_b32 a2, v82
v_perm_b32 v83, v39, v38, s44
v_accvgpr_write_b32 a3, v83
v_perm_b32 v84, v33, v32, s45
v_accvgpr_write_b32 a64, v84
v_perm_b32 v85, v35, v34, s45
v_accvgpr_write_b32 a65, v85
v_perm_b32 v86, v37, v36, s45
v_accvgpr_write_b32 a66, v86
v_perm_b32 v87, v39, v38, s45
v_accvgpr_write_b32 a67, v87
v_perm_b32 v80, v41, v40, s44
v_accvgpr_write_b32 a4, v80
v_perm_b32 v81, v43, v42, s44
v_accvgpr_write_b32 a5, v81
v_perm_b32 v82, v45, v44, s44
v_accvgpr_write_b32 a6, v82
v_perm_b32 v83, v47, v46, s44
v_accvgpr_write_b32 a7, v83
v_perm_b32 v84, v41, v40, s45
v_accvgpr_write_b32 a68, v84
v_perm_b32 v85, v43, v42, s45
v_accvgpr_write_b32 a69, v85
v_perm_b32 v86, v45, v44, s45
v_accvgpr_write_b32 a70, v86
v_perm_b32 v87, v47, v46, s45
v_accvgpr_write_b32 a71, v87
s_mov_b32 s60, 396288
buffer_load_dword v32, v16, s[12:15], s60 offen
s_mov_b32 s60, 401792
buffer_load_dword v33, v16, s[12:15], s60 offen
s_mov_b32 s60, 407296
buffer_load_dword v34, v16, s[12:15], s60 offen
s_mov_b32 s60, 412800
buffer_load_dword v35, v16, s[12:15], s60 offen
s_mov_b32 s60, 399040
buffer_load_dword v36, v16, s[12:15], s60 offen
s_mov_b32 s60, 404544
buffer_load_dword v37, v16, s[12:15], s60 offen
s_mov_b32 s60, 410048
buffer_load_dword v38, v16, s[12:15], s60 offen
s_mov_b32 s60, 415552
buffer_load_dword v39, v16, s[12:15], s60 offen
s_mov_b32 s60, 418304
buffer_load_dword v40, v16, s[12:15], s60 offen
s_mov_b32 s60, 423808
buffer_load_dword v41, v16, s[12:15], s60 offen
s_mov_b32 s60, 429312
buffer_load_dword v42, v16, s[12:15], s60 offen
s_mov_b32 s60, 434816
buffer_load_dword v43, v16, s[12:15], s60 offen
s_mov_b32 s60, 421056
buffer_load_dword v44, v16, s[12:15], s60 offen
s_mov_b32 s60, 426560
buffer_load_dword v45, v16, s[12:15], s60 offen
s_mov_b32 s60, 432064
buffer_load_dword v46, v16, s[12:15], s60 offen
s_mov_b32 s60, 437568
buffer_load_dword v47, v16, s[12:15], s60 offen
s_waitcnt vmcnt(32)
v_perm_b32 v80, v49, v48, s44
v_accvgpr_write_b32 a8, v80
v_perm_b32 v81, v51, v50, s44
v_accvgpr_write_b32 a9, v81
v_perm_b32 v82, v53, v52, s44
v_accvgpr_write_b32 a10, v82
v_perm_b32 v83, v55, v54, s44
v_accvgpr_write_b32 a11, v83
v_perm_b32 v84, v49, v48, s45
v_accvgpr_write_b32 a72, v84
v_perm_b32 v85, v51, v50, s45
v_accvgpr_write_b32 a73, v85
v_perm_b32 v86, v53, v52, s45
v_accvgpr_write_b32 a74, v86
v_perm_b32 v87, v55, v54, s45
v_accvgpr_write_b32 a75, v87
v_perm_b32 v80, v57, v56, s44
v_accvgpr_write_b32 a12, v80
v_perm_b32 v81, v59, v58, s44
v_accvgpr_write_b32 a13, v81
v_perm_b32 v82, v61, v60, s44
v_accvgpr_write_b32 a14, v82
v_perm_b32 v83, v63, v62, s44
v_accvgpr_write_b32 a15, v83
v_perm_b32 v84, v57, v56, s45
v_accvgpr_write_b32 a76, v84
v_perm_b32 v85, v59, v58, s45
v_accvgpr_write_b32 a77, v85
v_perm_b32 v86, v61, v60, s45
v_accvgpr_write_b32 a78, v86
v_perm_b32 v87, v63, v62, s45
v_accvgpr_write_b32 a79, v87
s_mov_b32 s60, 704512
buffer_load_dword v48, v16, s[12:15], s60 offen
s_mov_b32 s60, 710016
buffer_load_dword v49, v16, s[12:15], s60 offen
s_mov_b32 s60, 715520
buffer_load_dword v50, v16, s[12:15], s60 offen
s_mov_b32 s60, 721024
buffer_load_dword v51, v16, s[12:15], s60 offen
s_mov_b32 s60, 707264
buffer_load_dword v52, v16, s[12:15], s60 offen
s_mov_b32 s60, 712768
buffer_load_dword v53, v16, s[12:15], s60 offen
s_mov_b32 s60, 718272
buffer_load_dword v54, v16, s[12:15], s60 offen
s_mov_b32 s60, 723776
buffer_load_dword v55, v16, s[12:15], s60 offen
s_mov_b32 s60, 726528
buffer_load_dword v56, v16, s[12:15], s60 offen
s_mov_b32 s60, 732032
buffer_load_dword v57, v16, s[12:15], s60 offen
s_mov_b32 s60, 737536
buffer_load_dword v58, v16, s[12:15], s60 offen
s_mov_b32 s60, 743040
buffer_load_dword v59, v16, s[12:15], s60 offen
s_mov_b32 s60, 729280
buffer_load_dword v60, v16, s[12:15], s60 offen
s_mov_b32 s60, 734784
buffer_load_dword v61, v16, s[12:15], s60 offen
s_mov_b32 s60, 740288
buffer_load_dword v62, v16, s[12:15], s60 offen
s_mov_b32 s60, 745792
buffer_load_dword v63, v16, s[12:15], s60 offen
s_waitcnt vmcnt(32)
v_perm_b32 v80, v65, v64, s44
v_accvgpr_write_b32 a16, v80
v_perm_b32 v81, v67, v66, s44
v_accvgpr_write_b32 a17, v81
v_perm_b32 v82, v69, v68, s44
v_accvgpr_write_b32 a18, v82
v_perm_b32 v83, v71, v70, s44
v_accvgpr_write_b32 a19, v83
v_perm_b32 v84, v65, v64, s45
v_accvgpr_write_b32 a80, v84
v_perm_b32 v85, v67, v66, s45
v_accvgpr_write_b32 a81, v85
v_perm_b32 v86, v69, v68, s45
v_accvgpr_write_b32 a82, v86
v_perm_b32 v87, v71, v70, s45
v_accvgpr_write_b32 a83, v87
v_perm_b32 v80, v73, v72, s44
v_accvgpr_write_b32 a20, v80
v_perm_b32 v81, v75, v74, s44
v_accvgpr_write_b32 a21, v81
v_perm_b32 v82, v77, v76, s44
v_accvgpr_write_b32 a22, v82
v_perm_b32 v83, v79, v78, s44
v_accvgpr_write_b32 a23, v83
v_perm_b32 v84, v73, v72, s45
v_accvgpr_write_b32 a84, v84
v_perm_b32 v85, v75, v74, s45
v_accvgpr_write_b32 a85, v85
v_perm_b32 v86, v77, v76, s45
v_accvgpr_write_b32 a86, v86
v_perm_b32 v87, v79, v78, s45
v_accvgpr_write_b32 a87, v87
s_mov_b32 s60, 748544
buffer_load_dword v64, v16, s[12:15], s60 offen
s_mov_b32 s60, 754048
buffer_load_dword v65, v16, s[12:15], s60 offen
s_mov_b32 s60, 759552
buffer_load_dword v66, v16, s[12:15], s60 offen
s_mov_b32 s60, 765056
buffer_load_dword v67, v16, s[12:15], s60 offen
s_mov_b32 s60, 751296
buffer_load_dword v68, v16, s[12:15], s60 offen
s_mov_b32 s60, 756800
buffer_load_dword v69, v16, s[12:15], s60 offen
s_mov_b32 s60, 762304
buffer_load_dword v70, v16, s[12:15], s60 offen
s_mov_b32 s60, 767808
buffer_load_dword v71, v16, s[12:15], s60 offen
s_mov_b32 s60, 770560
buffer_load_dword v72, v16, s[12:15], s60 offen
s_mov_b32 s60, 776064
buffer_load_dword v73, v16, s[12:15], s60 offen
s_mov_b32 s60, 781568
buffer_load_dword v74, v16, s[12:15], s60 offen
s_mov_b32 s60, 787072
buffer_load_dword v75, v16, s[12:15], s60 offen
s_mov_b32 s60, 773312
buffer_load_dword v76, v16, s[12:15], s60 offen
s_mov_b32 s60, 778816
buffer_load_dword v77, v16, s[12:15], s60 offen
s_mov_b32 s60, 784320
buffer_load_dword v78, v16, s[12:15], s60 offen
s_mov_b32 s60, 789824
buffer_load_dword v79, v16, s[12:15], s60 offen
s_waitcnt vmcnt(32)
v_perm_b32 v80, v33, v32, s44
v_accvgpr_write_b32 a24, v80
v_perm_b32 v81, v35, v34, s44
v_accvgpr_write_b32 a25, v81
v_perm_b32 v82, v37, v36, s44
v_accvgpr_write_b32 a26, v82
v_perm_b32 v83, v39, v38, s44
v_accvgpr_write_b32 a27, v83
v_perm_b32 v84, v33, v32, s45
v_accvgpr_write_b32 a88, v84
v_perm_b32 v85, v35, v34, s45
v_accvgpr_write_b32 a89, v85
v_perm_b32 v86, v37, v36, s45
v_accvgpr_write_b32 a90, v86
v_perm_b32 v87, v39, v38, s45
v_accvgpr_write_b32 a91, v87
v_perm_b32 v80, v41, v40, s44
v_accvgpr_write_b32 a28, v80
v_perm_b32 v81, v43, v42, s44
v_accvgpr_write_b32 a29, v81
v_perm_b32 v82, v45, v44, s44
v_accvgpr_write_b32 a30, v82
v_perm_b32 v83, v47, v46, s44
v_accvgpr_write_b32 a31, v83
v_perm_b32 v84, v41, v40, s45
v_accvgpr_write_b32 a92, v84
v_perm_b32 v85, v43, v42, s45
v_accvgpr_write_b32 a93, v85
v_perm_b32 v86, v45, v44, s45
v_accvgpr_write_b32 a94, v86
v_perm_b32 v87, v47, v46, s45
v_accvgpr_write_b32 a95, v87
s_mov_b32 s60, 1056768
buffer_load_dword v32, v16, s[12:15], s60 offen
s_mov_b32 s60, 1062272
buffer_load_dword v33, v16, s[12:15], s60 offen
s_mov_b32 s60, 1067776
buffer_load_dword v34, v16, s[12:15], s60 offen
s_mov_b32 s60, 1073280
buffer_load_dword v35, v16, s[12:15], s60 offen
s_mov_b32 s60, 1059520
buffer_load_dword v36, v16, s[12:15], s60 offen
s_mov_b32 s60, 1065024
buffer_load_dword v37, v16, s[12:15], s60 offen
s_mov_b32 s60, 1070528
buffer_load_dword v38, v16, s[12:15], s60 offen
s_mov_b32 s60, 1076032
buffer_load_dword v39, v16, s[12:15], s60 offen
s_mov_b32 s60, 1078784
buffer_load_dword v40, v16, s[12:15], s60 offen
s_mov_b32 s60, 1084288
buffer_load_dword v41, v16, s[12:15], s60 offen
s_mov_b32 s60, 1089792
buffer_load_dword v42, v16, s[12:15], s60 offen
s_mov_b32 s60, 1095296
buffer_load_dword v43, v16, s[12:15], s60 offen
s_mov_b32 s60, 1081536
buffer_load_dword v44, v16, s[12:15], s60 offen
s_mov_b32 s60, 1087040
buffer_load_dword v45, v16, s[12:15], s60 offen
s_mov_b32 s60, 1092544
buffer_load_dword v46, v16, s[12:15], s60 offen
s_mov_b32 s60, 1098048
buffer_load_dword v47, v16, s[12:15], s60 offen
s_waitcnt vmcnt(32)
v_perm_b32 v80, v49, v48, s44
v_accvgpr_write_b32 a32, v80
v_perm_b32 v81, v51, v50, s44
v_accvgpr_write_b32 a33, v81
v_perm_b32 v82, v53, v52, s44
v_accvgpr_write_b32 a34, v82
v_perm_b32 v83, v55, v54, s44
v_accvgpr_write_b32 a35, v83
v_perm_b32 v84, v49, v48, s45
v_accvgpr_write_b32 a96, v84
v_perm_b32 v85, v51, v50, s45
v_accvgpr_write_b32 a97, v85
v_perm_b32 v86, v53, v52, s45
v_accvgpr_write_b32 a98, v86
v_perm_b32 v87, v55, v54, s45
v_accvgpr_write_b32 a99, v87
v_perm_b32 v80, v57, v56, s44
v_accvgpr_write_b32 a36, v80
v_perm_b32 v81, v59, v58, s44
v_accvgpr_write_b32 a37, v81
v_perm_b32 v82, v61, v60, s44
v_accvgpr_write_b32 a38, v82
v_perm_b32 v83, v63, v62, s44
v_accvgpr_write_b32 a39, v83
v_perm_b32 v84, v57, v56, s45
v_accvgpr_write_b32 a100, v84
v_perm_b32 v85, v59, v58, s45
v_accvgpr_write_b32 a101, v85
v_perm_b32 v86, v61, v60, s45
v_accvgpr_write_b32 a102, v86
v_perm_b32 v87, v63, v62, s45
v_accvgpr_write_b32 a103, v87
s_mov_b32 s60, 1100800
buffer_load_dword v48, v16, s[12:15], s60 offen
s_mov_b32 s60, 1106304
buffer_load_dword v49, v16, s[12:15], s60 offen
s_mov_b32 s60, 1111808
buffer_load_dword v50, v16, s[12:15], s60 offen
s_mov_b32 s60, 1117312
buffer_load_dword v51, v16, s[12:15], s60 offen
s_mov_b32 s60, 1103552
buffer_load_dword v52, v16, s[12:15], s60 offen
s_mov_b32 s60, 1109056
buffer_load_dword v53, v16, s[12:15], s60 offen
s_mov_b32 s60, 1114560
buffer_load_dword v54, v16, s[12:15], s60 offen
s_mov_b32 s60, 1120064
buffer_load_dword v55, v16, s[12:15], s60 offen
s_mov_b32 s60, 1122816
buffer_load_dword v56, v16, s[12:15], s60 offen
s_mov_b32 s60, 1128320
buffer_load_dword v57, v16, s[12:15], s60 offen
s_mov_b32 s60, 1133824
buffer_load_dword v58, v16, s[12:15], s60 offen
s_mov_b32 s60, 1139328
buffer_load_dword v59, v16, s[12:15], s60 offen
s_mov_b32 s60, 1125568
buffer_load_dword v60, v16, s[12:15], s60 offen
s_mov_b32 s60, 1131072
buffer_load_dword v61, v16, s[12:15], s60 offen
s_mov_b32 s60, 1136576
buffer_load_dword v62, v16, s[12:15], s60 offen
s_mov_b32 s60, 1142080
buffer_load_dword v63, v16, s[12:15], s60 offen
s_waitcnt vmcnt(32)
v_perm_b32 v80, v65, v64, s44
v_accvgpr_write_b32 a40, v80
v_perm_b32 v81, v67, v66, s44
v_accvgpr_write_b32 a41, v81
v_perm_b32 v82, v69, v68, s44
v_accvgpr_write_b32 a42, v82
v_perm_b32 v83, v71, v70, s44
v_accvgpr_write_b32 a43, v83
v_perm_b32 v84, v65, v64, s45
v_accvgpr_write_b32 a104, v84
v_perm_b32 v85, v67, v66, s45
v_accvgpr_write_b32 a105, v85
v_perm_b32 v86, v69, v68, s45
v_accvgpr_write_b32 a106, v86
v_perm_b32 v87, v71, v70, s45
v_accvgpr_write_b32 a107, v87
v_perm_b32 v80, v73, v72, s44
v_accvgpr_write_b32 a44, v80
v_perm_b32 v81, v75, v74, s44
v_accvgpr_write_b32 a45, v81
v_perm_b32 v82, v77, v76, s44
v_accvgpr_write_b32 a46, v82
v_perm_b32 v83, v79, v78, s44
v_accvgpr_write_b32 a47, v83
v_perm_b32 v84, v73, v72, s45
v_accvgpr_write_b32 a108, v84
v_perm_b32 v85, v75, v74, s45
v_accvgpr_write_b32 a109, v85
v_perm_b32 v86, v77, v76, s45
v_accvgpr_write_b32 a110, v86
v_perm_b32 v87, v79, v78, s45
v_accvgpr_write_b32 a111, v87
s_waitcnt vmcnt(16)
v_perm_b32 v80, v33, v32, s44
v_accvgpr_write_b32 a48, v80
v_perm_b32 v81, v35, v34, s44
v_accvgpr_write_b32 a49, v81
v_perm_b32 v82, v37, v36, s44
v_accvgpr_write_b32 a50, v82
v_perm_b32 v83, v39, v38, s44
v_accvgpr_write_b32 a51, v83
v_perm_b32 v84, v33, v32, s45
v_accvgpr_write_b32 a112, v84
v_perm_b32 v85, v35, v34, s45
v_accvgpr_write_b32 a113, v85
v_perm_b32 v86, v37, v36, s45
v_accvgpr_write_b32 a114, v86
v_perm_b32 v87, v39, v38, s45
v_accvgpr_write_b32 a115, v87
v_perm_b32 v80, v41, v40, s44
v_accvgpr_write_b32 a52, v80
v_perm_b32 v81, v43, v42, s44
v_accvgpr_write_b32 a53, v81
v_perm_b32 v82, v45, v44, s44
v_accvgpr_write_b32 a54, v82
v_perm_b32 v83, v47, v46, s44
v_accvgpr_write_b32 a55, v83
v_perm_b32 v84, v41, v40, s45
v_accvgpr_write_b32 a116, v84
v_perm_b32 v85, v43, v42, s45
v_accvgpr_write_b32 a117, v85
v_perm_b32 v86, v45, v44, s45
v_accvgpr_write_b32 a118, v86
v_perm_b32 v87, v47, v46, s45
v_accvgpr_write_b32 a119, v87
s_waitcnt vmcnt(0)
v_perm_b32 v80, v49, v48, s44
v_accvgpr_write_b32 a56, v80
v_perm_b32 v81, v51, v50, s44
v_accvgpr_write_b32 a57, v81
v_perm_b32 v82, v53, v52, s44
v_accvgpr_write_b32 a58, v82
v_perm_b32 v83, v55, v54, s44
v_accvgpr_write_b32 a59, v83
v_perm_b32 v84, v49, v48, s45
v_accvgpr_write_b32 a120, v84
v_perm_b32 v85, v51, v50, s45
v_accvgpr_write_b32 a121, v85
v_perm_b32 v86, v53, v52, s45
v_accvgpr_write_b32 a122, v86
v_perm_b32 v87, v55, v54, s45
v_accvgpr_write_b32 a123, v87
v_perm_b32 v80, v57, v56, s44
v_accvgpr_write_b32 a60, v80
v_perm_b32 v81, v59, v58, s44
v_accvgpr_write_b32 a61, v81
v_perm_b32 v82, v61, v60, s44
v_accvgpr_write_b32 a62, v82
v_perm_b32 v83, v63, v62, s44
v_accvgpr_write_b32 a63, v83
v_perm_b32 v84, v57, v56, s45
v_accvgpr_write_b32 a124, v84
v_perm_b32 v85, v59, v58, s45
v_accvgpr_write_b32 a125, v85
v_perm_b32 v86, v61, v60, s45
v_accvgpr_write_b32 a126, v86
v_perm_b32 v87, v63, v62, s45
v_accvgpr_write_b32 a127, v87
s_lshl_b32 s60, s66, 6
v_add_u32 v16, s60, v9
buffer_load_dword v32, v16, s[12:15], 0 offen offset:0
s_mov_b32 s60, 5504
buffer_load_dword v33, v16, s[12:15], s60 offen
s_mov_b32 s60, 11008
buffer_load_dword v34, v16, s[12:15], s60 offen
s_mov_b32 s60, 16512
buffer_load_dword v35, v16, s[12:15], s60 offen
buffer_load_dword v36, v16, s[12:15], 0 offen offset:2752
s_mov_b32 s60, 8256
buffer_load_dword v37, v16, s[12:15], s60 offen
s_mov_b32 s60, 13760
buffer_load_dword v38, v16, s[12:15], s60 offen
s_mov_b32 s60, 19264
buffer_load_dword v39, v16, s[12:15], s60 offen
s_mov_b32 s60, 22016
buffer_load_dword v40, v16, s[12:15], s60 offen
s_mov_b32 s60, 27520
buffer_load_dword v41, v16, s[12:15], s60 offen
s_mov_b32 s60, 33024
buffer_load_dword v42, v16, s[12:15], s60 offen
s_mov_b32 s60, 38528
buffer_load_dword v43, v16, s[12:15], s60 offen
s_mov_b32 s60, 24768
buffer_load_dword v44, v16, s[12:15], s60 offen
s_mov_b32 s60, 30272
buffer_load_dword v45, v16, s[12:15], s60 offen
s_mov_b32 s60, 35776
buffer_load_dword v46, v16, s[12:15], s60 offen
s_mov_b32 s60, 41280
buffer_load_dword v47, v16, s[12:15], s60 offen
s_mov_b32 s60, 44032
buffer_load_dword v48, v16, s[12:15], s60 offen
s_mov_b32 s60, 49536
buffer_load_dword v49, v16, s[12:15], s60 offen
s_mov_b32 s60, 55040
buffer_load_dword v50, v16, s[12:15], s60 offen
s_mov_b32 s60, 60544
buffer_load_dword v51, v16, s[12:15], s60 offen
s_mov_b32 s60, 46784
buffer_load_dword v52, v16, s[12:15], s60 offen
s_mov_b32 s60, 52288
buffer_load_dword v53, v16, s[12:15], s60 offen
s_mov_b32 s60, 57792
buffer_load_dword v54, v16, s[12:15], s60 offen
s_mov_b32 s60, 63296
buffer_load_dword v55, v16, s[12:15], s60 offen
s_mov_b32 s60, 66048
buffer_load_dword v56, v16, s[12:15], s60 offen
s_mov_b32 s60, 71552
buffer_load_dword v57, v16, s[12:15], s60 offen
s_mov_b32 s60, 77056
buffer_load_dword v58, v16, s[12:15], s60 offen
s_mov_b32 s60, 82560
buffer_load_dword v59, v16, s[12:15], s60 offen
s_mov_b32 s60, 68800
buffer_load_dword v60, v16, s[12:15], s60 offen
s_mov_b32 s60, 74304
buffer_load_dword v61, v16, s[12:15], s60 offen
s_mov_b32 s60, 79808
buffer_load_dword v62, v16, s[12:15], s60 offen
s_mov_b32 s60, 85312
buffer_load_dword v63, v16, s[12:15], s60 offen
s_mov_b32 s60, 352256
buffer_load_dword v64, v16, s[12:15], s60 offen
s_mov_b32 s60, 357760
buffer_load_dword v65, v16, s[12:15], s60 offen
s_mov_b32 s60, 363264
buffer_load_dword v66, v16, s[12:15], s60 offen
s_mov_b32 s60, 368768
buffer_load_dword v67, v16, s[12:15], s60 offen
s_mov_b32 s60, 355008
buffer_load_dword v68, v16, s[12:15], s60 offen
s_mov_b32 s60, 360512
buffer_load_dword v69, v16, s[12:15], s60 offen
s_mov_b32 s60, 366016
buffer_load_dword v70, v16, s[12:15], s60 offen
s_mov_b32 s60, 371520
buffer_load_dword v71, v16, s[12:15], s60 offen
s_mov_b32 s60, 374272
buffer_load_dword v72, v16, s[12:15], s60 offen
s_mov_b32 s60, 379776
buffer_load_dword v73, v16, s[12:15], s60 offen
s_mov_b32 s60, 385280
buffer_load_dword v74, v16, s[12:15], s60 offen
s_mov_b32 s60, 390784
buffer_load_dword v75, v16, s[12:15], s60 offen
s_mov_b32 s60, 377024
buffer_load_dword v76, v16, s[12:15], s60 offen
s_mov_b32 s60, 382528
buffer_load_dword v77, v16, s[12:15], s60 offen
s_mov_b32 s60, 388032
buffer_load_dword v78, v16, s[12:15], s60 offen
s_mov_b32 s60, 393536
buffer_load_dword v79, v16, s[12:15], s60 offen
s_waitcnt vmcnt(32)
v_perm_b32 v80, v33, v32, s44
v_accvgpr_write_b32 a128, v80
v_perm_b32 v81, v35, v34, s44
v_accvgpr_write_b32 a129, v81
v_perm_b32 v82, v37, v36, s44
v_accvgpr_write_b32 a130, v82
v_perm_b32 v83, v39, v38, s44
v_accvgpr_write_b32 a131, v83
v_perm_b32 v84, v33, v32, s45
v_accvgpr_write_b32 a192, v84
v_perm_b32 v85, v35, v34, s45
v_accvgpr_write_b32 a193, v85
v_perm_b32 v86, v37, v36, s45
v_accvgpr_write_b32 a194, v86
v_perm_b32 v87, v39, v38, s45
v_accvgpr_write_b32 a195, v87
v_perm_b32 v80, v41, v40, s44
v_accvgpr_write_b32 a132, v80
v_perm_b32 v81, v43, v42, s44
v_accvgpr_write_b32 a133, v81
v_perm_b32 v82, v45, v44, s44
v_accvgpr_write_b32 a134, v82
v_perm_b32 v83, v47, v46, s44
v_accvgpr_write_b32 a135, v83
v_perm_b32 v84, v41, v40, s45
v_accvgpr_write_b32 a196, v84
v_perm_b32 v85, v43, v42, s45
v_accvgpr_write_b32 a197, v85
v_perm_b32 v86, v45, v44, s45
v_accvgpr_write_b32 a198, v86
v_perm_b32 v87, v47, v46, s45
v_accvgpr_write_b32 a199, v87
s_mov_b32 s60, 396288
buffer_load_dword v32, v16, s[12:15], s60 offen
s_mov_b32 s60, 401792
buffer_load_dword v33, v16, s[12:15], s60 offen
s_mov_b32 s60, 407296
buffer_load_dword v34, v16, s[12:15], s60 offen
s_mov_b32 s60, 412800
buffer_load_dword v35, v16, s[12:15], s60 offen
s_mov_b32 s60, 399040
buffer_load_dword v36, v16, s[12:15], s60 offen
s_mov_b32 s60, 404544
buffer_load_dword v37, v16, s[12:15], s60 offen
s_mov_b32 s60, 410048
buffer_load_dword v38, v16, s[12:15], s60 offen
s_mov_b32 s60, 415552
buffer_load_dword v39, v16, s[12:15], s60 offen
s_mov_b32 s60, 418304
buffer_load_dword v40, v16, s[12:15], s60 offen
s_mov_b32 s60, 423808
buffer_load_dword v41, v16, s[12:15], s60 offen
s_mov_b32 s60, 429312
buffer_load_dword v42, v16, s[12:15], s60 offen
s_mov_b32 s60, 434816
buffer_load_dword v43, v16, s[12:15], s60 offen
s_mov_b32 s60, 421056
buffer_load_dword v44, v16, s[12:15], s60 offen
s_mov_b32 s60, 426560
buffer_load_dword v45, v16, s[12:15], s60 offen
s_mov_b32 s60, 432064
buffer_load_dword v46, v16, s[12:15], s60 offen
s_mov_b32 s60, 437568
buffer_load_dword v47, v16, s[12:15], s60 offen
s_waitcnt vmcnt(32)
v_perm_b32 v80, v49, v48, s44
v_accvgpr_write_b32 a136, v80
v_perm_b32 v81, v51, v50, s44
v_accvgpr_write_b32 a137, v81
v_perm_b32 v82, v53, v52, s44
v_accvgpr_write_b32 a138, v82
v_perm_b32 v83, v55, v54, s44
v_accvgpr_write_b32 a139, v83
v_perm_b32 v84, v49, v48, s45
v_accvgpr_write_b32 a200, v84
v_perm_b32 v85, v51, v50, s45
v_accvgpr_write_b32 a201, v85
v_perm_b32 v86, v53, v52, s45
v_accvgpr_write_b32 a202, v86
v_perm_b32 v87, v55, v54, s45
v_accvgpr_write_b32 a203, v87
v_perm_b32 v80, v57, v56, s44
v_accvgpr_write_b32 a140, v80
v_perm_b32 v81, v59, v58, s44
v_accvgpr_write_b32 a141, v81
v_perm_b32 v82, v61, v60, s44
v_accvgpr_write_b32 a142, v82
v_perm_b32 v83, v63, v62, s44
v_accvgpr_write_b32 a143, v83
v_perm_b32 v84, v57, v56, s45
v_accvgpr_write_b32 a204, v84
v_perm_b32 v85, v59, v58, s45
v_accvgpr_write_b32 a205, v85
v_perm_b32 v86, v61, v60, s45
v_accvgpr_write_b32 a206, v86
v_perm_b32 v87, v63, v62, s45
v_accvgpr_write_b32 a207, v87
s_mov_b32 s60, 704512
buffer_load_dword v48, v16, s[12:15], s60 offen
s_mov_b32 s60, 710016
buffer_load_dword v49, v16, s[12:15], s60 offen
s_mov_b32 s60, 715520
buffer_load_dword v50, v16, s[12:15], s60 offen
s_mov_b32 s60, 721024
buffer_load_dword v51, v16, s[12:15], s60 offen
s_mov_b32 s60, 707264
buffer_load_dword v52, v16, s[12:15], s60 offen
s_mov_b32 s60, 712768
buffer_load_dword v53, v16, s[12:15], s60 offen
s_mov_b32 s60, 718272
buffer_load_dword v54, v16, s[12:15], s60 offen
s_mov_b32 s60, 723776
buffer_load_dword v55, v16, s[12:15], s60 offen
s_mov_b32 s60, 726528
buffer_load_dword v56, v16, s[12:15], s60 offen
s_mov_b32 s60, 732032
buffer_load_dword v57, v16, s[12:15], s60 offen
s_mov_b32 s60, 737536
buffer_load_dword v58, v16, s[12:15], s60 offen
s_mov_b32 s60, 743040
buffer_load_dword v59, v16, s[12:15], s60 offen
s_mov_b32 s60, 729280
buffer_load_dword v60, v16, s[12:15], s60 offen
s_mov_b32 s60, 734784
buffer_load_dword v61, v16, s[12:15], s60 offen
s_mov_b32 s60, 740288
buffer_load_dword v62, v16, s[12:15], s60 offen
s_mov_b32 s60, 745792
buffer_load_dword v63, v16, s[12:15], s60 offen
s_waitcnt vmcnt(32)
v_perm_b32 v80, v65, v64, s44
v_accvgpr_write_b32 a144, v80
v_perm_b32 v81, v67, v66, s44
v_accvgpr_write_b32 a145, v81
v_perm_b32 v82, v69, v68, s44
v_accvgpr_write_b32 a146, v82
v_perm_b32 v83, v71, v70, s44
v_accvgpr_write_b32 a147, v83
v_perm_b32 v84, v65, v64, s45
v_accvgpr_write_b32 a208, v84
v_perm_b32 v85, v67, v66, s45
v_accvgpr_write_b32 a209, v85
v_perm_b32 v86, v69, v68, s45
v_accvgpr_write_b32 a210, v86
v_perm_b32 v87, v71, v70, s45
v_accvgpr_write_b32 a211, v87
v_perm_b32 v80, v73, v72, s44
v_accvgpr_write_b32 a148, v80
v_perm_b32 v81, v75, v74, s44
v_accvgpr_write_b32 a149, v81
v_perm_b32 v82, v77, v76, s44
v_accvgpr_write_b32 a150, v82
v_perm_b32 v83, v79, v78, s44
v_accvgpr_write_b32 a151, v83
v_perm_b32 v84, v73, v72, s45
v_accvgpr_write_b32 a212, v84
v_perm_b32 v85, v75, v74, s45
v_accvgpr_write_b32 a213, v85
v_perm_b32 v86, v77, v76, s45
v_accvgpr_write_b32 a214, v86
v_perm_b32 v87, v79, v78, s45
v_accvgpr_write_b32 a215, v87
s_mov_b32 s60, 748544
buffer_load_dword v64, v16, s[12:15], s60 offen
s_mov_b32 s60, 754048
buffer_load_dword v65, v16, s[12:15], s60 offen
s_mov_b32 s60, 759552
buffer_load_dword v66, v16, s[12:15], s60 offen
s_mov_b32 s60, 765056
buffer_load_dword v67, v16, s[12:15], s60 offen
s_mov_b32 s60, 751296
buffer_load_dword v68, v16, s[12:15], s60 offen
s_mov_b32 s60, 756800
buffer_load_dword v69, v16, s[12:15], s60 offen
s_mov_b32 s60, 762304
buffer_load_dword v70, v16, s[12:15], s60 offen
s_mov_b32 s60, 767808
buffer_load_dword v71, v16, s[12:15], s60 offen
s_mov_b32 s60, 770560
buffer_load_dword v72, v16, s[12:15], s60 offen
s_mov_b32 s60, 776064
buffer_load_dword v73, v16, s[12:15], s60 offen
s_mov_b32 s60, 781568
buffer_load_dword v74, v16, s[12:15], s60 offen
s_mov_b32 s60, 787072
buffer_load_dword v75, v16, s[12:15], s60 offen
s_mov_b32 s60, 773312
buffer_load_dword v76, v16, s[12:15], s60 offen
s_mov_b32 s60, 778816
buffer_load_dword v77, v16, s[12:15], s60 offen
s_mov_b32 s60, 784320
buffer_load_dword v78, v16, s[12:15], s60 offen
s_mov_b32 s60, 789824
buffer_load_dword v79, v16, s[12:15], s60 offen
s_waitcnt vmcnt(32)
v_perm_b32 v80, v33, v32, s44
v_accvgpr_write_b32 a152, v80
v_perm_b32 v81, v35, v34, s44
v_accvgpr_write_b32 a153, v81
v_perm_b32 v82, v37, v36, s44
v_accvgpr_write_b32 a154, v82
v_perm_b32 v83, v39, v38, s44
v_accvgpr_write_b32 a155, v83
v_perm_b32 v84, v33, v32, s45
v_accvgpr_write_b32 a216, v84
v_perm_b32 v85, v35, v34, s45
v_accvgpr_write_b32 a217, v85
v_perm_b32 v86, v37, v36, s45
v_accvgpr_write_b32 a218, v86
v_perm_b32 v87, v39, v38, s45
v_accvgpr_write_b32 a219, v87
v_perm_b32 v80, v41, v40, s44
v_accvgpr_write_b32 a156, v80
v_perm_b32 v81, v43, v42, s44
v_accvgpr_write_b32 a157, v81
v_perm_b32 v82, v45, v44, s44
v_accvgpr_write_b32 a158, v82
v_perm_b32 v83, v47, v46, s44
v_accvgpr_write_b32 a159, v83
v_perm_b32 v84, v41, v40, s45
v_accvgpr_write_b32 a220, v84
v_perm_b32 v85, v43, v42, s45
v_accvgpr_write_b32 a221, v85
v_perm_b32 v86, v45, v44, s45
v_accvgpr_write_b32 a222, v86
v_perm_b32 v87, v47, v46, s45
v_accvgpr_write_b32 a223, v87
s_mov_b32 s60, 1056768
buffer_load_dword v32, v16, s[12:15], s60 offen
s_mov_b32 s60, 1062272
buffer_load_dword v33, v16, s[12:15], s60 offen
s_mov_b32 s60, 1067776
buffer_load_dword v34, v16, s[12:15], s60 offen
s_mov_b32 s60, 1073280
buffer_load_dword v35, v16, s[12:15], s60 offen
s_mov_b32 s60, 1059520
buffer_load_dword v36, v16, s[12:15], s60 offen
s_mov_b32 s60, 1065024
buffer_load_dword v37, v16, s[12:15], s60 offen
s_mov_b32 s60, 1070528
buffer_load_dword v38, v16, s[12:15], s60 offen
s_mov_b32 s60, 1076032
buffer_load_dword v39, v16, s[12:15], s60 offen
s_mov_b32 s60, 1078784
buffer_load_dword v40, v16, s[12:15], s60 offen
s_mov_b32 s60, 1084288
buffer_load_dword v41, v16, s[12:15], s60 offen
s_mov_b32 s60, 1089792
buffer_load_dword v42, v16, s[12:15], s60 offen
s_mov_b32 s60, 1095296
buffer_load_dword v43, v16, s[12:15], s60 offen
s_mov_b32 s60, 1081536
buffer_load_dword v44, v16, s[12:15], s60 offen
s_mov_b32 s60, 1087040
buffer_load_dword v45, v16, s[12:15], s60 offen
s_mov_b32 s60, 1092544
buffer_load_dword v46, v16, s[12:15], s60 offen
s_mov_b32 s60, 1098048
buffer_load_dword v47, v16, s[12:15], s60 offen
s_waitcnt vmcnt(32)
v_perm_b32 v80, v49, v48, s44
v_accvgpr_write_b32 a160, v80
v_perm_b32 v81, v51, v50, s44
v_accvgpr_write_b32 a161, v81
v_perm_b32 v82, v53, v52, s44
v_accvgpr_write_b32 a162, v82
v_perm_b32 v83, v55, v54, s44
v_accvgpr_write_b32 a163, v83
v_perm_b32 v84, v49, v48, s45
v_accvgpr_write_b32 a224, v84
v_perm_b32 v85, v51, v50, s45
v_accvgpr_write_b32 a225, v85
v_perm_b32 v86, v53, v52, s45
v_accvgpr_write_b32 a226, v86
v_perm_b32 v87, v55, v54, s45
v_accvgpr_write_b32 a227, v87
v_perm_b32 v80, v57, v56, s44
v_accvgpr_write_b32 a164, v80
v_perm_b32 v81, v59, v58, s44
v_accvgpr_write_b32 a165, v81
v_perm_b32 v82, v61, v60, s44
v_accvgpr_write_b32 a166, v82
v_perm_b32 v83, v63, v62, s44
v_accvgpr_write_b32 a167, v83
v_perm_b32 v84, v57, v56, s45
v_accvgpr_write_b32 a228, v84
v_perm_b32 v85, v59, v58, s45
v_accvgpr_write_b32 a229, v85
v_perm_b32 v86, v61, v60, s45
v_accvgpr_write_b32 a230, v86
v_perm_b32 v87, v63, v62, s45
v_accvgpr_write_b32 a231, v87
s_mov_b32 s60, 1100800
buffer_load_dword v48, v16, s[12:15], s60 offen
s_mov_b32 s60, 1106304
buffer_load_dword v49, v16, s[12:15], s60 offen
s_mov_b32 s60, 1111808
buffer_load_dword v50, v16, s[12:15], s60 offen
s_mov_b32 s60, 1117312
buffer_load_dword v51, v16, s[12:15], s60 offen
s_mov_b32 s60, 1103552
buffer_load_dword v52, v16, s[12:15], s60 offen
s_mov_b32 s60, 1109056
buffer_load_dword v53, v16, s[12:15], s60 offen
s_mov_b32 s60, 1114560
buffer_load_dword v54, v16, s[12:15], s60 offen
s_mov_b32 s60, 1120064
buffer_load_dword v55, v16, s[12:15], s60 offen
s_mov_b32 s60, 1122816
buffer_load_dword v56, v16, s[12:15], s60 offen
s_mov_b32 s60, 1128320
buffer_load_dword v57, v16, s[12:15], s60 offen
s_mov_b32 s60, 1133824
buffer_load_dword v58, v16, s[12:15], s60 offen
s_mov_b32 s60, 1139328
buffer_load_dword v59, v16, s[12:15], s60 offen
s_mov_b32 s60, 1125568
buffer_load_dword v60, v16, s[12:15], s60 offen
s_mov_b32 s60, 1131072
buffer_load_dword v61, v16, s[12:15], s60 offen
s_mov_b32 s60, 1136576
buffer_load_dword v62, v16, s[12:15], s60 offen
s_mov_b32 s60, 1142080
buffer_load_dword v63, v16, s[12:15], s60 offen
s_waitcnt vmcnt(32)
v_perm_b32 v80, v65, v64, s44
v_accvgpr_write_b32 a168, v80
v_perm_b32 v81, v67, v66, s44
v_accvgpr_write_b32 a169, v81
v_perm_b32 v82, v69, v68, s44
v_accvgpr_write_b32 a170, v82
v_perm_b32 v83, v71, v70, s44
v_accvgpr_write_b32 a171, v83
v_perm_b32 v84, v65, v64, s45
v_accvgpr_write_b32 a232, v84
v_perm_b32 v85, v67, v66, s45
v_accvgpr_write_b32 a233, v85
v_perm_b32 v86, v69, v68, s45
v_accvgpr_write_b32 a234, v86
v_perm_b32 v87, v71, v70, s45
v_accvgpr_write_b32 a235, v87
v_perm_b32 v80, v73, v72, s44
v_accvgpr_write_b32 a172, v80
v_perm_b32 v81, v75, v74, s44
v_accvgpr_write_b32 a173, v81
v_perm_b32 v82, v77, v76, s44
v_accvgpr_write_b32 a174, v82
v_perm_b32 v83, v79, v78, s44
v_accvgpr_write_b32 a175, v83
v_perm_b32 v84, v73, v72, s45
v_accvgpr_write_b32 a236, v84
v_perm_b32 v85, v75, v74, s45
v_accvgpr_write_b32 a237, v85
v_perm_b32 v86, v77, v76, s45
v_accvgpr_write_b32 a238, v86
v_perm_b32 v87, v79, v78, s45
v_accvgpr_write_b32 a239, v87
s_waitcnt vmcnt(16)
v_perm_b32 v80, v33, v32, s44
v_accvgpr_write_b32 a176, v80
v_perm_b32 v81, v35, v34, s44
v_accvgpr_write_b32 a177, v81
v_perm_b32 v82, v37, v36, s44
v_accvgpr_write_b32 a178, v82
v_perm_b32 v83, v39, v38, s44
v_accvgpr_write_b32 a179, v83
v_perm_b32 v84, v33, v32, s45
v_accvgpr_write_b32 a240, v84
v_perm_b32 v85, v35, v34, s45
v_accvgpr_write_b32 a241, v85
v_perm_b32 v86, v37, v36, s45
v_accvgpr_write_b32 a242, v86
v_perm_b32 v87, v39, v38, s45
v_accvgpr_write_b32 a243, v87
v_perm_b32 v80, v41, v40, s44
v_accvgpr_write_b32 a180, v80
v_perm_b32 v81, v43, v42, s44
v_accvgpr_write_b32 a181, v81
v_perm_b32 v82, v45, v44, s44
v_accvgpr_write_b32 a182, v82
v_perm_b32 v83, v47, v46, s44
v_accvgpr_write_b32 a183, v83
v_perm_b32 v84, v41, v40, s45
v_accvgpr_write_b32 a244, v84
v_perm_b32 v85, v43, v42, s45
v_accvgpr_write_b32 a245, v85
v_perm_b32 v86, v45, v44, s45
v_accvgpr_write_b32 a246, v86
v_perm_b32 v87, v47, v46, s45
v_accvgpr_write_b32 a247, v87
s_waitcnt vmcnt(0)
v_perm_b32 v80, v49, v48, s44
v_accvgpr_write_b32 a184, v80
v_perm_b32 v81, v51, v50, s44
v_accvgpr_write_b32 a185, v81
v_perm_b32 v82, v53, v52, s44
v_accvgpr_write_b32 a186, v82
v_perm_b32 v83, v55, v54, s44
v_accvgpr_write_b32 a187, v83
v_perm_b32 v84, v49, v48, s45
v_accvgpr_write_b32 a248, v84
v_perm_b32 v85, v51, v50, s45
v_accvgpr_write_b32 a249, v85
v_perm_b32 v86, v53, v52, s45
v_accvgpr_write_b32 a250, v86
v_perm_b32 v87, v55, v54, s45
v_accvgpr_write_b32 a251, v87
v_perm_b32 v80, v57, v56, s44
v_accvgpr_write_b32 a188, v80
v_perm_b32 v81, v59, v58, s44
v_accvgpr_write_b32 a189, v81
v_perm_b32 v82, v61, v60, s44
v_accvgpr_write_b32 a190, v82
v_perm_b32 v83, v63, v62, s44
v_accvgpr_write_b32 a191, v83
v_perm_b32 v84, v57, v56, s45
v_accvgpr_write_b32 a252, v84
v_perm_b32 v85, v59, v58, s45
v_accvgpr_write_b32 a253, v85
v_perm_b32 v86, v61, v60, s45
v_accvgpr_write_b32 a254, v86
v_perm_b32 v87, v63, v62, s45
v_accvgpr_write_b32 a255, v87
s_lshl_b32 s60, s67, 6
v_add_u32 v16, s60, v9
buffer_load_dword v32, v16, s[12:15], 0 offen offset:0
s_mov_b32 s60, 5504
buffer_load_dword v33, v16, s[12:15], s60 offen
s_mov_b32 s60, 11008
buffer_load_dword v34, v16, s[12:15], s60 offen
s_mov_b32 s60, 16512
buffer_load_dword v35, v16, s[12:15], s60 offen
buffer_load_dword v36, v16, s[12:15], 0 offen offset:2752
s_mov_b32 s60, 8256
buffer_load_dword v37, v16, s[12:15], s60 offen
s_mov_b32 s60, 13760
buffer_load_dword v38, v16, s[12:15], s60 offen
s_mov_b32 s60, 19264
buffer_load_dword v39, v16, s[12:15], s60 offen
s_mov_b32 s60, 22016
buffer_load_dword v40, v16, s[12:15], s60 offen
s_mov_b32 s60, 27520
buffer_load_dword v41, v16, s[12:15], s60 offen
s_mov_b32 s60, 33024
buffer_load_dword v42, v16, s[12:15], s60 offen
s_mov_b32 s60, 38528
buffer_load_dword v43, v16, s[12:15], s60 offen
s_mov_b32 s60, 24768
buffer_load_dword v44, v16, s[12:15], s60 offen
s_mov_b32 s60, 30272
buffer_load_dword v45, v16, s[12:15], s60 offen
s_mov_b32 s60, 35776
buffer_load_dword v46, v16, s[12:15], s60 offen
s_mov_b32 s60, 41280
buffer_load_dword v47, v16, s[12:15], s60 offen
s_mov_b32 s60, 44032
buffer_load_dword v48, v16, s[12:15], s60 offen
s_mov_b32 s60, 49536
buffer_load_dword v49, v16, s[12:15], s60 offen
s_mov_b32 s60, 55040
buffer_load_dword v50, v16, s[12:15], s60 offen
s_mov_b32 s60, 60544
buffer_load_dword v51, v16, s[12:15], s60 offen
s_mov_b32 s60, 46784
buffer_load_dword v52, v16, s[12:15], s60 offen
s_mov_b32 s60, 52288
buffer_load_dword v53, v16, s[12:15], s60 offen
s_mov_b32 s60, 57792
buffer_load_dword v54, v16, s[12:15], s60 offen
s_mov_b32 s60, 63296
buffer_load_dword v55, v16, s[12:15], s60 offen
s_mov_b32 s60, 66048
buffer_load_dword v56, v16, s[12:15], s60 offen
s_mov_b32 s60, 71552
buffer_load_dword v57, v16, s[12:15], s60 offen
s_mov_b32 s60, 77056
buffer_load_dword v58, v16, s[12:15], s60 offen
s_mov_b32 s60, 82560
buffer_load_dword v59, v16, s[12:15], s60 offen
s_mov_b32 s60, 68800
buffer_load_dword v60, v16, s[12:15], s60 offen
s_mov_b32 s60, 74304
buffer_load_dword v61, v16, s[12:15], s60 offen
s_mov_b32 s60, 79808
buffer_load_dword v62, v16, s[12:15], s60 offen
s_mov_b32 s60, 85312
buffer_load_dword v63, v16, s[12:15], s60 offen
s_mov_b32 s60, 352256
buffer_load_dword v64, v16, s[12:15], s60 offen
s_mov_b32 s60, 357760
buffer_load_dword v65, v16, s[12:15], s60 offen
s_mov_b32 s60, 363264
buffer_load_dword v66, v16, s[12:15], s60 offen
s_mov_b32 s60, 368768
buffer_load_dword v67, v16, s[12:15], s60 offen
s_mov_b32 s60, 355008
buffer_load_dword v68, v16, s[12:15], s60 offen
s_mov_b32 s60, 360512
buffer_load_dword v69, v16, s[12:15], s60 offen
s_mov_b32 s60, 366016
buffer_load_dword v70, v16, s[12:15], s60 offen
s_mov_b32 s60, 371520
buffer_load_dword v71, v16, s[12:15], s60 offen
s_mov_b32 s60, 374272
buffer_load_dword v72, v16, s[12:15], s60 offen
s_mov_b32 s60, 379776
buffer_load_dword v73, v16, s[12:15], s60 offen
s_mov_b32 s60, 385280
buffer_load_dword v74, v16, s[12:15], s60 offen
s_mov_b32 s60, 390784
buffer_load_dword v75, v16, s[12:15], s60 offen
s_mov_b32 s60, 377024
buffer_load_dword v76, v16, s[12:15], s60 offen
s_mov_b32 s60, 382528
buffer_load_dword v77, v16, s[12:15], s60 offen
s_mov_b32 s60, 388032
buffer_load_dword v78, v16, s[12:15], s60 offen
s_mov_b32 s60, 393536
buffer_load_dword v79, v16, s[12:15], s60 offen
s_waitcnt vmcnt(32)
v_perm_b32 v128, v33, v32, s44
v_perm_b32 v129, v35, v34, s44
v_perm_b32 v130, v37, v36, s44
v_perm_b32 v131, v39, v38, s44
v_perm_b32 v192, v33, v32, s45
v_perm_b32 v193, v35, v34, s45
v_perm_b32 v194, v37, v36, s45
v_perm_b32 v195, v39, v38, s45
v_perm_b32 v132, v41, v40, s44
v_perm_b32 v133, v43, v42, s44
v_perm_b32 v134, v45, v44, s44
v_perm_b32 v135, v47, v46, s44
v_perm_b32 v196, v41, v40, s45
v_perm_b32 v197, v43, v42, s45
v_perm_b32 v198, v45, v44, s45
v_perm_b32 v199, v47, v46, s45
s_mov_b32 s60, 396288
buffer_load_dword v32, v16, s[12:15], s60 offen
s_mov_b32 s60, 401792
buffer_load_dword v33, v16, s[12:15], s60 offen
s_mov_b32 s60, 407296
buffer_load_dword v34, v16, s[12:15], s60 offen
s_mov_b32 s60, 412800
buffer_load_dword v35, v16, s[12:15], s60 offen
s_mov_b32 s60, 399040
buffer_load_dword v36, v16, s[12:15], s60 offen
s_mov_b32 s60, 404544
buffer_load_dword v37, v16, s[12:15], s60 offen
s_mov_b32 s60, 410048
buffer_load_dword v38, v16, s[12:15], s60 offen
s_mov_b32 s60, 415552
buffer_load_dword v39, v16, s[12:15], s60 offen
s_mov_b32 s60, 418304
buffer_load_dword v40, v16, s[12:15], s60 offen
s_mov_b32 s60, 423808
buffer_load_dword v41, v16, s[12:15], s60 offen
s_mov_b32 s60, 429312
buffer_load_dword v42, v16, s[12:15], s60 offen
s_mov_b32 s60, 434816
buffer_load_dword v43, v16, s[12:15], s60 offen
s_mov_b32 s60, 421056
buffer_load_dword v44, v16, s[12:15], s60 offen
s_mov_b32 s60, 426560
buffer_load_dword v45, v16, s[12:15], s60 offen
s_mov_b32 s60, 432064
buffer_load_dword v46, v16, s[12:15], s60 offen
s_mov_b32 s60, 437568
buffer_load_dword v47, v16, s[12:15], s60 offen
s_waitcnt vmcnt(32)
v_perm_b32 v136, v49, v48, s44
v_perm_b32 v137, v51, v50, s44
v_perm_b32 v138, v53, v52, s44
v_perm_b32 v139, v55, v54, s44
v_perm_b32 v200, v49, v48, s45
v_perm_b32 v201, v51, v50, s45
v_perm_b32 v202, v53, v52, s45
v_perm_b32 v203, v55, v54, s45
v_perm_b32 v140, v57, v56, s44
v_perm_b32 v141, v59, v58, s44
v_perm_b32 v142, v61, v60, s44
v_perm_b32 v143, v63, v62, s44
v_perm_b32 v204, v57, v56, s45
v_perm_b32 v205, v59, v58, s45
v_perm_b32 v206, v61, v60, s45
v_perm_b32 v207, v63, v62, s45
s_mov_b32 s60, 704512
buffer_load_dword v48, v16, s[12:15], s60 offen
s_mov_b32 s60, 710016
buffer_load_dword v49, v16, s[12:15], s60 offen
s_mov_b32 s60, 715520
buffer_load_dword v50, v16, s[12:15], s60 offen
s_mov_b32 s60, 721024
buffer_load_dword v51, v16, s[12:15], s60 offen
s_mov_b32 s60, 707264
buffer_load_dword v52, v16, s[12:15], s60 offen
s_mov_b32 s60, 712768
buffer_load_dword v53, v16, s[12:15], s60 offen
s_mov_b32 s60, 718272
buffer_load_dword v54, v16, s[12:15], s60 offen
s_mov_b32 s60, 723776
buffer_load_dword v55, v16, s[12:15], s60 offen
s_mov_b32 s60, 726528
buffer_load_dword v56, v16, s[12:15], s60 offen
s_mov_b32 s60, 732032
buffer_load_dword v57, v16, s[12:15], s60 offen
s_mov_b32 s60, 737536
buffer_load_dword v58, v16, s[12:15], s60 offen
s_mov_b32 s60, 743040
buffer_load_dword v59, v16, s[12:15], s60 offen
s_mov_b32 s60, 729280
buffer_load_dword v60, v16, s[12:15], s60 offen
s_mov_b32 s60, 734784
buffer_load_dword v61, v16, s[12:15], s60 offen
s_mov_b32 s60, 740288
buffer_load_dword v62, v16, s[12:15], s60 offen
s_mov_b32 s60, 745792
buffer_load_dword v63, v16, s[12:15], s60 offen
s_waitcnt vmcnt(32)
v_perm_b32 v144, v65, v64, s44
v_perm_b32 v145, v67, v66, s44
v_perm_b32 v146, v69, v68, s44
v_perm_b32 v147, v71, v70, s44
v_perm_b32 v208, v65, v64, s45
v_perm_b32 v209, v67, v66, s45
v_perm_b32 v210, v69, v68, s45
v_perm_b32 v211, v71, v70, s45
v_perm_b32 v148, v73, v72, s44
v_perm_b32 v149, v75, v74, s44
v_perm_b32 v150, v77, v76, s44
v_perm_b32 v151, v79, v78, s44
v_perm_b32 v212, v73, v72, s45
v_perm_b32 v213, v75, v74, s45
v_perm_b32 v214, v77, v76, s45
v_perm_b32 v215, v79, v78, s45
s_mov_b32 s60, 748544
buffer_load_dword v64, v16, s[12:15], s60 offen
s_mov_b32 s60, 754048
buffer_load_dword v65, v16, s[12:15], s60 offen
s_mov_b32 s60, 759552
buffer_load_dword v66, v16, s[12:15], s60 offen
s_mov_b32 s60, 765056
buffer_load_dword v67, v16, s[12:15], s60 offen
s_mov_b32 s60, 751296
buffer_load_dword v68, v16, s[12:15], s60 offen
s_mov_b32 s60, 756800
buffer_load_dword v69, v16, s[12:15], s60 offen
s_mov_b32 s60, 762304
buffer_load_dword v70, v16, s[12:15], s60 offen
s_mov_b32 s60, 767808
buffer_load_dword v71, v16, s[12:15], s60 offen
s_mov_b32 s60, 770560
buffer_load_dword v72, v16, s[12:15], s60 offen
s_mov_b32 s60, 776064
buffer_load_dword v73, v16, s[12:15], s60 offen
s_mov_b32 s60, 781568
buffer_load_dword v74, v16, s[12:15], s60 offen
s_mov_b32 s60, 787072
buffer_load_dword v75, v16, s[12:15], s60 offen
s_mov_b32 s60, 773312
buffer_load_dword v76, v16, s[12:15], s60 offen
s_mov_b32 s60, 778816
buffer_load_dword v77, v16, s[12:15], s60 offen
s_mov_b32 s60, 784320
buffer_load_dword v78, v16, s[12:15], s60 offen
s_mov_b32 s60, 789824
buffer_load_dword v79, v16, s[12:15], s60 offen
s_waitcnt vmcnt(32)
v_perm_b32 v152, v33, v32, s44
v_perm_b32 v153, v35, v34, s44
v_perm_b32 v154, v37, v36, s44
v_perm_b32 v155, v39, v38, s44
v_perm_b32 v216, v33, v32, s45
v_perm_b32 v217, v35, v34, s45
v_perm_b32 v218, v37, v36, s45
v_perm_b32 v219, v39, v38, s45
v_perm_b32 v156, v41, v40, s44
v_perm_b32 v157, v43, v42, s44
v_perm_b32 v158, v45, v44, s44
v_perm_b32 v159, v47, v46, s44
v_perm_b32 v220, v41, v40, s45
v_perm_b32 v221, v43, v42, s45
v_perm_b32 v222, v45, v44, s45
v_perm_b32 v223, v47, v46, s45
s_mov_b32 s60, 1056768
buffer_load_dword v32, v16, s[12:15], s60 offen
s_mov_b32 s60, 1062272
buffer_load_dword v33, v16, s[12:15], s60 offen
s_mov_b32 s60, 1067776
buffer_load_dword v34, v16, s[12:15], s60 offen
s_mov_b32 s60, 1073280
buffer_load_dword v35, v16, s[12:15], s60 offen
s_mov_b32 s60, 1059520
buffer_load_dword v36, v16, s[12:15], s60 offen
s_mov_b32 s60, 1065024
buffer_load_dword v37, v16, s[12:15], s60 offen
s_mov_b32 s60, 1070528
buffer_load_dword v38, v16, s[12:15], s60 offen
s_mov_b32 s60, 1076032
buffer_load_dword v39, v16, s[12:15], s60 offen
s_mov_b32 s60, 1078784
buffer_load_dword v40, v16, s[12:15], s60 offen
s_mov_b32 s60, 1084288
buffer_load_dword v41, v16, s[12:15], s60 offen
s_mov_b32 s60, 1089792
buffer_load_dword v42, v16, s[12:15], s60 offen
s_mov_b32 s60, 1095296
buffer_load_dword v43, v16, s[12:15], s60 offen
s_mov_b32 s60, 1081536
buffer_load_dword v44, v16, s[12:15], s60 offen
s_mov_b32 s60, 1087040
buffer_load_dword v45, v16, s[12:15], s60 offen
s_mov_b32 s60, 1092544
buffer_load_dword v46, v16, s[12:15], s60 offen
s_mov_b32 s60, 1098048
buffer_load_dword v47, v16, s[12:15], s60 offen
s_waitcnt vmcnt(32)
v_perm_b32 v160, v49, v48, s44
v_perm_b32 v161, v51, v50, s44
v_perm_b32 v162, v53, v52, s44
v_perm_b32 v163, v55, v54, s44
v_perm_b32 v224, v49, v48, s45
v_perm_b32 v225, v51, v50, s45
v_perm_b32 v226, v53, v52, s45
v_perm_b32 v227, v55, v54, s45
v_perm_b32 v164, v57, v56, s44
v_perm_b32 v165, v59, v58, s44
v_perm_b32 v166, v61, v60, s44
v_perm_b32 v167, v63, v62, s44
v_perm_b32 v228, v57, v56, s45
v_perm_b32 v229, v59, v58, s45
v_perm_b32 v230, v61, v60, s45
v_perm_b32 v231, v63, v62, s45
s_mov_b32 s60, 1100800
buffer_load_dword v48, v16, s[12:15], s60 offen
s_mov_b32 s60, 1106304
buffer_load_dword v49, v16, s[12:15], s60 offen
s_mov_b32 s60, 1111808
buffer_load_dword v50, v16, s[12:15], s60 offen
s_mov_b32 s60, 1117312
buffer_load_dword v51, v16, s[12:15], s60 offen
s_mov_b32 s60, 1103552
buffer_load_dword v52, v16, s[12:15], s60 offen
s_mov_b32 s60, 1109056
buffer_load_dword v53, v16, s[12:15], s60 offen
s_mov_b32 s60, 1114560
buffer_load_dword v54, v16, s[12:15], s60 offen
s_mov_b32 s60, 1120064
buffer_load_dword v55, v16, s[12:15], s60 offen
s_mov_b32 s60, 1122816
buffer_load_dword v56, v16, s[12:15], s60 offen
s_mov_b32 s60, 1128320
buffer_load_dword v57, v16, s[12:15], s60 offen
s_mov_b32 s60, 1133824
buffer_load_dword v58, v16, s[12:15], s60 offen
s_mov_b32 s60, 1139328
buffer_load_dword v59, v16, s[12:15], s60 offen
s_mov_b32 s60, 1125568
buffer_load_dword v60, v16, s[12:15], s60 offen
s_mov_b32 s60, 1131072
buffer_load_dword v61, v16, s[12:15], s60 offen
s_mov_b32 s60, 1136576
buffer_load_dword v62, v16, s[12:15], s60 offen
s_mov_b32 s60, 1142080
buffer_load_dword v63, v16, s[12:15], s60 offen
s_waitcnt vmcnt(32)
v_perm_b32 v168, v65, v64, s44
v_perm_b32 v169, v67, v66, s44
v_perm_b32 v170, v69, v68, s44
v_perm_b32 v171, v71, v70, s44
v_perm_b32 v232, v65, v64, s45
v_perm_b32 v233, v67, v66, s45
v_perm_b32 v234, v69, v68, s45
v_perm_b32 v235, v71, v70, s45
v_perm_b32 v172, v73, v72, s44
v_perm_b32 v173, v75, v74, s44
v_perm_b32 v174, v77, v76, s44
v_perm_b32 v175, v79, v78, s44
v_perm_b32 v236, v73, v72, s45
v_perm_b32 v237, v75, v74, s45
v_perm_b32 v238, v77, v76, s45
v_perm_b32 v239, v79, v78, s45
s_waitcnt vmcnt(16)
v_perm_b32 v176, v33, v32, s44
v_perm_b32 v177, v35, v34, s44
v_perm_b32 v178, v37, v36, s44
v_perm_b32 v179, v39, v38, s44
v_perm_b32 v240, v33, v32, s45
v_perm_b32 v241, v35, v34, s45
v_perm_b32 v242, v37, v36, s45
v_perm_b32 v243, v39, v38, s45
v_perm_b32 v180, v41, v40, s44
v_perm_b32 v181, v43, v42, s44
v_perm_b32 v182, v45, v44, s44
v_perm_b32 v183, v47, v46, s44
v_perm_b32 v244, v41, v40, s45
v_perm_b32 v245, v43, v42, s45
v_perm_b32 v246, v45, v44, s45
v_perm_b32 v247, v47, v46, s45
s_waitcnt vmcnt(0)
v_perm_b32 v184, v49, v48, s44
v_perm_b32 v185, v51, v50, s44
v_perm_b32 v186, v53, v52, s44
v_perm_b32 v187, v55, v54, s44
v_perm_b32 v248, v49, v48, s45
v_perm_b32 v249, v51, v50, s45
v_perm_b32 v250, v53, v52, s45
v_perm_b32 v251, v55, v54, s45
v_perm_b32 v188, v57, v56, s44
v_perm_b32 v189, v59, v58, s44
v_perm_b32 v190, v61, v60, s44
v_perm_b32 v191, v63, v62, s44
v_perm_b32 v252, v57, v56, s45
v_perm_b32 v253, v59, v58, s45
v_perm_b32 v254, v61, v60, s45
v_perm_b32 v255, v63, v62, s45
v_mov_b32 v32, s71
v_mov_b32 v33, s71
v_mov_b32 v34, s71
v_mov_b32 v35, s71
s_nop 1
v_mfma_f32_16x16x32_bf16 v[64:67], a[0:3], v[32:35], 0
v_mfma_f32_16x16x32_bf16 v[68:71], a[64:67], v[32:35], 0
v_mfma_f32_16x16x32_bf16 v[72:75], a[128:131], v[32:35], 0
v_mfma_f32_16x16x32_bf16 v[76:79], a[192:195], v[32:35], 0
v_mfma_f32_16x16x32_bf16 v[80:83], v[128:131], v[32:35], 0
v_mfma_f32_16x16x32_bf16 v[84:87], v[192:195], v[32:35], 0
v_mfma_f32_16x16x32_bf16 v[64:67], a[4:7], v[32:35], v[64:67]
v_mfma_f32_16x16x32_bf16 v[68:71], a[68:71], v[32:35], v[68:71]
v_mfma_f32_16x16x32_bf16 v[72:75], a[132:135], v[32:35], v[72:75]
v_mfma_f32_16x16x32_bf16 v[76:79], a[196:199], v[32:35], v[76:79]
v_mfma_f32_16x16x32_bf16 v[80:83], v[132:135], v[32:35], v[80:83]
v_mfma_f32_16x16x32_bf16 v[84:87], v[196:199], v[32:35], v[84:87]
v_mfma_f32_16x16x32_bf16 v[64:67], a[8:11], v[32:35], v[64:67]
v_mfma_f32_16x16x32_bf16 v[68:71], a[72:75], v[32:35], v[68:71]
v_mfma_f32_16x16x32_bf16 v[72:75], a[136:139], v[32:35], v[72:75]
v_mfma_f32_16x16x32_bf16 v[76:79], a[200:203], v[32:35], v[76:79]
v_mfma_f32_16x16x32_bf16 v[80:83], v[136:139], v[32:35], v[80:83]
v_mfma_f32_16x16x32_bf16 v[84:87], v[200:203], v[32:35], v[84:87]
v_mfma_f32_16x16x32_bf16 v[64:67], a[12:15], v[32:35], v[64:67]
v_mfma_f32_16x16x32_bf16 v[68:71], a[76:79], v[32:35], v[68:71]
v_mfma_f32_16x16x32_bf16 v[72:75], a[140:143], v[32:35], v[72:75]
v_mfma_f32_16x16x32_bf16 v[76:79], a[204:207], v[32:35], v[76:79]
v_mfma_f32_16x16x32_bf16 v[80:83], v[140:143], v[32:35], v[80:83]
v_mfma_f32_16x16x32_bf16 v[84:87], v[204:207], v[32:35], v[84:87]
v_mfma_f32_16x16x32_bf16 v[64:67], a[16:19], v[32:35], v[64:67]
v_mfma_f32_16x16x32_bf16 v[68:71], a[80:83], v[32:35], v[68:71]
v_mfma_f32_16x16x32_bf16 v[72:75], a[144:147], v[32:35], v[72:75]
v_mfma_f32_16x16x32_bf16 v[76:79], a[208:211], v[32:35], v[76:79]
v_mfma_f32_16x16x32_bf16 v[80:83], v[144:147], v[32:35], v[80:83]
v_mfma_f32_16x16x32_bf16 v[84:87], v[208:211], v[32:35], v[84:87]
v_mfma_f32_16x16x32_bf16 v[64:67], a[20:23], v[32:35], v[64:67]
v_mfma_f32_16x16x32_bf16 v[68:71], a[84:87], v[32:35], v[68:71]
v_mfma_f32_16x16x32_bf16 v[72:75], a[148:151], v[32:35], v[72:75]
v_mfma_f32_16x16x32_bf16 v[76:79], a[212:215], v[32:35], v[76:79]
v_mfma_f32_16x16x32_bf16 v[80:83], v[148:151], v[32:35], v[80:83]
v_mfma_f32_16x16x32_bf16 v[84:87], v[212:215], v[32:35], v[84:87]
v_mfma_f32_16x16x32_bf16 v[64:67], a[24:27], v[32:35], v[64:67]
v_mfma_f32_16x16x32_bf16 v[68:71], a[88:91], v[32:35], v[68:71]
v_mfma_f32_16x16x32_bf16 v[72:75], a[152:155], v[32:35], v[72:75]
v_mfma_f32_16x16x32_bf16 v[76:79], a[216:219], v[32:35], v[76:79]
v_mfma_f32_16x16x32_bf16 v[80:83], v[152:155], v[32:35], v[80:83]
v_mfma_f32_16x16x32_bf16 v[84:87], v[216:219], v[32:35], v[84:87]
v_mfma_f32_16x16x32_bf16 v[64:67], a[28:31], v[32:35], v[64:67]
v_mfma_f32_16x16x32_bf16 v[68:71], a[92:95], v[32:35], v[68:71]
v_mfma_f32_16x16x32_bf16 v[72:75], a[156:159], v[32:35], v[72:75]
v_mfma_f32_16x16x32_bf16 v[76:79], a[220:223], v[32:35], v[76:79]
v_mfma_f32_16x16x32_bf16 v[80:83], v[156:159], v[32:35], v[80:83]
v_mfma_f32_16x16x32_bf16 v[84:87], v[220:223], v[32:35], v[84:87]
v_mfma_f32_16x16x32_bf16 v[64:67], a[32:35], v[32:35], v[64:67]
v_mfma_f32_16x16x32_bf16 v[68:71], a[96:99], v[32:35], v[68:71]
v_mfma_f32_16x16x32_bf16 v[72:75], a[160:163], v[32:35], v[72:75]
v_mfma_f32_16x16x32_bf16 v[76:79], a[224:227], v[32:35], v[76:79]
v_mfma_f32_16x16x32_bf16 v[80:83], v[160:163], v[32:35], v[80:83]
v_mfma_f32_16x16x32_bf16 v[84:87], v[224:227], v[32:35], v[84:87]
v_mfma_f32_16x16x32_bf16 v[64:67], a[36:39], v[32:35], v[64:67]
v_mfma_f32_16x16x32_bf16 v[68:71], a[100:103], v[32:35], v[68:71]
v_mfma_f32_16x16x32_bf16 v[72:75], a[164:167], v[32:35], v[72:75]
v_mfma_f32_16x16x32_bf16 v[76:79], a[228:231], v[32:35], v[76:79]
v_mfma_f32_16x16x32_bf16 v[80:83], v[164:167], v[32:35], v[80:83]
v_mfma_f32_16x16x32_bf16 v[84:87], v[228:231], v[32:35], v[84:87]
v_mfma_f32_16x16x32_bf16 v[64:67], a[40:43], v[32:35], v[64:67]
v_mfma_f32_16x16x32_bf16 v[68:71], a[104:107], v[32:35], v[68:71]
v_mfma_f32_16x16x32_bf16 v[72:75], a[168:171], v[32:35], v[72:75]
v_mfma_f32_16x16x32_bf16 v[76:79], a[232:235], v[32:35], v[76:79]
v_mfma_f32_16x16x32_bf16 v[80:83], v[168:171], v[32:35], v[80:83]
v_mfma_f32_16x16x32_bf16 v[84:87], v[232:235], v[32:35], v[84:87]
v_mfma_f32_16x16x32_bf16 v[64:67], a[44:47], v[32:35], v[64:67]
v_mfma_f32_16x16x32_bf16 v[68:71], a[108:111], v[32:35], v[68:71]
v_mfma_f32_16x16x32_bf16 v[72:75], a[172:175], v[32:35], v[72:75]
v_mfma_f32_16x16x32_bf16 v[76:79], a[236:239], v[32:35], v[76:79]
v_mfma_f32_16x16x32_bf16 v[80:83], v[172:175], v[32:35], v[80:83]
v_mfma_f32_16x16x32_bf16 v[84:87], v[236:239], v[32:35], v[84:87]
v_mfma_f32_16x16x32_bf16 v[64:67], a[48:51], v[32:35], v[64:67]
v_mfma_f32_16x16x32_bf16 v[68:71], a[112:115], v[32:35], v[68:71]
v_mfma_f32_16x16x32_bf16 v[72:75], a[176:179], v[32:35], v[72:75]
v_mfma_f32_16x16x32_bf16 v[76:79], a[240:243], v[32:35], v[76:79]
v_mfma_f32_16x16x32_bf16 v[80:83], v[176:179], v[32:35], v[80:83]
v_mfma_f32_16x16x32_bf16 v[84:87], v[240:243], v[32:35], v[84:87]
v_mfma_f32_16x16x32_bf16 v[64:67], a[52:55], v[32:35], v[64:67]
v_mfma_f32_16x16x32_bf16 v[68:71], a[116:119], v[32:35], v[68:71]
v_mfma_f32_16x16x32_bf16 v[72:75], a[180:183], v[32:35], v[72:75]
v_mfma_f32_16x16x32_bf16 v[76:79], a[244:247], v[32:35], v[76:79]
v_mfma_f32_16x16x32_bf16 v[80:83], v[180:183], v[32:35], v[80:83]
v_mfma_f32_16x16x32_bf16 v[84:87], v[244:247], v[32:35], v[84:87]
v_mfma_f32_16x16x32_bf16 v[64:67], a[56:59], v[32:35], v[64:67]
v_mfma_f32_16x16x32_bf16 v[68:71], a[120:123], v[32:35], v[68:71]
v_mfma_f32_16x16x32_bf16 v[72:75], a[184:187], v[32:35], v[72:75]
v_mfma_f32_16x16x32_bf16 v[76:79], a[248:251], v[32:35], v[76:79]
v_mfma_f32_16x16x32_bf16 v[80:83], v[184:187], v[32:35], v[80:83]
v_mfma_f32_16x16x32_bf16 v[84:87], v[248:251], v[32:35], v[84:87]
v_mfma_f32_16x16x32_bf16 v[64:67], a[60:63], v[32:35], v[64:67]
v_mfma_f32_16x16x32_bf16 v[68:71], a[124:127], v[32:35], v[68:71]
v_mfma_f32_16x16x32_bf16 v[72:75], a[188:191], v[32:35], v[72:75]
v_mfma_f32_16x16x32_bf16 v[76:79], a[252:255], v[32:35], v[76:79]
v_mfma_f32_16x16x32_bf16 v[80:83], v[188:191], v[32:35], v[80:83]
v_mfma_f32_16x16x32_bf16 v[84:87], v[252:255], v[32:35], v[84:87]
s_nop 2
ds_write_b128 v11, v[64:67] offset:0
ds_write_b128 v11, v[68:71] offset:1024
ds_write_b128 v11, v[72:75] offset:2048
ds_write_b128 v11, v[76:79] offset:3072
ds_write_b128 v11, v[80:83] offset:4096
ds_write_b128 v11, v[84:87] offset:5120
s_mov_b32 s12, s34
s_mov_b32 s13, s35
s_mov_b32 s14, 2752
s_mov_b32 s15, 0x00020000
v_lshlrev_b32 v16, 4, v15
s_lshl_b32 s60, s63, 6
buffer_load_dwordx4 v[32:35], v16, s[12:15], s60 offen
s_lshl_b32 s60, s66, 6
buffer_load_dwordx4 v[36:39], v16, s[12:15], s60 offen
s_lshl_b32 s60, s67, 6
buffer_load_dwordx4 v[40:43], v16, s[12:15], s60 offen
s_waitcnt vmcnt(0)
v_lshlrev_b32 v64, 16, v32
v_and_b32 v68, 0xffff0000, v32
v_lshlrev_b32 v65, 16, v33
v_and_b32 v69, 0xffff0000, v33
v_lshlrev_b32 v66, 16, v34
v_and_b32 v70, 0xffff0000, v34
v_lshlrev_b32 v67, 16, v35
v_and_b32 v71, 0xffff0000, v35
v_lshlrev_b32 v72, 16, v36
v_and_b32 v76, 0xffff0000, v36
v_lshlrev_b32 v73, 16, v37
v_and_b32 v77, 0xffff0000, v37
v_lshlrev_b32 v74, 16, v38
v_and_b32 v78, 0xffff0000, v38
v_lshlrev_b32 v75, 16, v39
v_and_b32 v79, 0xffff0000, v39
v_lshlrev_b32 v80, 16, v40
v_and_b32 v84, 0xffff0000, v40
v_lshlrev_b32 v81, 16, v41
v_and_b32 v85, 0xffff0000, v41
v_lshlrev_b32 v82, 16, v42
v_and_b32 v86, 0xffff0000, v42
v_lshlrev_b32 v83, 16, v43
v_and_b32 v87, 0xffff0000, v43
ds_write_b128 v11, v[64:67] offset:24576
ds_write_b128 v11, v[68:71] offset:25600
ds_write_b128 v11, v[72:75] offset:26624
ds_write_b128 v11, v[76:79] offset:27648
ds_write_b128 v11, v[80:83] offset:28672
ds_write_b128 v11, v[84:87] offset:29696
s_waitcnt lgkmcnt(0)
s_cmp_eq_u32 s57, 1
s_cbranch_scc1 L_F1_main
L_F0_main:
s_lshl_b32 s60, s59, 10
s_lshl_b32 s63, s63, 11
s_add_u32 s63, s63, 16777216
s_add_u32 s63, s63, s60
s_lshl_b32 s66, s66, 11
s_add_u32 s66, s66, 16777216
s_add_u32 s66, s66, s60
s_lshl_b32 s67, s67, 11
s_add_u32 s67, s67, 16777216
s_add_u32 s67, s67, s60
s_lshl_b32 s78, s47, 10
s_lshl_b32 s92, s47, 11
s_add_u32 s93, s60, 4194304
s_mov_b32 s77, 0x10000
s_mov_b32 s76, 0
s_mov_b32 s94, 0x55555555
s_lshl_b32 s94, s94, s59
s_mov_b32 s95, s94
s_lshl_b32 s96, s59, 12
s_add_u32 s96, s96, 13631488
s_lshl_b32 s60, s59, 6
v_add_u32 v8, s60, v8
s_lshl_b32 s61, s62, 2
s_add_u32 s69, s60, s61
s_add_u32 s69, s69, 16384
v_add_u32 v2, 0x10000, v1
v_lshlrev_b32 v3, 3, v0
ds_read_b128 v[88:91], v11 offset:0
ds_read_b128 v[92:95], v11 offset:1024
ds_read_b128 v[96:99], v11 offset:2048
ds_read_b128 v[100:103], v11 offset:3072
ds_read_b128 v[104:107], v11 offset:4096
ds_read_b128 v[108:111], v11 offset:5120
s_mov_b64 exec, 1
v_mov_b32 v33, 136
s_nop 1
Lgb_249:
buffer_load_dword v32, v33, s[8:11], 0 offen sc1
s_memtime s[60:61]
s_waitcnt lgkmcnt(0)
s_sub_u32 s60, s60, s46
s_mov_b32 s61, 2
s_cmp_gt_u32 s60, 67108864
s_cbranch_scc1 L_abortF
s_waitcnt vmcnt(0)
v_readfirstlane_b32 s60, v32
s_and_b32 s61, s60, 0xffff
s_cmp_lt_u32 s61, 256
s_cbranch_scc1 Lgb_249
s_mov_b64 exec, -1
s_cmp_lt_u32 s60, 0x10000
s_cselect_b32 s75, 1, 0
s_mov_b32 s68, 0
s_and_b32 s60, s56, 7
s_lshl_b32 s60, s60, 2
s_add_u32 s60, s60, s47
s_lshl_b32 s61, s60, 8
s_add_u32 s61, s61, 13631488
s_lshl_b32 s60, s60, 10
s_add_u32 s60, s60, 4194304
v_and_b32 v59, 7, v0
v_lshlrev_b32 v59, 7, v59
v_and_b32 v56, 1, v0
v_lshlrev_b32 v56, 7, v56
v_add_u32 v56, s61, v56
v_mov_b32 v57, 8192
v_add_u32 v60, s60, v59
v_mov_b32 v61, 32768
v_cmp_gt_u32 vcc, 32, v0
s_nop 1
v_cndmask_b32 v56, v56, v60, vcc
v_cndmask_b32 v57, v57, v61, vcc
v_mov_b32 v61, 90112
v_cmp_gt_u32 vcc, 24, v0
s_nop 1
v_cndmask_b32 v57, v57, v61, vcc
v_add_u32 v60, s67, v59
v_cmp_gt_u32 vcc, 24, v0
s_nop 1
v_cndmask_b32 v56, v56, v60, vcc
v_add_u32 v60, s66, v59
v_cmp_gt_u32 vcc, 16, v0
s_nop 1
v_cndmask_b32 v56, v56, v60, vcc
v_add_u32 v60, s63, v59
v_cmp_gt_u32 vcc, 8, v0
s_nop 1
v_cndmask_b32 v56, v56, v60, vcc
s_cmp_eq_u32 s75, 0
s_cbranch_scc1 Lslow_250
buffer_load_dword v58, v56, s[4:7], 0 offen
s_branch Ljoin_251
Lslow_250:
buffer_load_dword v58, v56, s[4:7], 0 offen sc1
Ljoin_251:
v_add_u32 v56, v56, v57
s_cmp_eq_u32 s75, 0
s_cbranch_scc1 Lslow_252
buffer_load_dword v58, v56, s[4:7], 0 offen
s_branch Ljoin_253
Lslow_252:
buffer_load_dword v58, v56, s[4:7], 0 offen sc1
Ljoin_253:
v_add_u32 v56, v56, v57
s_cmp_eq_u32 s75, 0
s_cbranch_scc1 Lslow_254
buffer_load_dword v58, v56, s[4:7], 0 offen
s_branch Ljoin_255
Lslow_254:
buffer_load_dword v58, v56, s[4:7], 0 offen sc1
Ljoin_255:
v_add_u32 v56, v56, v57
s_nop 1
L_F0_loop:
s_lshl_b32 s64, s68, 8
s_add_u32 s64, s64, 196608
s_mov_b64 exec, s[94:95]
s_branch Lpoll_257
Lpoll_256:
s_sleep 1
Lpoll_257:
buffer_load_dword v46, v6, s[4:7], s64 offen sc1
s_memtime s[60:61]
s_waitcnt lgkmcnt(0)
s_sub_u32 s60, s60, s46
s_mov_b32 s61, 40
s_cmp_gt_u32 s60, 67108864
s_cbranch_scc1 L_abortF
s_waitcnt vmcnt(0)
s_cmp_eq_u32 s76, 0
s_cbranch_scc1 Lnp_258
s_mov_b64 s[98:99], exec
s_mov_b64 exec, 1
s_cmp_eq_u32 s75, 0
s_cbranch_scc1 Lslow_259
buffer_store_dword v4, off, s[4:7], s76
s_branch Ljoin_260
Lslow_259:
buffer_store_dword v4, off, s[4:7], s76 sc1
Ljoin_260:
s_mov_b64 exec, s[98:99]
s_mov_b32 s76, 0
Lnp_258:
v_cmp_eq_u32 vcc, 0, v46
s_cbranch_vccnz Lpoll_256
s_mov_b64 exec, -1
s_lshl_b32 s64, s68, 15
s_add_u32 s64, s64, s93
s_lshl_b32 s65, s68, 13
s_add_u32 s65, s65, s96
s_add_u32 s100, s77, s78
s_add_u32 m0, s100, 0
s_lshl1_add_u32 s100, s78, s64
s_add_u32 s100, s100, 0
buffer_load_dwordx4 v1, s[4:7], s100 offen sc1 lds
s_add_u32 s100, s77, s78
s_add_u32 m0, s100, 4096
s_lshl1_add_u32 s100, s78, s64
s_add_u32 s100, s100, 8192
buffer_load_dwordx4 v1, s[4:7], s100 offen sc1 lds
s_add_u32 s100, s77, s92
s_add_u32 m0, s100, 8192
s_lshl1_add_u32 s100, s92, s64
s_add_u32 s100, s100, 16384
buffer_load_dwordx4 v1, s[4:7], s100 offen sc1 lds
s_add_u32 m0, m0, 1024
s_add_u32 s100, s100, 2048
buffer_load_dwordx4 v1, s[4:7], s100 offen sc1 lds
buffer_load_dwordx4 v[16:19], v1, s[4:7], s65 offen offset:0 sc1
buffer_load_dwordx4 v[20:23], v1, s[4:7], s65 offen offset:1024 sc1
buffer_load_dwordx4 v[24:27], v1, s[4:7], s65 offen offset:2048 sc1
buffer_load_dwordx4 v[28:31], v1, s[4:7], s65 offen offset:3072 sc1
s_cmp_eq_u32 s75, 0
s_cbranch_scc1 Lslow_261
buffer_load_dword v58, v56, s[4:7], 0 offen
s_branch Ljoin_262
Lslow_261:
buffer_load_dword v58, v56, s[4:7], 0 offen sc1
Ljoin_262:
s_cmp_ge_u32 s68, 60
s_cselect_b32 s60, 0, -1
v_and_b32 v59, s60, v57
v_add_u32 v56, v56, v59
s_waitcnt vmcnt(8)
s_barrier
ds_read_b128 v[32:35], v2 offset:0
ds_read_b128 v[36:39], v2 offset:1024
ds_read_b128 v[40:43], v2 offset:2048
ds_read_b128 v[44:47], v2 offset:3072
s_waitcnt lgkmcnt(3)
v_mfma_f32_16x16x32_bf16 v[64:67], a[0:3], v[32:35], 0
v_mfma_f32_16x16x32_bf16 v[68:71], a[64:67], v[32:35], 0
v_mfma_f32_16x16x32_bf16 v[72:75], a[128:131], v[32:35], 0
v_mfma_f32_16x16x32_bf16 v[76:79], a[192:195], v[32:35], 0
v_mfma_f32_16x16x32_bf16 v[80:83], v[128:131], v[32:35], 0
v_mfma_f32_16x16x32_bf16 v[84:87], v[192:195], v[32:35], 0
s_waitcnt vmcnt(7)
s_barrier
ds_read_b128 v[32:35], v2 offset:4096
s_waitcnt lgkmcnt(3)
v_mfma_f32_16x16x32_bf16 v[64:67], a[4:7], v[36:39], v[64:67]
v_mfma_f32_16x16x32_bf16 v[68:71], a[68:71], v[36:39], v[68:71]
v_mfma_f32_16x16x32_bf16 v[72:75], a[132:135], v[36:39], v[72:75]
v_mfma_f32_16x16x32_bf16 v[76:79], a[196:199], v[36:39], v[76:79]
v_mfma_f32_16x16x32_bf16 v[80:83], v[132:135], v[36:39], v[80:83]
v_mfma_f32_16x16x32_bf16 v[84:87], v[196:199], v[36:39], v[84:87]
ds_read_b128 v[36:39], v2 offset:5120
s_waitcnt lgkmcnt(3)
v_mfma_f32_16x16x32_bf16 v[64:67], a[8:11], v[40:43], v[64:67]
v_mfma_f32_16x16x32_bf16 v[68:71], a[72:75], v[40:43], v[68:71]
v_mfma_f32_16x16x32_bf16 v[72:75], a[136:139], v[40:43], v[72:75]
v_mfma_f32_16x16x32_bf16 v[76:79], a[200:203], v[40:43], v[76:79]
v_mfma_f32_16x16x32_bf16 v[80:83], v[136:139], v[40:43], v[80:83]
v_mfma_f32_16x16x32_bf16 v[84:87], v[200:203], v[40:43], v[84:87]
ds_read_b128 v[40:43], v2 offset:6144
s_waitcnt lgkmcnt(3)
v_mfma_f32_16x16x32_bf16 v[64:67], a[12:15], v[44:47], v[64:67]
v_mfma_f32_16x16x32_bf16 v[68:71], a[76:79], v[44:47], v[68:71]
v_mfma_f32_16x16x32_bf16 v[72:75], a[140:143], v[44:47], v[72:75]
v_mfma_f32_16x16x32_bf16 v[76:79], a[204:207], v[44:47], v[76:79]
v_mfma_f32_16x16x32_bf16 v[80:83], v[140:143], v[44:47], v[80:83]
v_mfma_f32_16x16x32_bf16 v[84:87], v[204:207], v[44:47], v[84:87]
ds_read_b128 v[44:47], v2 offset:7168
s_waitcnt lgkmcnt(3)
v_mfma_f32_16x16x32_bf16 v[64:67], a[16:19], v[32:35], v[64:67]
v_mfma_f32_16x16x32_bf16 v[68:71], a[80:83], v[32:35], v[68:71]
v_mfma_f32_16x16x32_bf16 v[72:75], a[144:147], v[32:35], v[72:75]
v_mfma_f32_16x16x32_bf16 v[76:79], a[208:211], v[32:35], v[76:79]
v_mfma_f32_16x16x32_bf16 v[80:83], v[144:147], v[32:35], v[80:83]
v_mfma_f32_16x16x32_bf16 v[84:87], v[208:211], v[32:35], v[84:87]
s_waitcnt vmcnt(5)
s_barrier
ds_read_b128 v[32:35], v2 offset:8192
s_waitcnt lgkmcnt(3)
v_mfma_f32_16x16x32_bf16 v[64:67], a[20:23], v[36:39], v[64:67]
v_mfma_f32_16x16x32_bf16 v[68:71], a[84:87], v[36:39], v[68:71]
v_mfma_f32_16x16x32_bf16 v[72:75], a[148:151], v[36:39], v[72:75]
v_mfma_f32_16x16x32_bf16 v[76:79], a[212:215], v[36:39], v[76:79]
v_mfma_f32_16x16x32_bf16 v[80:83], v[148:151], v[36:39], v[80:83]
v_mfma_f32_16x16x32_bf16 v[84:87], v[212:215], v[36:39], v[84:87]
ds_read_b128 v[36:39], v2 offset:9216
s_waitcnt lgkmcnt(3)
v_mfma_f32_16x16x32_bf16 v[64:67], a[24:27], v[40:43], v[64:67]
s_waitcnt vmcnt(1)
v_add_f32 v16, v16, v17
v_mfma_f32_16x16x32_bf16 v[68:71], a[88:91], v[40:43], v[68:71]
v_add_f32 v18, v18, v19
v_mfma_f32_16x16x32_bf16 v[72:75], a[152:155], v[40:43], v[72:75]
v_add_f32 v20, v20, v21
v_mfma_f32_16x16x32_bf16 v[76:79], a[216:219], v[40:43], v[76:79]
v_add_f32 v22, v22, v23
v_mfma_f32_16x16x32_bf16 v[80:83], v[152:155], v[40:43], v[80:83]
v_add_f32 v24, v24, v25
v_mfma_f32_16x16x32_bf16 v[84:87], v[216:219], v[40:43], v[84:87]
v_add_f32 v26, v26, v27
ds_read_b128 v[40:43], v2 offset:10240
s_waitcnt lgkmcnt(3)
v_mfma_f32_16x16x32_bf16 v[64:67], a[28:31], v[44:47], v[64:67]
v_add_f32 v28, v28, v29
v_mfma_f32_16x16x32_bf16 v[68:71], a[92:95], v[44:47], v[68:71]
v_add_f32 v30, v30, v31
v_mfma_f32_16x16x32_bf16 v[72:75], a[156:159], v[44:47], v[72:75]
v_add_f32 v16, v16, v18
v_mfma_f32_16x16x32_bf16 v[76:79], a[220:223], v[44:47], v[76:79]
v_add_f32 v20, v20, v22
v_mfma_f32_16x16x32_bf16 v[80:83], v[156:159], v[44:47], v[80:83]
v_add_f32 v24, v24, v26
v_mfma_f32_16x16x32_bf16 v[84:87], v[220:223], v[44:47], v[84:87]
v_add_f32 v28, v28, v30
ds_read_b128 v[44:47], v2 offset:11264
s_waitcnt lgkmcnt(3)
v_mfma_f32_16x16x32_bf16 v[64:67], a[32:35], v[32:35], v[64:67]
v_add_f32 v16, v16, v20
v_mfma_f32_16x16x32_bf16 v[68:71], a[96:99], v[32:35], v[68:71]
v_add_f32 v24, v24, v28
v_mfma_f32_16x16x32_bf16 v[72:75], a[160:163], v[32:35], v[72:75]
v_add_f32 v112, v16, v24
v_mfma_f32_16x16x32_bf16 v[76:79], a[224:227], v[32:35], v[76:79]
v_mfma_f32_16x16x32_bf16 v[80:83], v[160:163], v[32:35], v[80:83]
v_mfma_f32_16x16x32_bf16 v[84:87], v[224:227], v[32:35], v[84:87]
ds_read_b128 v[32:35], v2 offset:12288
s_waitcnt lgkmcnt(3)
v_mfma_f32_16x16x32_bf16 v[64:67], a[36:39], v[36:39], v[64:67]
v_mfma_f32_16x16x32_bf16 v[68:71], a[100:103], v[36:39], v[68:71]
v_mfma_f32_16x16x32_bf16 v[72:75], a[164:167], v[36:39], v[72:75]
v_mfma_f32_16x16x32_bf16 v[76:79], a[228:231], v[36:39], v[76:79]
v_mfma_f32_16x16x32_bf16 v[80:83], v[164:167], v[36:39], v[80:83]
v_mfma_f32_16x16x32_bf16 v[84:87], v[228:231], v[36:39], v[84:87]
ds_read_b128 v[36:39], v2 offset:13312
s_waitcnt lgkmcnt(3)
v_mfma_f32_16x16x32_bf16 v[64:67], a[40:43], v[40:43], v[64:67]
v_mov_b32 v113, v112
s_nop 1
v_permlane16_swap_b32 v112, v113
v_add_f32 v112, v112, v113
v_mfma_f32_16x16x32_bf16 v[68:71], a[104:107], v[40:43], v[68:71]
v_mfma_f32_16x16x32_bf16 v[72:75], a[168:171], v[40:43], v[72:75]
v_mfma_f32_16x16x32_bf16 v[76:79], a[232:235], v[40:43], v[76:79]
v_mfma_f32_16x16x32_bf16 v[80:83], v[168:171], v[40:43], v[80:83]
v_mfma_f32_16x16x32_bf16 v[84:87], v[232:235], v[40:43], v[84:87]
ds_read_b128 v[40:43], v2 offset:14336
s_waitcnt lgkmcnt(3)
v_mfma_f32_16x16x32_bf16 v[64:67], a[44:47], v[44:47], v[64:67]
v_mfma_f32_16x16x32_bf16 v[68:71], a[108:111], v[44:47], v[68:71]
v_mfma_f32_16x16x32_bf16 v[72:75], a[172:175], v[44:47], v[72:75]
v_mfma_f32_16x16x32_bf16 v[76:79], a[236:239], v[44:47], v[76:79]
v_mfma_f32_16x16x32_bf16 v[80:83], v[172:175], v[44:47], v[80:83]
v_mfma_f32_16x16x32_bf16 v[84:87], v[236:239], v[44:47], v[84:87]
ds_read_b128 v[44:47], v2 offset:15360
s_waitcnt lgkmcnt(3)
v_mfma_f32_16x16x32_bf16 v[64:67], a[48:51], v[32:35], v[64:67]
v_mov_b32 v113, v112
s_nop 1
v_permlane32_swap_b32 v112, v113
v_mul_f32 v112, 0x3b000000, v112
v_mul_f32 v113, 0x3b000000, v113
v_fma_f32 v113, -v112, v112, v113
v_max_f32 v113, 0, v113
v_add_f32 v113, 0x3727c5ac, v113
v_rsq_f32 v113, v113
s_nop 0
v_mul_f32 v112, -v112, v113
ds_write_b32 v10, v113
ds_write_b32 v10, v112 offset:128
v_mfma_f32_16x16x32_bf16 v[68:71], a[112:115], v[32:35], v[68:71]
v_mfma_f32_16x16x32_bf16 v[72:75], a[176:179], v[32:35], v[72:75]
v_mfma_f32_16x16x32_bf16 v[76:79], a[240:243], v[32:35], v[76:79]
v_mfma_f32_16x16x32_bf16 v[80:83], v[176:179], v[32:35], v[80:83]
v_mfma_f32_16x16x32_bf16 v[84:87], v[240:243], v[32:35], v[84:87]
s_waitcnt lgkmcnt(4)
v_mfma_f32_16x16x32_bf16 v[64:67], a[52:55], v[36:39], v[64:67]
ds_read_b128 v[16:19], v11 offset:24576
v_mfma_f32_16x16x32_bf16 v[68:71], a[116:119], v[36:39], v[68:71]
ds_read_b128 v[20:23], v11 offset:25600
v_mfma_f32_16x16x32_bf16 v[72:75], a[180:183], v[36:39], v[72:75]
ds_read_b128 v[24:27], v11 offset:26624
v_mfma_f32_16x16x32_bf16 v[76:79], a[244:247], v[36:39], v[76:79]
ds_read_b128 v[28:31], v11 offset:27648
v_mfma_f32_16x16x32_bf16 v[80:83], v[180:183], v[36:39], v[80:83]
ds_read_b128 v[48:51], v11 offset:28672
v_mfma_f32_16x16x32_bf16 v[84:87], v[244:247], v[36:39], v[84:87]
ds_read_b128 v[52:55], v11 offset:29696
s_waitcnt lgkmcnt(9)
v_mfma_f32_16x16x32_bf16 v[64:67], a[56:59], v[40:43], v[64:67]
v_mfma_f32_16x16x32_bf16 v[68:71], a[120:123], v[40:43], v[68:71]
v_mfma_f32_16x16x32_bf16 v[72:75], a[184:187], v[40:43], v[72:75]
v_mfma_f32_16x16x32_bf16 v[76:79], a[248:251], v[40:43], v[76:79]
v_mfma_f32_16x16x32_bf16 v[80:83], v[184:187], v[40:43], v[80:83]
v_mfma_f32_16x16x32_bf16 v[84:87], v[248:251], v[40:43], v[84:87]
s_waitcnt lgkmcnt(8)
v_mfma_f32_16x16x32_bf16 v[64:67], a[60:63], v[44:47], v[64:67]
ds_read_b32 v116, v8
ds_read_b32 v117, v8 offset:128
v_mfma_f32_16x16x32_bf16 v[68:71], a[124:127], v[44:47], v[68:71]
v_mfma_f32_16x16x32_bf16 v[72:75], a[188:191], v[44:47], v[72:75]
v_mfma_f32_16x16x32_bf16 v[76:79], a[252:255], v[44:47], v[76:79]
v_mfma_f32_16x16x32_bf16 v[80:83], v[188:191], v[44:47], v[80:83]
v_mfma_f32_16x16x32_bf16 v[84:87], v[252:255], v[44:47], v[84:87]
v_xor_b32 v2, 0x8000, v2
s_xor_b32 s77, s77, 0x8000
s_mul_i32 s74, s68, 90112
s_waitcnt lgkmcnt(0)
v_pk_fma_f32 v[120:121], v[88:89], v[116:117], v[16:17] op_sel:[0,1,0] op_sel_hi:[1,1,1]
v_pk_fma_f32 v[64:65], v[64:65], v[116:117], v[120:121] op_sel:[0,0,0] op_sel_hi:[1,0,1]
v_pk_fma_f32 v[122:123], v[90:91], v[116:117], v[18:19] op_sel:[0,1,0] op_sel_hi:[1,1,1]
v_pk_fma_f32 v[66:67], v[66:67], v[116:117], v[122:123] op_sel:[0,0,0] op_sel_hi:[1,0,1]
v_pk_fma_f32 v[124:125], v[92:93], v[116:117], v[20:21] op_sel:[0,1,0] op_sel_hi:[1,1,1]
v_pk_fma_f32 v[68:69], v[68:69], v[116:117], v[124:125] op_sel:[0,0,0] op_sel_hi:[1,0,1]
v_pk_fma_f32 v[126:127], v[94:95], v[116:117], v[22:23] op_sel:[0,1,0] op_sel_hi:[1,1,1]
v_pk_fma_f32 v[70:71], v[70:71], v[116:117], v[126:127] op_sel:[0,0,0] op_sel_hi:[1,0,1]
v_pk_mul_f32 v[120:121], v[64:65], v[64:65]
v_pk_mul_f32 v[122:123], v[66:67], v[66:67]
v_pk_mul_f32 v[124:125], v[68:69], v[68:69]
v_pk_mul_f32 v[126:127], v[70:71], v[70:71]
v_pk_fma_f32 v[120:121], v[120:121], s[72:73], v[12:13]
v_pk_fma_f32 v[122:123], v[122:123], s[72:73], v[12:13]
v_pk_fma_f32 v[124:125], v[124:125], s[72:73], v[12:13]
v_pk_fma_f32 v[126:127], v[126:127], s[72:73], v[12:13]
v_pk_mul_f32 v[120:121], v[120:121], v[64:65]
v_pk_mul_f32 v[122:123], v[122:123], v[66:67]
v_pk_mul_f32 v[124:125], v[124:125], v[68:69]
v_pk_mul_f32 v[126:127], v[126:127], v[70:71]
v_exp_f32 v120, v120
v_exp_f32 v121, v121
v_exp_f32 v122, v122
v_exp_f32 v123, v123
v_exp_f32 v124, v124
v_exp_f32 v125, v125
v_exp_f32 v126, v126
v_exp_f32 v127, v127
v_pk_add_f32 v[120:121], v[120:121], 1.0 op_sel_hi:[1,0]
v_pk_add_f32 v[122:123], v[122:123], 1.0 op_sel_hi:[1,0]
v_pk_add_f32 v[124:125], v[124:125], 1.0 op_sel_hi:[1,0]
v_pk_add_f32 v[126:127], v[126:127], 1.0 op_sel_hi:[1,0]
v_rcp_f32 v120, v120
v_rcp_f32 v121, v121
v_rcp_f32 v122, v122
v_rcp_f32 v123, v123
v_rcp_f32 v124, v124
v_rcp_f32 v125, v125
v_rcp_f32 v126, v126
v_rcp_f32 v127, v127
v_pk_mul_f32 v[64:65], v[120:121], v[64:65]
v_pk_mul_f32 v[66:67], v[122:123], v[66:67]
v_pk_mul_f32 v[68:69], v[124:125], v[68:69]
v_pk_mul_f32 v[70:71], v[126:127], v[70:71]
v_cvt_pk_bf16_f32 v32, v64, v68
v_cvt_pk_bf16_f32 v33, v65, v69
v_cvt_pk_bf16_f32 v34, v66, v70
v_cvt_pk_bf16_f32 v35, v67, v71
s_add_u32 s60, s74, s63
s_cmp_eq_u32 s75, 0
s_cbranch_scc1 Lslow_263
buffer_store_dwordx4 v[32:35], v1, s[4:7], s60 offen
s_branch Ljoin_264
Lslow_263:
buffer_store_dwordx4 v[32:35], v1, s[4:7], s60 offen sc1
Ljoin_264:
v_pk_fma_f32 v[120:121], v[96:97], v[116:117], v[24:25] op_sel:[0,1,0] op_sel_hi:[1,1,1]
v_pk_fma_f32 v[72:73], v[72:73], v[116:117], v[120:121] op_sel:[0,0,0] op_sel_hi:[1,0,1]
v_pk_fma_f32 v[122:123], v[98:99], v[116:117], v[26:27] op_sel:[0,1,0] op_sel_hi:[1,1,1]
v_pk_fma_f32 v[74:75], v[74:75], v[116:117], v[122:123] op_sel:[0,0,0] op_sel_hi:[1,0,1]
v_pk_fma_f32 v[124:125], v[100:101], v[116:117], v[28:29] op_sel:[0,1,0] op_sel_hi:[1,1,1]
v_pk_fma_f32 v[76:77], v[76:77], v[116:117], v[124:125] op_sel:[0,0,0] op_sel_hi:[1,0,1]
v_pk_fma_f32 v[126:127], v[102:103], v[116:117], v[30:31] op_sel:[0,1,0] op_sel_hi:[1,1,1]
v_pk_fma_f32 v[78:79], v[78:79], v[116:117], v[126:127] op_sel:[0,0,0] op_sel_hi:[1,0,1]
v_pk_mul_f32 v[120:121], v[72:73], v[72:73]
v_pk_mul_f32 v[122:123], v[74:75], v[74:75]
v_pk_mul_f32 v[124:125], v[76:77], v[76:77]
v_pk_mul_f32 v[126:127], v[78:79], v[78:79]
v_pk_fma_f32 v[120:121], v[120:121], s[72:73], v[12:13]
v_pk_fma_f32 v[122:123], v[122:123], s[72:73], v[12:13]
v_pk_fma_f32 v[124:125], v[124:125], s[72:73], v[12:13]
v_pk_fma_f32 v[126:127], v[126:127], s[72:73], v[12:13]
v_pk_mul_f32 v[120:121], v[120:121], v[72:73]
v_pk_mul_f32 v[122:123], v[122:123], v[74:75]
v_pk_mul_f32 v[124:125], v[124:125], v[76:77]
v_pk_mul_f32 v[126:127], v[126:127], v[78:79]
v_exp_f32 v120, v120
v_exp_f32 v121, v121
v_exp_f32 v122, v122
v_exp_f32 v123, v123
v_exp_f32 v124, v124
v_exp_f32 v125, v125
v_exp_f32 v126, v126
v_exp_f32 v127, v127
v_pk_add_f32 v[120:121], v[120:121], 1.0 op_sel_hi:[1,0]
v_pk_add_f32 v[122:123], v[122:123], 1.0 op_sel_hi:[1,0]
v_pk_add_f32 v[124:125], v[124:125], 1.0 op_sel_hi:[1,0]
v_pk_add_f32 v[126:127], v[126:127], 1.0 op_sel_hi:[1,0]
v_rcp_f32 v120, v120
v_rcp_f32 v121, v121
v_rcp_f32 v122, v122
v_rcp_f32 v123, v123
v_rcp_f32 v124, v124
v_rcp_f32 v125, v125
v_rcp_f32 v126, v126
v_rcp_f32 v127, v127
v_pk_mul_f32 v[72:73], v[120:121], v[72:73]
v_pk_mul_f32 v[74:75], v[122:123], v[74:75]
v_pk_mul_f32 v[76:77], v[124:125], v[76:77]
v_pk_mul_f32 v[78:79], v[126:127], v[78:79]
v_cvt_pk_bf16_f32 v36, v72, v76
v_cvt_pk_bf16_f32 v37, v73, v77
v_cvt_pk_bf16_f32 v38, v74, v78
v_cvt_pk_bf16_f32 v39, v75, v79
s_add_u32 s60, s74, s66
s_cmp_eq_u32 s75, 0
s_cbranch_scc1 Lslow_265
buffer_store_dwordx4 v[36:39], v1, s[4:7], s60 offen
s_branch Ljoin_266
Lslow_265:
buffer_store_dwordx4 v[36:39], v1, s[4:7], s60 offen sc1
Ljoin_266:
v_pk_fma_f32 v[120:121], v[104:105], v[116:117], v[48:49] op_sel:[0,1,0] op_sel_hi:[1,1,1]
v_pk_fma_f32 v[80:81], v[80:81], v[116:117], v[120:121] op_sel:[0,0,0] op_sel_hi:[1,0,1]
v_pk_fma_f32 v[122:123], v[106:107], v[116:117], v[50:51] op_sel:[0,1,0] op_sel_hi:[1,1,1]
v_pk_fma_f32 v[82:83], v[82:83], v[116:117], v[122:123] op_sel:[0,0,0] op_sel_hi:[1,0,1]
v_pk_fma_f32 v[124:125], v[108:109], v[116:117], v[52:53] op_sel:[0,1,0] op_sel_hi:[1,1,1]
v_pk_fma_f32 v[84:85], v[84:85], v[116:117], v[124:125] op_sel:[0,0,0] op_sel_hi:[1,0,1]
v_pk_fma_f32 v[126:127], v[110:111], v[116:117], v[54:55] op_sel:[0,1,0] op_sel_hi:[1,1,1]
v_pk_fma_f32 v[86:87], v[86:87], v[116:117], v[126:127] op_sel:[0,0,0] op_sel_hi:[1,0,1]
v_pk_mul_f32 v[120:121], v[80:81], v[80:81]
v_pk_mul_f32 v[122:123], v[82:83], v[82:83]
v_pk_mul_f32 v[124:125], v[84:85], v[84:85]
v_pk_mul_f32 v[126:127], v[86:87], v[86:87]
v_pk_fma_f32 v[120:121], v[120:121], s[72:73], v[12:13]
v_pk_fma_f32 v[122:123], v[122:123], s[72:73], v[12:13]
v_pk_fma_f32 v[124:125], v[124:125], s[72:73], v[12:13]
v_pk_fma_f32 v[126:127], v[126:127], s[72:73], v[12:13]
v_pk_mul_f32 v[120:121], v[120:121], v[80:81]
v_pk_mul_f32 v[122:123], v[122:123], v[82:83]
v_pk_mul_f32 v[124:125], v[124:125], v[84:85]
v_pk_mul_f32 v[126:127], v[126:127], v[86:87]
v_exp_f32 v120, v120
v_exp_f32 v121, v121
v_exp_f32 v122, v122
v_exp_f32 v123, v123
v_exp_f32 v124, v124
v_exp_f32 v125, v125
v_exp_f32 v126, v126
v_exp_f32 v127, v127
v_pk_add_f32 v[120:121], v[120:121], 1.0 op_sel_hi:[1,0]
v_pk_add_f32 v[122:123], v[122:123], 1.0 op_sel_hi:[1,0]
v_pk_add_f32 v[124:125], v[124:125], 1.0 op_sel_hi:[1,0]
v_pk_add_f32 v[126:127], v[126:127], 1.0 op_sel_hi:[1,0]
v_rcp_f32 v120, v120
v_rcp_f32 v121, v121
v_rcp_f32 v122, v122
v_rcp_f32 v123, v123
v_rcp_f32 v124, v124
v_rcp_f32 v125, v125
v_rcp_f32 v126, v126
v_rcp_f32 v127, v127
v_pk_mul_f32 v[80:81], v[120:121], v[80:81]
v_pk_mul_f32 v[82:83], v[122:123], v[82:83]
v_pk_mul_f32 v[84:85], v[124:125], v[84:85]
v_pk_mul_f32 v[86:87], v[126:127], v[86:87]
v_cvt_pk_bf16_f32 v40, v80, v84
v_cvt_pk_bf16_f32 v41, v81, v85
v_cvt_pk_bf16_f32 v42, v82, v86
v_cvt_pk_bf16_f32 v43, v83, v87
s_add_u32 s60, s74, s67
s_cmp_eq_u32 s75, 0
s_cbranch_scc1 Lslow_267
buffer_store_dwordx4 v[40:43], v1, s[4:7], s60 offen
s_branch Ljoin_268
Lslow_267:
buffer_store_dwordx4 v[40:43], v1, s[4:7], s60 offen sc1
Ljoin_268:
s_lshl_b32 s60, s68, 7
s_add_u32 s76, s60, s69
s_add_u32 s68, s68, 1
s_cmp_lt_u32 s68, 64
s_cbranch_scc1 L_F0_loop
s_waitcnt vmcnt(0)
s_cmp_eq_u32 s76, 0
s_cbranch_scc1 Lnp_269
s_mov_b64 s[98:99], exec
s_mov_b64 exec, 1
s_cmp_eq_u32 s75, 0
s_cbranch_scc1 Lslow_270
buffer_store_dword v4, off, s[4:7], s76
s_branch Ljoin_271
Lslow_270:
buffer_store_dword v4, off, s[4:7], s76 sc1
Ljoin_271:
s_mov_b64 exec, s[98:99]
s_mov_b32 s76, 0
Lnp_269:
s_endpgm
L_F1_main:
s_lshl_b32 s60, s59, 10
s_lshl_b32 s63, s63, 11
s_add_u32 s63, s63, 22544384
s_add_u32 s63, s63, s60
s_lshl_b32 s66, s66, 11
s_add_u32 s66, s66, 22544384
s_add_u32 s66, s66, s60
s_lshl_b32 s67, s67, 11
s_add_u32 s67, s67, 22544384
s_add_u32 s67, s67, s60
s_lshl_b32 s78, s47, 10
s_lshl_b32 s92, s47, 11
s_add_u32 s93, s60, 6291456
s_mov_b32 s77, 0x10000
s_mov_b32 s76, 0
s_mov_b32 s94, 0x55555555
s_lshl_b32 s94, s94, s59
s_mov_b32 s95, s94
s_lshl_b32 s96, s59, 12
s_add_u32 s96, s96, 14155776
s_lshl_b32 s60, s59, 6
v_add_u32 v8, s60, v8
s_lshl_b32 s61, s62, 2
s_add_u32 s69, s60, s61
s_add_u32 s69, s69, 24576
v_add_u32 v2, 0x10000, v1
v_lshlrev_b32 v3, 3, v0
ds_read_b128 v[88:91], v11 offset:0
ds_read_b128 v[92:95], v11 offset:1024
ds_read_b128 v[96:99], v11 offset:2048
ds_read_b128 v[100:103], v11 offset:3072
ds_read_b128 v[104:107], v11 offset:4096
ds_read_b128 v[108:111], v11 offset:5120
s_mov_b64 exec, 1
v_mov_b32 v33, 136
s_nop 1
Lgb_274:
buffer_load_dword v32, v33, s[8:11], 0 offen sc1
s_memtime s[60:61]
s_waitcnt lgkmcnt(0)
s_sub_u32 s60, s60, s46
s_mov_b32 s61, 2
s_cmp_gt_u32 s60, 67108864
s_cbranch_scc1 L_abortF
s_waitcnt vmcnt(0)
v_readfirstlane_b32 s60, v32
s_and_b32 s61, s60, 0xffff
s_cmp_lt_u32 s61, 256
s_cbranch_scc1 Lgb_274
s_mov_b64 exec, -1
s_cmp_lt_u32 s60, 0x10000
s_cselect_b32 s75, 1, 0
s_and_b32 s61, s56, 31
s_mov_b32 s52, s40
s_mov_b32 s53, s41
s_mov_b32 s54, 2097152
s_mov_b32 s55, 0x00020000
s_lshl_b32 s61, s61, 2
s_add_u32 s61, s61, s47
s_mul_i32 s60, s61, 8192
v_mul_u32_u24 v32, 128, v0
v_add_u32 v32, s60, v32
s_sleep 64
s_sleep 64
s_sleep 64
s_sleep 64
s_sleep 64
s_sleep 64
s_mov_b32 s60, 0x600000
buffer_load_dword v33, v32, s[4:7], s60 offen sc1
s_waitcnt vmcnt(12)
s_mov_b32 s60, 0x1500000
buffer_load_dword v33, v32, s[4:7], s60 offen sc1
s_waitcnt vmcnt(12)
s_mov_b32 s60, 0x1600000
buffer_load_dword v33, v32, s[4:7], s60 offen sc1
s_waitcnt vmcnt(12)
s_mov_b32 s60, 0x0
buffer_load_dword v33, v32, s[52:55], s60 offen sc1
s_waitcnt vmcnt(12)
s_mov_b32 s60, 0x1700000
buffer_load_dword v33, v32, s[4:7], s60 offen sc1
s_waitcnt vmcnt(12)
s_mov_b32 s60, 0x1800000
buffer_load_dword v33, v32, s[4:7], s60 offen sc1
s_waitcnt vmcnt(12)
s_mov_b32 s60, 0x1900000
buffer_load_dword v33, v32, s[4:7], s60 offen sc1
s_waitcnt vmcnt(12)
s_mov_b32 s60, 0x1a00000
buffer_load_dword v33, v32, s[4:7], s60 offen sc1
s_waitcnt vmcnt(12)
s_mov_b32 s60, 0x700000
buffer_load_dword v33, v32, s[4:7], s60 offen sc1
s_waitcnt vmcnt(12)
s_mov_b32 s60, 0x100000
buffer_load_dword v33, v32, s[52:55], s60 offen sc1
s_waitcnt vmcnt(12)
s_waitcnt vmcnt(0)
s_mov_b32 s68, 0
s_and_b32 s60, s56, 7
s_lshl_b32 s60, s60, 2
s_add_u32 s60, s60, s47
s_lshl_b32 s61, s60, 8
s_add_u32 s61, s61, 14155776
s_lshl_b32 s60, s60, 10
s_add_u32 s60, s60, 6291456
v_and_b32 v59, 7, v0
v_lshlrev_b32 v59, 7, v59
v_and_b32 v56, 1, v0
v_lshlrev_b32 v56, 7, v56
v_add_u32 v56, s61, v56
v_mov_b32 v57, 8192
v_add_u32 v60, s60, v59
v_mov_b32 v61, 32768
v_cmp_gt_u32 vcc, 32, v0
s_nop 1
v_cndmask_b32 v56, v56, v60, vcc
v_cndmask_b32 v57, v57, v61, vcc
v_mov_b32 v61, 90112
v_cmp_gt_u32 vcc, 24, v0
s_nop 1
v_cndmask_b32 v57, v57, v61, vcc
v_add_u32 v60, s67, v59
v_cmp_gt_u32 vcc, 24, v0
s_nop 1
v_cndmask_b32 v56, v56, v60, vcc
v_add_u32 v60, s66, v59
v_cmp_gt_u32 vcc, 16, v0
s_nop 1
v_cndmask_b32 v56, v56, v60, vcc
v_add_u32 v60, s63, v59
v_cmp_gt_u32 vcc, 8, v0
s_nop 1
v_cndmask_b32 v56, v56, v60, vcc
s_cmp_eq_u32 s75, 0
s_cbranch_scc1 Lslow_275
buffer_load_dword v58, v56, s[4:7], 0 offen
s_branch Ljoin_276
Lslow_275:
buffer_load_dword v58, v56, s[4:7], 0 offen sc1
Ljoin_276:
v_add_u32 v56, v56, v57
s_cmp_eq_u32 s75, 0
s_cbranch_scc1 Lslow_277
buffer_load_dword v58, v56, s[4:7], 0 offen
s_branch Ljoin_278
Lslow_277:
buffer_load_dword v58, v56, s[4:7], 0 offen sc1
Ljoin_278:
v_add_u32 v56, v56, v57
s_cmp_eq_u32 s75, 0
s_cbranch_scc1 Lslow_279
buffer_load_dword v58, v56, s[4:7], 0 offen
s_branch Ljoin_280
Lslow_279:
buffer_load_dword v58, v56, s[4:7], 0 offen sc1
Ljoin_280:
v_add_u32 v56, v56, v57
s_nop 1
L_F1_loop:
s_lshl_b32 s64, s68, 8
s_add_u32 s64, s64, 212992
s_mov_b64 exec, s[94:95]
s_branch Lpoll_282
Lpoll_281:
s_sleep 1
Lpoll_282:
buffer_load_dword v46, v6, s[4:7], s64 offen sc1
s_memtime s[60:61]
s_waitcnt lgkmcnt(0)
s_sub_u32 s60, s60, s46
s_mov_b32 s61, 40
s_cmp_gt_u32 s60, 67108864
s_cbranch_scc1 L_abortF
s_waitcnt vmcnt(0)
s_cmp_eq_u32 s76, 0
s_cbranch_scc1 Lnp_283
s_mov_b64 s[98:99], exec
s_mov_b64 exec, 1
s_cmp_eq_u32 s75, 0
s_cbranch_scc1 Lslow_284
buffer_store_dword v4, off, s[4:7], s76
s_branch Ljoin_285
Lslow_284:
buffer_store_dword v4, off, s[4:7], s76 sc1
Ljoin_285:
s_mov_b64 exec, s[98:99]
s_mov_b32 s76, 0
Lnp_283:
v_cmp_eq_u32 vcc, 0, v46
s_cbranch_vccnz Lpoll_281
s_mov_b64 exec, -1
s_lshl_b32 s64, s68, 15
s_add_u32 s64, s64, s93
s_lshl_b32 s65, s68, 13
s_add_u32 s65, s65, s96
s_add_u32 s100, s77, s78
s_add_u32 m0, s100, 0
s_lshl1_add_u32 s100, s78, s64
s_add_u32 s100, s100, 0
buffer_load_dwordx4 v1, s[4:7], s100 offen sc1 lds
s_add_u32 s100, s77, s78
s_add_u32 m0, s100, 4096
s_lshl1_add_u32 s100, s78, s64
s_add_u32 s100, s100, 8192
buffer_load_dwordx4 v1, s[4:7], s100 offen sc1 lds
s_add_u32 s100, s77, s92
s_add_u32 m0, s100, 8192
s_lshl1_add_u32 s100, s92, s64
s_add_u32 s100, s100, 16384
buffer_load_dwordx4 v1, s[4:7], s100 offen sc1 lds
s_add_u32 m0, m0, 1024
s_add_u32 s100, s100, 2048
buffer_load_dwordx4 v1, s[4:7], s100 offen sc1 lds
buffer_load_dwordx4 v[16:19], v1, s[4:7], s65 offen offset:0 sc1
buffer_load_dwordx4 v[20:23], v1, s[4:7], s65 offen offset:1024 sc1
buffer_load_dwordx4 v[24:27], v1, s[4:7], s65 offen offset:2048 sc1
buffer_load_dwordx4 v[28:31], v1, s[4:7], s65 offen offset:3072 sc1
s_cmp_eq_u32 s75, 0
s_cbranch_scc1 Lslow_286
buffer_load_dword v58, v56, s[4:7], 0 offen
s_branch Ljoin_287
Lslow_286:
buffer_load_dword v58, v56, s[4:7], 0 offen sc1
Ljoin_287:
s_cmp_ge_u32 s68, 60
s_cselect_b32 s60, 0, -1
v_and_b32 v59, s60, v57
v_add_u32 v56, v56, v59
s_waitcnt vmcnt(8)
s_barrier
ds_read_b128 v[32:35], v2 offset:0
ds_read_b128 v[36:39], v2 offset:1024
ds_read_b128 v[40:43], v2 offset:2048
ds_read_b128 v[44:47], v2 offset:3072
s_waitcnt lgkmcnt(3)
v_mfma_f32_16x16x32_bf16 v[64:67], a[0:3], v[32:35], 0
v_mfma_f32_16x16x32_bf16 v[68:71], a[64:67], v[32:35], 0
v_mfma_f32_16x16x32_bf16 v[72:75], a[128:131], v[32:35], 0
v_mfma_f32_16x16x32_bf16 v[76:79], a[192:195], v[32:35], 0
v_mfma_f32_16x16x32_bf16 v[80:83], v[128:131], v[32:35], 0
v_mfma_f32_16x16x32_bf16 v[84:87], v[192:195], v[32:35], 0
s_waitcnt vmcnt(7)
s_barrier
ds_read_b128 v[32:35], v2 offset:4096
s_waitcnt lgkmcnt(3)
v_mfma_f32_16x16x32_bf16 v[64:67], a[4:7], v[36:39], v[64:67]
v_mfma_f32_16x16x32_bf16 v[68:71], a[68:71], v[36:39], v[68:71]
v_mfma_f32_16x16x32_bf16 v[72:75], a[132:135], v[36:39], v[72:75]
v_mfma_f32_16x16x32_bf16 v[76:79], a[196:199], v[36:39], v[76:79]
v_mfma_f32_16x16x32_bf16 v[80:83], v[132:135], v[36:39], v[80:83]
v_mfma_f32_16x16x32_bf16 v[84:87], v[196:199], v[36:39], v[84:87]
ds_read_b128 v[36:39], v2 offset:5120
s_waitcnt lgkmcnt(3)
v_mfma_f32_16x16x32_bf16 v[64:67], a[8:11], v[40:43], v[64:67]
v_mfma_f32_16x16x32_bf16 v[68:71], a[72:75], v[40:43], v[68:71]
v_mfma_f32_16x16x32_bf16 v[72:75], a[136:139], v[40:43], v[72:75]
v_mfma_f32_16x16x32_bf16 v[76:79], a[200:203], v[40:43], v[76:79]
v_mfma_f32_16x16x32_bf16 v[80:83], v[136:139], v[40:43], v[80:83]
v_mfma_f32_16x16x32_bf16 v[84:87], v[200:203], v[40:43], v[84:87]
ds_read_b128 v[40:43], v2 offset:6144
s_waitcnt lgkmcnt(3)
v_mfma_f32_16x16x32_bf16 v[64:67], a[12:15], v[44:47], v[64:67]
v_mfma_f32_16x16x32_bf16 v[68:71], a[76:79], v[44:47], v[68:71]
v_mfma_f32_16x16x32_bf16 v[72:75], a[140:143], v[44:47], v[72:75]
v_mfma_f32_16x16x32_bf16 v[76:79], a[204:207], v[44:47], v[76:79]
v_mfma_f32_16x16x32_bf16 v[80:83], v[140:143], v[44:47], v[80:83]
v_mfma_f32_16x16x32_bf16 v[84:87], v[204:207], v[44:47], v[84:87]
ds_read_b128 v[44:47], v2 offset:7168
s_waitcnt lgkmcnt(3)
v_mfma_f32_16x16x32_bf16 v[64:67], a[16:19], v[32:35], v[64:67]
v_mfma_f32_16x16x32_bf16 v[68:71], a[80:83], v[32:35], v[68:71]
v_mfma_f32_16x16x32_bf16 v[72:75], a[144:147], v[32:35], v[72:75]
v_mfma_f32_16x16x32_bf16 v[76:79], a[208:211], v[32:35], v[76:79]
v_mfma_f32_16x16x32_bf16 v[80:83], v[144:147], v[32:35], v[80:83]
v_mfma_f32_16x16x32_bf16 v[84:87], v[208:211], v[32:35], v[84:87]
s_waitcnt vmcnt(5)
s_barrier
ds_read_b128 v[32:35], v2 offset:8192
s_waitcnt lgkmcnt(3)
v_mfma_f32_16x16x32_bf16 v[64:67], a[20:23], v[36:39], v[64:67]
v_mfma_f32_16x16x32_bf16 v[68:71], a[84:87], v[36:39], v[68:71]
v_mfma_f32_16x16x32_bf16 v[72:75], a[148:151], v[36:39], v[72:75]
v_mfma_f32_16x16x32_bf16 v[76:79], a[212:215], v[36:39], v[76:79]
v_mfma_f32_16x16x32_bf16 v[80:83], v[148:151], v[36:39], v[80:83]
v_mfma_f32_16x16x32_bf16 v[84:87], v[212:215], v[36:39], v[84:87]
ds_read_b128 v[36:39], v2 offset:9216
s_waitcnt lgkmcnt(3)
v_mfma_f32_16x16x32_bf16 v[64:67], a[24:27], v[40:43], v[64:67]
s_waitcnt vmcnt(1)
v_add_f32 v16, v16, v17
v_mfma_f32_16x16x32_bf16 v[68:71], a[88:91], v[40:43], v[68:71]
v_add_f32 v18, v18, v19
v_mfma_f32_16x16x32_bf16 v[72:75], a[152:155], v[40:43], v[72:75]
v_add_f32 v20, v20, v21
v_mfma_f32_16x16x32_bf16 v[76:79], a[216:219], v[40:43], v[76:79]
v_add_f32 v22, v22, v23
v_mfma_f32_16x16x32_bf16 v[80:83], v[152:155], v[40:43], v[80:83]
v_add_f32 v24, v24, v25
v_mfma_f32_16x16x32_bf16 v[84:87], v[216:219], v[40:43], v[84:87]
v_add_f32 v26, v26, v27
ds_read_b128 v[40:43], v2 offset:10240
s_waitcnt lgkmcnt(3)
v_mfma_f32_16x16x32_bf16 v[64:67], a[28:31], v[44:47], v[64:67]
v_add_f32 v28, v28, v29
v_mfma_f32_16x16x32_bf16 v[68:71], a[92:95], v[44:47], v[68:71]
v_add_f32 v30, v30, v31
v_mfma_f32_16x16x32_bf16 v[72:75], a[156:159], v[44:47], v[72:75]
v_add_f32 v16, v16, v18
v_mfma_f32_16x16x32_bf16 v[76:79], a[220:223], v[44:47], v[76:79]
v_add_f32 v20, v20, v22
v_mfma_f32_16x16x32_bf16 v[80:83], v[156:159], v[44:47], v[80:83]
v_add_f32 v24, v24, v26
v_mfma_f32_16x16x32_bf16 v[84:87], v[220:223], v[44:47], v[84:87]
v_add_f32 v28, v28, v30
ds_read_b128 v[44:47], v2 offset:11264
s_waitcnt lgkmcnt(3)
v_mfma_f32_16x16x32_bf16 v[64:67], a[32:35], v[32:35], v[64:67]
v_add_f32 v16, v16, v20
v_mfma_f32_16x16x32_bf16 v[68:71], a[96:99], v[32:35], v[68:71]
v_add_f32 v24, v24, v28
v_mfma_f32_16x16x32_bf16 v[72:75], a[160:163], v[32:35], v[72:75]
v_add_f32 v112, v16, v24
v_mfma_f32_16x16x32_bf16 v[76:79], a[224:227], v[32:35], v[76:79]
v_mfma_f32_16x16x32_bf16 v[80:83], v[160:163], v[32:35], v[80:83]
v_mfma_f32_16x16x32_bf16 v[84:87], v[224:227], v[32:35], v[84:87]
ds_read_b128 v[32:35], v2 offset:12288
s_waitcnt lgkmcnt(3)
v_mfma_f32_16x16x32_bf16 v[64:67], a[36:39], v[36:39], v[64:67]
v_mfma_f32_16x16x32_bf16 v[68:71], a[100:103], v[36:39], v[68:71]
v_mfma_f32_16x16x32_bf16 v[72:75], a[164:167], v[36:39], v[72:75]
v_mfma_f32_16x16x32_bf16 v[76:79], a[228:231], v[36:39], v[76:79]
v_mfma_f32_16x16x32_bf16 v[80:83], v[164:167], v[36:39], v[80:83]
v_mfma_f32_16x16x32_bf16 v[84:87], v[228:231], v[36:39], v[84:87]
ds_read_b128 v[36:39], v2 offset:13312
s_waitcnt lgkmcnt(3)
v_mfma_f32_16x16x32_bf16 v[64:67], a[40:43], v[40:43], v[64:67]
v_mov_b32 v113, v112
s_nop 1
v_permlane16_swap_b32 v112, v113
v_add_f32 v112, v112, v113
v_mfma_f32_16x16x32_bf16 v[68:71], a[104:107], v[40:43], v[68:71]
v_mfma_f32_16x16x32_bf16 v[72:75], a[168:171], v[40:43], v[72:75]
v_mfma_f32_16x16x32_bf16 v[76:79], a[232:235], v[40:43], v[76:79]
v_mfma_f32_16x16x32_bf16 v[80:83], v[168:171], v[40:43], v[80:83]
v_mfma_f32_16x16x32_bf16 v[84:87], v[232:235], v[40:43], v[84:87]
ds_read_b128 v[40:43], v2 offset:14336
s_waitcnt lgkmcnt(3)
v_mfma_f32_16x16x32_bf16 v[64:67], a[44:47], v[44:47], v[64:67]
v_mfma_f32_16x16x32_bf16 v[68:71], a[108:111], v[44:47], v[68:71]
v_mfma_f32_16x16x32_bf16 v[72:75], a[172:175], v[44:47], v[72:75]
v_mfma_f32_16x16x32_bf16 v[76:79], a[236:239], v[44:47], v[76:79]
v_mfma_f32_16x16x32_bf16 v[80:83], v[172:175], v[44:47], v[80:83]
v_mfma_f32_16x16x32_bf16 v[84:87], v[236:239], v[44:47], v[84:87]
ds_read_b128 v[44:47], v2 offset:15360
s_waitcnt lgkmcnt(3)
v_mfma_f32_16x16x32_bf16 v[64:67], a[48:51], v[32:35], v[64:67]
v_mov_b32 v113, v112
s_nop 1
v_permlane32_swap_b32 v112, v113
v_mul_f32 v112, 0x3b000000, v112
v_mul_f32 v113, 0x3b000000, v113
v_fma_f32 v113, -v112, v112, v113
v_max_f32 v113, 0, v113
v_add_f32 v113, 0x3727c5ac, v113
v_rsq_f32 v113, v113
s_nop 0
v_mul_f32 v112, -v112, v113
ds_write_b32 v10, v113
ds_write_b32 v10, v112 offset:128
v_mfma_f32_16x16x32_bf16 v[68:71], a[112:115], v[32:35], v[68:71]
v_mfma_f32_16x16x32_bf16 v[72:75], a[176:179], v[32:35], v[72:75]
v_mfma_f32_16x16x32_bf16 v[76:79], a[240:243], v[32:35], v[76:79]
v_mfma_f32_16x16x32_bf16 v[80:83], v[176:179], v[32:35], v[80:83]
v_mfma_f32_16x16x32_bf16 v[84:87], v[240:243], v[32:35], v[84:87]
s_waitcnt lgkmcnt(4)
v_mfma_f32_16x16x32_bf16 v[64:67], a[52:55], v[36:39], v[64:67]
ds_read_b128 v[16:19], v11 offset:24576
v_mfma_f32_16x16x32_bf16 v[68:71], a[116:119], v[36:39], v[68:71]
ds_read_b128 v[20:23], v11 offset:25600
v_mfma_f32_16x16x32_bf16 v[72:75], a[180:183], v[36:39], v[72:75]
ds_read_b128 v[24:27], v11 offset:26624
v_mfma_f32_16x16x32_bf16 v[76:79], a[244:247], v[36:39], v[76:79]
ds_read_b128 v[28:31], v11 offset:27648
v_mfma_f32_16x16x32_bf16 v[80:83], v[180:183], v[36:39], v[80:83]
ds_read_b128 v[48:51], v11 offset:28672
v_mfma_f32_16x16x32_bf16 v[84:87], v[244:247], v[36:39], v[84:87]
ds_read_b128 v[52:55], v11 offset:29696
s_waitcnt lgkmcnt(9)
v_mfma_f32_16x16x32_bf16 v[64:67], a[56:59], v[40:43], v[64:67]
v_mfma_f32_16x16x32_bf16 v[68:71], a[120:123], v[40:43], v[68:71]
v_mfma_f32_16x16x32_bf16 v[72:75], a[184:187], v[40:43], v[72:75]
v_mfma_f32_16x16x32_bf16 v[76:79], a[248:251], v[40:43], v[76:79]
v_mfma_f32_16x16x32_bf16 v[80:83], v[184:187], v[40:43], v[80:83]
v_mfma_f32_16x16x32_bf16 v[84:87], v[248:251], v[40:43], v[84:87]
s_waitcnt lgkmcnt(8)
v_mfma_f32_16x16x32_bf16 v[64:67], a[60:63], v[44:47], v[64:67]
ds_read_b32 v116, v8
ds_read_b32 v117, v8 offset:128
v_mfma_f32_16x16x32_bf16 v[68:71], a[124:127], v[44:47], v[68:71]
v_mfma_f32_16x16x32_bf16 v[72:75], a[188:191], v[44:47], v[72:75]
v_mfma_f32_16x16x32_bf16 v[76:79], a[252:255], v[44:47], v[76:79]
v_mfma_f32_16x16x32_bf16 v[80:83], v[188:191], v[44:47], v[80:83]
v_mfma_f32_16x16x32_bf16 v[84:87], v[252:255], v[44:47], v[84:87]
v_xor_b32 v2, 0x8000, v2
s_xor_b32 s77, s77, 0x8000
s_mul_i32 s74, s68, 90112
s_waitcnt lgkmcnt(0)
v_pk_fma_f32 v[120:121], v[88:89], v[116:117], v[16:17] op_sel:[0,1,0] op_sel_hi:[1,1,1]
v_pk_fma_f32 v[64:65], v[64:65], v[116:117], v[120:121] op_sel:[0,0,0] op_sel_hi:[1,0,1]
v_pk_fma_f32 v[122:123], v[90:91], v[116:117], v[18:19] op_sel:[0,1,0] op_sel_hi:[1,1,1]
v_pk_fma_f32 v[66:67], v[66:67], v[116:117], v[122:123] op_sel:[0,0,0] op_sel_hi:[1,0,1]
v_pk_fma_f32 v[124:125], v[92:93], v[116:117], v[20:21] op_sel:[0,1,0] op_sel_hi:[1,1,1]
v_pk_fma_f32 v[68:69], v[68:69], v[116:117], v[124:125] op_sel:[0,0,0] op_sel_hi:[1,0,1]
v_pk_fma_f32 v[126:127], v[94:95], v[116:117], v[22:23] op_sel:[0,1,0] op_sel_hi:[1,1,1]
v_pk_fma_f32 v[70:71], v[70:71], v[116:117], v[126:127] op_sel:[0,0,0] op_sel_hi:[1,0,1]
v_pk_mul_f32 v[120:121], v[64:65], v[64:65]
v_pk_mul_f32 v[122:123], v[66:67], v[66:67]
v_pk_mul_f32 v[124:125], v[68:69], v[68:69]
v_pk_mul_f32 v[126:127], v[70:71], v[70:71]
v_pk_fma_f32 v[120:121], v[120:121], s[72:73], v[12:13]
v_pk_fma_f32 v[122:123], v[122:123], s[72:73], v[12:13]
v_pk_fma_f32 v[124:125], v[124:125], s[72:73], v[12:13]
v_pk_fma_f32 v[126:127], v[126:127], s[72:73], v[12:13]
v_pk_mul_f32 v[120:121], v[120:121], v[64:65]
v_pk_mul_f32 v[122:123], v[122:123], v[66:67]
v_pk_mul_f32 v[124:125], v[124:125], v[68:69]
v_pk_mul_f32 v[126:127], v[126:127], v[70:71]
v_exp_f32 v120, v120
v_exp_f32 v121, v121
v_exp_f32 v122, v122
v_exp_f32 v123, v123
v_exp_f32 v124, v124
v_exp_f32 v125, v125
v_exp_f32 v126, v126
v_exp_f32 v127, v127
v_pk_add_f32 v[120:121], v[120:121], 1.0 op_sel_hi:[1,0]
v_pk_add_f32 v[122:123], v[122:123], 1.0 op_sel_hi:[1,0]
v_pk_add_f32 v[124:125], v[124:125], 1.0 op_sel_hi:[1,0]
v_pk_add_f32 v[126:127], v[126:127], 1.0 op_sel_hi:[1,0]
v_rcp_f32 v120, v120
v_rcp_f32 v121, v121
v_rcp_f32 v122, v122
v_rcp_f32 v123, v123
v_rcp_f32 v124, v124
v_rcp_f32 v125, v125
v_rcp_f32 v126, v126
v_rcp_f32 v127, v127
v_pk_mul_f32 v[64:65], v[120:121], v[64:65]
v_pk_mul_f32 v[66:67], v[122:123], v[66:67]
v_pk_mul_f32 v[68:69], v[124:125], v[68:69]
v_pk_mul_f32 v[70:71], v[126:127], v[70:71]
v_cvt_pk_bf16_f32 v32, v64, v68
v_cvt_pk_bf16_f32 v33, v65, v69
v_cvt_pk_bf16_f32 v34, v66, v70
v_cvt_pk_bf16_f32 v35, v67, v71
s_add_u32 s60, s74, s63
s_cmp_eq_u32 s75, 0
s_cbranch_scc1 Lslow_288
buffer_store_dwordx4 v[32:35], v1, s[4:7], s60 offen
s_branch Ljoin_289
Lslow_288:
buffer_store_dwordx4 v[32:35], v1, s[4:7], s60 offen sc1
Ljoin_289:
v_pk_fma_f32 v[120:121], v[96:97], v[116:117], v[24:25] op_sel:[0,1,0] op_sel_hi:[1,1,1]
v_pk_fma_f32 v[72:73], v[72:73], v[116:117], v[120:121] op_sel:[0,0,0] op_sel_hi:[1,0,1]
v_pk_fma_f32 v[122:123], v[98:99], v[116:117], v[26:27] op_sel:[0,1,0] op_sel_hi:[1,1,1]
v_pk_fma_f32 v[74:75], v[74:75], v[116:117], v[122:123] op_sel:[0,0,0] op_sel_hi:[1,0,1]
v_pk_fma_f32 v[124:125], v[100:101], v[116:117], v[28:29] op_sel:[0,1,0] op_sel_hi:[1,1,1]
v_pk_fma_f32 v[76:77], v[76:77], v[116:117], v[124:125] op_sel:[0,0,0] op_sel_hi:[1,0,1]
v_pk_fma_f32 v[126:127], v[102:103], v[116:117], v[30:31] op_sel:[0,1,0] op_sel_hi:[1,1,1]
v_pk_fma_f32 v[78:79], v[78:79], v[116:117], v[126:127] op_sel:[0,0,0] op_sel_hi:[1,0,1]
v_pk_mul_f32 v[120:121], v[72:73], v[72:73]
v_pk_mul_f32 v[122:123], v[74:75], v[74:75]
v_pk_mul_f32 v[124:125], v[76:77], v[76:77]
v_pk_mul_f32 v[126:127], v[78:79], v[78:79]
v_pk_fma_f32 v[120:121], v[120:121], s[72:73], v[12:13]
v_pk_fma_f32 v[122:123], v[122:123], s[72:73], v[12:13]
v_pk_fma_f32 v[124:125], v[124:125], s[72:73], v[12:13]
v_pk_fma_f32 v[126:127], v[126:127], s[72:73], v[12:13]
v_pk_mul_f32 v[120:121], v[120:121], v[72:73]
v_pk_mul_f32 v[122:123], v[122:123], v[74:75]
v_pk_mul_f32 v[124:125], v[124:125], v[76:77]
v_pk_mul_f32 v[126:127], v[126:127], v[78:79]
v_exp_f32 v120, v120
v_exp_f32 v121, v121
v_exp_f32 v122, v122
v_exp_f32 v123, v123
v_exp_f32 v124, v124
v_exp_f32 v125, v125
v_exp_f32 v126, v126
v_exp_f32 v127, v127
v_pk_add_f32 v[120:121], v[120:121], 1.0 op_sel_hi:[1,0]
v_pk_add_f32 v[122:123], v[122:123], 1.0 op_sel_hi:[1,0]
v_pk_add_f32 v[124:125], v[124:125], 1.0 op_sel_hi:[1,0]
v_pk_add_f32 v[126:127], v[126:127], 1.0 op_sel_hi:[1,0]
v_rcp_f32 v120, v120
v_rcp_f32 v121, v121
v_rcp_f32 v122, v122
v_rcp_f32 v123, v123
v_rcp_f32 v124, v124
v_rcp_f32 v125, v125
v_rcp_f32 v126, v126
v_rcp_f32 v127, v127
v_pk_mul_f32 v[72:73], v[120:121], v[72:73]
v_pk_mul_f32 v[74:75], v[122:123], v[74:75]
v_pk_mul_f32 v[76:77], v[124:125], v[76:77]
v_pk_mul_f32 v[78:79], v[126:127], v[78:79]
v_cvt_pk_bf16_f32 v36, v72, v76
v_cvt_pk_bf16_f32 v37, v73, v77
v_cvt_pk_bf16_f32 v38, v74, v78
v_cvt_pk_bf16_f32 v39, v75, v79
s_add_u32 s60, s74, s66
s_cmp_eq_u32 s75, 0
s_cbranch_scc1 Lslow_290
buffer_store_dwordx4 v[36:39], v1, s[4:7], s60 offen
s_branch Ljoin_291
Lslow_290:
buffer_store_dwordx4 v[36:39], v1, s[4:7], s60 offen sc1
Ljoin_291:
v_pk_fma_f32 v[120:121], v[104:105], v[116:117], v[48:49] op_sel:[0,1,0] op_sel_hi:[1,1,1]
v_pk_fma_f32 v[80:81], v[80:81], v[116:117], v[120:121] op_sel:[0,0,0] op_sel_hi:[1,0,1]
v_pk_fma_f32 v[122:123], v[106:107], v[116:117], v[50:51] op_sel:[0,1,0] op_sel_hi:[1,1,1]
v_pk_fma_f32 v[82:83], v[82:83], v[116:117], v[122:123] op_sel:[0,0,0] op_sel_hi:[1,0,1]
v_pk_fma_f32 v[124:125], v[108:109], v[116:117], v[52:53] op_sel:[0,1,0] op_sel_hi:[1,1,1]
v_pk_fma_f32 v[84:85], v[84:85], v[116:117], v[124:125] op_sel:[0,0,0] op_sel_hi:[1,0,1]
v_pk_fma_f32 v[126:127], v[110:111], v[116:117], v[54:55] op_sel:[0,1,0] op_sel_hi:[1,1,1]
v_pk_fma_f32 v[86:87], v[86:87], v[116:117], v[126:127] op_sel:[0,0,0] op_sel_hi:[1,0,1]
v_pk_mul_f32 v[120:121], v[80:81], v[80:81]
v_pk_mul_f32 v[122:123], v[82:83], v[82:83]
v_pk_mul_f32 v[124:125], v[84:85], v[84:85]
v_pk_mul_f32 v[126:127], v[86:87], v[86:87]
v_pk_fma_f32 v[120:121], v[120:121], s[72:73], v[12:13]
v_pk_fma_f32 v[122:123], v[122:123], s[72:73], v[12:13]
v_pk_fma_f32 v[124:125], v[124:125], s[72:73], v[12:13]
v_pk_fma_f32 v[126:127], v[126:127], s[72:73], v[12:13]
v_pk_mul_f32 v[120:121], v[120:121], v[80:81]
v_pk_mul_f32 v[122:123], v[122:123], v[82:83]
v_pk_mul_f32 v[124:125], v[124:125], v[84:85]
v_pk_mul_f32 v[126:127], v[126:127], v[86:87]
v_exp_f32 v120, v120
v_exp_f32 v121, v121
v_exp_f32 v122, v122
v_exp_f32 v123, v123
v_exp_f32 v124, v124
v_exp_f32 v125, v125
v_exp_f32 v126, v126
v_exp_f32 v127, v127
v_pk_add_f32 v[120:121], v[120:121], 1.0 op_sel_hi:[1,0]
v_pk_add_f32 v[122:123], v[122:123], 1.0 op_sel_hi:[1,0]
v_pk_add_f32 v[124:125], v[124:125], 1.0 op_sel_hi:[1,0]
v_pk_add_f32 v[126:127], v[126:127], 1.0 op_sel_hi:[1,0]
v_rcp_f32 v120, v120
v_rcp_f32 v121, v121
v_rcp_f32 v122, v122
v_rcp_f32 v123, v123
v_rcp_f32 v124, v124
v_rcp_f32 v125, v125
v_rcp_f32 v126, v126
v_rcp_f32 v127, v127
v_pk_mul_f32 v[80:81], v[120:121], v[80:81]
v_pk_mul_f32 v[82:83], v[122:123], v[82:83]
v_pk_mul_f32 v[84:85], v[124:125], v[84:85]
v_pk_mul_f32 v[86:87], v[126:127], v[86:87]
v_cvt_pk_bf16_f32 v40, v80, v84
v_cvt_pk_bf16_f32 v41, v81, v85
v_cvt_pk_bf16_f32 v42, v82, v86
v_cvt_pk_bf16_f32 v43, v83, v87
s_add_u32 s60, s74, s67
s_cmp_eq_u32 s75, 0
s_cbranch_scc1 Lslow_292
buffer_store_dwordx4 v[40:43], v1, s[4:7], s60 offen
s_branch Ljoin_293
Lslow_292:
buffer_store_dwordx4 v[40:43], v1, s[4:7], s60 offen sc1
Ljoin_293:
s_lshl_b32 s60, s68, 7
s_add_u32 s76, s60, s69
s_add_u32 s68, s68, 1
s_cmp_lt_u32 s68, 64
s_cbranch_scc1 L_F1_loop
s_waitcnt vmcnt(0)
s_cmp_eq_u32 s76, 0
s_cbranch_scc1 Lnp_294
s_mov_b64 s[98:99], exec
s_mov_b64 exec, 1
s_cmp_eq_u32 s75, 0
s_cbranch_scc1 Lslow_295
buffer_store_dword v4, off, s[4:7], s76
s_branch Ljoin_296
Lslow_295:
buffer_store_dword v4, off, s[4:7], s76 sc1
Ljoin_296:
s_mov_b64 exec, s[98:99]
s_mov_b32 s76, 0
Lnp_294:
s_endpgm
L_abortF:
s_mov_b64 exec, 1
s_lshl_b32 s60, s56, 8
s_or_b32 s60, s60, s61
s_lshl_b32 s61, s47, 16
s_or_b32 s60, s60, s61
s_or_b32 s60, s60, 0x40000000
v_mov_b32 v1, s60
v_mov_b32 v2, 160
buffer_store_dword v1, v2, s[8:11], 0 offen sc1
s_waitcnt vmcnt(0)
s_endpgm
L_G0:
L_G1:
s_waitcnt vmcnt(0)
s_barrier
s_cmp_lg_u32 s47, 0
s_cbranch_scc1 Larr_297
s_getreg_b32 s60, hwreg(HW_REG_XCC_ID)
s_and_b32 s60, s60, 7
s_lshr_b32 s61, s56, 5
s_cmp_eq_u32 s60, s61
s_cselect_b32 s60, 1, 0x10001
s_mov_b64 exec, 1
v_mov_b32 v1, s60
v_mov_b32 v2, 136
buffer_atomic_add v1, v2, s[8:11], 0 offen sc1
s_mov_b64 exec, -1
Larr_297:
v_lshlrev_b32 v1, 4, v0
v_lshlrev_b32 v6, 2, v0
v_and_b32 v14, 15, v0
v_lshrrev_b32 v15, 4, v0
v_mov_b32 v4, 1
v_mov_b32 v5, 0
s_sub_u32 s62, s58, 24
s_lshr_b32 s62, s62, 1
v_lshlrev_b32 v7, 13, v15
v_lshrrev_b32 v8, 2, v14
v_lshl_add_u32 v7, v8, 6, v7
v_and_b32 v8, 3, v14
v_lshl_add_u32 v7, v8, 2, v7
s_lshl_b32 s60, s62, 8
s_lshl_b32 s61, s47, 4
s_add_u32 s60, s60, s61
v_add_u32 v7, s60, v7
s_mov_b32 s12, s36
s_mov_b32 s13, s37
s_mov_b32 s14, 1409024
s_mov_b32 s15, 0x00020000
buffer_load_dword v24, v7, s[12:15], 0 offen offset:0
buffer_load_dword v25, v7, s[12:15], 0 offen offset:1024
buffer_load_dword v26, v7, s[12:15], 0 offen offset:2048
buffer_load_dword v27, v7, s[12:15], 0 offen offset:3072
s_mov_b32 s60, 4096
buffer_load_dword v28, v7, s[12:15], s60 offen
s_mov_b32 s60, 5120
buffer_load_dword v29, v7, s[12:15], s60 offen
s_mov_b32 s60, 6144
buffer_load_dword v30, v7, s[12:15], s60 offen
s_mov_b32 s60, 7168
buffer_load_dword v31, v7, s[12:15], s60 offen
s_mov_b32 s60, 32768
buffer_load_dword v32, v7, s[12:15], s60 offen
s_mov_b32 s60, 33792
buffer_load_dword v33, v7, s[12:15], s60 offen
s_mov_b32 s60, 34816
buffer_load_dword v34, v7, s[12:15], s60 offen
s_mov_b32 s60, 35840
buffer_load_dword v35, v7, s[12:15], s60 offen
s_mov_b32 s60, 36864
buffer_load_dword v36, v7, s[12:15], s60 offen
s_mov_b32 s60, 37888
buffer_load_dword v37, v7, s[12:15], s60 offen
s_mov_b32 s60, 38912
buffer_load_dword v38, v7, s[12:15], s60 offen
s_mov_b32 s60, 39936
buffer_load_dword v39, v7, s[12:15], s60 offen
s_mov_b32 s60, 65536
buffer_load_dword v40, v7, s[12:15], s60 offen
s_mov_b32 s60, 66560
buffer_load_dword v41, v7, s[12:15], s60 offen
s_mov_b32 s60, 67584
buffer_load_dword v42, v7, s[12:15], s60 offen
s_mov_b32 s60, 68608
buffer_load_dword v43, v7, s[12:15], s60 offen
s_mov_b32 s60, 69632
buffer_load_dword v44, v7, s[12:15], s60 offen
s_mov_b32 s60, 70656
buffer_load_dword v45, v7, s[12:15], s60 offen
s_mov_b32 s60, 71680
buffer_load_dword v46, v7, s[12:15], s60 offen
s_mov_b32 s60, 72704
buffer_load_dword v47, v7, s[12:15], s60 offen
s_mov_b32 s60, 98304
buffer_load_dword v48, v7, s[12:15], s60 offen
s_mov_b32 s60, 99328
buffer_load_dword v49, v7, s[12:15], s60 offen
s_mov_b32 s60, 100352
buffer_load_dword v50, v7, s[12:15], s60 offen
s_mov_b32 s60, 101376
buffer_load_dword v51, v7, s[12:15], s60 offen
s_mov_b32 s60, 102400
buffer_load_dword v52, v7, s[12:15], s60 offen
s_mov_b32 s60, 103424
buffer_load_dword v53, v7, s[12:15], s60 offen
s_mov_b32 s60, 104448
buffer_load_dword v54, v7, s[12:15], s60 offen
s_mov_b32 s60, 105472
buffer_load_dword v55, v7, s[12:15], s60 offen
s_mov_b32 s60, 131072
buffer_load_dword v56, v7, s[12:15], s60 offen
s_mov_b32 s60, 132096
buffer_load_dword v57, v7, s[12:15], s60 offen
s_mov_b32 s60, 133120
buffer_load_dword v58, v7, s[12:15], s60 offen
s_mov_b32 s60, 134144
buffer_load_dword v59, v7, s[12:15], s60 offen
s_mov_b32 s60, 135168
buffer_load_dword v60, v7, s[12:15], s60 offen
s_mov_b32 s60, 136192
buffer_load_dword v61, v7, s[12:15], s60 offen
s_mov_b32 s60, 137216
buffer_load_dword v62, v7, s[12:15], s60 offen
s_mov_b32 s60, 138240
buffer_load_dword v63, v7, s[12:15], s60 offen
s_mov_b32 s60, 163840
buffer_load_dword v64, v7, s[12:15], s60 offen
s_mov_b32 s60, 164864
buffer_load_dword v65, v7, s[12:15], s60 offen
s_mov_b32 s60, 165888
buffer_load_dword v66, v7, s[12:15], s60 offen
s_mov_b32 s60, 166912
buffer_load_dword v67, v7, s[12:15], s60 offen
s_mov_b32 s60, 167936
buffer_load_dword v68, v7, s[12:15], s60 offen
s_mov_b32 s60, 168960
buffer_load_dword v69, v7, s[12:15], s60 offen
s_mov_b32 s60, 169984
buffer_load_dword v70, v7, s[12:15], s60 offen
s_mov_b32 s60, 171008
buffer_load_dword v71, v7, s[12:15], s60 offen
s_mov_b32 s60, 196608
buffer_load_dword v72, v7, s[12:15], s60 offen
s_mov_b32 s60, 197632
buffer_load_dword v73, v7, s[12:15], s60 offen
s_mov_b32 s60, 198656
buffer_load_dword v74, v7, s[12:15], s60 offen
s_mov_b32 s60, 199680
buffer_load_dword v75, v7, s[12:15], s60 offen
s_mov_b32 s60, 200704
buffer_load_dword v76, v7, s[12:15], s60 offen
s_mov_b32 s60, 201728
buffer_load_dword v77, v7, s[12:15], s60 offen
s_mov_b32 s60, 202752
buffer_load_dword v78, v7, s[12:15], s60 offen
s_mov_b32 s60, 203776
buffer_load_dword v79, v7, s[12:15], s60 offen
s_mov_b32 s60, 229376
buffer_load_dword v80, v7, s[12:15], s60 offen
s_mov_b32 s60, 230400
buffer_load_dword v81, v7, s[12:15], s60 offen
s_mov_b32 s60, 231424
buffer_load_dword v82, v7, s[12:15], s60 offen
s_mov_b32 s60, 232448
buffer_load_dword v83, v7, s[12:15], s60 offen
s_mov_b32 s60, 233472
buffer_load_dword v84, v7, s[12:15], s60 offen
s_mov_b32 s60, 234496
buffer_load_dword v85, v7, s[12:15], s60 offen
s_mov_b32 s60, 235520
buffer_load_dword v86, v7, s[12:15], s60 offen
s_mov_b32 s60, 236544
buffer_load_dword v87, v7, s[12:15], s60 offen
s_waitcnt vmcnt(48)
v_perm_b32 v88, v25, v24, s44
v_accvgpr_write_b32 a0, v88
v_perm_b32 v89, v27, v26, s44
v_accvgpr_write_b32 a1, v89
v_perm_b32 v90, v29, v28, s44
v_accvgpr_write_b32 a2, v90
v_perm_b32 v91, v31, v30, s44
v_accvgpr_write_b32 a3, v91
v_perm_b32 v92, v25, v24, s45
v_accvgpr_write_b32 a128, v92
v_perm_b32 v93, v27, v26, s45
v_accvgpr_write_b32 a129, v93
v_perm_b32 v94, v29, v28, s45
v_accvgpr_write_b32 a130, v94
v_perm_b32 v95, v31, v30, s45
v_accvgpr_write_b32 a131, v95
v_perm_b32 v88, v33, v32, s44
v_accvgpr_write_b32 a4, v88
v_perm_b32 v89, v35, v34, s44
v_accvgpr_write_b32 a5, v89
v_perm_b32 v90, v37, v36, s44
v_accvgpr_write_b32 a6, v90
v_perm_b32 v91, v39, v38, s44
v_accvgpr_write_b32 a7, v91
v_perm_b32 v92, v33, v32, s45
v_accvgpr_write_b32 a132, v92
v_perm_b32 v93, v35, v34, s45
v_accvgpr_write_b32 a133, v93
v_perm_b32 v94, v37, v36, s45
v_accvgpr_write_b32 a134, v94
v_perm_b32 v95, v39, v38, s45
v_accvgpr_write_b32 a135, v95
s_mov_b32 s60, 262144
buffer_load_dword v24, v7, s[12:15], s60 offen
s_mov_b32 s60, 263168
buffer_load_dword v25, v7, s[12:15], s60 offen
s_mov_b32 s60, 264192
buffer_load_dword v26, v7, s[12:15], s60 offen
s_mov_b32 s60, 265216
buffer_load_dword v27, v7, s[12:15], s60 offen
s_mov_b32 s60, 266240
buffer_load_dword v28, v7, s[12:15], s60 offen
s_mov_b32 s60, 267264
buffer_load_dword v29, v7, s[12:15], s60 offen
s_mov_b32 s60, 268288
buffer_load_dword v30, v7, s[12:15], s60 offen
s_mov_b32 s60, 269312
buffer_load_dword v31, v7, s[12:15], s60 offen
s_mov_b32 s60, 294912
buffer_load_dword v32, v7, s[12:15], s60 offen
s_mov_b32 s60, 295936
buffer_load_dword v33, v7, s[12:15], s60 offen
s_mov_b32 s60, 296960
buffer_load_dword v34, v7, s[12:15], s60 offen
s_mov_b32 s60, 297984
buffer_load_dword v35, v7, s[12:15], s60 offen
s_mov_b32 s60, 299008
buffer_load_dword v36, v7, s[12:15], s60 offen
s_mov_b32 s60, 300032
buffer_load_dword v37, v7, s[12:15], s60 offen
s_mov_b32 s60, 301056
buffer_load_dword v38, v7, s[12:15], s60 offen
s_mov_b32 s60, 302080
buffer_load_dword v39, v7, s[12:15], s60 offen
s_waitcnt vmcnt(48)
v_perm_b32 v88, v41, v40, s44
v_accvgpr_write_b32 a8, v88
v_perm_b32 v89, v43, v42, s44
v_accvgpr_write_b32 a9, v89
v_perm_b32 v90, v45, v44, s44
v_accvgpr_write_b32 a10, v90
v_perm_b32 v91, v47, v46, s44
v_accvgpr_write_b32 a11, v91
v_perm_b32 v92, v41, v40, s45
v_accvgpr_write_b32 a136, v92
v_perm_b32 v93, v43, v42, s45
v_accvgpr_write_b32 a137, v93
v_perm_b32 v94, v45, v44, s45
v_accvgpr_write_b32 a138, v94
v_perm_b32 v95, v47, v46, s45
v_accvgpr_write_b32 a139, v95
v_perm_b32 v88, v49, v48, s44
v_accvgpr_write_b32 a12, v88
v_perm_b32 v89, v51, v50, s44
v_accvgpr_write_b32 a13, v89
v_perm_b32 v90, v53, v52, s44
v_accvgpr_write_b32 a14, v90
v_perm_b32 v91, v55, v54, s44
v_accvgpr_write_b32 a15, v91
v_perm_b32 v92, v49, v48, s45
v_accvgpr_write_b32 a140, v92
v_perm_b32 v93, v51, v50, s45
v_accvgpr_write_b32 a141, v93
v_perm_b32 v94, v53, v52, s45
v_accvgpr_write_b32 a142, v94
v_perm_b32 v95, v55, v54, s45
v_accvgpr_write_b32 a143, v95
s_mov_b32 s60, 327680
buffer_load_dword v40, v7, s[12:15], s60 offen
s_mov_b32 s60, 328704
buffer_load_dword v41, v7, s[12:15], s60 offen
s_mov_b32 s60, 329728
buffer_load_dword v42, v7, s[12:15], s60 offen
s_mov_b32 s60, 330752
buffer_load_dword v43, v7, s[12:15], s60 offen
s_mov_b32 s60, 331776
buffer_load_dword v44, v7, s[12:15], s60 offen
s_mov_b32 s60, 332800
buffer_load_dword v45, v7, s[12:15], s60 offen
s_mov_b32 s60, 333824
buffer_load_dword v46, v7, s[12:15], s60 offen
s_mov_b32 s60, 334848
buffer_load_dword v47, v7, s[12:15], s60 offen
s_mov_b32 s60, 360448
buffer_load_dword v48, v7, s[12:15], s60 offen
s_mov_b32 s60, 361472
buffer_load_dword v49, v7, s[12:15], s60 offen
s_mov_b32 s60, 362496
buffer_load_dword v50, v7, s[12:15], s60 offen
s_mov_b32 s60, 363520
buffer_load_dword v51, v7, s[12:15], s60 offen
s_mov_b32 s60, 364544
buffer_load_dword v52, v7, s[12:15], s60 offen
s_mov_b32 s60, 365568
buffer_load_dword v53, v7, s[12:15], s60 offen
s_mov_b32 s60, 366592
buffer_load_dword v54, v7, s[12:15], s60 offen
s_mov_b32 s60, 367616
buffer_load_dword v55, v7, s[12:15], s60 offen
s_waitcnt vmcnt(48)
v_perm_b32 v88, v57, v56, s44
v_accvgpr_write_b32 a16, v88
v_perm_b32 v89, v59, v58, s44
v_accvgpr_write_b32 a17, v89
v_perm_b32 v90, v61, v60, s44
v_accvgpr_write_b32 a18, v90
v_perm_b32 v91, v63, v62, s44
v_accvgpr_write_b32 a19, v91
v_perm_b32 v92, v57, v56, s45
v_accvgpr_write_b32 a144, v92
v_perm_b32 v93, v59, v58, s45
v_accvgpr_write_b32 a145, v93
v_perm_b32 v94, v61, v60, s45
v_accvgpr_write_b32 a146, v94
v_perm_b32 v95, v63, v62, s45
v_accvgpr_write_b32 a147, v95
v_perm_b32 v88, v65, v64, s44
v_accvgpr_write_b32 a20, v88
v_perm_b32 v89, v67, v66, s44
v_accvgpr_write_b32 a21, v89
v_perm_b32 v90, v69, v68, s44
v_accvgpr_write_b32 a22, v90
v_perm_b32 v91, v71, v70, s44
v_accvgpr_write_b32 a23, v91
v_perm_b32 v92, v65, v64, s45
v_accvgpr_write_b32 a148, v92
v_perm_b32 v93, v67, v66, s45
v_accvgpr_write_b32 a149, v93
v_perm_b32 v94, v69, v68, s45
v_accvgpr_write_b32 a150, v94
v_perm_b32 v95, v71, v70, s45
v_accvgpr_write_b32 a151, v95
s_mov_b32 s60, 393216
buffer_load_dword v56, v7, s[12:15], s60 offen
s_mov_b32 s60, 394240
buffer_load_dword v57, v7, s[12:15], s60 offen
s_mov_b32 s60, 395264
buffer_load_dword v58, v7, s[12:15], s60 offen
s_mov_b32 s60, 396288
buffer_load_dword v59, v7, s[12:15], s60 offen
s_mov_b32 s60, 397312
buffer_load_dword v60, v7, s[12:15], s60 offen
s_mov_b32 s60, 398336
buffer_load_dword v61, v7, s[12:15], s60 offen
s_mov_b32 s60, 399360
buffer_load_dword v62, v7, s[12:15], s60 offen
s_mov_b32 s60, 400384
buffer_load_dword v63, v7, s[12:15], s60 offen
s_mov_b32 s60, 425984
buffer_load_dword v64, v7, s[12:15], s60 offen
s_mov_b32 s60, 427008
buffer_load_dword v65, v7, s[12:15], s60 offen
s_mov_b32 s60, 428032
buffer_load_dword v66, v7, s[12:15], s60 offen
s_mov_b32 s60, 429056
buffer_load_dword v67, v7, s[12:15], s60 offen
s_mov_b32 s60, 430080
buffer_load_dword v68, v7, s[12:15], s60 offen
s_mov_b32 s60, 431104
buffer_load_dword v69, v7, s[12:15], s60 offen
s_mov_b32 s60, 432128
buffer_load_dword v70, v7, s[12:15], s60 offen
s_mov_b32 s60, 433152
buffer_load_dword v71, v7, s[12:15], s60 offen
s_waitcnt vmcnt(48)
v_perm_b32 v88, v73, v72, s44
v_accvgpr_write_b32 a24, v88
v_perm_b32 v89, v75, v74, s44
v_accvgpr_write_b32 a25, v89
v_perm_b32 v90, v77, v76, s44
v_accvgpr_write_b32 a26, v90
v_perm_b32 v91, v79, v78, s44
v_accvgpr_write_b32 a27, v91
v_perm_b32 v92, v73, v72, s45
v_accvgpr_write_b32 a152, v92
v_perm_b32 v93, v75, v74, s45
v_accvgpr_write_b32 a153, v93
v_perm_b32 v94, v77, v76, s45
v_accvgpr_write_b32 a154, v94
v_perm_b32 v95, v79, v78, s45
v_accvgpr_write_b32 a155, v95
v_perm_b32 v88, v81, v80, s44
v_accvgpr_write_b32 a28, v88
v_perm_b32 v89, v83, v82, s44
v_accvgpr_write_b32 a29, v89
v_perm_b32 v90, v85, v84, s44
v_accvgpr_write_b32 a30, v90
v_perm_b32 v91, v87, v86, s44
v_accvgpr_write_b32 a31, v91
v_perm_b32 v92, v81, v80, s45
v_accvgpr_write_b32 a156, v92
v_perm_b32 v93, v83, v82, s45
v_accvgpr_write_b32 a157, v93
v_perm_b32 v94, v85, v84, s45
v_accvgpr_write_b32 a158, v94
v_perm_b32 v95, v87, v86, s45
v_accvgpr_write_b32 a159, v95
s_mov_b32 s60, 458752
buffer_load_dword v72, v7, s[12:15], s60 offen
s_mov_b32 s60, 459776
buffer_load_dword v73, v7, s[12:15], s60 offen
s_mov_b32 s60, 460800
buffer_load_dword v74, v7, s[12:15], s60 offen
s_mov_b32 s60, 461824
buffer_load_dword v75, v7, s[12:15], s60 offen
s_mov_b32 s60, 462848
buffer_load_dword v76, v7, s[12:15], s60 offen
s_mov_b32 s60, 463872
buffer_load_dword v77, v7, s[12:15], s60 offen
s_mov_b32 s60, 464896
buffer_load_dword v78, v7, s[12:15], s60 offen
s_mov_b32 s60, 465920
buffer_load_dword v79, v7, s[12:15], s60 offen
s_mov_b32 s60, 491520
buffer_load_dword v80, v7, s[12:15], s60 offen
s_mov_b32 s60, 492544
buffer_load_dword v81, v7, s[12:15], s60 offen
s_mov_b32 s60, 493568
buffer_load_dword v82, v7, s[12:15], s60 offen
s_mov_b32 s60, 494592
buffer_load_dword v83, v7, s[12:15], s60 offen
s_mov_b32 s60, 495616
buffer_load_dword v84, v7, s[12:15], s60 offen
s_mov_b32 s60, 496640
buffer_load_dword v85, v7, s[12:15], s60 offen
s_mov_b32 s60, 497664
buffer_load_dword v86, v7, s[12:15], s60 offen
s_mov_b32 s60, 498688
buffer_load_dword v87, v7, s[12:15], s60 offen
s_waitcnt vmcnt(48)
v_perm_b32 v88, v25, v24, s44
v_accvgpr_write_b32 a32, v88
v_perm_b32 v89, v27, v26, s44
v_accvgpr_write_b32 a33, v89
v_perm_b32 v90, v29, v28, s44
v_accvgpr_write_b32 a34, v90
v_perm_b32 v91, v31, v30, s44
v_accvgpr_write_b32 a35, v91
v_perm_b32 v92, v25, v24, s45
v_accvgpr_write_b32 a160, v92
v_perm_b32 v93, v27, v26, s45
v_accvgpr_write_b32 a161, v93
v_perm_b32 v94, v29, v28, s45
v_accvgpr_write_b32 a162, v94
v_perm_b32 v95, v31, v30, s45
v_accvgpr_write_b32 a163, v95
v_perm_b32 v88, v33, v32, s44
v_accvgpr_write_b32 a36, v88
v_perm_b32 v89, v35, v34, s44
v_accvgpr_write_b32 a37, v89
v_perm_b32 v90, v37, v36, s44
v_accvgpr_write_b32 a38, v90
v_perm_b32 v91, v39, v38, s44
v_accvgpr_write_b32 a39, v91
v_perm_b32 v92, v33, v32, s45
v_accvgpr_write_b32 a164, v92
v_perm_b32 v93, v35, v34, s45
v_accvgpr_write_b32 a165, v93
v_perm_b32 v94, v37, v36, s45
v_accvgpr_write_b32 a166, v94
v_perm_b32 v95, v39, v38, s45
v_accvgpr_write_b32 a167, v95
s_mov_b32 s60, 524288
buffer_load_dword v24, v7, s[12:15], s60 offen
s_mov_b32 s60, 525312
buffer_load_dword v25, v7, s[12:15], s60 offen
s_mov_b32 s60, 526336
buffer_load_dword v26, v7, s[12:15], s60 offen
s_mov_b32 s60, 527360
buffer_load_dword v27, v7, s[12:15], s60 offen
s_mov_b32 s60, 528384
buffer_load_dword v28, v7, s[12:15], s60 offen
s_mov_b32 s60, 529408
buffer_load_dword v29, v7, s[12:15], s60 offen
s_mov_b32 s60, 530432
buffer_load_dword v30, v7, s[12:15], s60 offen
s_mov_b32 s60, 531456
buffer_load_dword v31, v7, s[12:15], s60 offen
s_mov_b32 s60, 557056
buffer_load_dword v32, v7, s[12:15], s60 offen
s_mov_b32 s60, 558080
buffer_load_dword v33, v7, s[12:15], s60 offen
s_mov_b32 s60, 559104
buffer_load_dword v34, v7, s[12:15], s60 offen
s_mov_b32 s60, 560128
buffer_load_dword v35, v7, s[12:15], s60 offen
s_mov_b32 s60, 561152
buffer_load_dword v36, v7, s[12:15], s60 offen
s_mov_b32 s60, 562176
buffer_load_dword v37, v7, s[12:15], s60 offen
s_mov_b32 s60, 563200
buffer_load_dword v38, v7, s[12:15], s60 offen
s_mov_b32 s60, 564224
buffer_load_dword v39, v7, s[12:15], s60 offen
s_waitcnt vmcnt(48)
v_perm_b32 v88, v41, v40, s44
v_accvgpr_write_b32 a40, v88
v_perm_b32 v89, v43, v42, s44
v_accvgpr_write_b32 a41, v89
v_perm_b32 v90, v45, v44, s44
v_accvgpr_write_b32 a42, v90
v_perm_b32 v91, v47, v46, s44
v_accvgpr_write_b32 a43, v91
v_perm_b32 v92, v41, v40, s45
v_accvgpr_write_b32 a168, v92
v_perm_b32 v93, v43, v42, s45
v_accvgpr_write_b32 a169, v93
v_perm_b32 v94, v45, v44, s45
v_accvgpr_write_b32 a170, v94
v_perm_b32 v95, v47, v46, s45
v_accvgpr_write_b32 a171, v95
v_perm_b32 v88, v49, v48, s44
v_accvgpr_write_b32 a44, v88
v_perm_b32 v89, v51, v50, s44
v_accvgpr_write_b32 a45, v89
v_perm_b32 v90, v53, v52, s44
v_accvgpr_write_b32 a46, v90
v_perm_b32 v91, v55, v54, s44
v_accvgpr_write_b32 a47, v91
v_perm_b32 v92, v49, v48, s45
v_accvgpr_write_b32 a172, v92
v_perm_b32 v93, v51, v50, s45
v_accvgpr_write_b32 a173, v93
v_perm_b32 v94, v53, v52, s45
v_accvgpr_write_b32 a174, v94
v_perm_b32 v95, v55, v54, s45
v_accvgpr_write_b32 a175, v95
s_mov_b32 s60, 589824
buffer_load_dword v40, v7, s[12:15], s60 offen
s_mov_b32 s60, 590848
buffer_load_dword v41, v7, s[12:15], s60 offen
s_mov_b32 s60, 591872
buffer_load_dword v42, v7, s[12:15], s60 offen
s_mov_b32 s60, 592896
buffer_load_dword v43, v7, s[12:15], s60 offen
s_mov_b32 s60, 593920
buffer_load_dword v44, v7, s[12:15], s60 offen
s_mov_b32 s60, 594944
buffer_load_dword v45, v7, s[12:15], s60 offen
s_mov_b32 s60, 595968
buffer_load_dword v46, v7, s[12:15], s60 offen
s_mov_b32 s60, 596992
buffer_load_dword v47, v7, s[12:15], s60 offen
s_mov_b32 s60, 622592
buffer_load_dword v48, v7, s[12:15], s60 offen
s_mov_b32 s60, 623616
buffer_load_dword v49, v7, s[12:15], s60 offen
s_mov_b32 s60, 624640
buffer_load_dword v50, v7, s[12:15], s60 offen
s_mov_b32 s60, 625664
buffer_load_dword v51, v7, s[12:15], s60 offen
s_mov_b32 s60, 626688
buffer_load_dword v52, v7, s[12:15], s60 offen
s_mov_b32 s60, 627712
buffer_load_dword v53, v7, s[12:15], s60 offen
s_mov_b32 s60, 628736
buffer_load_dword v54, v7, s[12:15], s60 offen
s_mov_b32 s60, 629760
buffer_load_dword v55, v7, s[12:15], s60 offen
s_waitcnt vmcnt(48)
v_perm_b32 v88, v57, v56, s44
v_accvgpr_write_b32 a48, v88
v_perm_b32 v89, v59, v58, s44
v_accvgpr_write_b32 a49, v89
v_perm_b32 v90, v61, v60, s44
v_accvgpr_write_b32 a50, v90
v_perm_b32 v91, v63, v62, s44
v_accvgpr_write_b32 a51, v91
v_perm_b32 v92, v57, v56, s45
v_accvgpr_write_b32 a176, v92
v_perm_b32 v93, v59, v58, s45
v_accvgpr_write_b32 a177, v93
v_perm_b32 v94, v61, v60, s45
v_accvgpr_write_b32 a178, v94
v_perm_b32 v95, v63, v62, s45
v_accvgpr_write_b32 a179, v95
v_perm_b32 v88, v65, v64, s44
v_accvgpr_write_b32 a52, v88
v_perm_b32 v89, v67, v66, s44
v_accvgpr_write_b32 a53, v89
v_perm_b32 v90, v69, v68, s44
v_accvgpr_write_b32 a54, v90
v_perm_b32 v91, v71, v70, s44
v_accvgpr_write_b32 a55, v91
v_perm_b32 v92, v65, v64, s45
v_accvgpr_write_b32 a180, v92
v_perm_b32 v93, v67, v66, s45
v_accvgpr_write_b32 a181, v93
v_perm_b32 v94, v69, v68, s45
v_accvgpr_write_b32 a182, v94
v_perm_b32 v95, v71, v70, s45
v_accvgpr_write_b32 a183, v95
s_mov_b32 s60, 655360
buffer_load_dword v56, v7, s[12:15], s60 offen
s_mov_b32 s60, 656384
buffer_load_dword v57, v7, s[12:15], s60 offen
s_mov_b32 s60, 657408
buffer_load_dword v58, v7, s[12:15], s60 offen
s_mov_b32 s60, 658432
buffer_load_dword v59, v7, s[12:15], s60 offen
s_mov_b32 s60, 659456
buffer_load_dword v60, v7, s[12:15], s60 offen
s_mov_b32 s60, 660480
buffer_load_dword v61, v7, s[12:15], s60 offen
s_mov_b32 s60, 661504
buffer_load_dword v62, v7, s[12:15], s60 offen
s_mov_b32 s60, 662528
buffer_load_dword v63, v7, s[12:15], s60 offen
s_mov_b32 s60, 688128
buffer_load_dword v64, v7, s[12:15], s60 offen
s_mov_b32 s60, 689152
buffer_load_dword v65, v7, s[12:15], s60 offen
s_mov_b32 s60, 690176
buffer_load_dword v66, v7, s[12:15], s60 offen
s_mov_b32 s60, 691200
buffer_load_dword v67, v7, s[12:15], s60 offen
s_mov_b32 s60, 692224
buffer_load_dword v68, v7, s[12:15], s60 offen
s_mov_b32 s60, 693248
buffer_load_dword v69, v7, s[12:15], s60 offen
s_mov_b32 s60, 694272
buffer_load_dword v70, v7, s[12:15], s60 offen
s_mov_b32 s60, 695296
buffer_load_dword v71, v7, s[12:15], s60 offen
s_waitcnt vmcnt(48)
v_perm_b32 v88, v73, v72, s44
v_accvgpr_write_b32 a56, v88
v_perm_b32 v89, v75, v74, s44
v_accvgpr_write_b32 a57, v89
v_perm_b32 v90, v77, v76, s44
v_accvgpr_write_b32 a58, v90
v_perm_b32 v91, v79, v78, s44
v_accvgpr_write_b32 a59, v91
v_perm_b32 v92, v73, v72, s45
v_accvgpr_write_b32 a184, v92
v_perm_b32 v93, v75, v74, s45
v_accvgpr_write_b32 a185, v93
v_perm_b32 v94, v77, v76, s45
v_accvgpr_write_b32 a186, v94
v_perm_b32 v95, v79, v78, s45
v_accvgpr_write_b32 a187, v95
v_perm_b32 v88, v81, v80, s44
v_accvgpr_write_b32 a60, v88
v_perm_b32 v89, v83, v82, s44
v_accvgpr_write_b32 a61, v89
v_perm_b32 v90, v85, v84, s44
v_accvgpr_write_b32 a62, v90
v_perm_b32 v91, v87, v86, s44
v_accvgpr_write_b32 a63, v91
v_perm_b32 v92, v81, v80, s45
v_accvgpr_write_b32 a188, v92
v_perm_b32 v93, v83, v82, s45
v_accvgpr_write_b32 a189, v93
v_perm_b32 v94, v85, v84, s45
v_accvgpr_write_b32 a190, v94
v_perm_b32 v95, v87, v86, s45
v_accvgpr_write_b32 a191, v95
s_mov_b32 s60, 720896
buffer_load_dword v72, v7, s[12:15], s60 offen
s_mov_b32 s60, 721920
buffer_load_dword v73, v7, s[12:15], s60 offen
s_mov_b32 s60, 722944
buffer_load_dword v74, v7, s[12:15], s60 offen
s_mov_b32 s60, 723968
buffer_load_dword v75, v7, s[12:15], s60 offen
s_mov_b32 s60, 724992
buffer_load_dword v76, v7, s[12:15], s60 offen
s_mov_b32 s60, 726016
buffer_load_dword v77, v7, s[12:15], s60 offen
s_mov_b32 s60, 727040
buffer_load_dword v78, v7, s[12:15], s60 offen
s_mov_b32 s60, 728064
buffer_load_dword v79, v7, s[12:15], s60 offen
s_mov_b32 s60, 753664
buffer_load_dword v80, v7, s[12:15], s60 offen
s_mov_b32 s60, 754688
buffer_load_dword v81, v7, s[12:15], s60 offen
s_mov_b32 s60, 755712
buffer_load_dword v82, v7, s[12:15], s60 offen
s_mov_b32 s60, 756736
buffer_load_dword v83, v7, s[12:15], s60 offen
s_mov_b32 s60, 757760
buffer_load_dword v84, v7, s[12:15], s60 offen
s_mov_b32 s60, 758784
buffer_load_dword v85, v7, s[12:15], s60 offen
s_mov_b32 s60, 759808
buffer_load_dword v86, v7, s[12:15], s60 offen
s_mov_b32 s60, 760832
buffer_load_dword v87, v7, s[12:15], s60 offen
s_waitcnt vmcnt(48)
v_perm_b32 v88, v25, v24, s44
v_accvgpr_write_b32 a64, v88
v_perm_b32 v89, v27, v26, s44
v_accvgpr_write_b32 a65, v89
v_perm_b32 v90, v29, v28, s44
v_accvgpr_write_b32 a66, v90
v_perm_b32 v91, v31, v30, s44
v_accvgpr_write_b32 a67, v91
v_perm_b32 v92, v25, v24, s45
v_accvgpr_write_b32 a192, v92
v_perm_b32 v93, v27, v26, s45
v_accvgpr_write_b32 a193, v93
v_perm_b32 v94, v29, v28, s45
v_accvgpr_write_b32 a194, v94
v_perm_b32 v95, v31, v30, s45
v_accvgpr_write_b32 a195, v95
v_perm_b32 v88, v33, v32, s44
v_accvgpr_write_b32 a68, v88
v_perm_b32 v89, v35, v34, s44
v_accvgpr_write_b32 a69, v89
v_perm_b32 v90, v37, v36, s44
v_accvgpr_write_b32 a70, v90
v_perm_b32 v91, v39, v38, s44
v_accvgpr_write_b32 a71, v91
v_perm_b32 v92, v33, v32, s45
v_accvgpr_write_b32 a196, v92
v_perm_b32 v93, v35, v34, s45
v_accvgpr_write_b32 a197, v93
v_perm_b32 v94, v37, v36, s45
v_accvgpr_write_b32 a198, v94
v_perm_b32 v95, v39, v38, s45
v_accvgpr_write_b32 a199, v95
s_mov_b32 s60, 786432
buffer_load_dword v24, v7, s[12:15], s60 offen
s_mov_b32 s60, 787456
buffer_load_dword v25, v7, s[12:15], s60 offen
s_mov_b32 s60, 788480
buffer_load_dword v26, v7, s[12:15], s60 offen
s_mov_b32 s60, 789504
buffer_load_dword v27, v7, s[12:15], s60 offen
s_mov_b32 s60, 790528
buffer_load_dword v28, v7, s[12:15], s60 offen
s_mov_b32 s60, 791552
buffer_load_dword v29, v7, s[12:15], s60 offen
s_mov_b32 s60, 792576
buffer_load_dword v30, v7, s[12:15], s60 offen
s_mov_b32 s60, 793600
buffer_load_dword v31, v7, s[12:15], s60 offen
s_mov_b32 s60, 819200
buffer_load_dword v32, v7, s[12:15], s60 offen
s_mov_b32 s60, 820224
buffer_load_dword v33, v7, s[12:15], s60 offen
s_mov_b32 s60, 821248
buffer_load_dword v34, v7, s[12:15], s60 offen
s_mov_b32 s60, 822272
buffer_load_dword v35, v7, s[12:15], s60 offen
s_mov_b32 s60, 823296
buffer_load_dword v36, v7, s[12:15], s60 offen
s_mov_b32 s60, 824320
buffer_load_dword v37, v7, s[12:15], s60 offen
s_mov_b32 s60, 825344
buffer_load_dword v38, v7, s[12:15], s60 offen
s_mov_b32 s60, 826368
buffer_load_dword v39, v7, s[12:15], s60 offen
s_waitcnt vmcnt(48)
v_perm_b32 v88, v41, v40, s44
v_accvgpr_write_b32 a72, v88
v_perm_b32 v89, v43, v42, s44
v_accvgpr_write_b32 a73, v89
v_perm_b32 v90, v45, v44, s44
v_accvgpr_write_b32 a74, v90
v_perm_b32 v91, v47, v46, s44
v_accvgpr_write_b32 a75, v91
v_perm_b32 v92, v41, v40, s45
v_accvgpr_write_b32 a200, v92
v_perm_b32 v93, v43, v42, s45
v_accvgpr_write_b32 a201, v93
v_perm_b32 v94, v45, v44, s45
v_accvgpr_write_b32 a202, v94
v_perm_b32 v95, v47, v46, s45
v_accvgpr_write_b32 a203, v95
v_perm_b32 v88, v49, v48, s44
v_accvgpr_write_b32 a76, v88
v_perm_b32 v89, v51, v50, s44
v_accvgpr_write_b32 a77, v89
v_perm_b32 v90, v53, v52, s44
v_accvgpr_write_b32 a78, v90
v_perm_b32 v91, v55, v54, s44
v_accvgpr_write_b32 a79, v91
v_perm_b32 v92, v49, v48, s45
v_accvgpr_write_b32 a204, v92
v_perm_b32 v93, v51, v50, s45
v_accvgpr_write_b32 a205, v93
v_perm_b32 v94, v53, v52, s45
v_accvgpr_write_b32 a206, v94
v_perm_b32 v95, v55, v54, s45
v_accvgpr_write_b32 a207, v95
s_mov_b32 s60, 851968
buffer_load_dword v40, v7, s[12:15], s60 offen
s_mov_b32 s60, 852992
buffer_load_dword v41, v7, s[12:15], s60 offen
s_mov_b32 s60, 854016
buffer_load_dword v42, v7, s[12:15], s60 offen
s_mov_b32 s60, 855040
buffer_load_dword v43, v7, s[12:15], s60 offen
s_mov_b32 s60, 856064
buffer_load_dword v44, v7, s[12:15], s60 offen
s_mov_b32 s60, 857088
buffer_load_dword v45, v7, s[12:15], s60 offen
s_mov_b32 s60, 858112
buffer_load_dword v46, v7, s[12:15], s60 offen
s_mov_b32 s60, 859136
buffer_load_dword v47, v7, s[12:15], s60 offen
s_mov_b32 s60, 884736
buffer_load_dword v48, v7, s[12:15], s60 offen
s_mov_b32 s60, 885760
buffer_load_dword v49, v7, s[12:15], s60 offen
s_mov_b32 s60, 886784
buffer_load_dword v50, v7, s[12:15], s60 offen
s_mov_b32 s60, 887808
buffer_load_dword v51, v7, s[12:15], s60 offen
s_mov_b32 s60, 888832
buffer_load_dword v52, v7, s[12:15], s60 offen
s_mov_b32 s60, 889856
buffer_load_dword v53, v7, s[12:15], s60 offen
s_mov_b32 s60, 890880
buffer_load_dword v54, v7, s[12:15], s60 offen
s_mov_b32 s60, 891904
buffer_load_dword v55, v7, s[12:15], s60 offen
s_waitcnt vmcnt(48)
v_perm_b32 v88, v57, v56, s44
v_accvgpr_write_b32 a80, v88
v_perm_b32 v89, v59, v58, s44
v_accvgpr_write_b32 a81, v89
v_perm_b32 v90, v61, v60, s44
v_accvgpr_write_b32 a82, v90
v_perm_b32 v91, v63, v62, s44
v_accvgpr_write_b32 a83, v91
v_perm_b32 v92, v57, v56, s45
v_accvgpr_write_b32 a208, v92
v_perm_b32 v93, v59, v58, s45
v_accvgpr_write_b32 a209, v93
v_perm_b32 v94, v61, v60, s45
v_accvgpr_write_b32 a210, v94
v_perm_b32 v95, v63, v62, s45
v_accvgpr_write_b32 a211, v95
v_perm_b32 v88, v65, v64, s44
v_accvgpr_write_b32 a84, v88
v_perm_b32 v89, v67, v66, s44
v_accvgpr_write_b32 a85, v89
v_perm_b32 v90, v69, v68, s44
v_accvgpr_write_b32 a86, v90
v_perm_b32 v91, v71, v70, s44
v_accvgpr_write_b32 a87, v91
v_perm_b32 v92, v65, v64, s45
v_accvgpr_write_b32 a212, v92
v_perm_b32 v93, v67, v66, s45
v_accvgpr_write_b32 a213, v93
v_perm_b32 v94, v69, v68, s45
v_accvgpr_write_b32 a214, v94
v_perm_b32 v95, v71, v70, s45
v_accvgpr_write_b32 a215, v95
s_mov_b32 s60, 917504
buffer_load_dword v56, v7, s[12:15], s60 offen
s_mov_b32 s60, 918528
buffer_load_dword v57, v7, s[12:15], s60 offen
s_mov_b32 s60, 919552
buffer_load_dword v58, v7, s[12:15], s60 offen
s_mov_b32 s60, 920576
buffer_load_dword v59, v7, s[12:15], s60 offen
s_mov_b32 s60, 921600
buffer_load_dword v60, v7, s[12:15], s60 offen
s_mov_b32 s60, 922624
buffer_load_dword v61, v7, s[12:15], s60 offen
s_mov_b32 s60, 923648
buffer_load_dword v62, v7, s[12:15], s60 offen
s_mov_b32 s60, 924672
buffer_load_dword v63, v7, s[12:15], s60 offen
s_mov_b32 s60, 950272
buffer_load_dword v64, v7, s[12:15], s60 offen
s_mov_b32 s60, 951296
buffer_load_dword v65, v7, s[12:15], s60 offen
s_mov_b32 s60, 952320
buffer_load_dword v66, v7, s[12:15], s60 offen
s_mov_b32 s60, 953344
buffer_load_dword v67, v7, s[12:15], s60 offen
s_mov_b32 s60, 954368
buffer_load_dword v68, v7, s[12:15], s60 offen
s_mov_b32 s60, 955392
buffer_load_dword v69, v7, s[12:15], s60 offen
s_mov_b32 s60, 956416
buffer_load_dword v70, v7, s[12:15], s60 offen
s_mov_b32 s60, 957440
buffer_load_dword v71, v7, s[12:15], s60 offen
s_waitcnt vmcnt(48)
v_perm_b32 v88, v73, v72, s44
v_accvgpr_write_b32 a88, v88
v_perm_b32 v89, v75, v74, s44
v_accvgpr_write_b32 a89, v89
v_perm_b32 v90, v77, v76, s44
v_accvgpr_write_b32 a90, v90
v_perm_b32 v91, v79, v78, s44
v_accvgpr_write_b32 a91, v91
v_perm_b32 v92, v73, v72, s45
v_accvgpr_write_b32 a216, v92
v_perm_b32 v93, v75, v74, s45
v_accvgpr_write_b32 a217, v93
v_perm_b32 v94, v77, v76, s45
v_accvgpr_write_b32 a218, v94
v_perm_b32 v95, v79, v78, s45
v_accvgpr_write_b32 a219, v95
v_perm_b32 v88, v81, v80, s44
v_accvgpr_write_b32 a92, v88
v_perm_b32 v89, v83, v82, s44
v_accvgpr_write_b32 a93, v89
v_perm_b32 v90, v85, v84, s44
v_accvgpr_write_b32 a94, v90
v_perm_b32 v91, v87, v86, s44
v_accvgpr_write_b32 a95, v91
v_perm_b32 v92, v81, v80, s45
v_accvgpr_write_b32 a220, v92
v_perm_b32 v93, v83, v82, s45
v_accvgpr_write_b32 a221, v93
v_perm_b32 v94, v85, v84, s45
v_accvgpr_write_b32 a222, v94
v_perm_b32 v95, v87, v86, s45
v_accvgpr_write_b32 a223, v95
s_mov_b32 s60, 983040
buffer_load_dword v72, v7, s[12:15], s60 offen
s_mov_b32 s60, 984064
buffer_load_dword v73, v7, s[12:15], s60 offen
s_mov_b32 s60, 985088
buffer_load_dword v74, v7, s[12:15], s60 offen
s_mov_b32 s60, 986112
buffer_load_dword v75, v7, s[12:15], s60 offen
s_mov_b32 s60, 987136
buffer_load_dword v76, v7, s[12:15], s60 offen
s_mov_b32 s60, 988160
buffer_load_dword v77, v7, s[12:15], s60 offen
s_mov_b32 s60, 989184
buffer_load_dword v78, v7, s[12:15], s60 offen
s_mov_b32 s60, 990208
buffer_load_dword v79, v7, s[12:15], s60 offen
s_mov_b32 s60, 1015808
buffer_load_dword v80, v7, s[12:15], s60 offen
s_mov_b32 s60, 1016832
buffer_load_dword v81, v7, s[12:15], s60 offen
s_mov_b32 s60, 1017856
buffer_load_dword v82, v7, s[12:15], s60 offen
s_mov_b32 s60, 1018880
buffer_load_dword v83, v7, s[12:15], s60 offen
s_mov_b32 s60, 1019904
buffer_load_dword v84, v7, s[12:15], s60 offen
s_mov_b32 s60, 1020928
buffer_load_dword v85, v7, s[12:15], s60 offen
s_mov_b32 s60, 1021952
buffer_load_dword v86, v7, s[12:15], s60 offen
s_mov_b32 s60, 1022976
buffer_load_dword v87, v7, s[12:15], s60 offen
s_waitcnt vmcnt(48)
v_perm_b32 v88, v25, v24, s44
v_accvgpr_write_b32 a96, v88
v_perm_b32 v89, v27, v26, s44
v_accvgpr_write_b32 a97, v89
v_perm_b32 v90, v29, v28, s44
v_accvgpr_write_b32 a98, v90
v_perm_b32 v91, v31, v30, s44
v_accvgpr_write_b32 a99, v91
v_perm_b32 v92, v25, v24, s45
v_accvgpr_write_b32 a224, v92
v_perm_b32 v93, v27, v26, s45
v_accvgpr_write_b32 a225, v93
v_perm_b32 v94, v29, v28, s45
v_accvgpr_write_b32 a226, v94
v_perm_b32 v95, v31, v30, s45
v_accvgpr_write_b32 a227, v95
v_perm_b32 v88, v33, v32, s44
v_accvgpr_write_b32 a100, v88
v_perm_b32 v89, v35, v34, s44
v_accvgpr_write_b32 a101, v89
v_perm_b32 v90, v37, v36, s44
v_accvgpr_write_b32 a102, v90
v_perm_b32 v91, v39, v38, s44
v_accvgpr_write_b32 a103, v91
v_perm_b32 v92, v33, v32, s45
v_accvgpr_write_b32 a228, v92
v_perm_b32 v93, v35, v34, s45
v_accvgpr_write_b32 a229, v93
v_perm_b32 v94, v37, v36, s45
v_accvgpr_write_b32 a230, v94
v_perm_b32 v95, v39, v38, s45
v_accvgpr_write_b32 a231, v95
s_mov_b32 s60, 1048576
buffer_load_dword v24, v7, s[12:15], s60 offen
s_mov_b32 s60, 1049600
buffer_load_dword v25, v7, s[12:15], s60 offen
s_mov_b32 s60, 1050624
buffer_load_dword v26, v7, s[12:15], s60 offen
s_mov_b32 s60, 1051648
buffer_load_dword v27, v7, s[12:15], s60 offen
s_mov_b32 s60, 1052672
buffer_load_dword v28, v7, s[12:15], s60 offen
s_mov_b32 s60, 1053696
buffer_load_dword v29, v7, s[12:15], s60 offen
s_mov_b32 s60, 1054720
buffer_load_dword v30, v7, s[12:15], s60 offen
s_mov_b32 s60, 1055744
buffer_load_dword v31, v7, s[12:15], s60 offen
s_mov_b32 s60, 1081344
buffer_load_dword v32, v7, s[12:15], s60 offen
s_mov_b32 s60, 1082368
buffer_load_dword v33, v7, s[12:15], s60 offen
s_mov_b32 s60, 1083392
buffer_load_dword v34, v7, s[12:15], s60 offen
s_mov_b32 s60, 1084416
buffer_load_dword v35, v7, s[12:15], s60 offen
s_mov_b32 s60, 1085440
buffer_load_dword v36, v7, s[12:15], s60 offen
s_mov_b32 s60, 1086464
buffer_load_dword v37, v7, s[12:15], s60 offen
s_mov_b32 s60, 1087488
buffer_load_dword v38, v7, s[12:15], s60 offen
s_mov_b32 s60, 1088512
buffer_load_dword v39, v7, s[12:15], s60 offen
s_waitcnt vmcnt(48)
v_perm_b32 v88, v41, v40, s44
v_accvgpr_write_b32 a104, v88
v_perm_b32 v89, v43, v42, s44
v_accvgpr_write_b32 a105, v89
v_perm_b32 v90, v45, v44, s44
v_accvgpr_write_b32 a106, v90
v_perm_b32 v91, v47, v46, s44
v_accvgpr_write_b32 a107, v91
v_perm_b32 v92, v41, v40, s45
v_accvgpr_write_b32 a232, v92
v_perm_b32 v93, v43, v42, s45
v_accvgpr_write_b32 a233, v93
v_perm_b32 v94, v45, v44, s45
v_accvgpr_write_b32 a234, v94
v_perm_b32 v95, v47, v46, s45
v_accvgpr_write_b32 a235, v95
v_perm_b32 v88, v49, v48, s44
v_accvgpr_write_b32 a108, v88
v_perm_b32 v89, v51, v50, s44
v_accvgpr_write_b32 a109, v89
v_perm_b32 v90, v53, v52, s44
v_accvgpr_write_b32 a110, v90
v_perm_b32 v91, v55, v54, s44
v_accvgpr_write_b32 a111, v91
v_perm_b32 v92, v49, v48, s45
v_accvgpr_write_b32 a236, v92
v_perm_b32 v93, v51, v50, s45
v_accvgpr_write_b32 a237, v93
v_perm_b32 v94, v53, v52, s45
v_accvgpr_write_b32 a238, v94
v_perm_b32 v95, v55, v54, s45
v_accvgpr_write_b32 a239, v95
s_mov_b32 s60, 1114112
buffer_load_dword v40, v7, s[12:15], s60 offen
s_mov_b32 s60, 1115136
buffer_load_dword v41, v7, s[12:15], s60 offen
s_mov_b32 s60, 1116160
buffer_load_dword v42, v7, s[12:15], s60 offen
s_mov_b32 s60, 1117184
buffer_load_dword v43, v7, s[12:15], s60 offen
s_mov_b32 s60, 1118208
buffer_load_dword v44, v7, s[12:15], s60 offen
s_mov_b32 s60, 1119232
buffer_load_dword v45, v7, s[12:15], s60 offen
s_mov_b32 s60, 1120256
buffer_load_dword v46, v7, s[12:15], s60 offen
s_mov_b32 s60, 1121280
buffer_load_dword v47, v7, s[12:15], s60 offen
s_mov_b32 s60, 1146880
buffer_load_dword v48, v7, s[12:15], s60 offen
s_mov_b32 s60, 1147904
buffer_load_dword v49, v7, s[12:15], s60 offen
s_mov_b32 s60, 1148928
buffer_load_dword v50, v7, s[12:15], s60 offen
s_mov_b32 s60, 1149952
buffer_load_dword v51, v7, s[12:15], s60 offen
s_mov_b32 s60, 1150976
buffer_load_dword v52, v7, s[12:15], s60 offen
s_mov_b32 s60, 1152000
buffer_load_dword v53, v7, s[12:15], s60 offen
s_mov_b32 s60, 1153024
buffer_load_dword v54, v7, s[12:15], s60 offen
s_mov_b32 s60, 1154048
buffer_load_dword v55, v7, s[12:15], s60 offen
s_waitcnt vmcnt(48)
v_perm_b32 v88, v57, v56, s44
v_accvgpr_write_b32 a112, v88
v_perm_b32 v89, v59, v58, s44
v_accvgpr_write_b32 a113, v89
v_perm_b32 v90, v61, v60, s44
v_accvgpr_write_b32 a114, v90
v_perm_b32 v91, v63, v62, s44
v_accvgpr_write_b32 a115, v91
v_perm_b32 v92, v57, v56, s45
v_accvgpr_write_b32 a240, v92
v_perm_b32 v93, v59, v58, s45
v_accvgpr_write_b32 a241, v93
v_perm_b32 v94, v61, v60, s45
v_accvgpr_write_b32 a242, v94
v_perm_b32 v95, v63, v62, s45
v_accvgpr_write_b32 a243, v95
v_perm_b32 v88, v65, v64, s44
v_accvgpr_write_b32 a116, v88
v_perm_b32 v89, v67, v66, s44
v_accvgpr_write_b32 a117, v89
v_perm_b32 v90, v69, v68, s44
v_accvgpr_write_b32 a118, v90
v_perm_b32 v91, v71, v70, s44
v_accvgpr_write_b32 a119, v91
v_perm_b32 v92, v65, v64, s45
v_accvgpr_write_b32 a244, v92
v_perm_b32 v93, v67, v66, s45
v_accvgpr_write_b32 a245, v93
v_perm_b32 v94, v69, v68, s45
v_accvgpr_write_b32 a246, v94
v_perm_b32 v95, v71, v70, s45
v_accvgpr_write_b32 a247, v95
s_mov_b32 s60, 1179648
buffer_load_dword v56, v7, s[12:15], s60 offen
s_mov_b32 s60, 1180672
buffer_load_dword v57, v7, s[12:15], s60 offen
s_mov_b32 s60, 1181696
buffer_load_dword v58, v7, s[12:15], s60 offen
s_mov_b32 s60, 1182720
buffer_load_dword v59, v7, s[12:15], s60 offen
s_mov_b32 s60, 1183744
buffer_load_dword v60, v7, s[12:15], s60 offen
s_mov_b32 s60, 1184768
buffer_load_dword v61, v7, s[12:15], s60 offen
s_mov_b32 s60, 1185792
buffer_load_dword v62, v7, s[12:15], s60 offen
s_mov_b32 s60, 1186816
buffer_load_dword v63, v7, s[12:15], s60 offen
s_mov_b32 s60, 1212416
buffer_load_dword v64, v7, s[12:15], s60 offen
s_mov_b32 s60, 1213440
buffer_load_dword v65, v7, s[12:15], s60 offen
s_mov_b32 s60, 1214464
buffer_load_dword v66, v7, s[12:15], s60 offen
s_mov_b32 s60, 1215488
buffer_load_dword v67, v7, s[12:15], s60 offen
s_mov_b32 s60, 1216512
buffer_load_dword v68, v7, s[12:15], s60 offen
s_mov_b32 s60, 1217536
buffer_load_dword v69, v7, s[12:15], s60 offen
s_mov_b32 s60, 1218560
buffer_load_dword v70, v7, s[12:15], s60 offen
s_mov_b32 s60, 1219584
buffer_load_dword v71, v7, s[12:15], s60 offen
s_waitcnt vmcnt(48)
v_perm_b32 v88, v73, v72, s44
v_accvgpr_write_b32 a120, v88
v_perm_b32 v89, v75, v74, s44
v_accvgpr_write_b32 a121, v89
v_perm_b32 v90, v77, v76, s44
v_accvgpr_write_b32 a122, v90
v_perm_b32 v91, v79, v78, s44
v_accvgpr_write_b32 a123, v91
v_perm_b32 v92, v73, v72, s45
v_accvgpr_write_b32 a248, v92
v_perm_b32 v93, v75, v74, s45
v_accvgpr_write_b32 a249, v93
v_perm_b32 v94, v77, v76, s45
v_accvgpr_write_b32 a250, v94
v_perm_b32 v95, v79, v78, s45
v_accvgpr_write_b32 a251, v95
v_perm_b32 v88, v81, v80, s44
v_accvgpr_write_b32 a124, v88
v_perm_b32 v89, v83, v82, s44
v_accvgpr_write_b32 a125, v89
v_perm_b32 v90, v85, v84, s44
v_accvgpr_write_b32 a126, v90
v_perm_b32 v91, v87, v86, s44
v_accvgpr_write_b32 a127, v91
v_perm_b32 v92, v81, v80, s45
v_accvgpr_write_b32 a252, v92
v_perm_b32 v93, v83, v82, s45
v_accvgpr_write_b32 a253, v93
v_perm_b32 v94, v85, v84, s45
v_accvgpr_write_b32 a254, v94
v_perm_b32 v95, v87, v86, s45
v_accvgpr_write_b32 a255, v95
s_mov_b32 s60, 1245184
buffer_load_dword v72, v7, s[12:15], s60 offen
s_mov_b32 s60, 1246208
buffer_load_dword v73, v7, s[12:15], s60 offen
s_mov_b32 s60, 1247232
buffer_load_dword v74, v7, s[12:15], s60 offen
s_mov_b32 s60, 1248256
buffer_load_dword v75, v7, s[12:15], s60 offen
s_mov_b32 s60, 1249280
buffer_load_dword v76, v7, s[12:15], s60 offen
s_mov_b32 s60, 1250304
buffer_load_dword v77, v7, s[12:15], s60 offen
s_mov_b32 s60, 1251328
buffer_load_dword v78, v7, s[12:15], s60 offen
s_mov_b32 s60, 1252352
buffer_load_dword v79, v7, s[12:15], s60 offen
s_mov_b32 s60, 1277952
buffer_load_dword v80, v7, s[12:15], s60 offen
s_mov_b32 s60, 1278976
buffer_load_dword v81, v7, s[12:15], s60 offen
s_mov_b32 s60, 1280000
buffer_load_dword v82, v7, s[12:15], s60 offen
s_mov_b32 s60, 1281024
buffer_load_dword v83, v7, s[12:15], s60 offen
s_mov_b32 s60, 1282048
buffer_load_dword v84, v7, s[12:15], s60 offen
s_mov_b32 s60, 1283072
buffer_load_dword v85, v7, s[12:15], s60 offen
s_mov_b32 s60, 1284096
buffer_load_dword v86, v7, s[12:15], s60 offen
s_mov_b32 s60, 1285120
buffer_load_dword v87, v7, s[12:15], s60 offen
s_waitcnt vmcnt(48)
v_perm_b32 v168, v25, v24, s44
v_perm_b32 v169, v27, v26, s44
v_perm_b32 v170, v29, v28, s44
v_perm_b32 v171, v31, v30, s44
v_perm_b32 v212, v25, v24, s45
v_perm_b32 v213, v27, v26, s45
v_perm_b32 v214, v29, v28, s45
v_perm_b32 v215, v31, v30, s45
v_perm_b32 v172, v33, v32, s44
v_perm_b32 v173, v35, v34, s44
v_perm_b32 v174, v37, v36, s44
v_perm_b32 v175, v39, v38, s44
v_perm_b32 v216, v33, v32, s45
v_perm_b32 v217, v35, v34, s45
v_perm_b32 v218, v37, v36, s45
v_perm_b32 v219, v39, v38, s45
s_mov_b32 s60, 1310720
buffer_load_dword v24, v7, s[12:15], s60 offen
s_mov_b32 s60, 1311744
buffer_load_dword v25, v7, s[12:15], s60 offen
s_mov_b32 s60, 1312768
buffer_load_dword v26, v7, s[12:15], s60 offen
s_mov_b32 s60, 1313792
buffer_load_dword v27, v7, s[12:15], s60 offen
s_mov_b32 s60, 1314816
buffer_load_dword v28, v7, s[12:15], s60 offen
s_mov_b32 s60, 1315840
buffer_load_dword v29, v7, s[12:15], s60 offen
s_mov_b32 s60, 1316864
buffer_load_dword v30, v7, s[12:15], s60 offen
s_mov_b32 s60, 1317888
buffer_load_dword v31, v7, s[12:15], s60 offen
s_mov_b32 s60, 1343488
buffer_load_dword v32, v7, s[12:15], s60 offen
s_mov_b32 s60, 1344512
buffer_load_dword v33, v7, s[12:15], s60 offen
s_mov_b32 s60, 1345536
buffer_load_dword v34, v7, s[12:15], s60 offen
s_mov_b32 s60, 1346560
buffer_load_dword v35, v7, s[12:15], s60 offen
s_mov_b32 s60, 1347584
buffer_load_dword v36, v7, s[12:15], s60 offen
s_mov_b32 s60, 1348608
buffer_load_dword v37, v7, s[12:15], s60 offen
s_mov_b32 s60, 1349632
buffer_load_dword v38, v7, s[12:15], s60 offen
s_mov_b32 s60, 1350656
buffer_load_dword v39, v7, s[12:15], s60 offen
s_waitcnt vmcnt(48)
v_perm_b32 v176, v41, v40, s44
v_perm_b32 v177, v43, v42, s44
v_perm_b32 v178, v45, v44, s44
v_perm_b32 v179, v47, v46, s44
v_perm_b32 v220, v41, v40, s45
v_perm_b32 v221, v43, v42, s45
v_perm_b32 v222, v45, v44, s45
v_perm_b32 v223, v47, v46, s45
v_perm_b32 v180, v49, v48, s44
v_perm_b32 v181, v51, v50, s44
v_perm_b32 v182, v53, v52, s44
v_perm_b32 v183, v55, v54, s44
v_perm_b32 v224, v49, v48, s45
v_perm_b32 v225, v51, v50, s45
v_perm_b32 v226, v53, v52, s45
v_perm_b32 v227, v55, v54, s45
s_mov_b32 s60, 1376256
buffer_load_dword v40, v7, s[12:15], s60 offen
s_mov_b32 s60, 1377280
buffer_load_dword v41, v7, s[12:15], s60 offen
s_mov_b32 s60, 1378304
buffer_load_dword v42, v7, s[12:15], s60 offen
s_mov_b32 s60, 1379328
buffer_load_dword v43, v7, s[12:15], s60 offen
s_mov_b32 s60, 1380352
buffer_load_dword v44, v7, s[12:15], s60 offen
s_mov_b32 s60, 1381376
buffer_load_dword v45, v7, s[12:15], s60 offen
s_mov_b32 s60, 1382400
buffer_load_dword v46, v7, s[12:15], s60 offen
s_mov_b32 s60, 1383424
buffer_load_dword v47, v7, s[12:15], s60 offen
s_waitcnt vmcnt(40)
v_perm_b32 v184, v57, v56, s44
v_perm_b32 v185, v59, v58, s44
v_perm_b32 v186, v61, v60, s44
v_perm_b32 v187, v63, v62, s44
v_perm_b32 v228, v57, v56, s45
v_perm_b32 v229, v59, v58, s45
v_perm_b32 v230, v61, v60, s45
v_perm_b32 v231, v63, v62, s45
v_perm_b32 v188, v65, v64, s44
v_perm_b32 v189, v67, v66, s44
v_perm_b32 v190, v69, v68, s44
v_perm_b32 v191, v71, v70, s44
v_perm_b32 v232, v65, v64, s45
v_perm_b32 v233, v67, v66, s45
v_perm_b32 v234, v69, v68, s45
v_perm_b32 v235, v71, v70, s45
s_waitcnt vmcnt(24)
v_perm_b32 v192, v73, v72, s44
v_perm_b32 v193, v75, v74, s44
v_perm_b32 v194, v77, v76, s44
v_perm_b32 v195, v79, v78, s44
v_perm_b32 v236, v73, v72, s45
v_perm_b32 v237, v75, v74, s45
v_perm_b32 v238, v77, v76, s45
v_perm_b32 v239, v79, v78, s45
v_perm_b32 v196, v81, v80, s44
v_perm_b32 v197, v83, v82, s44
v_perm_b32 v198, v85, v84, s44
v_perm_b32 v199, v87, v86, s44
v_perm_b32 v240, v81, v80, s45
v_perm_b32 v241, v83, v82, s45
v_perm_b32 v242, v85, v84, s45
v_perm_b32 v243, v87, v86, s45
s_waitcnt vmcnt(8)
v_perm_b32 v200, v25, v24, s44
v_perm_b32 v201, v27, v26, s44
v_perm_b32 v202, v29, v28, s44
v_perm_b32 v203, v31, v30, s44
v_perm_b32 v244, v25, v24, s45
v_perm_b32 v245, v27, v26, s45
v_perm_b32 v246, v29, v28, s45
v_perm_b32 v247, v31, v30, s45
v_perm_b32 v204, v33, v32, s44
v_perm_b32 v205, v35, v34, s44
v_perm_b32 v206, v37, v36, s44
v_perm_b32 v207, v39, v38, s44
v_perm_b32 v248, v33, v32, s45
v_perm_b32 v249, v35, v34, s45
v_perm_b32 v250, v37, v36, s45
v_perm_b32 v251, v39, v38, s45
s_waitcnt vmcnt(0)
v_perm_b32 v208, v41, v40, s44
v_perm_b32 v209, v43, v42, s44
v_perm_b32 v210, v45, v44, s44
v_perm_b32 v211, v47, v46, s44
v_perm_b32 v252, v41, v40, s45
v_perm_b32 v253, v43, v42, s45
v_perm_b32 v254, v45, v44, s45
v_perm_b32 v255, v47, v46, s45
s_mov_b32 s12, s38
s_mov_b32 s13, s39
s_mov_b32 s14, 1024
s_mov_b32 s15, 0x00020000
s_lshl_b32 s60, s62, 8
s_lshl_b32 s61, s47, 4
s_add_u32 s60, s60, s61
v_lshlrev_b32 v7, 6, v15
buffer_load_dwordx4 v[24:27], v7, s[12:15], s60 offen
s_waitcnt vmcnt(0)
v_lshlrev_b32 v16, 16, v24
v_and_b32 v20, 0xffff0000, v24
v_lshlrev_b32 v17, 16, v25
v_and_b32 v21, 0xffff0000, v25
v_lshlrev_b32 v18, 16, v26
v_and_b32 v22, 0xffff0000, v26
v_lshlrev_b32 v19, 16, v27
v_and_b32 v23, 0xffff0000, v27
s_nop 1
s_cmp_eq_u32 s57, 1
s_cbranch_scc1 L_G1_main
L_G0_main:
s_lshl_b32 s67, s62, 2
s_add_u32 s67, s67, s47
s_lshl_b32 s72, s47, 10
s_lshl_b32 s73, s47, 11
s_mul_i32 s74, s47, 3072
s_lshl_b32 s76, s67, 11
s_lshl_b32 s60, s59, 10
s_add_u32 s76, s76, s60
s_add_u32 s66, s60, 16777216
s_lshl_b32 s77, s59, 6
s_mov_b32 s75, 0
s_mov_b32 s63, 0
v_mov_b32 v10, v1
v_lshlrev_b32 v9, 9, v15
v_lshl_add_u32 v9, v14, 4, v9
s_lshl_b32 s60, s59, 8
s_lshl_b32 s61, s47, 2
s_add_u32 s60, s60, s61
v_add_u32 v9, s60, v9
s_mov_b64 exec, 1
v_mov_b32 v33, 136
s_nop 1
Lgb_306:
buffer_load_dword v32, v33, s[8:11], 0 offen sc1
s_memtime s[60:61]
s_waitcnt lgkmcnt(0)
s_sub_u32 s60, s60, s46
s_mov_b32 s61, 2
s_cmp_gt_u32 s60, 67108864
s_cbranch_scc1 L_abortG
s_waitcnt vmcnt(0)
v_readfirstlane_b32 s60, v32
s_and_b32 s61, s60, 0xffff
s_cmp_lt_u32 s61, 256
s_cbranch_scc1 Lgb_306
s_mov_b64 exec, -1
s_mov_b32 s68, 0
L_G0_loop:
s_lshl_b32 s69, s68, 7
s_add_u32 s69, s69, s77
s_add_u32 s64, s69, 16384
s_mov_b64 exec, 0xffff
s_branch Lpoll_308
Lpoll_307:
s_sleep 1
Lpoll_308:
buffer_load_dword v8, v6, s[4:7], s64 offen sc1
s_memtime s[60:61]
s_waitcnt lgkmcnt(0)
s_sub_u32 s60, s60, s46
s_mov_b32 s61, 50
s_cmp_gt_u32 s60, 67108864
s_cbranch_scc1 L_abortG
s_waitcnt vmcnt(0)
s_cmp_eq_u32 s63, 0
s_cbranch_scc1 Lnp_309
s_mov_b64 s[98:99], exec
s_mov_b64 exec, 1
buffer_store_dword v4, off, s[4:7], s63 sc1
s_mov_b64 exec, s[98:99]
s_mov_b32 s63, 0
Lnp_309:
v_cmp_eq_u32 vcc, 0, v8
s_cbranch_vccnz Lpoll_307
s_mov_b64 exec, -1
s_mul_i32 s64, s68, 90112
s_add_u32 s64, s64, s66
s_lshl_b32 s70, s68, 15
s_add_u32 s71, s70, s76
s_add_u32 s60, s71, 4194304
buffer_load_dwordx4 v[72:75], v1, s[4:7], s60 offen sc1
s_add_u32 s100, s75, s72
s_add_u32 m0, s100, 0
s_lshl1_add_u32 s100, s72, s64
s_add_u32 s100, s100, 0
buffer_load_dwordx4 v1, s[4:7], s100 offen sc1 lds
s_add_u32 s100, s75, s72
s_add_u32 m0, s100, 4096
s_lshl1_add_u32 s100, s72, s64
s_add_u32 s100, s100, 8192
buffer_load_dwordx4 v1, s[4:7], s100 offen sc1 lds
s_add_u32 s100, s75, s73
s_add_u32 m0, s100, 8192
s_lshl1_add_u32 s100, s73, s64
s_add_u32 s100, s100, 16384
buffer_load_dwordx4 v1, s[4:7], s100 offen sc1 lds
s_add_u32 m0, m0, 1024
s_add_u32 s100, s100, 2048
buffer_load_dwordx4 v1, s[4:7], s100 offen sc1 lds
s_add_u32 s100, s75, s73
s_add_u32 m0, s100, 16384
s_lshl1_add_u32 s100, s73, s64
s_add_u32 s100, s100, 32768
buffer_load_dwordx4 v1, s[4:7], s100 offen sc1 lds
s_add_u32 m0, m0, 1024
s_add_u32 s100, s100, 2048
buffer_load_dwordx4 v1, s[4:7], s100 offen sc1 lds
s_waitcnt vmcnt(6)
v_lshlrev_b32 v24, 16, v72
v_and_b32 v25, 0xffff0000, v72
v_lshlrev_b32 v26, 16, v73
v_and_b32 v27, 0xffff0000, v73
v_lshlrev_b32 v28, 16, v74
v_and_b32 v29, 0xffff0000, v74
v_lshlrev_b32 v30, 16, v75
v_and_b32 v31, 0xffff0000, v75
v_add_f32 v24, v24, v16
v_add_f32 v25, v25, v17
v_add_f32 v26, v26, v18
v_add_f32 v27, v27, v19
v_add_f32 v28, v28, v20
v_add_f32 v29, v29, v21
v_add_f32 v30, v30, v22
v_add_f32 v31, v31, v23
s_waitcnt vmcnt(5)
s_barrier
ds_read_b128 v[40:43], v10 offset:0
ds_read_b128 v[44:47], v10 offset:1024
ds_read_b128 v[48:51], v10 offset:2048
ds_read_b128 v[52:55], v10 offset:3072
s_waitcnt vmcnt(4)
s_barrier
ds_read_b128 v[56:59], v10 offset:4096
ds_read_b128 v[60:63], v10 offset:5120
ds_read_b128 v[64:67], v10 offset:6144
ds_read_b128 v[68:71], v10 offset:7168
s_waitcnt lgkmcnt(7)
v_mfma_f32_16x16x32_bf16 v[24:27], a[0:3], v[40:43], v[24:27]
v_mfma_f32_16x16x32_bf16 v[28:31], a[128:131], v[40:43], v[28:31]
s_waitcnt vmcnt(2)
s_barrier
ds_read_b128 v[40:43], v10 offset:8192
s_waitcnt lgkmcnt(7)
v_mfma_f32_16x16x32_bf16 v[24:27], a[4:7], v[44:47], v[24:27]
s_add_u32 s100, s75, s73
s_add_u32 m0, s100, 24576
s_lshl1_add_u32 s100, s73, s64
s_add_u32 s100, s100, 49152
buffer_load_dwordx4 v1, s[4:7], s100 offen sc1 lds
v_mfma_f32_16x16x32_bf16 v[28:31], a[132:135], v[44:47], v[28:31]
ds_read_b128 v[44:47], v10 offset:9216
s_waitcnt lgkmcnt(7)
v_mfma_f32_16x16x32_bf16 v[24:27], a[8:11], v[48:51], v[24:27]
v_mfma_f32_16x16x32_bf16 v[28:31], a[136:139], v[48:51], v[28:31]
s_add_u32 m0, m0, 1024
s_add_u32 s100, s100, 2048
buffer_load_dwordx4 v1, s[4:7], s100 offen sc1 lds
ds_read_b128 v[48:51], v10 offset:10240
s_waitcnt lgkmcnt(7)
v_mfma_f32_16x16x32_bf16 v[24:27], a[12:15], v[52:55], v[24:27]
v_mfma_f32_16x16x32_bf16 v[28:31], a[140:143], v[52:55], v[28:31]
ds_read_b128 v[52:55], v10 offset:11264
s_waitcnt lgkmcnt(7)
v_mfma_f32_16x16x32_bf16 v[24:27], a[16:19], v[56:59], v[24:27]
s_add_u32 s100, s75, s74
s_add_u32 m0, s100, 32768
s_lshl1_add_u32 s100, s74, s64
s_add_u32 s100, s100, 65536
buffer_load_dwordx4 v1, s[4:7], s100 offen sc1 lds
v_mfma_f32_16x16x32_bf16 v[28:31], a[144:147], v[56:59], v[28:31]
ds_read_b128 v[56:59], v10 offset:12288
s_waitcnt lgkmcnt(7)
v_mfma_f32_16x16x32_bf16 v[24:27], a[20:23], v[60:63], v[24:27]
v_mfma_f32_16x16x32_bf16 v[28:31], a[148:151], v[60:63], v[28:31]
s_add_u32 m0, m0, 1024
s_add_u32 s100, s100, 2048
buffer_load_dwordx4 v1, s[4:7], s100 offen sc1 lds
ds_read_b128 v[60:63], v10 offset:13312
s_waitcnt lgkmcnt(7)
v_mfma_f32_16x16x32_bf16 v[24:27], a[24:27], v[64:67], v[24:27]
v_mfma_f32_16x16x32_bf16 v[28:31], a[152:155], v[64:67], v[28:31]
ds_read_b128 v[64:67], v10 offset:14336
s_waitcnt lgkmcnt(7)
v_mfma_f32_16x16x32_bf16 v[24:27], a[28:31], v[68:71], v[24:27]
s_add_u32 m0, m0, 1024
s_add_u32 s100, s100, 2048
buffer_load_dwordx4 v1, s[4:7], s100 offen sc1 lds
v_mfma_f32_16x16x32_bf16 v[28:31], a[156:159], v[68:71], v[28:31]
ds_read_b128 v[68:71], v10 offset:15360
s_waitcnt lgkmcnt(7)
v_mfma_f32_16x16x32_bf16 v[24:27], a[32:35], v[40:43], v[24:27]
v_mfma_f32_16x16x32_bf16 v[28:31], a[160:163], v[40:43], v[28:31]
s_waitcnt vmcnt(5)
s_barrier
ds_read_b128 v[40:43], v10 offset:16384
s_waitcnt lgkmcnt(7)
v_mfma_f32_16x16x32_bf16 v[24:27], a[36:39], v[44:47], v[24:27]
v_mfma_f32_16x16x32_bf16 v[28:31], a[164:167], v[44:47], v[28:31]
ds_read_b128 v[44:47], v10 offset:17408
s_waitcnt lgkmcnt(7)
v_mfma_f32_16x16x32_bf16 v[24:27], a[40:43], v[48:51], v[24:27]
v_mfma_f32_16x16x32_bf16 v[28:31], a[168:171], v[48:51], v[28:31]
ds_read_b128 v[48:51], v10 offset:18432
s_waitcnt lgkmcnt(7)
v_mfma_f32_16x16x32_bf16 v[24:27], a[44:47], v[52:55], v[24:27]
v_mfma_f32_16x16x32_bf16 v[28:31], a[172:175], v[52:55], v[28:31]
ds_read_b128 v[52:55], v10 offset:19456
s_waitcnt lgkmcnt(7)
v_mfma_f32_16x16x32_bf16 v[24:27], a[48:51], v[56:59], v[24:27]
v_mfma_f32_16x16x32_bf16 v[28:31], a[176:179], v[56:59], v[28:31]
ds_read_b128 v[56:59], v10 offset:20480
s_waitcnt lgkmcnt(7)
v_mfma_f32_16x16x32_bf16 v[24:27], a[52:55], v[60:63], v[24:27]
v_mfma_f32_16x16x32_bf16 v[28:31], a[180:183], v[60:63], v[28:31]
ds_read_b128 v[60:63], v10 offset:21504
s_waitcnt lgkmcnt(7)
v_mfma_f32_16x16x32_bf16 v[24:27], a[56:59], v[64:67], v[24:27]
v_mfma_f32_16x16x32_bf16 v[28:31], a[184:187], v[64:67], v[28:31]
ds_read_b128 v[64:67], v10 offset:22528
s_waitcnt lgkmcnt(7)
v_mfma_f32_16x16x32_bf16 v[24:27], a[60:63], v[68:71], v[24:27]
v_mfma_f32_16x16x32_bf16 v[28:31], a[188:191], v[68:71], v[28:31]
ds_read_b128 v[68:71], v10 offset:23552
s_waitcnt lgkmcnt(7)
v_mfma_f32_16x16x32_bf16 v[24:27], a[64:67], v[40:43], v[24:27]
v_mfma_f32_16x16x32_bf16 v[28:31], a[192:195], v[40:43], v[28:31]
s_waitcnt vmcnt(3)
s_barrier
ds_read_b128 v[40:43], v10 offset:24576
s_waitcnt lgkmcnt(7)
v_mfma_f32_16x16x32_bf16 v[24:27], a[68:71], v[44:47], v[24:27]
v_mfma_f32_16x16x32_bf16 v[28:31], a[196:199], v[44:47], v[28:31]
ds_read_b128 v[44:47], v10 offset:25600
s_waitcnt lgkmcnt(7)
v_mfma_f32_16x16x32_bf16 v[24:27], a[72:75], v[48:51], v[24:27]
v_mfma_f32_16x16x32_bf16 v[28:31], a[200:203], v[48:51], v[28:31]
ds_read_b128 v[48:51], v10 offset:26624
s_waitcnt lgkmcnt(7)
v_mfma_f32_16x16x32_bf16 v[24:27], a[76:79], v[52:55], v[24:27]
v_mfma_f32_16x16x32_bf16 v[28:31], a[204:207], v[52:55], v[28:31]
ds_read_b128 v[52:55], v10 offset:27648
s_waitcnt lgkmcnt(7)
v_mfma_f32_16x16x32_bf16 v[24:27], a[80:83], v[56:59], v[24:27]
v_mfma_f32_16x16x32_bf16 v[28:31], a[208:211], v[56:59], v[28:31]
ds_read_b128 v[56:59], v10 offset:28672
s_waitcnt lgkmcnt(7)
v_mfma_f32_16x16x32_bf16 v[24:27], a[84:87], v[60:63], v[24:27]
v_mfma_f32_16x16x32_bf16 v[28:31], a[212:215], v[60:63], v[28:31]
ds_read_b128 v[60:63], v10 offset:29696
s_waitcnt lgkmcnt(7)
v_mfma_f32_16x16x32_bf16 v[24:27], a[88:91], v[64:67], v[24:27]
v_mfma_f32_16x16x32_bf16 v[28:31], a[216:219], v[64:67], v[28:31]
ds_read_b128 v[64:67], v10 offset:30720
s_waitcnt lgkmcnt(7)
v_mfma_f32_16x16x32_bf16 v[24:27], a[92:95], v[68:71], v[24:27]
v_mfma_f32_16x16x32_bf16 v[28:31], a[220:223], v[68:71], v[28:31]
ds_read_b128 v[68:71], v10 offset:31744
s_waitcnt lgkmcnt(7)
v_mfma_f32_16x16x32_bf16 v[24:27], a[96:99], v[40:43], v[24:27]
v_mfma_f32_16x16x32_bf16 v[28:31], a[224:227], v[40:43], v[28:31]
s_waitcnt vmcnt(0)
s_barrier
ds_read_b128 v[40:43], v10 offset:32768
s_waitcnt lgkmcnt(7)
v_mfma_f32_16x16x32_bf16 v[24:27], a[100:103], v[44:47], v[24:27]
v_mfma_f32_16x16x32_bf16 v[28:31], a[228:231], v[44:47], v[28:31]
ds_read_b128 v[44:47], v10 offset:33792
s_waitcnt lgkmcnt(7)
v_mfma_f32_16x16x32_bf16 v[24:27], a[104:107], v[48:51], v[24:27]
v_mfma_f32_16x16x32_bf16 v[28:31], a[232:235], v[48:51], v[28:31]
ds_read_b128 v[48:51], v10 offset:34816
s_waitcnt lgkmcnt(7)
v_mfma_f32_16x16x32_bf16 v[24:27], a[108:111], v[52:55], v[24:27]
v_mfma_f32_16x16x32_bf16 v[28:31], a[236:239], v[52:55], v[28:31]
ds_read_b128 v[52:55], v10 offset:35840
s_waitcnt lgkmcnt(7)
v_mfma_f32_16x16x32_bf16 v[24:27], a[112:115], v[56:59], v[24:27]
v_mfma_f32_16x16x32_bf16 v[28:31], a[240:243], v[56:59], v[28:31]
ds_read_b128 v[56:59], v10 offset:36864
s_waitcnt lgkmcnt(7)
v_mfma_f32_16x16x32_bf16 v[24:27], a[116:119], v[60:63], v[24:27]
v_mfma_f32_16x16x32_bf16 v[28:31], a[244:247], v[60:63], v[28:31]
ds_read_b128 v[60:63], v10 offset:37888
s_waitcnt lgkmcnt(7)
v_mfma_f32_16x16x32_bf16 v[24:27], a[120:123], v[64:67], v[24:27]
v_mfma_f32_16x16x32_bf16 v[28:31], a[248:251], v[64:67], v[28:31]
ds_read_b128 v[64:67], v10 offset:38912
s_waitcnt lgkmcnt(7)
v_mfma_f32_16x16x32_bf16 v[24:27], a[124:127], v[68:71], v[24:27]
v_mfma_f32_16x16x32_bf16 v[28:31], a[252:255], v[68:71], v[28:31]
ds_read_b128 v[68:71], v10 offset:39936
s_waitcnt lgkmcnt(7)
v_mfma_f32_16x16x32_bf16 v[24:27], v[168:171], v[40:43], v[24:27]
v_mfma_f32_16x16x32_bf16 v[28:31], v[212:215], v[40:43], v[28:31]
ds_read_b128 v[40:43], v10 offset:40960
s_waitcnt lgkmcnt(7)
v_mfma_f32_16x16x32_bf16 v[24:27], v[172:175], v[44:47], v[24:27]
v_mfma_f32_16x16x32_bf16 v[28:31], v[216:219], v[44:47], v[28:31]
ds_read_b128 v[44:47], v10 offset:41984
s_waitcnt lgkmcnt(7)
v_mfma_f32_16x16x32_bf16 v[24:27], v[176:179], v[48:51], v[24:27]
v_mfma_f32_16x16x32_bf16 v[28:31], v[220:223], v[48:51], v[28:31]
ds_read_b128 v[48:51], v10 offset:43008
s_waitcnt lgkmcnt(7)
v_mfma_f32_16x16x32_bf16 v[24:27], v[180:183], v[52:55], v[24:27]
v_mfma_f32_16x16x32_bf16 v[28:31], v[224:227], v[52:55], v[28:31]
s_waitcnt lgkmcnt(6)
v_mfma_f32_16x16x32_bf16 v[24:27], v[184:187], v[56:59], v[24:27]
v_mfma_f32_16x16x32_bf16 v[28:31], v[228:231], v[56:59], v[28:31]
s_waitcnt lgkmcnt(5)
v_mfma_f32_16x16x32_bf16 v[24:27], v[188:191], v[60:63], v[24:27]
v_mfma_f32_16x16x32_bf16 v[28:31], v[232:235], v[60:63], v[28:31]
s_waitcnt lgkmcnt(4)
v_mfma_f32_16x16x32_bf16 v[24:27], v[192:195], v[64:67], v[24:27]
v_mfma_f32_16x16x32_bf16 v[28:31], v[236:239], v[64:67], v[28:31]
s_waitcnt lgkmcnt(3)
v_mfma_f32_16x16x32_bf16 v[24:27], v[196:199], v[68:71], v[24:27]
v_mfma_f32_16x16x32_bf16 v[28:31], v[240:243], v[68:71], v[28:31]
s_waitcnt lgkmcnt(2)
v_mfma_f32_16x16x32_bf16 v[24:27], v[200:203], v[40:43], v[24:27]
v_mfma_f32_16x16x32_bf16 v[28:31], v[244:247], v[40:43], v[28:31]
s_waitcnt lgkmcnt(1)
v_mfma_f32_16x16x32_bf16 v[24:27], v[204:207], v[44:47], v[24:27]
v_mfma_f32_16x16x32_bf16 v[28:31], v[248:251], v[44:47], v[28:31]
s_waitcnt lgkmcnt(0)
v_mfma_f32_16x16x32_bf16 v[24:27], v[208:211], v[48:51], v[24:27]
v_mfma_f32_16x16x32_bf16 v[28:31], v[252:255], v[48:51], v[28:31]
v_xor_b32 v10, 0x10000, v10
s_xor_b32 s75, s75, 0x10000
s_nop 5
v_cvt_pk_bf16_f32 v72, v24, v28
v_cvt_pk_bf16_f32 v73, v25, v29
v_cvt_pk_bf16_f32 v74, v26, v30
v_cvt_pk_bf16_f32 v75, v27, v31
s_add_u32 s60, s71, 8388608
buffer_store_dwordx4 v[72:75], v1, s[4:7], s60 offen sc1
v_lshlrev_b32 v80, 16, v72
v_and_b32 v81, 0xffff0000, v72
v_lshlrev_b32 v82, 16, v73
v_and_b32 v83, 0xffff0000, v73
v_lshlrev_b32 v84, 16, v74
v_and_b32 v85, 0xffff0000, v74
v_lshlrev_b32 v86, 16, v75
v_and_b32 v87, 0xffff0000, v75
v_add_f32 v88, v80, v81
v_mul_f32 v89, v80, v80
v_fmac_f32 v89, v81, v81
v_add_f32 v88, v88, v82
v_fmac_f32 v89, v82, v82
v_add_f32 v88, v88, v83
v_fmac_f32 v89, v83, v83
v_add_f32 v88, v88, v84
v_fmac_f32 v89, v84, v84
v_add_f32 v88, v88, v85
v_fmac_f32 v89, v85, v85
v_add_f32 v88, v88, v86
v_fmac_f32 v89, v86, v86
v_add_f32 v88, v88, v87
v_fmac_f32 v89, v87, v87
s_nop 1
v_permlane16_swap_b32 v88, v89
v_add_f32 v88, v88, v89
v_mov_b32 v89, v88
s_nop 1
v_permlane32_swap_b32 v88, v89
v_add_f32 v88, v88, v89
s_lshl_b32 s60, s68, 12
s_lshl_b32 s61, s62, 10
s_add_u32 s60, s60, s61
s_add_u32 s60, s60, 13369344
s_mov_b64 exec, 0xffffffff
buffer_store_dword v88, v9, s[4:7], s60 offen sc1
s_mov_b64 exec, -1
s_lshl_b32 s60, s67, 2
s_add_u32 s69, s69, s60
s_add_u32 s63, s69, 32768
s_add_u32 s68, s68, 1
s_cmp_lt_u32 s68, 64
s_cbranch_scc1 L_G0_loop
s_waitcnt vmcnt(0)
s_cmp_eq_u32 s63, 0
s_cbranch_scc1 Lnp_310
s_mov_b64 s[98:99], exec
s_mov_b64 exec, 1
buffer_store_dword v4, off, s[4:7], s63 sc1
s_mov_b64 exec, s[98:99]
s_mov_b32 s63, 0
Lnp_310:
s_endpgm
L_G1_main:
s_lshl_b32 s67, s62, 2
s_add_u32 s67, s67, s47
s_lshl_b32 s72, s47, 10
s_lshl_b32 s73, s47, 11
s_mul_i32 s74, s47, 3072
s_lshl_b32 s76, s67, 11
s_lshl_b32 s60, s59, 10
s_add_u32 s76, s76, s60
s_add_u32 s66, s60, 22544384
s_lshl_b32 s77, s59, 6
s_mov_b32 s75, 0
s_mov_b32 s63, 0
v_mov_b32 v10, v1
v_lshlrev_b32 v9, 9, v15
v_lshl_add_u32 v9, v14, 4, v9
s_lshl_b32 s60, s59, 8
s_lshl_b32 s61, s47, 2
s_add_u32 s60, s60, s61
v_add_u32 v9, s60, v9
s_mov_b32 s52, s40
s_mov_b32 s53, s41
s_mov_b32 s54, 2097152
s_mov_b32 s55, 0x00020000
v_lshl_add_u32 v7, v14, 10, v7
s_lshl_b32 s60, s62, 8
s_lshl_b32 s61, s47, 4
s_add_u32 s60, s60, s61
s_lshl_b32 s61, s59, 14
s_add_u32 s60, s60, s61
v_add_u32 v7, s60, v7
s_mov_b64 exec, 1
v_mov_b32 v33, 136
s_nop 1
Lgb_313:
buffer_load_dword v32, v33, s[8:11], 0 offen sc1
s_memtime s[60:61]
s_waitcnt lgkmcnt(0)
s_sub_u32 s60, s60, s46
s_mov_b32 s61, 2
s_cmp_gt_u32 s60, 67108864
s_cbranch_scc1 L_abortG
s_waitcnt vmcnt(0)
v_readfirstlane_b32 s60, v32
s_and_b32 s61, s60, 0xffff
s_cmp_lt_u32 s61, 256
s_cbranch_scc1 Lgb_313
s_mov_b64 exec, -1
s_and_b32 s61, s56, 31
s_mov_b32 s52, s40
s_mov_b32 s53, s41
s_mov_b32 s54, 2097152
s_mov_b32 s55, 0x00020000
s_lshl_b32 s61, s61, 2
s_add_u32 s61, s61, s47
s_mul_i32 s60, s61, 8192
v_mul_u32_u24 v32, 128, v0
v_add_u32 v32, s60, v32
s_sleep 64
s_sleep 64
s_sleep 64
s_sleep 64
s_sleep 64
s_sleep 64
s_mov_b32 s60, 0x600000
buffer_load_dword v33, v32, s[4:7], s60 offen sc1
s_waitcnt vmcnt(12)
s_mov_b32 s60, 0x1500000
buffer_load_dword v33, v32, s[4:7], s60 offen sc1
s_waitcnt vmcnt(12)
s_mov_b32 s60, 0x1600000
buffer_load_dword v33, v32, s[4:7], s60 offen sc1
s_waitcnt vmcnt(12)
s_mov_b32 s60, 0x0
buffer_load_dword v33, v32, s[52:55], s60 offen sc1
s_waitcnt vmcnt(12)
s_mov_b32 s60, 0x1700000
buffer_load_dword v33, v32, s[4:7], s60 offen sc1
s_waitcnt vmcnt(12)
s_mov_b32 s60, 0x1800000
buffer_load_dword v33, v32, s[4:7], s60 offen sc1
s_waitcnt vmcnt(12)
s_mov_b32 s60, 0x1900000
buffer_load_dword v33, v32, s[4:7], s60 offen sc1
s_waitcnt vmcnt(12)
s_mov_b32 s60, 0x1a00000
buffer_load_dword v33, v32, s[4:7], s60 offen sc1
s_waitcnt vmcnt(12)
s_mov_b32 s60, 0x700000
buffer_load_dword v33, v32, s[4:7], s60 offen sc1
s_waitcnt vmcnt(12)
s_mov_b32 s60, 0x100000
buffer_load_dword v33, v32, s[52:55], s60 offen sc1
s_waitcnt vmcnt(12)
s_waitcnt vmcnt(0)
s_mov_b32 s68, 0
L_G1_loop:
s_lshl_b32 s69, s68, 7
s_add_u32 s69, s69, s77
s_add_u32 s64, s69, 24576
s_mov_b64 exec, 0xffff
s_branch Lpoll_315
Lpoll_314:
s_sleep 1
Lpoll_315:
buffer_load_dword v8, v6, s[4:7], s64 offen sc1
s_memtime s[60:61]
s_waitcnt lgkmcnt(0)
s_sub_u32 s60, s60, s46
s_mov_b32 s61, 50
s_cmp_gt_u32 s60, 67108864
s_cbranch_scc1 L_abortG
s_waitcnt vmcnt(0)
s_cmp_eq_u32 s63, 0
s_cbranch_scc1 Lnp_316
s_mov_b64 s[98:99], exec
s_mov_b64 exec, 1
buffer_store_dword v4, off, s[4:7], s63 sc1
s_mov_b64 exec, s[98:99]
s_mov_b32 s63, 0
Lnp_316:
v_cmp_eq_u32 vcc, 0, v8
s_cbranch_vccnz Lpoll_314
s_mov_b64 exec, -1
s_mul_i32 s64, s68, 90112
s_add_u32 s64, s64, s66
s_lshl_b32 s70, s68, 15
s_add_u32 s71, s70, s76
s_add_u32 s60, s71, 6291456
buffer_load_dwordx4 v[72:75], v1, s[4:7], s60 offen sc1
s_add_u32 s100, s75, s72
s_add_u32 m0, s100, 0
s_lshl1_add_u32 s100, s72, s64
s_add_u32 s100, s100, 0
buffer_load_dwordx4 v1, s[4:7], s100 offen sc1 lds
s_add_u32 s100, s75, s72
s_add_u32 m0, s100, 4096
s_lshl1_add_u32 s100, s72, s64
s_add_u32 s100, s100, 8192
buffer_load_dwordx4 v1, s[4:7], s100 offen sc1 lds
s_add_u32 s100, s75, s73
s_add_u32 m0, s100, 8192
s_lshl1_add_u32 s100, s73, s64
s_add_u32 s100, s100, 16384
buffer_load_dwordx4 v1, s[4:7], s100 offen sc1 lds
s_add_u32 m0, m0, 1024
s_add_u32 s100, s100, 2048
buffer_load_dwordx4 v1, s[4:7], s100 offen sc1 lds
s_add_u32 s100, s75, s73
s_add_u32 m0, s100, 16384
s_lshl1_add_u32 s100, s73, s64
s_add_u32 s100, s100, 32768
buffer_load_dwordx4 v1, s[4:7], s100 offen sc1 lds
s_add_u32 m0, m0, 1024
s_add_u32 s100, s100, 2048
buffer_load_dwordx4 v1, s[4:7], s100 offen sc1 lds
s_waitcnt vmcnt(6)
v_lshlrev_b32 v24, 16, v72
v_and_b32 v25, 0xffff0000, v72
v_lshlrev_b32 v26, 16, v73
v_and_b32 v27, 0xffff0000, v73
v_lshlrev_b32 v28, 16, v74
v_and_b32 v29, 0xffff0000, v74
v_lshlrev_b32 v30, 16, v75
v_and_b32 v31, 0xffff0000, v75
v_add_f32 v24, v24, v16
v_add_f32 v25, v25, v17
v_add_f32 v26, v26, v18
v_add_f32 v27, v27, v19
v_add_f32 v28, v28, v20
v_add_f32 v29, v29, v21
v_add_f32 v30, v30, v22
v_add_f32 v31, v31, v23
s_waitcnt vmcnt(5)
s_barrier
ds_read_b128 v[40:43], v10 offset:0
ds_read_b128 v[44:47], v10 offset:1024
ds_read_b128 v[48:51], v10 offset:2048
ds_read_b128 v[52:55], v10 offset:3072
s_waitcnt vmcnt(4)
s_barrier
ds_read_b128 v[56:59], v10 offset:4096
ds_read_b128 v[60:63], v10 offset:5120
ds_read_b128 v[64:67], v10 offset:6144
ds_read_b128 v[68:71], v10 offset:7168
s_waitcnt lgkmcnt(7)
v_mfma_f32_16x16x32_bf16 v[24:27], a[0:3], v[40:43], v[24:27]
v_mfma_f32_16x16x32_bf16 v[28:31], a[128:131], v[40:43], v[28:31]
s_waitcnt vmcnt(2)
s_barrier
ds_read_b128 v[40:43], v10 offset:8192
s_waitcnt lgkmcnt(7)
v_mfma_f32_16x16x32_bf16 v[24:27], a[4:7], v[44:47], v[24:27]
s_add_u32 s100, s75, s73
s_add_u32 m0, s100, 24576
s_lshl1_add_u32 s100, s73, s64
s_add_u32 s100, s100, 49152
buffer_load_dwordx4 v1, s[4:7], s100 offen sc1 lds
v_mfma_f32_16x16x32_bf16 v[28:31], a[132:135], v[44:47], v[28:31]
ds_read_b128 v[44:47], v10 offset:9216
s_waitcnt lgkmcnt(7)
v_mfma_f32_16x16x32_bf16 v[24:27], a[8:11], v[48:51], v[24:27]
v_mfma_f32_16x16x32_bf16 v[28:31], a[136:139], v[48:51], v[28:31]
s_add_u32 m0, m0, 1024
s_add_u32 s100, s100, 2048
buffer_load_dwordx4 v1, s[4:7], s100 offen sc1 lds
ds_read_b128 v[48:51], v10 offset:10240
s_waitcnt lgkmcnt(7)
v_mfma_f32_16x16x32_bf16 v[24:27], a[12:15], v[52:55], v[24:27]
v_mfma_f32_16x16x32_bf16 v[28:31], a[140:143], v[52:55], v[28:31]
ds_read_b128 v[52:55], v10 offset:11264
s_waitcnt lgkmcnt(7)
v_mfma_f32_16x16x32_bf16 v[24:27], a[16:19], v[56:59], v[24:27]
s_add_u32 s100, s75, s74
s_add_u32 m0, s100, 32768
s_lshl1_add_u32 s100, s74, s64
s_add_u32 s100, s100, 65536
buffer_load_dwordx4 v1, s[4:7], s100 offen sc1 lds
v_mfma_f32_16x16x32_bf16 v[28:31], a[144:147], v[56:59], v[28:31]
ds_read_b128 v[56:59], v10 offset:12288
s_waitcnt lgkmcnt(7)
v_mfma_f32_16x16x32_bf16 v[24:27], a[20:23], v[60:63], v[24:27]
v_mfma_f32_16x16x32_bf16 v[28:31], a[148:151], v[60:63], v[28:31]
s_add_u32 m0, m0, 1024
s_add_u32 s100, s100, 2048
buffer_load_dwordx4 v1, s[4:7], s100 offen sc1 lds
ds_read_b128 v[60:63], v10 offset:13312
s_waitcnt lgkmcnt(7)
v_mfma_f32_16x16x32_bf16 v[24:27], a[24:27], v[64:67], v[24:27]
v_mfma_f32_16x16x32_bf16 v[28:31], a[152:155], v[64:67], v[28:31]
ds_read_b128 v[64:67], v10 offset:14336
s_waitcnt lgkmcnt(7)
v_mfma_f32_16x16x32_bf16 v[24:27], a[28:31], v[68:71], v[24:27]
s_add_u32 m0, m0, 1024
s_add_u32 s100, s100, 2048
buffer_load_dwordx4 v1, s[4:7], s100 offen sc1 lds
v_mfma_f32_16x16x32_bf16 v[28:31], a[156:159], v[68:71], v[28:31]
ds_read_b128 v[68:71], v10 offset:15360
s_waitcnt lgkmcnt(7)
v_mfma_f32_16x16x32_bf16 v[24:27], a[32:35], v[40:43], v[24:27]
v_mfma_f32_16x16x32_bf16 v[28:31], a[160:163], v[40:43], v[28:31]
s_waitcnt vmcnt(5)
s_barrier
ds_read_b128 v[40:43], v10 offset:16384
s_waitcnt lgkmcnt(7)
v_mfma_f32_16x16x32_bf16 v[24:27], a[36:39], v[44:47], v[24:27]
v_mfma_f32_16x16x32_bf16 v[28:31], a[164:167], v[44:47], v[28:31]
ds_read_b128 v[44:47], v10 offset:17408
s_waitcnt lgkmcnt(7)
v_mfma_f32_16x16x32_bf16 v[24:27], a[40:43], v[48:51], v[24:27]
v_mfma_f32_16x16x32_bf16 v[28:31], a[168:171], v[48:51], v[28:31]
ds_read_b128 v[48:51], v10 offset:18432
s_waitcnt lgkmcnt(7)
v_mfma_f32_16x16x32_bf16 v[24:27], a[44:47], v[52:55], v[24:27]
v_mfma_f32_16x16x32_bf16 v[28:31], a[172:175], v[52:55], v[28:31]
ds_read_b128 v[52:55], v10 offset:19456
s_waitcnt lgkmcnt(7)
v_mfma_f32_16x16x32_bf16 v[24:27], a[48:51], v[56:59], v[24:27]
v_mfma_f32_16x16x32_bf16 v[28:31], a[176:179], v[56:59], v[28:31]
ds_read_b128 v[56:59], v10 offset:20480
s_waitcnt lgkmcnt(7)
v_mfma_f32_16x16x32_bf16 v[24:27], a[52:55], v[60:63], v[24:27]
v_mfma_f32_16x16x32_bf16 v[28:31], a[180:183], v[60:63], v[28:31]
ds_read_b128 v[60:63], v10 offset:21504
s_waitcnt lgkmcnt(7)
v_mfma_f32_16x16x32_bf16 v[24:27], a[56:59], v[64:67], v[24:27]
v_mfma_f32_16x16x32_bf16 v[28:31], a[184:187], v[64:67], v[28:31]
ds_read_b128 v[64:67], v10 offset:22528
s_waitcnt lgkmcnt(7)
v_mfma_f32_16x16x32_bf16 v[24:27], a[60:63], v[68:71], v[24:27]
v_mfma_f32_16x16x32_bf16 v[28:31], a[188:191], v[68:71], v[28:31]
ds_read_b128 v[68:71], v10 offset:23552
s_waitcnt lgkmcnt(7)
v_mfma_f32_16x16x32_bf16 v[24:27], a[64:67], v[40:43], v[24:27]
v_mfma_f32_16x16x32_bf16 v[28:31], a[192:195], v[40:43], v[28:31]
s_waitcnt vmcnt(3)
s_barrier
ds_read_b128 v[40:43], v10 offset:24576
s_waitcnt lgkmcnt(7)
v_mfma_f32_16x16x32_bf16 v[24:27], a[68:71], v[44:47], v[24:27]
v_mfma_f32_16x16x32_bf16 v[28:31], a[196:199], v[44:47], v[28:31]
ds_read_b128 v[44:47], v10 offset:25600
s_waitcnt lgkmcnt(7)
v_mfma_f32_16x16x32_bf16 v[24:27], a[72:75], v[48:51], v[24:27]
v_mfma_f32_16x16x32_bf16 v[28:31], a[200:203], v[48:51], v[28:31]
ds_read_b128 v[48:51], v10 offset:26624
s_waitcnt lgkmcnt(7)
v_mfma_f32_16x16x32_bf16 v[24:27], a[76:79], v[52:55], v[24:27]
v_mfma_f32_16x16x32_bf16 v[28:31], a[204:207], v[52:55], v[28:31]
ds_read_b128 v[52:55], v10 offset:27648
s_waitcnt lgkmcnt(7)
v_mfma_f32_16x16x32_bf16 v[24:27], a[80:83], v[56:59], v[24:27]
v_mfma_f32_16x16x32_bf16 v[28:31], a[208:211], v[56:59], v[28:31]
ds_read_b128 v[56:59], v10 offset:28672
s_waitcnt lgkmcnt(7)
v_mfma_f32_16x16x32_bf16 v[24:27], a[84:87], v[60:63], v[24:27]
v_mfma_f32_16x16x32_bf16 v[28:31], a[212:215], v[60:63], v[28:31]
ds_read_b128 v[60:63], v10 offset:29696
s_waitcnt lgkmcnt(7)
v_mfma_f32_16x16x32_bf16 v[24:27], a[88:91], v[64:67], v[24:27]
v_mfma_f32_16x16x32_bf16 v[28:31], a[216:219], v[64:67], v[28:31]
ds_read_b128 v[64:67], v10 offset:30720
s_waitcnt lgkmcnt(7)
v_mfma_f32_16x16x32_bf16 v[24:27], a[92:95], v[68:71], v[24:27]
v_mfma_f32_16x16x32_bf16 v[28:31], a[220:223], v[68:71], v[28:31]
ds_read_b128 v[68:71], v10 offset:31744
s_waitcnt lgkmcnt(7)
v_mfma_f32_16x16x32_bf16 v[24:27], a[96:99], v[40:43], v[24:27]
v_mfma_f32_16x16x32_bf16 v[28:31], a[224:227], v[40:43], v[28:31]
s_waitcnt vmcnt(0)
s_barrier
ds_read_b128 v[40:43], v10 offset:32768
s_waitcnt lgkmcnt(7)
v_mfma_f32_16x16x32_bf16 v[24:27], a[100:103], v[44:47], v[24:27]
v_mfma_f32_16x16x32_bf16 v[28:31], a[228:231], v[44:47], v[28:31]
ds_read_b128 v[44:47], v10 offset:33792
s_waitcnt lgkmcnt(7)
v_mfma_f32_16x16x32_bf16 v[24:27], a[104:107], v[48:51], v[24:27]
v_mfma_f32_16x16x32_bf16 v[28:31], a[232:235], v[48:51], v[28:31]
ds_read_b128 v[48:51], v10 offset:34816
s_waitcnt lgkmcnt(7)
v_mfma_f32_16x16x32_bf16 v[24:27], a[108:111], v[52:55], v[24:27]
v_mfma_f32_16x16x32_bf16 v[28:31], a[236:239], v[52:55], v[28:31]
ds_read_b128 v[52:55], v10 offset:35840
s_waitcnt lgkmcnt(7)
v_mfma_f32_16x16x32_bf16 v[24:27], a[112:115], v[56:59], v[24:27]
v_mfma_f32_16x16x32_bf16 v[28:31], a[240:243], v[56:59], v[28:31]
ds_read_b128 v[56:59], v10 offset:36864
s_waitcnt lgkmcnt(7)
v_mfma_f32_16x16x32_bf16 v[24:27], a[116:119], v[60:63], v[24:27]
v_mfma_f32_16x16x32_bf16 v[28:31], a[244:247], v[60:63], v[28:31]
ds_read_b128 v[60:63], v10 offset:37888
s_waitcnt lgkmcnt(7)
v_mfma_f32_16x16x32_bf16 v[24:27], a[120:123], v[64:67], v[24:27]
v_mfma_f32_16x16x32_bf16 v[28:31], a[248:251], v[64:67], v[28:31]
ds_read_b128 v[64:67], v10 offset:38912
s_waitcnt lgkmcnt(7)
v_mfma_f32_16x16x32_bf16 v[24:27], a[124:127], v[68:71], v[24:27]
v_mfma_f32_16x16x32_bf16 v[28:31], a[252:255], v[68:71], v[28:31]
ds_read_b128 v[68:71], v10 offset:39936
s_waitcnt lgkmcnt(7)
v_mfma_f32_16x16x32_bf16 v[24:27], v[168:171], v[40:43], v[24:27]
v_mfma_f32_16x16x32_bf16 v[28:31], v[212:215], v[40:43], v[28:31]
ds_read_b128 v[40:43], v10 offset:40960
s_waitcnt lgkmcnt(7)
v_mfma_f32_16x16x32_bf16 v[24:27], v[172:175], v[44:47], v[24:27]
v_mfma_f32_16x16x32_bf16 v[28:31], v[216:219], v[44:47], v[28:31]
ds_read_b128 v[44:47], v10 offset:41984
s_waitcnt lgkmcnt(7)
v_mfma_f32_16x16x32_bf16 v[24:27], v[176:179], v[48:51], v[24:27]
v_mfma_f32_16x16x32_bf16 v[28:31], v[220:223], v[48:51], v[28:31]
ds_read_b128 v[48:51], v10 offset:43008
s_waitcnt lgkmcnt(7)
v_mfma_f32_16x16x32_bf16 v[24:27], v[180:183], v[52:55], v[24:27]
v_mfma_f32_16x16x32_bf16 v[28:31], v[224:227], v[52:55], v[28:31]
s_waitcnt lgkmcnt(6)
v_mfma_f32_16x16x32_bf16 v[24:27], v[184:187], v[56:59], v[24:27]
v_mfma_f32_16x16x32_bf16 v[28:31], v[228:231], v[56:59], v[28:31]
s_waitcnt lgkmcnt(5)
v_mfma_f32_16x16x32_bf16 v[24:27], v[188:191], v[60:63], v[24:27]
v_mfma_f32_16x16x32_bf16 v[28:31], v[232:235], v[60:63], v[28:31]
s_waitcnt lgkmcnt(4)
v_mfma_f32_16x16x32_bf16 v[24:27], v[192:195], v[64:67], v[24:27]
v_mfma_f32_16x16x32_bf16 v[28:31], v[236:239], v[64:67], v[28:31]
s_waitcnt lgkmcnt(3)
v_mfma_f32_16x16x32_bf16 v[24:27], v[196:199], v[68:71], v[24:27]
v_mfma_f32_16x16x32_bf16 v[28:31], v[240:243], v[68:71], v[28:31]
s_waitcnt lgkmcnt(2)
v_mfma_f32_16x16x32_bf16 v[24:27], v[200:203], v[40:43], v[24:27]
v_mfma_f32_16x16x32_bf16 v[28:31], v[244:247], v[40:43], v[28:31]
s_waitcnt lgkmcnt(1)
v_mfma_f32_16x16x32_bf16 v[24:27], v[204:207], v[44:47], v[24:27]
v_mfma_f32_16x16x32_bf16 v[28:31], v[248:251], v[44:47], v[28:31]
s_waitcnt lgkmcnt(0)
v_mfma_f32_16x16x32_bf16 v[24:27], v[208:211], v[48:51], v[24:27]
v_mfma_f32_16x16x32_bf16 v[28:31], v[252:255], v[48:51], v[28:31]
v_xor_b32 v10, 0x10000, v10
s_xor_b32 s75, s75, 0x10000
s_nop 5
v_cvt_pk_bf16_f32 v72, v24, v28
v_cvt_pk_bf16_f32 v73, v25, v29
v_cvt_pk_bf16_f32 v74, v26, v30
v_cvt_pk_bf16_f32 v75, v27, v31
buffer_store_dwordx4 v[72:75], v7, s[52:55], s70 offen
s_add_u32 s68, s68, 1
s_cmp_lt_u32 s68, 64
s_cbranch_scc1 L_G1_loop
s_waitcnt vmcnt(0)
s_cmp_eq_u32 s63, 0
s_cbranch_scc1 Lnp_317
s_mov_b64 s[98:99], exec
s_mov_b64 exec, 1
buffer_store_dword v4, off, s[4:7], s63 sc1
s_mov_b64 exec, s[98:99]
s_mov_b32 s63, 0
Lnp_317:
s_endpgm
L_abortG:
s_mov_b64 exec, 1
s_lshl_b32 s60, s56, 8
s_or_b32 s60, s60, s61
s_lshl_b32 s61, s47, 16
s_or_b32 s60, s60, s61
s_or_b32 s60, s60, 0x40000000
v_mov_b32 v1, s60
v_mov_b32 v2, 160
buffer_store_dword v1, v2, s[8:11], 0 offen sc1
s_waitcnt vmcnt(0)
s_endpgm
.section .rodata,"a"
.p2align 6
.amdhsa_kernel interleave_layers__memory_aug_recurrent_mem_tr__dense_activation_gelu__prompt_kernel
  .amdhsa_next_free_vgpr 512
  .amdhsa_next_free_sgpr 102
  .amdhsa_accum_offset 256
  .amdhsa_group_segment_fixed_size 0
  .amdhsa_kernarg_size 120
  .amdhsa_user_sgpr_count 2
  .amdhsa_user_sgpr_kernarg_segment_ptr 1
  .amdhsa_system_sgpr_workgroup_id_x 1
.end_amdhsa_kernel
```
